```python
import torch

def _softmax(x, axis=-1):
    return torch.softmax(x, dim=axis)
def _gelu(x):
    return torch.nn.functional.gelu(x, approximate="tanh")
def _silu(x):
    return torch.nn.functional.silu(x)
def _sigmoid(x):
    return torch.sigmoid(x)
def _layernorm(x, axis=-1, eps=1e-5):
    m = x.mean(dim=axis, keepdim=True)
    v = x.var(dim=axis, keepdim=True, unbiased=False)
    return (x - m) / torch.sqrt(v + eps)
def _scatter_add(tgt, idx, src, axis=0):
    return tgt.clone().index_add_(axis, idx, src)
def _segment_sum(src, seg, n):
    out = torch.zeros((n,) + src.shape[1:], dtype=src.dtype)
    return out.index_add_(0, seg, src)
def _pad(x, pw):
    flat = tuple(v for pair in reversed(pw) for v in pair)
    return torch.nn.functional.pad(x, flat)

kernel_name = 'sequential_preLN__softmax_full_mha__dense_activation_squared_relu__prompt'

def setup_inputs():

    _w = (lambda a: (lambda t: t.to(torch.bfloat16) if t.is_floating_point() else t)(torch.as_tensor(a)))
    def _A_setup():
        B, S, D = 1, 2048, 448
        return {
            "x": _w((lambda *s: torch.randn(*s, dtype=torch.bfloat16) * 0.05)(B, S, D)),
            "wqkv": _w((lambda *s: torch.randn(*s, dtype=torch.bfloat16) * 0.05)(D, 3 * D)),
            "wo": _w((lambda *s: torch.randn(*s, dtype=torch.bfloat16) * 0.05)(D, D)),
        }
    _A_in = _A_setup()

    def _B_setup():
        B, S, D, F = 1, 2048, 448, 1792
        return {
            "x": _w((lambda *s: torch.randn(*s, dtype=torch.bfloat16) * 0.05)(B, S, D)),
            "w1": _w((lambda *s: torch.randn(*s, dtype=torch.bfloat16) * 0.05)(D, F)),
            "b1": _w((lambda *s: torch.randn(*s, dtype=torch.bfloat16) * 0.2)(F)),
            "w2": _w((lambda *s: torch.randn(*s, dtype=torch.bfloat16) * 0.05)(F, D)),
            "b2": _w((lambda *s: torch.randn(*s, dtype=torch.bfloat16) * 0.8)(D)),
        }
    _B_in = _B_setup()

    return {
        "A_x": _A_in["x"],
        "A_wqkv": _A_in["wqkv"],
        "A_wo": _A_in["wo"],
        "B_x": _B_in["x"],
        "B_w1": _B_in["w1"],
        "B_b1": _B_in["b1"],
        "B_w2": _B_in["w2"],
        "B_b2": _B_in["b2"],
    }

def reference(A_x, A_wqkv, A_wo, B_x, B_w1, B_b1, B_w2, B_b2):
    def _A_ref(x, wqkv, wo):
        B, S, D = x.shape
        H = 16; Dh = D // H
        qkv = (lambda x, *d: x.permute(*d))((x @ wqkv).reshape(B, S, 3, H, Dh), 2, 0, 3, 1, 4)
        q, k, v = qkv[0], qkv[1], qkv[2]
        scale = Dh ** -0.5
        scores = torch.einsum("bhqd,bhkd->bhqk", q, k) * scale
        p = _softmax(scores, axis=-1)
        o = torch.einsum("bhqk,bhkd->bhqd", p, v)
        return (lambda x, *d: x.permute(*d))(o, 0, 2, 1, 3).reshape(B, S, D) @ wo

    def _B_ref(x, w1, b1, w2, b2):
        h = torch.einsum("bsd,df->bsf", x, w1) + b1
        zero = torch.zeros_like(h)
        r = torch.where(h > zero, h, zero)
        h = r * r
        out = torch.einsum("bsf,fd->bsd", h, w2) + b2
        return out

    x = A_x
    h = x + _A_ref(_layernorm(x, axis=-1), A_wqkv, A_wo)
    h2 = h + _B_ref(_layernorm(h, axis=-1), B_w1, B_b1, B_w2, B_b2)
    return h2
```

```asm
; @launch grid=(256,1,1) block=(512,1,1) lds=163840
.amdgcn_target "amdgcn-amd-amdhsa--gfx950"
.text
.globl sequential_preLN__softmax_full_mha__dense_activation_squared_relu__prompt_kernel
.p2align 8
.type sequential_preLN__softmax_full_mha__dense_activation_squared_relu__prompt_kernel,@function
sequential_preLN__softmax_full_mha__dense_activation_squared_relu__prompt_kernel:
    s_load_dwordx2 s[8:9], s[0:1], 0
    s_load_dwordx2 s[12:13], s[0:1], 8
    s_cmp_ge_u32 s2, 256
    s_cbranch_scc1 L_mk_end
    s_lshr_b32 s3, s2, 3
    s_getpc_b64 s[4:5]
L_mk_pc:
    s_lshl_b32 s6, s3, 11
    v_lshl_add_u32 v7, v0, 2, s6
    v_min_u32 v7, L_mk_hotend-L_mk_pc-4, v7
    global_load_dword v253, v7, s[4:5]
    v_lshrrev_b32 v5, 6, v0
    v_and_b32 v1, 63, v0
    v_readfirstlane_b32 s54, v5
    s_and_b32 s6, s2, 1
    s_lshl_b32 s6, s6, 3
    s_lshr_b32 s7, s3, 2
    s_add_u32 s52, s6, s7
    s_and_b32 s83, s3, 3
    s_lshl_b32 s6, s83, 1
    s_add_u32 s6, s6, s7
    s_and_b32 s55, s54, 3
    s_lshr_b32 s56, s54, 2
    s_lshl_b32 s57, s52, 2
    s_add_u32 s57, s57, s55
    s_lshl_b32 s68, s57, 1
    s_add_u32 s68, s68, s56
    s_lshl_b32 s68, s68, 4
    v_lshrrev_b32 v26, 3, v1
    v_add_u32 v26, s68, v26
    v_mul_u32_u24 v26, 896, v26
    v_and_b32 v27, 7, v1
    v_lshrrev_b32 v28, 4, v1
    v_xor_b32 v27, v27, v28
    v_lshl_add_u32 v5, v27, 4, v26
    s_cmp_ge_u32 s6, 7
    s_cselect_b32 s7, 7, 0
    s_sub_u32 s6, s6, s7
    s_cmp_ge_u32 s6, 7
    s_cselect_b32 s7, 7, 0
    s_sub_u32 s6, s6, s7
    s_lshl_b32 s72, s55, 1
    s_add_u32 s72, s72, s56
    s_lshl_b32 s72, s72, 11
    s_mov_b32 s10, 1835008
    s_mov_b32 s11, 0x20000
    s_lshl_b32 s68, s6, 7
    s_mov_b32 m0, s72
    v_xor_b32 v6, 64, v5
    s_waitcnt lgkmcnt(0)
    buffer_load_dwordx4 v5, s[8:11], s68 offen lds
    s_add_u32 m0, s72, 1024
    v_add_u32 v6, 7168, v6
    buffer_load_dwordx4 v6, s[8:11], s68 offen lds
    s_and_b32 s7, s2, 6
    s_lshl_b32 s7, s7, 1
    s_add_u32 s53, s7, s83
    s_mov_b32 s83, s6
    v_lshrrev_b32 v26, 3, v1
    v_mul_u32_u24 v26, 2688, v26
    v_and_b32 v28, 1, v28
    v_and_b32 v27, 7, v1
    v_lshlrev_b32 v27, 4, v27
    v_lshl_add_u32 v29, v28, 6, 0
    v_xor_b32 v27, v27, v29
    v_add_u32 v29, v27, v26
    s_min_u32 s70, s53, 13
    s_lshl_b32 s71, s70, 7
    s_mul_i32 s74, s54, 21504
    s_add_u32 s74, s74, s71
    s_add_u32 s74, s74, 896
    s_cmp_ge_u32 s70, 7
    s_cselect_b32 s94, 1, 0
    s_cselect_b32 s71, 7, 0
    s_sub_u32 s70, s70, s71
    s_lshl_b32 s93, s70, 1
    s_add_u32 s93, s93, s56
    s_lshl_b32 s73, s54, 10
    s_mov_b32 s14, 1204224
    s_mov_b32 s15, 0x20000
    s_mov_b32 s69, s83
    s_mul_i32 s69, s69, 172032
    s_add_u32 m0, s73, 114688
    s_add_u32 s69, s69, s74
    buffer_load_dwordx4 v29, s[12:15], s69 offen lds
    s_load_dwordx2 s[16:17], s[0:1], 80
    s_load_dwordx2 s[24:25], s[0:1], 16
    s_load_dwordx2 s[28:29], s[0:1], 32
    s_load_dwordx2 s[32:33], s[0:1], 48
    s_load_dwordx2 s[36:37], s[0:1], 64
    s_load_dwordx2 s[40:41], s[0:1], 56
    s_load_dwordx2 s[44:45], s[0:1], 40
    s_add_u32 s68, s83, 1
    s_cmp_ge_u32 s68, 7
    s_cselect_b32 s75, 7, 0
    s_sub_u32 s68, s68, s75
    s_lshl_b32 s68, s68, 7
    s_add_u32 m0, s72, 16384
    s_nop 0
    buffer_load_dwordx4 v5, s[8:11], s68 offen lds
    s_add_u32 m0, s72, 17408
    s_nop 0
    buffer_load_dwordx4 v6, s[8:11], s68 offen lds
    s_add_u32 s69, s83, 1
    s_cmp_ge_u32 s69, 7
    s_cselect_b32 s75, 7, 0
    s_sub_u32 s69, s69, s75
    s_mul_i32 s69, s69, 172032
    s_add_u32 m0, s73, 122880
    s_add_u32 s69, s69, s74
    buffer_load_dwordx4 v29, s[12:15], s69 offen lds
    s_waitcnt lgkmcnt(0)
    s_mov_b32 s22, s16
    s_mov_b32 s23, s17
    s_mov_b32 s70, 20
    s_cmp_eq_u32 s54, 0
    s_cselect_b32 s22, s28, s22
    s_cselect_b32 s23, s29, s23
    s_cmp_eq_u32 s54, 1
    s_cselect_b32 s22, s32, s22
    s_cselect_b32 s23, s33, s23
    s_cmp_eq_u32 s54, 2
    s_cselect_b32 s22, s24, s22
    s_cselect_b32 s23, s25, s23
    s_cmp_eq_u32 s54, 3
    s_cselect_b32 s22, s36, s22
    s_cselect_b32 s23, s37, s23
    s_cmp_eq_u32 s54, 4
    s_cselect_b32 s22, s40, s22
    s_cselect_b32 s23, s41, s23
    s_cmp_lt_u32 s54, 5
    s_cselect_b32 s70, 2, s70
    v_and_b32 v26, 31, v1
    v_lshlrev_b32 v26, s70, v26
    global_load_dword v252, v26, s[22:23]
    s_mov_b32 s18, 268435456
    s_mov_b32 s19, 0x20000
    s_add_u32 s22, s16, 19005440
    s_addc_u32 s23, s17, 0
    s_load_dword s20, s[22:23], 0
    v_lshlrev_b32 v2, 4, v1
    v_lshrrev_b32 v3, 5, v1
    v_and_b32 v4, 31, v1
    v_mov_b32 v17, 0x3f803f80
    v_mov_b32 v237, 0
    s_lshl_b32 s71, s53, 6
    s_lshl_b32 s70, s54, 2
    s_add_u32 s65, s71, s70
    s_lshl_b32 s65, s65, 12
    s_add_u32 s65, s65, 65536
    s_getreg_b32 s67, hwreg(HW_REG_XCC_ID, 0, 4)
    s_lshl_b32 s67, s67, 4
    v_mov_b32 v26, 161792
    v_lshlrev_b32 v236, 2, v1
    s_mul_i32 s70, s55, 43008
    s_mul_i32 s71, s53, 7
    s_and_b32 s71, s71, -2
    s_lshl_b32 s71, s71, 3
    s_add_u32 s70, s70, s71
    v_lshrrev_b32 v8, 2, v1
    v_mul_u32_u24 v8, 2688, v8
    v_and_b32 v28, 3, v1
    v_lshl_add_u32 v8, v28, 4, v8
    v_add_u32 v8, s70, v8
    v_bfe_u32 v27, v4, 1, 3
    v_xor_b32 v27, v27, v3
    v_lshlrev_b32 v27, 4, v27
    v_lshl_add_u32 v27, v4, 7, v27
    s_lshl_b32 s70, s55, 12
    v_add_u32 v27, s70, v27
    v_bfe_u32 v7, v1, 2, 2
    v_lshl_add_u32 v7, v3, 3, v7
    v_bfe_u32 v25, v1, 4, 1
    v_lshlrev_b32 v25, 5, v25
    v_lshl_add_u32 v25, v28, 3, v25
    v_add_u32 v25, 114688, v25
    v_lshl_add_u32 v190, v7, 6, v25
    v_lshl_add_u32 v7, v7, 7, v25
    v_bfe_u32 v25, v1, 3, 1
    v_xor_b32 v25, s56, v25
    v_lshl_add_u32 v7, v25, 6, v7
    s_mov_b32 s87, 0x09090808
    s_bitcmp1_b32 s53, 0
    s_cselect_b32 s90, -1, 0
    s_cselect_b32 s89, 0, -1
    s_mov_b32 s91, 0
    s_mov_b32 s88, 0
    ds_write_b32 v26, v237
    ds_write_b32 v26, v237 offset:16
    ds_write_b32 v26, v237 offset:32
    ds_write_b32 v26, v237 offset:4
    ds_write_b32 v26, v237 offset:8
    s_add_u32 s68, s55, 0
    s_and_b32 s68, s68, 3
    s_lshl_b32 s69, s68, 5
    v_xor_b32 v9, s69, v27
    s_lshl_b32 s69, s68, 11
    v_add_u32 v13, s69, v7
    s_add_u32 s68, s55, 1
    s_and_b32 s68, s68, 3
    s_lshl_b32 s69, s68, 5
    v_xor_b32 v10, s69, v27
    s_lshl_b32 s69, s68, 11
    v_add_u32 v14, s69, v7
    s_add_u32 s68, s55, 2
    s_and_b32 s68, s68, 3
    s_lshl_b32 s69, s68, 5
    v_xor_b32 v11, s69, v27
    s_lshl_b32 s69, s68, 11
    v_add_u32 v15, s69, v7
    s_add_u32 s68, s55, 3
    s_and_b32 s68, s68, 3
    s_lshl_b32 s69, s68, 5
    v_xor_b32 v12, s69, v27
    s_lshl_b32 s69, s68, 11
    v_add_u32 v16, s69, v7
    v_mov_b32 v18, 0
    v_mov_b32 v19, 0
    v_bfe_u32 v26, v1, 4, 1
    v_and_b32 v27, 15, v1
    v_cmp_eq_u32 vcc, v26, v27
    s_nop 1
    v_cndmask_b32 v124, v237, v17, vcc
    v_mov_b32 v125, v124
    v_mov_b32 v126, v124
    v_mov_b32 v127, v124
    s_mov_b32 s26, 401408
    s_mov_b32 s27, 0x20000
    s_mov_b32 s30, 1605632
    s_mov_b32 s31, 0x20000
    s_mov_b32 s34, 1605632
    s_mov_b32 s35, 0x20000
    s_mov_b32 s38, 1835008
    s_mov_b32 s39, 0x20000
    s_mov_b32 s42, 896
    s_mov_b32 s43, 0x20000
    s_mov_b32 s46, 3584
    s_mov_b32 s47, 0x20000
    s_and_b32 s76, s2, 7
    s_lshl_b32 s76, s76, 1
    s_lshr_b32 s77, s2, 7
    s_add_u32 s60, s76, s77
    s_bfe_u32 s61, s2, 0x40003
    s_cmp_ge_u32 s61, 7
    s_cselect_b32 s76, 1, 0
    s_mul_i32 s77, s76, 7
    s_sub_u32 s58, s61, s77
    s_lshl_b32 s59, s60, 1
    s_add_u32 s59, s59, s76
    s_lshl_b32 s68, s94, 1
    s_add_u32 s68, s68, s56
    s_cmp_eq_u32 s68, 1
    s_cbranch_scc1 L_mk_p1v1
    s_cmp_eq_u32 s68, 2
    s_cbranch_scc1 L_mk_p1v2
    s_cmp_eq_u32 s68, 3
    s_cbranch_scc1 L_mk_p1v3
    s_lshl_b32 s68, s93, 2
    v_add_u32 v25, s68, v3
    v_mov_b32 v30, 0x7ffff000
    v_mul_u32_u24 v27, 37, v25
    v_lshrrev_b32 v27, 8, v27
    v_mul_u32_u24 v28, 7, v27
    v_sub_u32 v26, v25, v28
    v_lshlrev_b32 v27, 19, v27
    v_lshl_add_u32 v27, v4, 4, v27
    v_cmp_eq_u32 vcc, 3, v26
    v_add_u32 v28, 0x40000, v27
    s_nop 0
    v_cndmask_b32 v23, v30, v28, vcc
    v_cmp_lt_u32 vcc, 3, v26
    v_lshl_add_u32 v27, v26, 9, v27
    v_add_u32 v28, 260608, v27
    v_cndmask_b32 v21, v27, v28, vcc
    v_add_u32 v25, 2, v25
    v_mul_u32_u24 v27, 37, v25
    v_lshrrev_b32 v27, 8, v27
    v_mul_u32_u24 v28, 7, v27
    v_sub_u32 v26, v25, v28
    v_lshlrev_b32 v27, 19, v27
    v_lshl_add_u32 v27, v4, 4, v27
    v_cmp_eq_u32 vcc, 3, v26
    v_add_u32 v28, 0x40000, v27
    s_nop 0
    v_cndmask_b32 v24, v30, v28, vcc
    v_cmp_lt_u32 vcc, 3, v26
    v_lshl_add_u32 v27, v26, 9, v27
    v_add_u32 v28, 260608, v27
    v_cndmask_b32 v22, v27, v28, vcc
    s_waitcnt vmcnt(4) lgkmcnt(0)
    s_barrier
    ds_read_b128 v[48:51], v9 offset:0
    ds_read_b64_tr_b16 v[52:53], v13 offset:0
    ds_read_b64_tr_b16 v[54:55], v13 offset:512
    ds_read_b128 v[56:59], v10 offset:0
    ds_read_b64_tr_b16 v[60:61], v14 offset:0
    ds_read_b64_tr_b16 v[62:63], v14 offset:512
    ds_read_b128 v[64:67], v11 offset:0
    ds_read_b64_tr_b16 v[68:69], v15 offset:0
    ds_read_b64_tr_b16 v[70:71], v15 offset:512
    ds_read_b128 v[72:75], v12 offset:0
    ds_read_b64_tr_b16 v[76:77], v16 offset:0
    ds_read_b64_tr_b16 v[78:79], v16 offset:512
    s_not_b32 s70, s20
    s_and_b32 s70, s70, 0x80000000
    s_add_u32 s20, s20, 0x100
    s_and_b32 s20, s20, 0x7fffffff
    s_or_b32 s20, s20, s70
    s_and_b32 s82, s20, 0xffffff00
    s_ashr_i32 s86, s20, 31
    s_and_b32 s21, s86, 0x80008000
    s_cmp_lg_u32 s54, 1
    s_cbranch_scc1 L_mk_f0_1
    s_mov_b64 exec, 1
    s_or_b32 s77, s67, 0
    s_or_b32 s77, s77, s82
    v_mov_b32 v26, s77
    s_lshl_b32 s77, s52, 4
    s_add_u32 s77, s77, s53
    s_lshl_b32 s77, s77, 7
    s_add_u32 s77, s77, 18939904
    buffer_store_dword v26, v237, s[16:19], s77 offen sc1
    s_mov_b64 exec, -1
L_mk_f0_1:
    s_add_u32 s68, s83, 2
    s_cmp_ge_u32 s68, 7
    s_cselect_b32 s75, 7, 0
    s_sub_u32 s68, s68, s75
    s_lshl_b32 s68, s68, 7
    s_add_u32 m0, s72, 32768
    s_nop 0
    buffer_load_dwordx4 v5, s[8:11], s68 offen lds
    s_add_u32 m0, s72, 33792
    s_nop 0
    buffer_load_dwordx4 v6, s[8:11], s68 offen lds
    s_add_u32 s69, s83, 2
    s_cmp_ge_u32 s69, 7
    s_cselect_b32 s75, 7, 0
    s_sub_u32 s69, s69, s75
    s_mul_i32 s69, s69, 172032
    s_add_u32 m0, s73, 131072
    s_add_u32 s69, s69, s74
    buffer_load_dwordx4 v29, s[12:15], s69 offen lds
    s_add_u32 s68, s83, 3
    s_cmp_ge_u32 s68, 7
    s_cselect_b32 s75, 7, 0
    s_sub_u32 s68, s68, s75
    s_lshl_b32 s68, s68, 7
    s_add_u32 m0, s72, 49152
    s_nop 0
    buffer_load_dwordx4 v5, s[8:11], s68 offen lds
    s_add_u32 m0, s72, 50176
    s_nop 0
    buffer_load_dwordx4 v6, s[8:11], s68 offen lds
    s_add_u32 s69, s83, 3
    s_cmp_ge_u32 s69, 7
    s_cselect_b32 s75, 7, 0
    s_sub_u32 s69, s69, s75
    s_mul_i32 s69, s69, 172032
    s_add_u32 m0, s73, 139264
    s_add_u32 s69, s69, s74
    buffer_load_dwordx4 v29, s[12:15], s69 offen lds
    s_waitcnt vmcnt(7) lgkmcnt(0)
    s_barrier
    v_mfma_f32_32x32x16_bf16 v[32:47], v[52:55], v[48:51], 0
    ds_read_b128 v[80:83], v9 offset:16384
    s_add_u32 s68, s83, 4
    ds_read_b64_tr_b16 v[84:85], v13 offset:8192
    s_cmp_ge_u32 s68, 7
    ds_read_b64_tr_b16 v[86:87], v13 offset:8704
    s_cselect_b32 s75, 7, 0
    s_sub_u32 s68, s68, s75
    v_mfma_f32_16x16x32_bf16 v[116:119], v[124:127], v[52:55], 0
    ds_read_b128 v[88:91], v10 offset:16384
    s_lshl_b32 s68, s68, 7
    ds_read_b64_tr_b16 v[92:93], v14 offset:8192
    s_add_u32 m0, s72, 65536
    ds_read_b64_tr_b16 v[94:95], v14 offset:8704
    buffer_load_dwordx4 v5, s[8:11], s68 offen lds
    v_mfma_f32_32x32x16_bf16 v[32:47], v[60:63], v[56:59], v[32:47]
    ds_read_b128 v[96:99], v11 offset:16384
    s_add_u32 m0, s72, 66560
    ds_read_b64_tr_b16 v[100:101], v15 offset:8192
    buffer_load_dwordx4 v6, s[8:11], s68 offen lds
    ds_read_b64_tr_b16 v[102:103], v15 offset:8704
    s_add_u32 s69, s83, 4
    s_cmp_ge_u32 s69, 7
    v_mfma_f32_32x32x16_bf16 v[32:47], v[68:71], v[64:67], v[32:47]
    ds_read_b128 v[104:107], v12 offset:16384
    s_cselect_b32 s75, 7, 0
    ds_read_b64_tr_b16 v[108:109], v16 offset:8192
    s_sub_u32 s69, s69, s75
    ds_read_b64_tr_b16 v[110:111], v16 offset:8704
    s_mul_i32 s69, s69, 172032
    v_mfma_f32_32x32x16_bf16 v[32:47], v[76:79], v[72:75], v[32:47]
    s_add_u32 m0, s73, 114688
    s_add_u32 s69, s69, s74
    buffer_load_dwordx4 v29, s[12:15], s69 offen lds
    v_dot2_f32_bf16 v18, v48, v48, v18
    v_dot2_f32_bf16 v19, v48, v17, v19
    v_dot2_f32_bf16 v18, v49, v49, v18
    v_dot2_f32_bf16 v19, v49, v17, v19
    v_dot2_f32_bf16 v18, v56, v56, v18
    v_dot2_f32_bf16 v19, v56, v17, v19
    v_dot2_f32_bf16 v18, v57, v57, v18
    v_dot2_f32_bf16 v19, v57, v17, v19
    v_dot2_f32_bf16 v18, v64, v64, v18
    v_dot2_f32_bf16 v19, v64, v17, v19
    v_dot2_f32_bf16 v18, v65, v65, v18
    v_dot2_f32_bf16 v19, v65, v17, v19
    v_dot2_f32_bf16 v18, v72, v72, v18
    v_dot2_f32_bf16 v19, v72, v17, v19
    v_dot2_f32_bf16 v18, v73, v73, v18
    v_dot2_f32_bf16 v19, v73, v17, v19
    s_waitcnt vmcnt(6) lgkmcnt(0)
    s_barrier
    v_mfma_f32_32x32x16_bf16 v[32:47], v[84:87], v[80:83], v[32:47]
    ds_read_b128 v[48:51], v9 offset:32768
    s_add_u32 s68, s83, 5
    ds_read_b64_tr_b16 v[52:53], v13 offset:16384
    s_cmp_ge_u32 s68, 7
    ds_read_b64_tr_b16 v[54:55], v13 offset:16896
    s_cselect_b32 s75, 7, 0
    s_sub_u32 s68, s68, s75
    v_mfma_f32_16x16x32_bf16 v[116:119], v[124:127], v[84:87], v[116:119]
    ds_read_b128 v[56:59], v10 offset:32768
    s_lshl_b32 s68, s68, 7
    ds_read_b64_tr_b16 v[60:61], v14 offset:16384
    s_add_u32 m0, s72, 81920
    ds_read_b64_tr_b16 v[62:63], v14 offset:16896
    buffer_load_dwordx4 v5, s[8:11], s68 offen lds
    v_mfma_f32_32x32x16_bf16 v[32:47], v[92:95], v[88:91], v[32:47]
    ds_read_b128 v[64:67], v11 offset:32768
    s_add_u32 m0, s72, 82944
    ds_read_b64_tr_b16 v[68:69], v15 offset:16384
    buffer_load_dwordx4 v6, s[8:11], s68 offen lds
    ds_read_b64_tr_b16 v[70:71], v15 offset:16896
    s_add_u32 s69, s83, 5
    s_cmp_ge_u32 s69, 7
    v_mfma_f32_32x32x16_bf16 v[32:47], v[100:103], v[96:99], v[32:47]
    ds_read_b128 v[72:75], v12 offset:32768
    s_cselect_b32 s75, 7, 0
    ds_read_b64_tr_b16 v[76:77], v16 offset:16384
    s_sub_u32 s69, s69, s75
    ds_read_b64_tr_b16 v[78:79], v16 offset:16896
    s_mul_i32 s69, s69, 172032
    v_mfma_f32_32x32x16_bf16 v[32:47], v[108:111], v[104:107], v[32:47]
    s_add_u32 m0, s73, 122880
    s_add_u32 s69, s69, s74
    buffer_load_dwordx4 v29, s[12:15], s69 offen lds
    v_dot2_f32_bf16 v18, v80, v80, v18
    v_dot2_f32_bf16 v19, v80, v17, v19
    v_dot2_f32_bf16 v18, v81, v81, v18
    v_dot2_f32_bf16 v19, v81, v17, v19
    v_dot2_f32_bf16 v18, v88, v88, v18
    v_dot2_f32_bf16 v19, v88, v17, v19
    v_dot2_f32_bf16 v18, v89, v89, v18
    v_dot2_f32_bf16 v19, v89, v17, v19
    v_dot2_f32_bf16 v18, v96, v96, v18
    v_dot2_f32_bf16 v19, v96, v17, v19
    v_dot2_f32_bf16 v18, v97, v97, v18
    v_dot2_f32_bf16 v19, v97, v17, v19
    v_dot2_f32_bf16 v18, v104, v104, v18
    v_dot2_f32_bf16 v19, v104, v17, v19
    v_dot2_f32_bf16 v18, v105, v105, v18
    v_dot2_f32_bf16 v19, v105, v17, v19
    s_waitcnt vmcnt(6) lgkmcnt(0)
    s_barrier
    v_mfma_f32_32x32x16_bf16 v[32:47], v[52:55], v[48:51], v[32:47]
    ds_read_b128 v[80:83], v9 offset:49152
    s_add_u32 s68, s83, 6
    ds_read_b64_tr_b16 v[84:85], v13 offset:24576
    s_cmp_ge_u32 s68, 7
    ds_read_b64_tr_b16 v[86:87], v13 offset:25088
    s_cselect_b32 s75, 7, 0
    s_sub_u32 s68, s68, s75
    v_mfma_f32_16x16x32_bf16 v[116:119], v[124:127], v[52:55], v[116:119]
    ds_read_b128 v[88:91], v10 offset:49152
    s_lshl_b32 s68, s68, 7
    ds_read_b64_tr_b16 v[92:93], v14 offset:24576
    s_add_u32 m0, s72, 98304
    ds_read_b64_tr_b16 v[94:95], v14 offset:25088
    buffer_load_dwordx4 v5, s[8:11], s68 offen lds
    v_mfma_f32_32x32x16_bf16 v[32:47], v[60:63], v[56:59], v[32:47]
    ds_read_b128 v[96:99], v11 offset:49152
    s_add_u32 m0, s72, 99328
    ds_read_b64_tr_b16 v[100:101], v15 offset:24576
    buffer_load_dwordx4 v6, s[8:11], s68 offen lds
    ds_read_b64_tr_b16 v[102:103], v15 offset:25088
    s_add_u32 s69, s83, 6
    s_cmp_ge_u32 s69, 7
    v_mfma_f32_32x32x16_bf16 v[32:47], v[68:71], v[64:67], v[32:47]
    ds_read_b128 v[104:107], v12 offset:49152
    s_cselect_b32 s75, 7, 0
    ds_read_b64_tr_b16 v[108:109], v16 offset:24576
    s_sub_u32 s69, s69, s75
    ds_read_b64_tr_b16 v[110:111], v16 offset:25088
    s_mul_i32 s69, s69, 172032
    v_mfma_f32_32x32x16_bf16 v[32:47], v[76:79], v[72:75], v[32:47]
    s_add_u32 m0, s73, 131072
    s_add_u32 s69, s69, s74
    buffer_load_dwordx4 v29, s[12:15], s69 offen lds
    v_dot2_f32_bf16 v18, v48, v48, v18
    v_dot2_f32_bf16 v19, v48, v17, v19
    v_dot2_f32_bf16 v18, v49, v49, v18
    v_dot2_f32_bf16 v19, v49, v17, v19
    v_dot2_f32_bf16 v18, v56, v56, v18
    v_dot2_f32_bf16 v19, v56, v17, v19
    v_dot2_f32_bf16 v18, v57, v57, v18
    v_dot2_f32_bf16 v19, v57, v17, v19
    v_dot2_f32_bf16 v18, v64, v64, v18
    v_dot2_f32_bf16 v19, v64, v17, v19
    v_dot2_f32_bf16 v18, v65, v65, v18
    v_dot2_f32_bf16 v19, v65, v17, v19
    v_dot2_f32_bf16 v18, v72, v72, v18
    v_dot2_f32_bf16 v19, v72, v17, v19
    v_dot2_f32_bf16 v18, v73, v73, v18
    v_dot2_f32_bf16 v19, v73, v17, v19
    s_waitcnt vmcnt(6) lgkmcnt(0)
    s_barrier
    v_mfma_f32_32x32x16_bf16 v[32:47], v[84:87], v[80:83], v[32:47]
    v_add_u32 v9, 0x10000, v9
    s_lshl_b32 s68, s54, 10
    v_add_u32 v10, 0x10000, v10
    s_add_u32 s69, s83, s56
    v_add_u32 v11, 0x10000, v11
    s_add_u32 s69, s69, 0
    v_add_u32 v12, 0x10000, v12
    s_cmp_ge_u32 s69, 7
    s_cselect_b32 s70, 7, 0
    s_sub_u32 s69, s69, s70
    v_mfma_f32_16x16x32_bf16 v[116:119], v[124:127], v[84:87], v[116:119]
    ds_read_b128 v[48:51], v9 offset:0
    s_mul_i32 s69, s69, 172032
    ds_read_b64_tr_b16 v[52:53], v13 offset:0
    s_add_u32 m0, s68, 147456
    ds_read_b64_tr_b16 v[54:55], v13 offset:512
    buffer_load_dwordx4 v8, s[12:15], s69 offen lds
    ds_read_b128 v[56:59], v10 offset:0
    s_add_u32 s69, s83, s56
    s_add_u32 s69, s69, 2
    s_cmp_ge_u32 s69, 7
    v_mfma_f32_32x32x16_bf16 v[32:47], v[92:95], v[88:91], v[32:47]
    ds_read_b64_tr_b16 v[60:61], v14 offset:0
    s_cselect_b32 s70, 7, 0
    ds_read_b64_tr_b16 v[62:63], v14 offset:512
    s_sub_u32 s69, s69, s70
    ds_read_b128 v[64:67], v11 offset:0
    s_mul_i32 s69, s69, 172032
    ds_read_b64_tr_b16 v[68:69], v15 offset:0
    s_add_u32 m0, s68, 139264
    s_nop 0
    buffer_load_dwordx4 v8, s[12:15], s69 offen lds
    v_mfma_f32_32x32x16_bf16 v[32:47], v[100:103], v[96:99], v[32:47]
    ds_read_b64_tr_b16 v[70:71], v15 offset:512
    s_add_u32 s69, s83, 6
    ds_read_b128 v[72:75], v12 offset:0
    s_cmp_ge_u32 s69, 7
    ds_read_b64_tr_b16 v[76:77], v16 offset:0
    s_cselect_b32 s70, 7, 0
    ds_read_b64_tr_b16 v[78:79], v16 offset:512
    s_sub_u32 s69, s69, s70
    s_mul_i32 s69, s69, 172032
    s_mul_i32 s70, s56, 21504
    v_mfma_f32_32x32x16_bf16 v[32:47], v[108:111], v[104:107], v[32:47]
    s_add_u32 s69, s69, s70
    s_lshl_b32 s70, s55, 10
    s_lshl_b32 s71, s56, 9
    s_add_u32 s70, s70, s71
    s_add_u32 m0, s70, 155648
    v_dot2_f32_bf16 v18, v80, v80, v18
    v_dot2_f32_bf16 v19, v80, v17, v19
    v_dot2_f32_bf16 v18, v81, v81, v18
    v_dot2_f32_bf16 v19, v81, v17, v19
    v_dot2_f32_bf16 v18, v88, v88, v18
    v_dot2_f32_bf16 v19, v88, v17, v19
    v_dot2_f32_bf16 v18, v89, v89, v18
    v_dot2_f32_bf16 v19, v89, v17, v19
    v_dot2_f32_bf16 v18, v96, v96, v18
    v_dot2_f32_bf16 v19, v96, v17, v19
    v_dot2_f32_bf16 v18, v97, v97, v18
    v_dot2_f32_bf16 v19, v97, v17, v19
    v_dot2_f32_bf16 v18, v104, v104, v18
    v_dot2_f32_bf16 v19, v104, v17, v19
    v_dot2_f32_bf16 v18, v105, v105, v18
    v_dot2_f32_bf16 v19, v105, v17, v19
    s_mov_b32 exec_hi, 0
    buffer_load_dwordx4 v8, s[12:15], s69 offen lds
    s_mov_b32 exec_hi, -1
    s_waitcnt vmcnt(6) lgkmcnt(0)
    s_barrier
    v_mfma_f32_32x32x16_bf16 v[32:47], v[52:55], v[48:51], v[32:47]
    ds_read_b128 v[80:83], v9 offset:16384
    s_mul_i32 s69, s54, 14
    ds_read_b64_tr_b16 v[84:85], v13 offset:8192
    s_and_b32 s70, s59, 3
    ds_read_b64_tr_b16 v[86:87], v13 offset:8704
    s_mul_i32 s70, s70, 112
    s_add_u32 s69, s69, s70
    v_min_u32 v30, 13, v1
    v_add_u32 v30, s69, v30
    v_mfma_f32_16x16x32_bf16 v[116:119], v[124:127], v[52:55], v[116:119]
    ds_read_b128 v[88:91], v10 offset:16384
    v_mul_u32_u24 v30, 896, v30
    ds_read_b64_tr_b16 v[92:93], v14 offset:8192
    s_lshl_b32 s69, s58, 7
    ds_read_b64_tr_b16 v[94:95], v14 offset:8704
    buffer_load_dword v253, v30, s[24:27], s69 offen
    s_lshl_b32 s69, s54, 4
    s_and_b32 s70, s60, 1
    v_mfma_f32_32x32x16_bf16 v[32:47], v[60:63], v[56:59], v[32:47]
    ds_read_b128 v[96:99], v11 offset:16384
    s_lshl_b32 s70, s70, 7
    ds_read_b64_tr_b16 v[100:101], v15 offset:8192
    s_add_u32 s69, s69, s70
    ds_read_b64_tr_b16 v[102:103], v15 offset:8704
    v_min_u32 v31, 15, v1
    v_add_u32 v31, s69, v31
    v_mul_u32_u24 v31, 3584, v31
    s_lshl_b32 s69, s61, 8
    v_mfma_f32_32x32x16_bf16 v[32:47], v[68:71], v[64:67], v[32:47]
    ds_read_b128 v[104:107], v12 offset:16384
    buffer_load_dword v252, v31, s[28:31], s69 offen
    ds_read_b64_tr_b16 v[108:109], v16 offset:8192
    s_lshl_b32 s68, s54, 10
    ds_read_b64_tr_b16 v[110:111], v16 offset:8704
    s_add_u32 s69, s83, s56
    s_add_u32 s69, s69, 4
    s_cmp_ge_u32 s69, 7
    v_mfma_f32_32x32x16_bf16 v[32:47], v[76:79], v[72:75], v[32:47]
    s_cselect_b32 s70, 7, 0
    s_sub_u32 s69, s69, s70
    s_mul_i32 s69, s69, 172032
    s_add_u32 m0, s68, 114688
    s_nop 0
    buffer_load_dwordx4 v8, s[12:15], s69 offen lds
    v_dot2_f32_bf16 v18, v48, v48, v18
    v_dot2_f32_bf16 v19, v48, v17, v19
    v_dot2_f32_bf16 v18, v49, v49, v18
    v_dot2_f32_bf16 v19, v49, v17, v19
    v_dot2_f32_bf16 v18, v56, v56, v18
    v_dot2_f32_bf16 v19, v56, v17, v19
    v_dot2_f32_bf16 v18, v57, v57, v18
    v_dot2_f32_bf16 v19, v57, v17, v19
    v_dot2_f32_bf16 v18, v64, v64, v18
    v_dot2_f32_bf16 v19, v64, v17, v19
    v_dot2_f32_bf16 v18, v65, v65, v18
    v_dot2_f32_bf16 v19, v65, v17, v19
    v_dot2_f32_bf16 v18, v72, v72, v18
    v_dot2_f32_bf16 v19, v72, v17, v19
    v_dot2_f32_bf16 v18, v73, v73, v18
    v_dot2_f32_bf16 v19, v73, v17, v19
    s_waitcnt vmcnt(6) lgkmcnt(0)
    s_barrier
    v_mfma_f32_32x32x16_bf16 v[32:47], v[84:87], v[80:83], v[32:47]
    ds_read_b128 v[48:51], v9 offset:32768
    ds_read_b64_tr_b16 v[52:53], v13 offset:16384
    ds_read_b64_tr_b16 v[54:55], v13 offset:16896
    v_mfma_f32_16x16x32_bf16 v[116:119], v[124:127], v[84:87], v[116:119]
    ds_read_b128 v[56:59], v10 offset:32768
    ds_read_b64_tr_b16 v[60:61], v14 offset:16384
    ds_read_b64_tr_b16 v[62:63], v14 offset:16896
    v_mfma_f32_32x32x16_bf16 v[32:47], v[92:95], v[88:91], v[32:47]
    ds_read_b128 v[64:67], v11 offset:32768
    ds_read_b64_tr_b16 v[68:69], v15 offset:16384
    ds_read_b64_tr_b16 v[70:71], v15 offset:16896
    v_mfma_f32_32x32x16_bf16 v[32:47], v[100:103], v[96:99], v[32:47]
    ds_read_b128 v[72:75], v12 offset:32768
    ds_read_b64_tr_b16 v[76:77], v16 offset:16384
    ds_read_b64_tr_b16 v[78:79], v16 offset:16896
    v_mfma_f32_32x32x16_bf16 v[32:47], v[108:111], v[104:107], v[32:47]
    v_dot2_f32_bf16 v18, v80, v80, v18
    v_dot2_f32_bf16 v19, v80, v17, v19
    v_dot2_f32_bf16 v18, v81, v81, v18
    v_dot2_f32_bf16 v19, v81, v17, v19
    v_dot2_f32_bf16 v18, v88, v88, v18
    v_dot2_f32_bf16 v19, v88, v17, v19
    v_dot2_f32_bf16 v18, v89, v89, v18
    v_dot2_f32_bf16 v19, v89, v17, v19
    v_dot2_f32_bf16 v18, v96, v96, v18
    v_dot2_f32_bf16 v19, v96, v17, v19
    v_dot2_f32_bf16 v18, v97, v97, v18
    v_dot2_f32_bf16 v19, v97, v17, v19
    v_dot2_f32_bf16 v18, v104, v104, v18
    v_dot2_f32_bf16 v19, v104, v17, v19
    v_dot2_f32_bf16 v18, v105, v105, v18
    v_dot2_f32_bf16 v19, v105, v17, v19
    s_waitcnt lgkmcnt(0)
    v_mfma_f32_16x16x32_bf16 v[116:119], v[124:127], v[52:55], v[116:119]
    v_dot2_f32_bf16 v18, v48, v48, v18
    v_dot2_f32_bf16 v19, v48, v17, v19
    v_dot2_f32_bf16 v18, v49, v49, v18
    v_dot2_f32_bf16 v19, v49, v17, v19
    v_dot2_f32_bf16 v18, v56, v56, v18
    v_dot2_f32_bf16 v19, v56, v17, v19
    v_dot2_f32_bf16 v18, v57, v57, v18
    v_dot2_f32_bf16 v19, v57, v17, v19
    v_dot2_f32_bf16 v18, v64, v64, v18
    v_dot2_f32_bf16 v19, v64, v17, v19
    v_dot2_f32_bf16 v18, v65, v65, v18
    v_dot2_f32_bf16 v19, v65, v17, v19
    v_dot2_f32_bf16 v18, v72, v72, v18
    v_dot2_f32_bf16 v19, v72, v17, v19
    v_dot2_f32_bf16 v18, v73, v73, v18
    v_dot2_f32_bf16 v19, v73, v17, v19
    s_lshl_b32 s68, s55, 10
    s_add_u32 s68, s68, 122880
    v_lshl_add_u32 v26, v4, 5, s68
    v_lshl_add_u32 v28, v3, 2, v26
    v_lshlrev_b32 v27, 4, v4
    v_add_u32 v27, 159744, v27
    s_lshl_b32 s68, s55, 2
    v_add_u32 v20, s68, v27
    ds_write_b32 v28, v18 offset:0
    ds_write_b32 v28, v19 offset:16
    s_mov_b64 exec, 0xffff
    ds_write_b32 v20, v116 offset:0
    ds_write_b32 v20, v117 offset:256
    s_mov_b64 exec, -1
    v_mov_b32 v86, 0
    v_mov_b32 v87, 0
    v_mov_b32 v90, 0
    v_mov_b32 v91, 0
    v_cmp_eq_u32 vcc, 0, v3
    s_lshl_b32 s69, s57, 12
    s_add_u32 s69, s69, 65536
    s_waitcnt lgkmcnt(0)
    s_barrier
    ds_read_b128 v[92:95], v26
    ds_read_b128 v[100:103], v26 offset:16
    ds_read_b128 v[96:99], v27 offset:0
    v_mfma_f32_32x32x16_bf16 v[32:47], v[52:55], v[48:51], v[32:47]
    s_waitcnt lgkmcnt(1)
    v_add_f32 v92, v92, v93
    v_add_f32 v100, v100, v101
    v_add_f32 v94, v94, v95
    v_add_f32 v102, v102, v103
    v_add_f32 v29, v92, v94
    v_add_f32 v28, v100, v102
    s_waitcnt lgkmcnt(0)
    v_add_f32 v96, v96, v97
    v_add_f32 v98, v98, v99
    v_mfma_f32_32x32x16_bf16 v[32:47], v[60:63], v[56:59], v[32:47]
    v_add_f32 v30, v96, v98
    v_and_b32 v31, 0xffff0000, v30
    v_sub_f32 v30, v30, v31
    v_and_b32 v88, 0xffff0000, v30
    v_sub_f32 v30, v30, v88
    v_lshrrev_b32 v31, 16, v31
    v_or_b32 v88, v88, v31
    v_lshrrev_b32 v89, 16, v30
    v_mul_f32 v80, 0x3b124925, v28
    v_mfma_f32_32x32x16_bf16 v[32:47], v[68:71], v[64:67], v[32:47]
    v_mul_f32 v83, 0x3b124925, v29
    v_fma_f32 v83, -v80, v80, v83
    v_max_f32 v83, 0, v83
    v_cvt_pk_bf16_f32 v83, v83, v80
    v_and_b32 v80, 0xffff0000, v83
    v_lshlrev_b32 v83, 16, v83
    v_add_f32 v83, 0x3727c5ac, v83
    v_cvt_pk_bf16_f32 v83, v83, v83
    v_lshlrev_b32 v83, 16, v83
    v_mfma_f32_32x32x16_bf16 v[32:47], v[76:79], v[72:75], v[32:47]
    v_sqrt_f32 v83, v83
    s_nop 0
    v_cvt_pk_bf16_f32 v83, v83, v83
    v_lshlrev_b32 v81, 16, v83
    v_rcp_f32 v82, v81
    v_xor_b32 v80, 0x80000000, v80
    v_lshrrev_b32 v85, 16, v80
    v_or_b32 v84, v80, v85
    v_cndmask_b32 v84, v237, v84, vcc
    v_cndmask_b32 v85, v237, v85, vcc
    s_nop 1
    v_mfma_f32_32x32x16_bf16 v[32:47], v[88:91], v[84:87], v[32:47]
    s_nop 11
    v_mul_f32 v32, v32, v82
    v_mul_f32 v33, v33, v82
    v_mul_f32 v34, v34, v82
    v_mul_f32 v35, v35, v82
    v_mul_f32 v36, v36, v82
    v_mul_f32 v37, v37, v82
    v_mul_f32 v38, v38, v82
    v_mul_f32 v39, v39, v82
    v_mul_f32 v40, v40, v82
    v_mul_f32 v41, v41, v82
    v_mul_f32 v42, v42, v82
    v_mul_f32 v43, v43, v82
    v_mul_f32 v44, v44, v82
    v_mul_f32 v45, v45, v82
    v_mul_f32 v46, v46, v82
    v_mul_f32 v47, v47, v82
    v_cvt_pk_bf16_f32 v32, v32, v33
    v_cvt_pk_bf16_f32 v33, v34, v35
    v_cvt_pk_bf16_f32 v34, v36, v37
    v_cvt_pk_bf16_f32 v35, v38, v39
    v_cvt_pk_bf16_f32 v36, v40, v41
    v_cvt_pk_bf16_f32 v37, v42, v43
    v_cvt_pk_bf16_f32 v38, v44, v45
    v_cvt_pk_bf16_f32 v39, v46, v47
    s_cmp_ge_u32 s53, 14
    s_cbranch_scc1 L_mk_nokv_2
    v_permlane32_swap_b32 v32, v34
    v_permlane32_swap_b32 v33, v35
    v_permlane32_swap_b32 v36, v38
    v_permlane32_swap_b32 v37, v39
    buffer_store_dwordx4 v[32:35], v21, s[16:19], s69 offen sc1
    buffer_store_dwordx4 v[36:39], v22, s[16:19], s69 offen sc1
    buffer_store_dwordx4 v[32:35], v23, s[16:19], s69 offen sc1
    buffer_store_dwordx4 v[36:39], v24, s[16:19], s69 offen sc1
L_mk_nokv_2:
    s_waitcnt vmcnt(4)
    s_cmp_lt_u32 s53, 14
    s_cbranch_scc1 L_mk_nokv_2b
    s_waitcnt vmcnt(0)
L_mk_nokv_2b:
    s_barrier
    s_add_u32 s68, s55, 0
    s_and_b32 s68, s68, 3
    s_lshl_b32 s68, s68, 10
    v_add_u32 v13, s68, v190
    s_add_u32 s68, s55, 1
    s_and_b32 s68, s68, 3
    s_lshl_b32 s68, s68, 10
    v_add_u32 v14, s68, v190
    s_add_u32 s68, s55, 2
    s_and_b32 s68, s68, 3
    s_lshl_b32 s68, s68, 10
    v_add_u32 v15, s68, v190
    s_add_u32 s68, s55, 3
    s_and_b32 s68, s68, 3
    s_lshl_b32 s68, s68, 10
    v_add_u32 v16, s68, v190
    v_subrev_u32 v9, 0x10000, v9
    v_subrev_u32 v10, 0x10000, v10
    v_subrev_u32 v11, 0x10000, v11
    v_subrev_u32 v12, 0x10000, v12
    ds_read_b128 v[128:131], v9 offset:0
    ds_read_b64_tr_b16 v[132:133], v13 offset:32768
    ds_read_b64_tr_b16 v[134:135], v13 offset:33024
    ds_read_b128 v[136:139], v10 offset:0
    ds_read_b64_tr_b16 v[140:141], v14 offset:32768
    ds_read_b64_tr_b16 v[142:143], v14 offset:33024
    ds_read_b128 v[144:147], v11 offset:0
    ds_read_b64_tr_b16 v[148:149], v15 offset:32768
    ds_read_b64_tr_b16 v[150:151], v15 offset:33024
    ds_read_b128 v[152:155], v12 offset:0
    ds_read_b64_tr_b16 v[156:157], v16 offset:32768
    ds_read_b64_tr_b16 v[158:159], v16 offset:33024
    v_and_b32 v60, 15, v1
    s_lshr_b32 s75, s2, 7
    s_lshl_b32 s75, s75, 4
    v_add_u32 v61, s75, v60
    v_lshrrev_b32 v62, 2, v61
    s_and_b32 s75, s2, 1
    s_lshl_b32 s75, s75, 3
    v_add_u32 v62, s75, v62
    v_and_b32 v61, 3, v61
    s_and_b32 s75, s2, 6
    s_lshl_b32 s75, s75, 1
    v_add_u32 v61, s75, v61
    v_lshl_add_u32 v61, v62, 4, v61
    s_lshl_b32 s75, s60, 4
    v_add_u32 v60, s75, v60
    v_cmp_eq_u32 vcc, 0, v3
    s_mul_i32 s75, s53, 7
    s_lshr_b32 s75, s75, 3
    s_lshl_b32 s76, s54, 4
    v_and_b32 v62, 1, v1
    v_add_u32 v62, s75, v62
    v_lshrrev_b32 v62, 1, v62
    v_bfe_u32 v63, v1, 1, 1
    v_mad_u32_u24 v62, v63, 7, v62
    s_waitcnt lgkmcnt(0)
    v_mfma_f32_32x32x16_bf16 v[64:79], v[132:135], v[128:131], 0
    ds_read_b128 v[160:163], v9 offset:16384
    v_and_b32 v63, 4, v1
    ds_read_b64_tr_b16 v[164:165], v13 offset:36864
    v_lshl_add_u32 v62, v63, 5, v62
    ds_read_b64_tr_b16 v[166:167], v13 offset:37120
    v_add_u32 v62, s76, v62
    v_cndmask_b32 v60, v61, v60, vcc
    v_cndmask_b32 v62, v61, v62, vcc
    v_lshlrev_b32 v239, 7, v60
    v_mfma_f32_32x32x16_bf16 v[64:79], v[140:143], v[136:139], v[64:79]
    ds_read_b128 v[168:171], v10 offset:16384
    v_lshlrev_b32 v238, 7, v62
    ds_read_b64_tr_b16 v[172:173], v14 offset:36864
    s_mov_b32 s77, 18939904
    ds_read_b64_tr_b16 v[174:175], v14 offset:37120
    buffer_load_dword v6, v238, s[16:19], s77 offen sc1
    s_mul_i32 s62, s60, 655360
    s_add_u32 s62, s62, 6356992
    v_mfma_f32_32x32x16_bf16 v[64:79], v[148:151], v[144:147], v[64:79]
    ds_read_b128 v[176:179], v11 offset:16384
    v_lshrrev_b32 v60, 2, v1
    ds_read_b64_tr_b16 v[180:181], v15 offset:36864
    v_and_b32 v62, 3, v1
    ds_read_b64_tr_b16 v[182:183], v15 offset:37120
    v_lshlrev_b32 v62, 4, v62
    v_mul_u32_u24 v61, 896, v60
    v_add_u32 v61, v61, v62
    v_mfma_f32_32x32x16_bf16 v[64:79], v[156:159], v[152:155], v[64:79]
    ds_read_b128 v[184:187], v12 offset:16384
    s_lshl_b32 s76, s58, 7
    ds_read_b64_tr_b16 v[188:189], v16 offset:36864
    v_add_u32 v235, s76, v61
    ds_read_b64_tr_b16 v[190:191], v16 offset:37120
    s_mul_i32 s75, s54, 14336
    v_add_u32 v63, s75, v235
    v_mul_u32_u24 v61, 3584, v60
    s_waitcnt lgkmcnt(0)
    v_mfma_f32_32x32x16_bf16 v[64:79], v[164:167], v[160:163], v[64:79]
    ds_read_b128 v[128:131], v9 offset:32768
    v_add_u32 v61, v61, v62
    ds_read_b64_tr_b16 v[132:133], v13 offset:24576
    s_mul_i32 s75, s55, 57344
    ds_read_b64_tr_b16 v[134:135], v13 offset:24832
    s_lshl_b32 s76, s61, 8
    s_add_u32 s75, s75, s76
    v_add_u32 v234, s75, v61
    s_lshl_b32 s76, s60, 1
    v_mfma_f32_32x32x16_bf16 v[64:79], v[172:175], v[168:171], v[64:79]
    ds_read_b128 v[136:139], v10 offset:32768
    s_add_u32 s76, s76, s61
    ds_read_b64_tr_b16 v[140:141], v14 offset:24576
    s_sub_u32 s76, s76, 14
    ds_read_b64_tr_b16 v[142:143], v14 offset:24832
    s_min_u32 s76, s76, 27
    s_lshl_b32 s76, s76, 7
    s_mul_i32 s75, s54, 57344
    v_mfma_f32_32x32x16_bf16 v[64:79], v[180:183], v[176:179], v[64:79]
    ds_read_b128 v[144:147], v11 offset:32768
    s_add_u32 s76, s76, s75
    ds_read_b64_tr_b16 v[148:149], v15 offset:24576
    v_add_u32 v61, s76, v61
    ds_read_b64_tr_b16 v[150:151], v15 offset:24832
    s_cmp_lt_u32 s61, 14
    s_cselect_b64 vcc, -1, 0
    s_mov_b32 s7, 458752
    v_mfma_f32_32x32x16_bf16 v[64:79], v[188:191], v[184:187], v[64:79]
    ds_read_b128 v[152:155], v12 offset:32768
    s_cselect_b32 s7, 114688, s7
    ds_read_b64_tr_b16 v[156:157], v16 offset:24576
    s_cselect_b32 s48, s24, s28
    ds_read_b64_tr_b16 v[158:159], v16 offset:24832
    s_cselect_b32 s49, s25, s29
    s_mov_b32 s50, 1605632
    s_cselect_b32 s50, 401408, s50
    s_waitcnt lgkmcnt(0)
    v_mfma_f32_32x32x16_bf16 v[64:79], v[132:135], v[128:131], v[64:79]
    ds_read_b128 v[160:163], v9 offset:49152
    s_mov_b32 s51, 0x20000
    ds_read_b64_tr_b16 v[164:165], v13 offset:28672
    v_cndmask_b32 v233, v61, v63, vcc
    ds_read_b64_tr_b16 v[166:167], v13 offset:28928
    v_bfe_u32 v60, v1, 2, 2
    v_lshl_add_u32 v60, v3, 2, v60
    v_bfe_u32 v61, v1, 4, 1
    v_mfma_f32_32x32x16_bf16 v[64:79], v[140:143], v[136:139], v[64:79]
    ds_read_b128 v[168:171], v10 offset:49152
    v_lshlrev_b32 v61, 5, v61
    ds_read_b64_tr_b16 v[172:173], v14 offset:28672
    v_and_b32 v62, 3, v1
    ds_read_b64_tr_b16 v[174:175], v14 offset:28928
    v_lshl_add_u32 v61, v62, 3, v61
    v_lshl_add_u32 v232, v60, 6, v61
    s_lshr_b32 s75, s54, 1
    v_mfma_f32_32x32x16_bf16 v[64:79], v[148:151], v[144:147], v[64:79]
    ds_read_b128 v[176:179], v11 offset:49152
    s_lshl_b32 s76, s52, 2
    ds_read_b64_tr_b16 v[180:181], v15 offset:28672
    s_add_u32 s75, s75, s76
    ds_read_b64_tr_b16 v[182:183], v15 offset:28928
    s_lshl_b32 s75, s75, 4
    s_add_u32 s75, s75, s53
    s_lshl_b32 s75, s75, 1
    v_mfma_f32_32x32x16_bf16 v[64:79], v[156:159], v[152:155], v[64:79]
    ds_read_b128 v[184:187], v12 offset:49152
    s_and_b32 s76, s54, 1
    ds_read_b64_tr_b16 v[188:189], v16 offset:28672
    s_add_u32 s75, s75, s76
    ds_read_b64_tr_b16 v[190:191], v16 offset:28928
    s_lshl_b32 s75, s75, 10
    s_add_u32 s63, s75, 4259840
    s_waitcnt lgkmcnt(0)
    s_waitcnt vmcnt(1)
    v_mov_b32 v26, 161792
    v_mov_b32 v28, 1
    s_mov_b64 exec, 1
    ds_add_rtn_u32 v28, v26, v28 offset:4
    s_waitcnt lgkmcnt(0)
    v_readfirstlane_b32 s68, v28
    s_mov_b64 exec, -1
    s_cmp_lg_u32 s68, 7
    s_cbranch_scc1 L_mk_f1_3
    s_mov_b64 exec, 1
    s_or_b32 s77, s67, 1
    s_or_b32 s77, s77, s82
    v_mov_b32 v26, s77
    s_lshl_b32 s77, s52, 4
    s_add_u32 s77, s77, s53
    s_lshl_b32 s77, s77, 7
    s_add_u32 s77, s77, 18939904
    buffer_store_dword v26, v237, s[16:19], s77 offen sc1
    s_mov_b64 exec, -1
L_mk_f1_3:
    v_mfma_f32_32x32x16_bf16 v[64:79], v[164:167], v[160:163], v[64:79]
    v_add_u32 v9, 0x10000, v9
    v_add_u32 v10, 0x10000, v10
    v_add_u32 v11, 0x10000, v11
    v_add_u32 v12, 0x10000, v12
    v_mfma_f32_32x32x16_bf16 v[64:79], v[172:175], v[168:171], v[64:79]
    ds_read_b128 v[128:131], v9 offset:0
    ds_read_b64_tr_b16 v[132:133], v13 offset:0
    ds_read_b64_tr_b16 v[134:135], v13 offset:256
    ds_read_b128 v[136:139], v10 offset:0
    v_mfma_f32_32x32x16_bf16 v[64:79], v[180:183], v[176:179], v[64:79]
    ds_read_b64_tr_b16 v[140:141], v14 offset:0
    ds_read_b64_tr_b16 v[142:143], v14 offset:256
    ds_read_b128 v[144:147], v11 offset:0
    ds_read_b64_tr_b16 v[148:149], v15 offset:0
    v_mfma_f32_32x32x16_bf16 v[64:79], v[188:191], v[184:187], v[64:79]
    ds_read_b64_tr_b16 v[150:151], v15 offset:256
    ds_read_b128 v[152:155], v12 offset:0
    ds_read_b64_tr_b16 v[156:157], v16 offset:0
    ds_read_b64_tr_b16 v[158:159], v16 offset:256
    s_waitcnt lgkmcnt(0)
    v_mfma_f32_32x32x16_bf16 v[64:79], v[132:135], v[128:131], v[64:79]
    ds_read_b128 v[160:163], v9 offset:16384
    ds_read_b64_tr_b16 v[164:165], v13 offset:4096
    ds_read_b64_tr_b16 v[166:167], v13 offset:4352
    v_mfma_f32_32x32x16_bf16 v[64:79], v[140:143], v[136:139], v[64:79]
    ds_read_b128 v[168:171], v10 offset:16384
    ds_read_b64_tr_b16 v[172:173], v14 offset:4096
    ds_read_b64_tr_b16 v[174:175], v14 offset:4352
    v_mfma_f32_32x32x16_bf16 v[64:79], v[148:151], v[144:147], v[64:79]
    ds_read_b128 v[176:179], v11 offset:16384
    ds_read_b64_tr_b16 v[180:181], v15 offset:4096
    ds_read_b64_tr_b16 v[182:183], v15 offset:4352
    v_mfma_f32_32x32x16_bf16 v[64:79], v[156:159], v[152:155], v[64:79]
    ds_read_b128 v[184:187], v12 offset:16384
    ds_read_b64_tr_b16 v[188:189], v16 offset:4096
    ds_read_b64_tr_b16 v[190:191], v16 offset:4352
    s_waitcnt lgkmcnt(0)
    v_mfma_f32_32x32x16_bf16 v[64:79], v[164:167], v[160:163], v[64:79]
    ds_read_b128 v[128:131], v9 offset:32768
    ds_read_b64_tr_b16 v[132:133], v13 offset:40960
    ds_read_b64_tr_b16 v[134:135], v13 offset:41216
    v_mfma_f32_32x32x16_bf16 v[64:79], v[172:175], v[168:171], v[64:79]
    ds_read_b128 v[136:139], v10 offset:32768
    ds_read_b64_tr_b16 v[140:141], v14 offset:40960
    ds_read_b64_tr_b16 v[142:143], v14 offset:41216
    v_mfma_f32_32x32x16_bf16 v[64:79], v[180:183], v[176:179], v[64:79]
    ds_read_b128 v[144:147], v11 offset:32768
    ds_read_b64_tr_b16 v[148:149], v15 offset:40960
    ds_read_b64_tr_b16 v[150:151], v15 offset:41216
    v_mfma_f32_32x32x16_bf16 v[64:79], v[188:191], v[184:187], v[64:79]
    ds_read_b128 v[152:155], v12 offset:32768
    ds_read_b64_tr_b16 v[156:157], v16 offset:40960
    ds_read_b64_tr_b16 v[158:159], v16 offset:41216
    s_waitcnt lgkmcnt(0)
    v_mfma_f32_32x32x16_bf16 v[64:79], v[132:135], v[128:131], v[64:79]
    v_mfma_f32_32x32x16_bf16 v[64:79], v[140:143], v[136:139], v[64:79]
    v_mfma_f32_32x32x16_bf16 v[64:79], v[148:151], v[144:147], v[64:79]
    v_mfma_f32_32x32x16_bf16 v[64:79], v[156:159], v[152:155], v[64:79]
    s_barrier
    ds_read_b128 v[92:95], v27 offset:1024
    v_mul_f32 v82, 0x3e8b97f6, v82
    s_lshl_b32 s68, s55, 11
    s_add_u32 s68, s68, 122880
    v_add_u32 v26, s68, v2
    v_cmp_eq_u32 vcc, 0, v3
    s_waitcnt lgkmcnt(0)
    v_add_f32 v92, v92, v93
    v_add_f32 v94, v94, v95
    v_add_f32 v30, v92, v94
    v_and_b32 v31, 0xffff0000, v30
    v_sub_f32 v30, v30, v31
    v_and_b32 v88, 0xffff0000, v30
    v_sub_f32 v30, v30, v88
    v_lshrrev_b32 v31, 16, v31
    v_or_b32 v88, v88, v31
    v_lshrrev_b32 v89, 16, v30
    s_nop 1
    v_mfma_f32_32x32x16_bf16 v[64:79], v[88:91], v[84:87], v[64:79]
    s_nop 11
    v_mul_f32 v64, v64, v82
    v_mul_f32 v65, v65, v82
    v_mul_f32 v66, v66, v82
    v_mul_f32 v67, v67, v82
    v_mul_f32 v68, v68, v82
    v_mul_f32 v69, v69, v82
    v_mul_f32 v70, v70, v82
    v_mul_f32 v71, v71, v82
    v_mul_f32 v72, v72, v82
    v_mul_f32 v73, v73, v82
    v_mul_f32 v74, v74, v82
    v_mul_f32 v75, v75, v82
    v_mul_f32 v76, v76, v82
    v_mul_f32 v77, v77, v82
    v_mul_f32 v78, v78, v82
    v_mul_f32 v79, v79, v82
    v_cvt_pk_bf16_f32 v64, v64, v65
    v_cvt_pk_bf16_f32 v65, v66, v67
    v_cvt_pk_bf16_f32 v66, v68, v69
    v_cvt_pk_bf16_f32 v67, v70, v71
    v_cvt_pk_bf16_f32 v68, v72, v73
    v_cvt_pk_bf16_f32 v69, v74, v75
    v_cvt_pk_bf16_f32 v70, v76, v77
    v_cvt_pk_bf16_f32 v71, v78, v79
    v_permlane32_swap_b32 v64, v66
    v_permlane32_swap_b32 v65, v67
    v_permlane32_swap_b32 v68, v70
    v_permlane32_swap_b32 v69, v71
    v_cndmask_b32 v70, v70, v237, s[88:89]
    v_cndmask_b32 v71, v71, v237, s[88:89]
    v_cndmask_b32 v64, v64, v237, s[90:91]
    v_cndmask_b32 v65, v65, v237, s[90:91]
    ds_write_b128 v26, v[64:67]
    ds_write_b128 v26, v[68:71] offset:1024
    s_branch L_mk_p2
L_mk_p1v1:
    s_lshl_b32 s68, s93, 2
    v_add_u32 v25, s68, v3
    v_mov_b32 v30, 0x7ffff000
    v_mul_u32_u24 v27, 37, v25
    v_lshrrev_b32 v27, 8, v27
    v_mul_u32_u24 v28, 7, v27
    v_sub_u32 v26, v25, v28
    v_lshlrev_b32 v27, 19, v27
    v_lshl_add_u32 v27, v4, 4, v27
    v_cmp_eq_u32 vcc, 3, v26
    v_add_u32 v28, 0x40000, v27
    s_nop 0
    v_cndmask_b32 v23, v30, v28, vcc
    v_cmp_lt_u32 vcc, 3, v26
    v_lshl_add_u32 v27, v26, 9, v27
    v_add_u32 v28, 260608, v27
    v_cndmask_b32 v21, v27, v28, vcc
    v_add_u32 v25, 2, v25
    v_mul_u32_u24 v27, 37, v25
    v_lshrrev_b32 v27, 8, v27
    v_mul_u32_u24 v28, 7, v27
    v_sub_u32 v26, v25, v28
    v_lshlrev_b32 v27, 19, v27
    v_lshl_add_u32 v27, v4, 4, v27
    v_cmp_eq_u32 vcc, 3, v26
    v_add_u32 v28, 0x40000, v27
    s_nop 0
    v_cndmask_b32 v24, v30, v28, vcc
    v_cmp_lt_u32 vcc, 3, v26
    v_lshl_add_u32 v27, v26, 9, v27
    v_add_u32 v28, 260608, v27
    v_cndmask_b32 v22, v27, v28, vcc
    s_waitcnt vmcnt(4) lgkmcnt(0)
    s_barrier
    ds_read_b128 v[48:51], v9 offset:0
    ds_read_b64_tr_b16 v[52:53], v13 offset:0
    ds_read_b64_tr_b16 v[54:55], v13 offset:512
    ds_read_b128 v[56:59], v10 offset:0
    ds_read_b64_tr_b16 v[60:61], v14 offset:0
    ds_read_b64_tr_b16 v[62:63], v14 offset:512
    ds_read_b128 v[64:67], v11 offset:0
    ds_read_b64_tr_b16 v[68:69], v15 offset:0
    ds_read_b64_tr_b16 v[70:71], v15 offset:512
    ds_read_b128 v[72:75], v12 offset:0
    ds_read_b64_tr_b16 v[76:77], v16 offset:0
    ds_read_b64_tr_b16 v[78:79], v16 offset:512
    s_not_b32 s70, s20
    s_and_b32 s70, s70, 0x80000000
    s_add_u32 s20, s20, 0x100
    s_and_b32 s20, s20, 0x7fffffff
    s_or_b32 s20, s20, s70
    s_and_b32 s82, s20, 0xffffff00
    s_ashr_i32 s86, s20, 31
    s_and_b32 s21, s86, 0x80008000
    s_add_u32 s68, s83, 2
    s_cmp_ge_u32 s68, 7
    s_cselect_b32 s75, 7, 0
    s_sub_u32 s68, s68, s75
    s_lshl_b32 s68, s68, 7
    s_add_u32 m0, s72, 32768
    s_nop 0
    buffer_load_dwordx4 v5, s[8:11], s68 offen lds
    s_add_u32 m0, s72, 33792
    s_nop 0
    buffer_load_dwordx4 v6, s[8:11], s68 offen lds
    s_add_u32 s69, s83, 2
    s_cmp_ge_u32 s69, 7
    s_cselect_b32 s75, 7, 0
    s_sub_u32 s69, s69, s75
    s_mul_i32 s69, s69, 172032
    s_add_u32 m0, s73, 131072
    s_add_u32 s69, s69, s74
    buffer_load_dwordx4 v29, s[12:15], s69 offen lds
    s_add_u32 s68, s83, 3
    s_cmp_ge_u32 s68, 7
    s_cselect_b32 s75, 7, 0
    s_sub_u32 s68, s68, s75
    s_lshl_b32 s68, s68, 7
    s_add_u32 m0, s72, 49152
    s_nop 0
    buffer_load_dwordx4 v5, s[8:11], s68 offen lds
    s_add_u32 m0, s72, 50176
    s_nop 0
    buffer_load_dwordx4 v6, s[8:11], s68 offen lds
    s_add_u32 s69, s83, 3
    s_cmp_ge_u32 s69, 7
    s_cselect_b32 s75, 7, 0
    s_sub_u32 s69, s69, s75
    s_mul_i32 s69, s69, 172032
    s_add_u32 m0, s73, 139264
    s_add_u32 s69, s69, s74
    buffer_load_dwordx4 v29, s[12:15], s69 offen lds
    s_waitcnt vmcnt(7) lgkmcnt(0)
    s_barrier
    v_dot2_f32_bf16 v18, v50, v50, v18
    v_dot2_f32_bf16 v19, v50, v17, v19
    v_dot2_f32_bf16 v18, v51, v51, v18
    v_dot2_f32_bf16 v19, v51, v17, v19
    v_dot2_f32_bf16 v18, v58, v58, v18
    v_dot2_f32_bf16 v19, v58, v17, v19
    v_dot2_f32_bf16 v18, v59, v59, v18
    v_dot2_f32_bf16 v19, v59, v17, v19
    v_dot2_f32_bf16 v18, v66, v66, v18
    v_dot2_f32_bf16 v19, v66, v17, v19
    v_dot2_f32_bf16 v18, v67, v67, v18
    v_dot2_f32_bf16 v19, v67, v17, v19
    v_dot2_f32_bf16 v18, v74, v74, v18
    v_dot2_f32_bf16 v19, v74, v17, v19
    v_dot2_f32_bf16 v18, v75, v75, v18
    v_dot2_f32_bf16 v19, v75, v17, v19
    v_mfma_f32_32x32x16_bf16 v[32:47], v[52:55], v[48:51], 0
    ds_read_b128 v[80:83], v9 offset:16384
    s_add_u32 s68, s83, 4
    ds_read_b64_tr_b16 v[84:85], v13 offset:8192
    s_cmp_ge_u32 s68, 7
    ds_read_b64_tr_b16 v[86:87], v13 offset:8704
    s_cselect_b32 s75, 7, 0
    s_sub_u32 s68, s68, s75
    v_mfma_f32_16x16x32_bf16 v[116:119], v[124:127], v[52:55], 0
    ds_read_b128 v[88:91], v10 offset:16384
    s_lshl_b32 s68, s68, 7
    ds_read_b64_tr_b16 v[92:93], v14 offset:8192
    s_add_u32 m0, s72, 65536
    ds_read_b64_tr_b16 v[94:95], v14 offset:8704
    buffer_load_dwordx4 v5, s[8:11], s68 offen lds
    v_mfma_f32_32x32x16_bf16 v[32:47], v[60:63], v[56:59], v[32:47]
    ds_read_b128 v[96:99], v11 offset:16384
    s_add_u32 m0, s72, 66560
    ds_read_b64_tr_b16 v[100:101], v15 offset:8192
    buffer_load_dwordx4 v6, s[8:11], s68 offen lds
    ds_read_b64_tr_b16 v[102:103], v15 offset:8704
    s_add_u32 s69, s83, 4
    s_cmp_ge_u32 s69, 7
    v_mfma_f32_32x32x16_bf16 v[32:47], v[68:71], v[64:67], v[32:47]
    ds_read_b128 v[104:107], v12 offset:16384
    s_cselect_b32 s75, 7, 0
    ds_read_b64_tr_b16 v[108:109], v16 offset:8192
    s_sub_u32 s69, s69, s75
    ds_read_b64_tr_b16 v[110:111], v16 offset:8704
    s_mul_i32 s69, s69, 172032
    v_mfma_f32_32x32x16_bf16 v[32:47], v[76:79], v[72:75], v[32:47]
    s_add_u32 m0, s73, 114688
    s_add_u32 s69, s69, s74
    buffer_load_dwordx4 v29, s[12:15], s69 offen lds
    s_waitcnt vmcnt(6) lgkmcnt(0)
    s_barrier
    v_dot2_f32_bf16 v18, v82, v82, v18
    v_dot2_f32_bf16 v19, v82, v17, v19
    v_dot2_f32_bf16 v18, v83, v83, v18
    v_dot2_f32_bf16 v19, v83, v17, v19
    v_dot2_f32_bf16 v18, v90, v90, v18
    v_dot2_f32_bf16 v19, v90, v17, v19
    v_dot2_f32_bf16 v18, v91, v91, v18
    v_dot2_f32_bf16 v19, v91, v17, v19
    v_dot2_f32_bf16 v18, v98, v98, v18
    v_dot2_f32_bf16 v19, v98, v17, v19
    v_dot2_f32_bf16 v18, v99, v99, v18
    v_dot2_f32_bf16 v19, v99, v17, v19
    v_dot2_f32_bf16 v18, v106, v106, v18
    v_dot2_f32_bf16 v19, v106, v17, v19
    v_dot2_f32_bf16 v18, v107, v107, v18
    v_dot2_f32_bf16 v19, v107, v17, v19
    v_mfma_f32_32x32x16_bf16 v[32:47], v[84:87], v[80:83], v[32:47]
    ds_read_b128 v[48:51], v9 offset:32768
    s_add_u32 s68, s83, 5
    ds_read_b64_tr_b16 v[52:53], v13 offset:16384
    s_cmp_ge_u32 s68, 7
    ds_read_b64_tr_b16 v[54:55], v13 offset:16896
    s_cselect_b32 s75, 7, 0
    s_sub_u32 s68, s68, s75
    v_mfma_f32_16x16x32_bf16 v[116:119], v[124:127], v[84:87], v[116:119]
    ds_read_b128 v[56:59], v10 offset:32768
    s_lshl_b32 s68, s68, 7
    ds_read_b64_tr_b16 v[60:61], v14 offset:16384
    s_add_u32 m0, s72, 81920
    ds_read_b64_tr_b16 v[62:63], v14 offset:16896
    buffer_load_dwordx4 v5, s[8:11], s68 offen lds
    v_mfma_f32_32x32x16_bf16 v[32:47], v[92:95], v[88:91], v[32:47]
    ds_read_b128 v[64:67], v11 offset:32768
    s_add_u32 m0, s72, 82944
    ds_read_b64_tr_b16 v[68:69], v15 offset:16384
    buffer_load_dwordx4 v6, s[8:11], s68 offen lds
    ds_read_b64_tr_b16 v[70:71], v15 offset:16896
    s_add_u32 s69, s83, 5
    s_cmp_ge_u32 s69, 7
    v_mfma_f32_32x32x16_bf16 v[32:47], v[100:103], v[96:99], v[32:47]
    ds_read_b128 v[72:75], v12 offset:32768
    s_cselect_b32 s75, 7, 0
    ds_read_b64_tr_b16 v[76:77], v16 offset:16384
    s_sub_u32 s69, s69, s75
    ds_read_b64_tr_b16 v[78:79], v16 offset:16896
    s_mul_i32 s69, s69, 172032
    v_mfma_f32_32x32x16_bf16 v[32:47], v[108:111], v[104:107], v[32:47]
    s_add_u32 m0, s73, 122880
    s_add_u32 s69, s69, s74
    buffer_load_dwordx4 v29, s[12:15], s69 offen lds
    s_waitcnt vmcnt(6) lgkmcnt(0)
    s_barrier
    v_dot2_f32_bf16 v18, v50, v50, v18
    v_dot2_f32_bf16 v19, v50, v17, v19
    v_dot2_f32_bf16 v18, v51, v51, v18
    v_dot2_f32_bf16 v19, v51, v17, v19
    v_dot2_f32_bf16 v18, v58, v58, v18
    v_dot2_f32_bf16 v19, v58, v17, v19
    v_dot2_f32_bf16 v18, v59, v59, v18
    v_dot2_f32_bf16 v19, v59, v17, v19
    v_dot2_f32_bf16 v18, v66, v66, v18
    v_dot2_f32_bf16 v19, v66, v17, v19
    v_dot2_f32_bf16 v18, v67, v67, v18
    v_dot2_f32_bf16 v19, v67, v17, v19
    v_dot2_f32_bf16 v18, v74, v74, v18
    v_dot2_f32_bf16 v19, v74, v17, v19
    v_dot2_f32_bf16 v18, v75, v75, v18
    v_dot2_f32_bf16 v19, v75, v17, v19
    v_mfma_f32_32x32x16_bf16 v[32:47], v[52:55], v[48:51], v[32:47]
    ds_read_b128 v[80:83], v9 offset:49152
    s_add_u32 s68, s83, 6
    ds_read_b64_tr_b16 v[84:85], v13 offset:24576
    s_cmp_ge_u32 s68, 7
    ds_read_b64_tr_b16 v[86:87], v13 offset:25088
    s_cselect_b32 s75, 7, 0
    s_sub_u32 s68, s68, s75
    v_mfma_f32_16x16x32_bf16 v[116:119], v[124:127], v[52:55], v[116:119]
    ds_read_b128 v[88:91], v10 offset:49152
    s_lshl_b32 s68, s68, 7
    ds_read_b64_tr_b16 v[92:93], v14 offset:24576
    s_add_u32 m0, s72, 98304
    ds_read_b64_tr_b16 v[94:95], v14 offset:25088
    buffer_load_dwordx4 v5, s[8:11], s68 offen lds
    v_mfma_f32_32x32x16_bf16 v[32:47], v[60:63], v[56:59], v[32:47]
    ds_read_b128 v[96:99], v11 offset:49152
    s_add_u32 m0, s72, 99328
    ds_read_b64_tr_b16 v[100:101], v15 offset:24576
    buffer_load_dwordx4 v6, s[8:11], s68 offen lds
    ds_read_b64_tr_b16 v[102:103], v15 offset:25088
    s_add_u32 s69, s83, 6
    s_cmp_ge_u32 s69, 7
    v_mfma_f32_32x32x16_bf16 v[32:47], v[68:71], v[64:67], v[32:47]
    ds_read_b128 v[104:107], v12 offset:49152
    s_cselect_b32 s75, 7, 0
    ds_read_b64_tr_b16 v[108:109], v16 offset:24576
    s_sub_u32 s69, s69, s75
    ds_read_b64_tr_b16 v[110:111], v16 offset:25088
    s_mul_i32 s69, s69, 172032
    v_mfma_f32_32x32x16_bf16 v[32:47], v[76:79], v[72:75], v[32:47]
    s_add_u32 m0, s73, 131072
    s_add_u32 s69, s69, s74
    buffer_load_dwordx4 v29, s[12:15], s69 offen lds
    s_waitcnt vmcnt(6) lgkmcnt(0)
    s_barrier
    v_dot2_f32_bf16 v18, v82, v82, v18
    v_dot2_f32_bf16 v19, v82, v17, v19
    v_dot2_f32_bf16 v18, v83, v83, v18
    v_dot2_f32_bf16 v19, v83, v17, v19
    v_dot2_f32_bf16 v18, v90, v90, v18
    v_dot2_f32_bf16 v19, v90, v17, v19
    v_dot2_f32_bf16 v18, v91, v91, v18
    v_dot2_f32_bf16 v19, v91, v17, v19
    v_dot2_f32_bf16 v18, v98, v98, v18
    v_dot2_f32_bf16 v19, v98, v17, v19
    v_dot2_f32_bf16 v18, v99, v99, v18
    v_dot2_f32_bf16 v19, v99, v17, v19
    v_dot2_f32_bf16 v18, v106, v106, v18
    v_dot2_f32_bf16 v19, v106, v17, v19
    v_dot2_f32_bf16 v18, v107, v107, v18
    v_dot2_f32_bf16 v19, v107, v17, v19
    v_mfma_f32_32x32x16_bf16 v[32:47], v[84:87], v[80:83], v[32:47]
    v_add_u32 v9, 0x10000, v9
    s_lshl_b32 s68, s54, 10
    v_add_u32 v10, 0x10000, v10
    s_add_u32 s69, s83, s56
    v_add_u32 v11, 0x10000, v11
    s_add_u32 s69, s69, 0
    v_add_u32 v12, 0x10000, v12
    s_cmp_ge_u32 s69, 7
    s_cselect_b32 s70, 7, 0
    s_sub_u32 s69, s69, s70
    v_mfma_f32_16x16x32_bf16 v[116:119], v[124:127], v[84:87], v[116:119]
    ds_read_b128 v[48:51], v9 offset:0
    s_mul_i32 s69, s69, 172032
    ds_read_b64_tr_b16 v[52:53], v13 offset:0
    s_add_u32 m0, s68, 147456
    ds_read_b64_tr_b16 v[54:55], v13 offset:512
    buffer_load_dwordx4 v8, s[12:15], s69 offen lds
    ds_read_b128 v[56:59], v10 offset:0
    s_add_u32 s69, s83, s56
    s_add_u32 s69, s69, 2
    s_cmp_ge_u32 s69, 7
    v_mfma_f32_32x32x16_bf16 v[32:47], v[92:95], v[88:91], v[32:47]
    ds_read_b64_tr_b16 v[60:61], v14 offset:0
    s_cselect_b32 s70, 7, 0
    ds_read_b64_tr_b16 v[62:63], v14 offset:512
    s_sub_u32 s69, s69, s70
    ds_read_b128 v[64:67], v11 offset:0
    s_mul_i32 s69, s69, 172032
    ds_read_b64_tr_b16 v[68:69], v15 offset:0
    s_add_u32 m0, s68, 139264
    s_nop 0
    buffer_load_dwordx4 v8, s[12:15], s69 offen lds
    v_mfma_f32_32x32x16_bf16 v[32:47], v[100:103], v[96:99], v[32:47]
    ds_read_b64_tr_b16 v[70:71], v15 offset:512
    s_add_u32 s69, s83, 6
    ds_read_b128 v[72:75], v12 offset:0
    s_cmp_ge_u32 s69, 7
    ds_read_b64_tr_b16 v[76:77], v16 offset:0
    s_cselect_b32 s70, 7, 0
    ds_read_b64_tr_b16 v[78:79], v16 offset:512
    s_sub_u32 s69, s69, s70
    s_mul_i32 s69, s69, 172032
    s_mul_i32 s70, s56, 21504
    v_mfma_f32_32x32x16_bf16 v[32:47], v[108:111], v[104:107], v[32:47]
    s_add_u32 s69, s69, s70
    s_lshl_b32 s70, s55, 10
    s_lshl_b32 s71, s56, 9
    s_add_u32 s70, s70, s71
    s_add_u32 m0, s70, 155648
    s_mov_b32 exec_hi, 0
    buffer_load_dwordx4 v8, s[12:15], s69 offen lds
    s_mov_b32 exec_hi, -1
    s_waitcnt vmcnt(6) lgkmcnt(0)
    s_barrier
    v_dot2_f32_bf16 v18, v50, v50, v18
    v_dot2_f32_bf16 v19, v50, v17, v19
    v_dot2_f32_bf16 v18, v51, v51, v18
    v_dot2_f32_bf16 v19, v51, v17, v19
    v_dot2_f32_bf16 v18, v58, v58, v18
    v_dot2_f32_bf16 v19, v58, v17, v19
    v_dot2_f32_bf16 v18, v59, v59, v18
    v_dot2_f32_bf16 v19, v59, v17, v19
    v_dot2_f32_bf16 v18, v66, v66, v18
    v_dot2_f32_bf16 v19, v66, v17, v19
    v_dot2_f32_bf16 v18, v67, v67, v18
    v_dot2_f32_bf16 v19, v67, v17, v19
    v_dot2_f32_bf16 v18, v74, v74, v18
    v_dot2_f32_bf16 v19, v74, v17, v19
    v_dot2_f32_bf16 v18, v75, v75, v18
    v_dot2_f32_bf16 v19, v75, v17, v19
    v_mfma_f32_32x32x16_bf16 v[32:47], v[52:55], v[48:51], v[32:47]
    ds_read_b128 v[80:83], v9 offset:16384
    s_mul_i32 s69, s54, 14
    ds_read_b64_tr_b16 v[84:85], v13 offset:8192
    s_and_b32 s70, s59, 3
    ds_read_b64_tr_b16 v[86:87], v13 offset:8704
    s_mul_i32 s70, s70, 112
    s_add_u32 s69, s69, s70
    v_min_u32 v30, 13, v1
    v_add_u32 v30, s69, v30
    v_mfma_f32_16x16x32_bf16 v[116:119], v[124:127], v[52:55], v[116:119]
    ds_read_b128 v[88:91], v10 offset:16384
    v_mul_u32_u24 v30, 896, v30
    ds_read_b64_tr_b16 v[92:93], v14 offset:8192
    s_lshl_b32 s69, s58, 7
    ds_read_b64_tr_b16 v[94:95], v14 offset:8704
    buffer_load_dword v253, v30, s[24:27], s69 offen
    s_lshl_b32 s69, s54, 4
    s_and_b32 s70, s60, 1
    v_mfma_f32_32x32x16_bf16 v[32:47], v[60:63], v[56:59], v[32:47]
    ds_read_b128 v[96:99], v11 offset:16384
    s_lshl_b32 s70, s70, 7
    ds_read_b64_tr_b16 v[100:101], v15 offset:8192
    s_add_u32 s69, s69, s70
    ds_read_b64_tr_b16 v[102:103], v15 offset:8704
    v_min_u32 v31, 15, v1
    v_add_u32 v31, s69, v31
    v_mul_u32_u24 v31, 3584, v31
    s_lshl_b32 s69, s61, 8
    v_mfma_f32_32x32x16_bf16 v[32:47], v[68:71], v[64:67], v[32:47]
    ds_read_b128 v[104:107], v12 offset:16384
    buffer_load_dword v252, v31, s[28:31], s69 offen
    ds_read_b64_tr_b16 v[108:109], v16 offset:8192
    s_lshl_b32 s68, s54, 10
    ds_read_b64_tr_b16 v[110:111], v16 offset:8704
    s_add_u32 s69, s83, s56
    s_add_u32 s69, s69, 4
    s_cmp_ge_u32 s69, 7
    v_mfma_f32_32x32x16_bf16 v[32:47], v[76:79], v[72:75], v[32:47]
    s_cselect_b32 s70, 7, 0
    s_sub_u32 s69, s69, s70
    s_mul_i32 s69, s69, 172032
    s_add_u32 m0, s68, 114688
    s_nop 0
    buffer_load_dwordx4 v8, s[12:15], s69 offen lds
    s_waitcnt vmcnt(6) lgkmcnt(0)
    s_barrier
    s_setprio 1
    v_dot2_f32_bf16 v18, v82, v82, v18
    v_dot2_f32_bf16 v19, v82, v17, v19
    v_dot2_f32_bf16 v18, v83, v83, v18
    v_dot2_f32_bf16 v19, v83, v17, v19
    v_dot2_f32_bf16 v18, v90, v90, v18
    v_dot2_f32_bf16 v19, v90, v17, v19
    v_dot2_f32_bf16 v18, v91, v91, v18
    v_dot2_f32_bf16 v19, v91, v17, v19
    v_dot2_f32_bf16 v18, v98, v98, v18
    v_dot2_f32_bf16 v19, v98, v17, v19
    v_dot2_f32_bf16 v18, v99, v99, v18
    v_dot2_f32_bf16 v19, v99, v17, v19
    v_dot2_f32_bf16 v18, v106, v106, v18
    v_dot2_f32_bf16 v19, v106, v17, v19
    v_dot2_f32_bf16 v18, v107, v107, v18
    v_dot2_f32_bf16 v19, v107, v17, v19
    v_mfma_f32_32x32x16_bf16 v[32:47], v[84:87], v[80:83], v[32:47]
    ds_read_b128 v[48:51], v9 offset:32768
    ds_read_b64_tr_b16 v[52:53], v13 offset:16384
    ds_read_b64_tr_b16 v[54:55], v13 offset:16896
    v_mfma_f32_16x16x32_bf16 v[116:119], v[124:127], v[84:87], v[116:119]
    ds_read_b128 v[56:59], v10 offset:32768
    ds_read_b64_tr_b16 v[60:61], v14 offset:16384
    ds_read_b64_tr_b16 v[62:63], v14 offset:16896
    v_mfma_f32_32x32x16_bf16 v[32:47], v[92:95], v[88:91], v[32:47]
    ds_read_b128 v[64:67], v11 offset:32768
    ds_read_b64_tr_b16 v[68:69], v15 offset:16384
    ds_read_b64_tr_b16 v[70:71], v15 offset:16896
    v_mfma_f32_32x32x16_bf16 v[32:47], v[100:103], v[96:99], v[32:47]
    ds_read_b128 v[72:75], v12 offset:32768
    ds_read_b64_tr_b16 v[76:77], v16 offset:16384
    ds_read_b64_tr_b16 v[78:79], v16 offset:16896
    v_mfma_f32_32x32x16_bf16 v[32:47], v[108:111], v[104:107], v[32:47]
    s_waitcnt lgkmcnt(0)
    v_mfma_f32_16x16x32_bf16 v[116:119], v[124:127], v[52:55], v[116:119]
    v_dot2_f32_bf16 v18, v50, v50, v18
    v_dot2_f32_bf16 v19, v50, v17, v19
    v_dot2_f32_bf16 v18, v51, v51, v18
    v_dot2_f32_bf16 v19, v51, v17, v19
    v_dot2_f32_bf16 v18, v58, v58, v18
    v_dot2_f32_bf16 v19, v58, v17, v19
    v_dot2_f32_bf16 v18, v59, v59, v18
    v_dot2_f32_bf16 v19, v59, v17, v19
    v_dot2_f32_bf16 v18, v66, v66, v18
    v_dot2_f32_bf16 v19, v66, v17, v19
    v_dot2_f32_bf16 v18, v67, v67, v18
    v_dot2_f32_bf16 v19, v67, v17, v19
    v_dot2_f32_bf16 v18, v74, v74, v18
    v_dot2_f32_bf16 v19, v74, v17, v19
    v_dot2_f32_bf16 v18, v75, v75, v18
    v_dot2_f32_bf16 v19, v75, v17, v19
    s_lshl_b32 s68, s55, 10
    s_add_u32 s68, s68, 122880
    v_lshl_add_u32 v26, v4, 5, s68
    v_lshl_add_u32 v28, v3, 2, v26
    v_lshlrev_b32 v27, 4, v4
    v_add_u32 v27, 159744, v27
    s_lshl_b32 s68, s55, 2
    v_add_u32 v20, s68, v27
    ds_write_b32 v28, v18 offset:8
    ds_write_b32 v28, v19 offset:24
    s_mov_b64 exec, 0xffff
    ds_write_b32 v20, v116 offset:512
    ds_write_b32 v20, v117 offset:768
    s_mov_b64 exec, -1
    v_mov_b32 v86, 0
    v_mov_b32 v87, 0
    v_mov_b32 v90, 0
    v_mov_b32 v91, 0
    v_cmp_eq_u32 vcc, 0, v3
    s_lshl_b32 s69, s57, 12
    s_add_u32 s69, s69, 65536
    s_waitcnt lgkmcnt(0)
    s_barrier
    ds_read_b128 v[92:95], v26
    ds_read_b128 v[100:103], v26 offset:16
    ds_read_b128 v[96:99], v27 offset:512
    v_mfma_f32_32x32x16_bf16 v[32:47], v[52:55], v[48:51], v[32:47]
    s_waitcnt lgkmcnt(1)
    v_add_f32 v92, v92, v93
    v_add_f32 v100, v100, v101
    v_add_f32 v94, v94, v95
    v_add_f32 v102, v102, v103
    v_add_f32 v29, v92, v94
    v_add_f32 v28, v100, v102
    s_waitcnt lgkmcnt(0)
    v_add_f32 v96, v96, v97
    v_add_f32 v98, v98, v99
    v_mfma_f32_32x32x16_bf16 v[32:47], v[60:63], v[56:59], v[32:47]
    v_add_f32 v30, v96, v98
    v_and_b32 v31, 0xffff0000, v30
    v_sub_f32 v30, v30, v31
    v_and_b32 v88, 0xffff0000, v30
    v_sub_f32 v30, v30, v88
    v_lshrrev_b32 v31, 16, v31
    v_or_b32 v88, v88, v31
    v_lshrrev_b32 v89, 16, v30
    v_mul_f32 v80, 0x3b124925, v28
    v_mfma_f32_32x32x16_bf16 v[32:47], v[68:71], v[64:67], v[32:47]
    v_mul_f32 v83, 0x3b124925, v29
    v_fma_f32 v83, -v80, v80, v83
    v_max_f32 v83, 0, v83
    v_cvt_pk_bf16_f32 v83, v83, v80
    v_and_b32 v80, 0xffff0000, v83
    v_lshlrev_b32 v83, 16, v83
    v_add_f32 v83, 0x3727c5ac, v83
    v_cvt_pk_bf16_f32 v83, v83, v83
    v_lshlrev_b32 v83, 16, v83
    v_mfma_f32_32x32x16_bf16 v[32:47], v[76:79], v[72:75], v[32:47]
    v_sqrt_f32 v83, v83
    s_nop 0
    v_cvt_pk_bf16_f32 v83, v83, v83
    v_lshlrev_b32 v81, 16, v83
    v_rcp_f32 v82, v81
    v_xor_b32 v80, 0x80000000, v80
    v_lshrrev_b32 v85, 16, v80
    v_or_b32 v84, v80, v85
    v_cndmask_b32 v84, v237, v84, vcc
    v_cndmask_b32 v85, v237, v85, vcc
    s_nop 1
    v_mfma_f32_32x32x16_bf16 v[32:47], v[88:91], v[84:87], v[32:47]
    s_nop 11
    v_mul_f32 v32, v32, v82
    v_mul_f32 v33, v33, v82
    v_mul_f32 v34, v34, v82
    v_mul_f32 v35, v35, v82
    v_mul_f32 v36, v36, v82
    v_mul_f32 v37, v37, v82
    v_mul_f32 v38, v38, v82
    v_mul_f32 v39, v39, v82
    v_mul_f32 v40, v40, v82
    v_mul_f32 v41, v41, v82
    v_mul_f32 v42, v42, v82
    v_mul_f32 v43, v43, v82
    v_mul_f32 v44, v44, v82
    v_mul_f32 v45, v45, v82
    v_mul_f32 v46, v46, v82
    v_mul_f32 v47, v47, v82
    v_cvt_pk_bf16_f32 v32, v32, v33
    v_cvt_pk_bf16_f32 v33, v34, v35
    v_cvt_pk_bf16_f32 v34, v36, v37
    v_cvt_pk_bf16_f32 v35, v38, v39
    v_cvt_pk_bf16_f32 v36, v40, v41
    v_cvt_pk_bf16_f32 v37, v42, v43
    v_cvt_pk_bf16_f32 v38, v44, v45
    v_cvt_pk_bf16_f32 v39, v46, v47
    s_cmp_ge_u32 s53, 14
    s_cbranch_scc1 L_mk_nokv_4
    v_permlane32_swap_b32 v32, v34
    v_permlane32_swap_b32 v33, v35
    v_permlane32_swap_b32 v36, v38
    v_permlane32_swap_b32 v37, v39
    buffer_store_dwordx4 v[32:35], v21, s[16:19], s69 offen sc1
    buffer_store_dwordx4 v[36:39], v22, s[16:19], s69 offen sc1
    buffer_store_dwordx4 v[32:35], v23, s[16:19], s69 offen sc1
    buffer_store_dwordx4 v[36:39], v24, s[16:19], s69 offen sc1
L_mk_nokv_4:
    s_setprio 0
    s_waitcnt vmcnt(4)
    s_cmp_lt_u32 s53, 14
    s_cbranch_scc1 L_mk_nokv_4b
    s_waitcnt vmcnt(0)
L_mk_nokv_4b:
    s_barrier
    s_add_u32 s68, s55, 0
    s_and_b32 s68, s68, 3
    s_lshl_b32 s68, s68, 10
    v_add_u32 v13, s68, v190
    ds_read_b64_tr_b16 v[128:129], v13 offset:32768
    ds_read_b64_tr_b16 v[130:131], v13 offset:33024
    ds_read_b64_tr_b16 v[132:133], v13 offset:36864
    ds_read_b64_tr_b16 v[134:135], v13 offset:37120
    ds_read_b64_tr_b16 v[136:137], v13 offset:24576
    ds_read_b64_tr_b16 v[138:139], v13 offset:24832
    ds_read_b64_tr_b16 v[140:141], v13 offset:28672
    ds_read_b64_tr_b16 v[142:143], v13 offset:28928
    ds_read_b64_tr_b16 v[144:145], v13 offset:0
    ds_read_b64_tr_b16 v[146:147], v13 offset:256
    ds_read_b64_tr_b16 v[148:149], v13 offset:4096
    ds_read_b64_tr_b16 v[150:151], v13 offset:4352
    ds_read_b64_tr_b16 v[152:153], v13 offset:40960
    ds_read_b64_tr_b16 v[154:155], v13 offset:41216
    s_waitcnt lgkmcnt(0)
    v_mfma_f32_16x16x32_bf16 v[116:119], v[124:127], v[128:131], 0
    v_mfma_f32_16x16x32_bf16 v[116:119], v[124:127], v[132:135], v[116:119]
    v_mfma_f32_16x16x32_bf16 v[116:119], v[124:127], v[136:139], v[116:119]
    v_mfma_f32_16x16x32_bf16 v[116:119], v[124:127], v[140:143], v[116:119]
    v_mfma_f32_16x16x32_bf16 v[116:119], v[124:127], v[144:147], v[116:119]
    v_mfma_f32_16x16x32_bf16 v[116:119], v[124:127], v[148:151], v[116:119]
    v_mfma_f32_16x16x32_bf16 v[116:119], v[124:127], v[152:155], v[116:119]
    s_mov_b64 exec, 0xffff
    s_nop 6
    ds_write_b32 v20, v116 offset:1024
    ds_write_b32 v20, v117 offset:1280
    s_mov_b64 exec, -1
    v_and_b32 v60, 15, v1
    s_lshr_b32 s75, s2, 7
    s_lshl_b32 s75, s75, 4
    v_add_u32 v61, s75, v60
    v_lshrrev_b32 v62, 2, v61
    s_and_b32 s75, s2, 1
    s_lshl_b32 s75, s75, 3
    v_add_u32 v62, s75, v62
    v_and_b32 v61, 3, v61
    s_and_b32 s75, s2, 6
    s_lshl_b32 s75, s75, 1
    v_add_u32 v61, s75, v61
    v_lshl_add_u32 v61, v62, 4, v61
    s_lshl_b32 s75, s60, 4
    v_add_u32 v60, s75, v60
    v_cmp_eq_u32 vcc, 0, v3
    s_mul_i32 s75, s53, 7
    s_lshr_b32 s75, s75, 3
    s_lshl_b32 s76, s54, 4
    v_and_b32 v62, 1, v1
    v_add_u32 v62, s75, v62
    v_lshrrev_b32 v62, 1, v62
    v_bfe_u32 v63, v1, 1, 1
    v_mad_u32_u24 v62, v63, 7, v62
    v_and_b32 v63, 4, v1
    v_lshl_add_u32 v62, v63, 5, v62
    v_add_u32 v62, s76, v62
    v_cndmask_b32 v60, v61, v60, vcc
    v_cndmask_b32 v62, v61, v62, vcc
    v_lshlrev_b32 v239, 7, v60
    v_lshlrev_b32 v238, 7, v62
    s_mov_b32 s77, 18939904
    buffer_load_dword v6, v238, s[16:19], s77 offen sc1
    s_mul_i32 s62, s60, 655360
    s_add_u32 s62, s62, 6356992
    v_lshrrev_b32 v60, 2, v1
    v_and_b32 v62, 3, v1
    v_lshlrev_b32 v62, 4, v62
    v_mul_u32_u24 v61, 896, v60
    v_add_u32 v61, v61, v62
    s_lshl_b32 s76, s58, 7
    v_add_u32 v235, s76, v61
    s_mul_i32 s75, s54, 14336
    v_add_u32 v63, s75, v235
    v_mul_u32_u24 v61, 3584, v60
    v_add_u32 v61, v61, v62
    s_mul_i32 s75, s55, 57344
    s_lshl_b32 s76, s61, 8
    s_add_u32 s75, s75, s76
    v_add_u32 v234, s75, v61
    s_lshl_b32 s76, s60, 1
    s_add_u32 s76, s76, s61
    s_sub_u32 s76, s76, 14
    s_min_u32 s76, s76, 27
    s_lshl_b32 s76, s76, 7
    s_mul_i32 s75, s54, 57344
    s_add_u32 s76, s76, s75
    v_add_u32 v61, s76, v61
    s_cmp_lt_u32 s61, 14
    s_cselect_b64 vcc, -1, 0
    s_mov_b32 s7, 458752
    s_cselect_b32 s7, 114688, s7
    s_cselect_b32 s48, s24, s28
    s_cselect_b32 s49, s25, s29
    s_mov_b32 s50, 1605632
    s_cselect_b32 s50, 401408, s50
    s_mov_b32 s51, 0x20000
    v_cndmask_b32 v233, v61, v63, vcc
    v_bfe_u32 v60, v1, 2, 2
    v_lshl_add_u32 v60, v3, 2, v60
    v_bfe_u32 v61, v1, 4, 1
    v_lshlrev_b32 v61, 5, v61
    v_and_b32 v62, 3, v1
    v_lshl_add_u32 v61, v62, 3, v61
    v_lshl_add_u32 v232, v60, 6, v61
    s_lshr_b32 s75, s54, 1
    s_lshl_b32 s76, s52, 2
    s_add_u32 s75, s75, s76
    s_lshl_b32 s75, s75, 4
    s_add_u32 s75, s75, s53
    s_lshl_b32 s75, s75, 1
    s_and_b32 s76, s54, 1
    s_add_u32 s75, s75, s76
    s_lshl_b32 s75, s75, 10
    s_add_u32 s63, s75, 4259840
    s_waitcnt vmcnt(1) lgkmcnt(0)
    v_mov_b32 v26, 161792
    v_mov_b32 v28, 1
    s_mov_b64 exec, 1
    ds_add_rtn_u32 v28, v26, v28 offset:4
    s_waitcnt lgkmcnt(0)
    v_readfirstlane_b32 s68, v28
    s_mov_b64 exec, -1
    s_cmp_lg_u32 s68, 7
    s_cbranch_scc1 L_mk_f1_5
    s_mov_b64 exec, 1
    s_or_b32 s77, s67, 1
    s_or_b32 s77, s77, s82
    v_mov_b32 v26, s77
    s_lshl_b32 s77, s52, 4
    s_add_u32 s77, s77, s53
    s_lshl_b32 s77, s77, 7
    s_add_u32 s77, s77, 18939904
    buffer_store_dword v26, v237, s[16:19], s77 offen sc1
    s_mov_b64 exec, -1
L_mk_f1_5:
    s_barrier
    s_branch L_mk_p2
L_mk_p1v2:
    s_lshl_b32 s68, s93, 5
    v_add_u32 v26, s68, v4
    v_mul_u32_u24 v27, 2341, v26
    v_lshrrev_b32 v27, 16, v27
    v_mul_u32_u24 v28, 28, v27
    v_sub_u32 v26, v26, v28
    v_lshlrev_b32 v27, 18, v27
    v_cmp_eq_u32 vcc, 24, v26
    s_nop 1
    v_cndmask_b32 v120, v237, v17, vcc
    v_cmp_le_u32 vcc, 24, v26
    v_lshl_add_u32 v26, v3, 5, v26
    v_lshl_add_u32 v21, v26, 4, v27
    v_add_u32 v21, 2048, v21
    v_mov_b32 v25, 0x7ffff000
    v_cndmask_b32 v25, v25, v21, vcc
    v_mov_b32 v121, v120
    v_mov_b32 v122, v120
    v_mov_b32 v123, v120
    s_waitcnt vmcnt(4) lgkmcnt(0)
    s_barrier
    ds_read_b128 v[48:51], v9 offset:0
    ds_read_b64_tr_b16 v[52:53], v13 offset:0
    ds_read_b64_tr_b16 v[54:55], v13 offset:512
    ds_read_b128 v[56:59], v10 offset:0
    ds_read_b64_tr_b16 v[60:61], v14 offset:0
    ds_read_b64_tr_b16 v[62:63], v14 offset:512
    ds_read_b128 v[64:67], v11 offset:0
    ds_read_b64_tr_b16 v[68:69], v15 offset:0
    ds_read_b64_tr_b16 v[70:71], v15 offset:512
    ds_read_b128 v[72:75], v12 offset:0
    ds_read_b64_tr_b16 v[76:77], v16 offset:0
    ds_read_b64_tr_b16 v[78:79], v16 offset:512
    s_not_b32 s70, s20
    s_and_b32 s70, s70, 0x80000000
    s_add_u32 s20, s20, 0x100
    s_and_b32 s20, s20, 0x7fffffff
    s_or_b32 s20, s20, s70
    s_and_b32 s82, s20, 0xffffff00
    s_ashr_i32 s86, s20, 31
    s_and_b32 s21, s86, 0x80008000
    s_cmp_lg_u32 s54, 1
    s_cbranch_scc1 L_mk_f0_6
    s_mov_b64 exec, 1
    s_or_b32 s77, s67, 0
    s_or_b32 s77, s77, s82
    v_mov_b32 v26, s77
    s_lshl_b32 s77, s52, 4
    s_add_u32 s77, s77, s53
    s_lshl_b32 s77, s77, 7
    s_add_u32 s77, s77, 18939904
    buffer_store_dword v26, v237, s[16:19], s77 offen sc1
    s_mov_b64 exec, -1
L_mk_f0_6:
    s_add_u32 s68, s83, 2
    s_cmp_ge_u32 s68, 7
    s_cselect_b32 s75, 7, 0
    s_sub_u32 s68, s68, s75
    s_lshl_b32 s68, s68, 7
    s_add_u32 m0, s72, 32768
    s_nop 0
    buffer_load_dwordx4 v5, s[8:11], s68 offen lds
    s_add_u32 m0, s72, 33792
    s_nop 0
    buffer_load_dwordx4 v6, s[8:11], s68 offen lds
    s_add_u32 s69, s83, 2
    s_cmp_ge_u32 s69, 7
    s_cselect_b32 s75, 7, 0
    s_sub_u32 s69, s69, s75
    s_mul_i32 s69, s69, 172032
    s_add_u32 m0, s73, 131072
    s_add_u32 s69, s69, s74
    buffer_load_dwordx4 v29, s[12:15], s69 offen lds
    s_add_u32 s68, s83, 3
    s_cmp_ge_u32 s68, 7
    s_cselect_b32 s75, 7, 0
    s_sub_u32 s68, s68, s75
    s_lshl_b32 s68, s68, 7
    s_add_u32 m0, s72, 49152
    s_nop 0
    buffer_load_dwordx4 v5, s[8:11], s68 offen lds
    s_add_u32 m0, s72, 50176
    s_nop 0
    buffer_load_dwordx4 v6, s[8:11], s68 offen lds
    s_add_u32 s69, s83, 3
    s_cmp_ge_u32 s69, 7
    s_cselect_b32 s75, 7, 0
    s_sub_u32 s69, s69, s75
    s_mul_i32 s69, s69, 172032
    s_add_u32 m0, s73, 139264
    s_add_u32 s69, s69, s74
    buffer_load_dwordx4 v29, s[12:15], s69 offen lds
    s_waitcnt vmcnt(7) lgkmcnt(0)
    s_barrier
    v_mfma_f32_32x32x16_bf16 v[32:47], v[48:51], v[52:55], 0
    ds_read_b128 v[80:83], v9 offset:16384
    s_add_u32 s68, s83, 4
    ds_read_b64_tr_b16 v[84:85], v13 offset:8192
    s_cmp_ge_u32 s68, 7
    ds_read_b64_tr_b16 v[86:87], v13 offset:8704
    s_cselect_b32 s75, 7, 0
    s_sub_u32 s68, s68, s75
    v_mfma_f32_16x16x32_bf16 v[116:119], v[124:127], v[52:55], 0
    ds_read_b128 v[88:91], v10 offset:16384
    s_lshl_b32 s68, s68, 7
    ds_read_b64_tr_b16 v[92:93], v14 offset:8192
    s_add_u32 m0, s72, 65536
    ds_read_b64_tr_b16 v[94:95], v14 offset:8704
    buffer_load_dwordx4 v5, s[8:11], s68 offen lds
    v_mfma_f32_32x32x16_bf16 v[32:47], v[56:59], v[60:63], v[32:47]
    ds_read_b128 v[96:99], v11 offset:16384
    s_add_u32 m0, s72, 66560
    ds_read_b64_tr_b16 v[100:101], v15 offset:8192
    buffer_load_dwordx4 v6, s[8:11], s68 offen lds
    ds_read_b64_tr_b16 v[102:103], v15 offset:8704
    s_add_u32 s69, s83, 4
    s_cmp_ge_u32 s69, 7
    v_mfma_f32_32x32x16_bf16 v[32:47], v[64:67], v[68:71], v[32:47]
    ds_read_b128 v[104:107], v12 offset:16384
    s_cselect_b32 s75, 7, 0
    ds_read_b64_tr_b16 v[108:109], v16 offset:8192
    s_sub_u32 s69, s69, s75
    ds_read_b64_tr_b16 v[110:111], v16 offset:8704
    s_mul_i32 s69, s69, 172032
    v_mfma_f32_32x32x16_bf16 v[32:47], v[72:75], v[76:79], v[32:47]
    s_add_u32 m0, s73, 114688
    s_add_u32 s69, s69, s74
    buffer_load_dwordx4 v29, s[12:15], s69 offen lds
    v_dot2_f32_bf16 v18, v48, v48, v18
    v_dot2_f32_bf16 v19, v48, v17, v19
    v_dot2_f32_bf16 v18, v49, v49, v18
    v_dot2_f32_bf16 v19, v49, v17, v19
    v_dot2_f32_bf16 v18, v56, v56, v18
    v_dot2_f32_bf16 v19, v56, v17, v19
    v_dot2_f32_bf16 v18, v57, v57, v18
    v_dot2_f32_bf16 v19, v57, v17, v19
    v_dot2_f32_bf16 v18, v64, v64, v18
    v_dot2_f32_bf16 v19, v64, v17, v19
    v_dot2_f32_bf16 v18, v65, v65, v18
    v_dot2_f32_bf16 v19, v65, v17, v19
    v_dot2_f32_bf16 v18, v72, v72, v18
    v_dot2_f32_bf16 v19, v72, v17, v19
    v_dot2_f32_bf16 v18, v73, v73, v18
    v_dot2_f32_bf16 v19, v73, v17, v19
    s_waitcnt vmcnt(6) lgkmcnt(0)
    s_barrier
    v_mfma_f32_32x32x16_bf16 v[32:47], v[80:83], v[84:87], v[32:47]
    ds_read_b128 v[48:51], v9 offset:32768
    s_add_u32 s68, s83, 5
    ds_read_b64_tr_b16 v[52:53], v13 offset:16384
    s_cmp_ge_u32 s68, 7
    ds_read_b64_tr_b16 v[54:55], v13 offset:16896
    s_cselect_b32 s75, 7, 0
    s_sub_u32 s68, s68, s75
    v_mfma_f32_16x16x32_bf16 v[116:119], v[124:127], v[84:87], v[116:119]
    ds_read_b128 v[56:59], v10 offset:32768
    s_lshl_b32 s68, s68, 7
    ds_read_b64_tr_b16 v[60:61], v14 offset:16384
    s_add_u32 m0, s72, 81920
    ds_read_b64_tr_b16 v[62:63], v14 offset:16896
    buffer_load_dwordx4 v5, s[8:11], s68 offen lds
    v_mfma_f32_32x32x16_bf16 v[32:47], v[88:91], v[92:95], v[32:47]
    ds_read_b128 v[64:67], v11 offset:32768
    s_add_u32 m0, s72, 82944
    ds_read_b64_tr_b16 v[68:69], v15 offset:16384
    buffer_load_dwordx4 v6, s[8:11], s68 offen lds
    ds_read_b64_tr_b16 v[70:71], v15 offset:16896
    s_add_u32 s69, s83, 5
    s_cmp_ge_u32 s69, 7
    v_mfma_f32_32x32x16_bf16 v[32:47], v[96:99], v[100:103], v[32:47]
    ds_read_b128 v[72:75], v12 offset:32768
    s_cselect_b32 s75, 7, 0
    ds_read_b64_tr_b16 v[76:77], v16 offset:16384
    s_sub_u32 s69, s69, s75
    ds_read_b64_tr_b16 v[78:79], v16 offset:16896
    s_mul_i32 s69, s69, 172032
    v_mfma_f32_32x32x16_bf16 v[32:47], v[104:107], v[108:111], v[32:47]
    s_add_u32 m0, s73, 122880
    s_add_u32 s69, s69, s74
    buffer_load_dwordx4 v29, s[12:15], s69 offen lds
    v_dot2_f32_bf16 v18, v80, v80, v18
    v_dot2_f32_bf16 v19, v80, v17, v19
    v_dot2_f32_bf16 v18, v81, v81, v18
    v_dot2_f32_bf16 v19, v81, v17, v19
    v_dot2_f32_bf16 v18, v88, v88, v18
    v_dot2_f32_bf16 v19, v88, v17, v19
    v_dot2_f32_bf16 v18, v89, v89, v18
    v_dot2_f32_bf16 v19, v89, v17, v19
    v_dot2_f32_bf16 v18, v96, v96, v18
    v_dot2_f32_bf16 v19, v96, v17, v19
    v_dot2_f32_bf16 v18, v97, v97, v18
    v_dot2_f32_bf16 v19, v97, v17, v19
    v_dot2_f32_bf16 v18, v104, v104, v18
    v_dot2_f32_bf16 v19, v104, v17, v19
    v_dot2_f32_bf16 v18, v105, v105, v18
    v_dot2_f32_bf16 v19, v105, v17, v19
    s_waitcnt vmcnt(6) lgkmcnt(0)
    s_barrier
    v_mfma_f32_32x32x16_bf16 v[32:47], v[48:51], v[52:55], v[32:47]
    ds_read_b128 v[80:83], v9 offset:49152
    s_add_u32 s68, s83, 6
    ds_read_b64_tr_b16 v[84:85], v13 offset:24576
    s_cmp_ge_u32 s68, 7
    ds_read_b64_tr_b16 v[86:87], v13 offset:25088
    s_cselect_b32 s75, 7, 0
    s_sub_u32 s68, s68, s75
    v_mfma_f32_16x16x32_bf16 v[116:119], v[124:127], v[52:55], v[116:119]
    ds_read_b128 v[88:91], v10 offset:49152
    s_lshl_b32 s68, s68, 7
    ds_read_b64_tr_b16 v[92:93], v14 offset:24576
    s_add_u32 m0, s72, 98304
    ds_read_b64_tr_b16 v[94:95], v14 offset:25088
    buffer_load_dwordx4 v5, s[8:11], s68 offen lds
    v_mfma_f32_32x32x16_bf16 v[32:47], v[56:59], v[60:63], v[32:47]
    ds_read_b128 v[96:99], v11 offset:49152
    s_add_u32 m0, s72, 99328
    ds_read_b64_tr_b16 v[100:101], v15 offset:24576
    buffer_load_dwordx4 v6, s[8:11], s68 offen lds
    ds_read_b64_tr_b16 v[102:103], v15 offset:25088
    s_add_u32 s69, s83, 6
    s_cmp_ge_u32 s69, 7
    v_mfma_f32_32x32x16_bf16 v[32:47], v[64:67], v[68:71], v[32:47]
    ds_read_b128 v[104:107], v12 offset:49152
    s_cselect_b32 s75, 7, 0
    ds_read_b64_tr_b16 v[108:109], v16 offset:24576
    s_sub_u32 s69, s69, s75
    ds_read_b64_tr_b16 v[110:111], v16 offset:25088
    s_mul_i32 s69, s69, 172032
    v_mfma_f32_32x32x16_bf16 v[32:47], v[72:75], v[76:79], v[32:47]
    s_add_u32 m0, s73, 131072
    s_add_u32 s69, s69, s74
    buffer_load_dwordx4 v29, s[12:15], s69 offen lds
    v_dot2_f32_bf16 v18, v48, v48, v18
    v_dot2_f32_bf16 v19, v48, v17, v19
    v_dot2_f32_bf16 v18, v49, v49, v18
    v_dot2_f32_bf16 v19, v49, v17, v19
    v_dot2_f32_bf16 v18, v56, v56, v18
    v_dot2_f32_bf16 v19, v56, v17, v19
    v_dot2_f32_bf16 v18, v57, v57, v18
    v_dot2_f32_bf16 v19, v57, v17, v19
    v_dot2_f32_bf16 v18, v64, v64, v18
    v_dot2_f32_bf16 v19, v64, v17, v19
    v_dot2_f32_bf16 v18, v65, v65, v18
    v_dot2_f32_bf16 v19, v65, v17, v19
    v_dot2_f32_bf16 v18, v72, v72, v18
    v_dot2_f32_bf16 v19, v72, v17, v19
    v_dot2_f32_bf16 v18, v73, v73, v18
    v_dot2_f32_bf16 v19, v73, v17, v19
    s_waitcnt vmcnt(6) lgkmcnt(0)
    s_barrier
    v_mfma_f32_32x32x16_bf16 v[32:47], v[80:83], v[84:87], v[32:47]
    v_add_u32 v9, 0x10000, v9
    s_lshl_b32 s68, s54, 10
    v_add_u32 v10, 0x10000, v10
    s_add_u32 s69, s83, s56
    v_add_u32 v11, 0x10000, v11
    s_add_u32 s69, s69, 0
    v_add_u32 v12, 0x10000, v12
    s_cmp_ge_u32 s69, 7
    s_cselect_b32 s70, 7, 0
    s_sub_u32 s69, s69, s70
    v_mfma_f32_16x16x32_bf16 v[116:119], v[124:127], v[84:87], v[116:119]
    ds_read_b128 v[48:51], v9 offset:0
    s_mul_i32 s69, s69, 172032
    ds_read_b64_tr_b16 v[52:53], v13 offset:0
    s_add_u32 m0, s68, 147456
    ds_read_b64_tr_b16 v[54:55], v13 offset:512
    buffer_load_dwordx4 v8, s[12:15], s69 offen lds
    ds_read_b128 v[56:59], v10 offset:0
    s_add_u32 s69, s83, s56
    s_add_u32 s69, s69, 2
    s_cmp_ge_u32 s69, 7
    v_mfma_f32_32x32x16_bf16 v[32:47], v[88:91], v[92:95], v[32:47]
    ds_read_b64_tr_b16 v[60:61], v14 offset:0
    s_cselect_b32 s70, 7, 0
    ds_read_b64_tr_b16 v[62:63], v14 offset:512
    s_sub_u32 s69, s69, s70
    ds_read_b128 v[64:67], v11 offset:0
    s_mul_i32 s69, s69, 172032
    ds_read_b64_tr_b16 v[68:69], v15 offset:0
    s_add_u32 m0, s68, 139264
    s_nop 0
    buffer_load_dwordx4 v8, s[12:15], s69 offen lds
    v_mfma_f32_32x32x16_bf16 v[32:47], v[96:99], v[100:103], v[32:47]
    ds_read_b64_tr_b16 v[70:71], v15 offset:512
    s_add_u32 s69, s83, 6
    ds_read_b128 v[72:75], v12 offset:0
    s_cmp_ge_u32 s69, 7
    ds_read_b64_tr_b16 v[76:77], v16 offset:0
    s_cselect_b32 s70, 7, 0
    ds_read_b64_tr_b16 v[78:79], v16 offset:512
    s_sub_u32 s69, s69, s70
    s_mul_i32 s69, s69, 172032
    s_mul_i32 s70, s56, 21504
    v_mfma_f32_32x32x16_bf16 v[32:47], v[104:107], v[108:111], v[32:47]
    s_add_u32 s69, s69, s70
    s_lshl_b32 s70, s55, 10
    s_lshl_b32 s71, s56, 9
    s_add_u32 s70, s70, s71
    s_add_u32 m0, s70, 155648
    v_dot2_f32_bf16 v18, v80, v80, v18
    v_dot2_f32_bf16 v19, v80, v17, v19
    v_dot2_f32_bf16 v18, v81, v81, v18
    v_dot2_f32_bf16 v19, v81, v17, v19
    v_dot2_f32_bf16 v18, v88, v88, v18
    v_dot2_f32_bf16 v19, v88, v17, v19
    v_dot2_f32_bf16 v18, v89, v89, v18
    v_dot2_f32_bf16 v19, v89, v17, v19
    v_dot2_f32_bf16 v18, v96, v96, v18
    v_dot2_f32_bf16 v19, v96, v17, v19
    v_dot2_f32_bf16 v18, v97, v97, v18
    v_dot2_f32_bf16 v19, v97, v17, v19
    v_dot2_f32_bf16 v18, v104, v104, v18
    v_dot2_f32_bf16 v19, v104, v17, v19
    v_dot2_f32_bf16 v18, v105, v105, v18
    v_dot2_f32_bf16 v19, v105, v17, v19
    s_mov_b32 exec_hi, 0
    buffer_load_dwordx4 v8, s[12:15], s69 offen lds
    s_mov_b32 exec_hi, -1
    s_waitcnt vmcnt(6) lgkmcnt(0)
    s_barrier
    v_mfma_f32_32x32x16_bf16 v[32:47], v[48:51], v[52:55], v[32:47]
    ds_read_b128 v[80:83], v9 offset:16384
    s_mul_i32 s69, s54, 14
    ds_read_b64_tr_b16 v[84:85], v13 offset:8192
    s_and_b32 s70, s59, 3
    ds_read_b64_tr_b16 v[86:87], v13 offset:8704
    s_mul_i32 s70, s70, 112
    s_add_u32 s69, s69, s70
    v_min_u32 v30, 13, v1
    v_add_u32 v30, s69, v30
    v_mfma_f32_16x16x32_bf16 v[116:119], v[124:127], v[52:55], v[116:119]
    ds_read_b128 v[88:91], v10 offset:16384
    v_mul_u32_u24 v30, 896, v30
    ds_read_b64_tr_b16 v[92:93], v14 offset:8192
    s_lshl_b32 s69, s58, 7
    ds_read_b64_tr_b16 v[94:95], v14 offset:8704
    buffer_load_dword v253, v30, s[24:27], s69 offen
    s_lshl_b32 s69, s54, 4
    s_and_b32 s70, s60, 1
    v_mfma_f32_32x32x16_bf16 v[32:47], v[56:59], v[60:63], v[32:47]
    ds_read_b128 v[96:99], v11 offset:16384
    s_lshl_b32 s70, s70, 7
    ds_read_b64_tr_b16 v[100:101], v15 offset:8192
    s_add_u32 s69, s69, s70
    ds_read_b64_tr_b16 v[102:103], v15 offset:8704
    v_min_u32 v31, 15, v1
    v_add_u32 v31, s69, v31
    v_mul_u32_u24 v31, 3584, v31
    s_lshl_b32 s69, s61, 8
    v_mfma_f32_32x32x16_bf16 v[32:47], v[64:67], v[68:71], v[32:47]
    ds_read_b128 v[104:107], v12 offset:16384
    buffer_load_dword v252, v31, s[28:31], s69 offen
    ds_read_b64_tr_b16 v[108:109], v16 offset:8192
    s_lshl_b32 s68, s54, 10
    ds_read_b64_tr_b16 v[110:111], v16 offset:8704
    s_add_u32 s69, s83, s56
    s_add_u32 s69, s69, 4
    s_cmp_ge_u32 s69, 7
    v_mfma_f32_32x32x16_bf16 v[32:47], v[72:75], v[76:79], v[32:47]
    s_cselect_b32 s70, 7, 0
    s_sub_u32 s69, s69, s70
    s_mul_i32 s69, s69, 172032
    s_add_u32 m0, s68, 114688
    s_nop 0
    buffer_load_dwordx4 v8, s[12:15], s69 offen lds
    v_dot2_f32_bf16 v18, v48, v48, v18
    v_dot2_f32_bf16 v19, v48, v17, v19
    v_dot2_f32_bf16 v18, v49, v49, v18
    v_dot2_f32_bf16 v19, v49, v17, v19
    v_dot2_f32_bf16 v18, v56, v56, v18
    v_dot2_f32_bf16 v19, v56, v17, v19
    v_dot2_f32_bf16 v18, v57, v57, v18
    v_dot2_f32_bf16 v19, v57, v17, v19
    v_dot2_f32_bf16 v18, v64, v64, v18
    v_dot2_f32_bf16 v19, v64, v17, v19
    v_dot2_f32_bf16 v18, v65, v65, v18
    v_dot2_f32_bf16 v19, v65, v17, v19
    v_dot2_f32_bf16 v18, v72, v72, v18
    v_dot2_f32_bf16 v19, v72, v17, v19
    v_dot2_f32_bf16 v18, v73, v73, v18
    v_dot2_f32_bf16 v19, v73, v17, v19
    s_waitcnt vmcnt(6) lgkmcnt(0)
    s_barrier
    v_mfma_f32_32x32x16_bf16 v[32:47], v[80:83], v[84:87], v[32:47]
    ds_read_b128 v[48:51], v9 offset:32768
    ds_read_b64_tr_b16 v[52:53], v13 offset:16384
    ds_read_b64_tr_b16 v[54:55], v13 offset:16896
    v_mfma_f32_16x16x32_bf16 v[116:119], v[124:127], v[84:87], v[116:119]
    ds_read_b128 v[56:59], v10 offset:32768
    ds_read_b64_tr_b16 v[60:61], v14 offset:16384
    ds_read_b64_tr_b16 v[62:63], v14 offset:16896
    v_mfma_f32_32x32x16_bf16 v[32:47], v[88:91], v[92:95], v[32:47]
    ds_read_b128 v[64:67], v11 offset:32768
    ds_read_b64_tr_b16 v[68:69], v15 offset:16384
    ds_read_b64_tr_b16 v[70:71], v15 offset:16896
    v_mfma_f32_32x32x16_bf16 v[32:47], v[96:99], v[100:103], v[32:47]
    ds_read_b128 v[72:75], v12 offset:32768
    ds_read_b64_tr_b16 v[76:77], v16 offset:16384
    ds_read_b64_tr_b16 v[78:79], v16 offset:16896
    v_mfma_f32_32x32x16_bf16 v[32:47], v[104:107], v[108:111], v[32:47]
    v_dot2_f32_bf16 v18, v80, v80, v18
    v_dot2_f32_bf16 v19, v80, v17, v19
    v_dot2_f32_bf16 v18, v81, v81, v18
    v_dot2_f32_bf16 v19, v81, v17, v19
    v_dot2_f32_bf16 v18, v88, v88, v18
    v_dot2_f32_bf16 v19, v88, v17, v19
    v_dot2_f32_bf16 v18, v89, v89, v18
    v_dot2_f32_bf16 v19, v89, v17, v19
    v_dot2_f32_bf16 v18, v96, v96, v18
    v_dot2_f32_bf16 v19, v96, v17, v19
    v_dot2_f32_bf16 v18, v97, v97, v18
    v_dot2_f32_bf16 v19, v97, v17, v19
    v_dot2_f32_bf16 v18, v104, v104, v18
    v_dot2_f32_bf16 v19, v104, v17, v19
    v_dot2_f32_bf16 v18, v105, v105, v18
    v_dot2_f32_bf16 v19, v105, v17, v19
    s_waitcnt lgkmcnt(0)
    v_mfma_f32_16x16x32_bf16 v[116:119], v[124:127], v[52:55], v[116:119]
    v_dot2_f32_bf16 v18, v48, v48, v18
    v_dot2_f32_bf16 v19, v48, v17, v19
    v_dot2_f32_bf16 v18, v49, v49, v18
    v_dot2_f32_bf16 v19, v49, v17, v19
    v_dot2_f32_bf16 v18, v56, v56, v18
    v_dot2_f32_bf16 v19, v56, v17, v19
    v_dot2_f32_bf16 v18, v57, v57, v18
    v_dot2_f32_bf16 v19, v57, v17, v19
    v_dot2_f32_bf16 v18, v64, v64, v18
    v_dot2_f32_bf16 v19, v64, v17, v19
    v_dot2_f32_bf16 v18, v65, v65, v18
    v_dot2_f32_bf16 v19, v65, v17, v19
    v_dot2_f32_bf16 v18, v72, v72, v18
    v_dot2_f32_bf16 v19, v72, v17, v19
    v_dot2_f32_bf16 v18, v73, v73, v18
    v_dot2_f32_bf16 v19, v73, v17, v19
    s_lshl_b32 s68, s55, 10
    s_add_u32 s68, s68, 122880
    v_lshl_add_u32 v26, v4, 5, s68
    v_lshl_add_u32 v28, v3, 2, v26
    v_lshlrev_b32 v27, 4, v4
    v_add_u32 v27, 159744, v27
    s_lshl_b32 s68, s55, 2
    v_add_u32 v20, s68, v27
    ds_write_b32 v28, v18 offset:0
    ds_write_b32 v28, v19 offset:16
    s_mov_b64 exec, 0xffff
    ds_write_b32 v20, v116 offset:0
    ds_write_b32 v20, v117 offset:256
    s_mov_b64 exec, -1
    v_mov_b32 v86, 0
    v_mov_b32 v87, 0
    v_mov_b32 v90, 0
    v_mov_b32 v91, 0
    v_cmp_eq_u32 vcc, 0, v3
    s_lshl_b32 s69, s57, 12
    s_add_u32 s69, s69, 65536
    s_waitcnt lgkmcnt(0)
    s_barrier
    ds_read_b128 v[92:95], v26
    ds_read_b128 v[100:103], v26 offset:16
    ds_read_b128 v[96:99], v27 offset:0
    v_mfma_f32_32x32x16_bf16 v[32:47], v[48:51], v[52:55], v[32:47]
    s_waitcnt lgkmcnt(1)
    v_add_f32 v92, v92, v93
    v_add_f32 v100, v100, v101
    v_add_f32 v94, v94, v95
    v_add_f32 v102, v102, v103
    v_add_f32 v29, v92, v94
    v_add_f32 v28, v100, v102
    s_waitcnt lgkmcnt(0)
    v_add_f32 v96, v96, v97
    v_add_f32 v98, v98, v99
    v_add_f32 v30, v96, v98
    v_and_b32 v31, 0xffff0000, v30
    v_mfma_f32_32x32x16_bf16 v[32:47], v[56:59], v[60:63], v[32:47]
    v_sub_f32 v30, v30, v31
    v_and_b32 v88, 0xffff0000, v30
    v_sub_f32 v30, v30, v88
    v_lshrrev_b32 v31, 16, v31
    v_or_b32 v88, v88, v31
    v_lshrrev_b32 v89, 16, v30
    v_mul_f32 v80, 0x3b124925, v28
    v_mul_f32 v83, 0x3b124925, v29
    v_fma_f32 v83, -v80, v80, v83
    v_max_f32 v83, 0, v83
    v_cvt_pk_bf16_f32 v83, v83, v80
    v_and_b32 v80, 0xffff0000, v83
    v_mfma_f32_32x32x16_bf16 v[32:47], v[64:67], v[68:71], v[32:47]
    v_lshlrev_b32 v83, 16, v83
    v_add_f32 v83, 0x3727c5ac, v83
    v_cvt_pk_bf16_f32 v83, v83, v83
    v_lshlrev_b32 v83, 16, v83
    v_sqrt_f32 v83, v83
    s_nop 0
    v_cvt_pk_bf16_f32 v83, v83, v83
    v_lshlrev_b32 v81, 16, v83
    v_rcp_f32 v82, v81
    s_lshl_b32 s68, s55, 7
    s_add_u32 s68, s68, 161280
    v_lshl_add_u32 v26, v4, 2, s68
    ds_write_b32 v26, v82
    v_mfma_f32_32x32x16_bf16 v[32:47], v[72:75], v[76:79], v[32:47]
    v_lshl_add_u32 v26, v3, 4, s68
    v_xor_b32 v80, 0x80000000, v80
    v_lshrrev_b32 v85, 16, v80
    v_or_b32 v84, v80, v85
    v_cndmask_b32 v84, v237, v84, vcc
    v_cndmask_b32 v85, v237, v85, vcc
    s_waitcnt lgkmcnt(0)
    ds_read_b128 v[96:99], v26 offset:0
    ds_read_b128 v[100:103], v26 offset:32
    ds_read_b128 v[104:107], v26 offset:64
    ds_read_b128 v[108:111], v26 offset:96
    v_mfma_f32_32x32x16_bf16 v[32:47], v[84:87], v[88:91], v[32:47]
    s_waitcnt lgkmcnt(0)
    s_nop 10
    v_mul_f32 v32, v32, v96
    v_mul_f32 v33, v33, v97
    v_mul_f32 v34, v34, v98
    v_mul_f32 v35, v35, v99
    v_mul_f32 v36, v36, v100
    v_mul_f32 v37, v37, v101
    v_mul_f32 v38, v38, v102
    v_mul_f32 v39, v39, v103
    v_mul_f32 v40, v40, v104
    v_mul_f32 v41, v41, v105
    v_mul_f32 v42, v42, v106
    v_mul_f32 v43, v43, v107
    v_mul_f32 v44, v44, v108
    v_mul_f32 v45, v45, v109
    v_mul_f32 v46, v46, v110
    v_mul_f32 v47, v47, v111
    v_cvt_pk_bf16_f32 v32, v32, v33
    v_cvt_pk_bf16_f32 v33, v34, v35
    v_cvt_pk_bf16_f32 v34, v36, v37
    v_cvt_pk_bf16_f32 v35, v38, v39
    v_cvt_pk_bf16_f32 v36, v40, v41
    v_cvt_pk_bf16_f32 v37, v42, v43
    v_cvt_pk_bf16_f32 v38, v44, v45
    v_cvt_pk_bf16_f32 v39, v46, v47
    s_cmp_ge_u32 s53, 14
    s_cbranch_scc1 L_mk_nokv_7
    buffer_store_dwordx4 v[32:35], v21, s[16:19], s69 offen sc1
    buffer_store_dwordx4 v[36:39], v21, s[16:19], s69 offen offset:1024 sc1
    buffer_store_dwordx4 v[120:123], v25, s[16:19], s69 offen offset:64 sc1
    buffer_store_dwordx4 v[120:123], v25, s[16:19], s69 offen offset:1088 sc1
L_mk_nokv_7:
    s_waitcnt vmcnt(4)
    s_cmp_lt_u32 s53, 14
    s_cbranch_scc1 L_mk_nokv_7b
    s_waitcnt vmcnt(0)
L_mk_nokv_7b:
    s_barrier
    s_add_u32 s68, s55, 0
    s_and_b32 s68, s68, 3
    s_lshl_b32 s68, s68, 10
    v_add_u32 v13, s68, v190
    s_add_u32 s68, s55, 1
    s_and_b32 s68, s68, 3
    s_lshl_b32 s68, s68, 10
    v_add_u32 v14, s68, v190
    s_add_u32 s68, s55, 2
    s_and_b32 s68, s68, 3
    s_lshl_b32 s68, s68, 10
    v_add_u32 v15, s68, v190
    s_add_u32 s68, s55, 3
    s_and_b32 s68, s68, 3
    s_lshl_b32 s68, s68, 10
    v_add_u32 v16, s68, v190
    v_subrev_u32 v9, 0x10000, v9
    v_subrev_u32 v10, 0x10000, v10
    v_subrev_u32 v11, 0x10000, v11
    v_subrev_u32 v12, 0x10000, v12
    ds_read_b128 v[128:131], v9 offset:0
    ds_read_b64_tr_b16 v[132:133], v13 offset:32768
    ds_read_b64_tr_b16 v[134:135], v13 offset:33024
    ds_read_b128 v[136:139], v10 offset:0
    ds_read_b64_tr_b16 v[140:141], v14 offset:32768
    ds_read_b64_tr_b16 v[142:143], v14 offset:33024
    ds_read_b128 v[144:147], v11 offset:0
    ds_read_b64_tr_b16 v[148:149], v15 offset:32768
    ds_read_b64_tr_b16 v[150:151], v15 offset:33024
    ds_read_b128 v[152:155], v12 offset:0
    ds_read_b64_tr_b16 v[156:157], v16 offset:32768
    ds_read_b64_tr_b16 v[158:159], v16 offset:33024
    v_and_b32 v60, 15, v1
    s_lshr_b32 s75, s2, 7
    s_lshl_b32 s75, s75, 4
    v_add_u32 v61, s75, v60
    v_lshrrev_b32 v62, 2, v61
    s_and_b32 s75, s2, 1
    s_lshl_b32 s75, s75, 3
    v_add_u32 v62, s75, v62
    v_and_b32 v61, 3, v61
    s_and_b32 s75, s2, 6
    s_lshl_b32 s75, s75, 1
    v_add_u32 v61, s75, v61
    v_lshl_add_u32 v61, v62, 4, v61
    s_lshl_b32 s75, s60, 4
    v_add_u32 v60, s75, v60
    v_cmp_eq_u32 vcc, 0, v3
    s_mul_i32 s75, s53, 7
    s_lshr_b32 s75, s75, 3
    s_lshl_b32 s76, s54, 4
    v_and_b32 v62, 1, v1
    v_add_u32 v62, s75, v62
    v_lshrrev_b32 v62, 1, v62
    v_bfe_u32 v63, v1, 1, 1
    v_mad_u32_u24 v62, v63, 7, v62
    s_waitcnt lgkmcnt(0)
    v_mfma_f32_32x32x16_bf16 v[64:79], v[132:135], v[128:131], 0
    ds_read_b128 v[160:163], v9 offset:16384
    v_and_b32 v63, 4, v1
    ds_read_b64_tr_b16 v[164:165], v13 offset:36864
    v_lshl_add_u32 v62, v63, 5, v62
    ds_read_b64_tr_b16 v[166:167], v13 offset:37120
    v_add_u32 v62, s76, v62
    v_cndmask_b32 v60, v61, v60, vcc
    v_cndmask_b32 v62, v61, v62, vcc
    v_lshlrev_b32 v239, 7, v60
    v_mfma_f32_32x32x16_bf16 v[64:79], v[140:143], v[136:139], v[64:79]
    ds_read_b128 v[168:171], v10 offset:16384
    v_lshlrev_b32 v238, 7, v62
    ds_read_b64_tr_b16 v[172:173], v14 offset:36864
    s_mov_b32 s77, 18939904
    ds_read_b64_tr_b16 v[174:175], v14 offset:37120
    buffer_load_dword v6, v238, s[16:19], s77 offen sc1
    s_mul_i32 s62, s60, 655360
    s_add_u32 s62, s62, 6356992
    v_mfma_f32_32x32x16_bf16 v[64:79], v[148:151], v[144:147], v[64:79]
    ds_read_b128 v[176:179], v11 offset:16384
    v_lshrrev_b32 v60, 2, v1
    ds_read_b64_tr_b16 v[180:181], v15 offset:36864
    v_and_b32 v62, 3, v1
    ds_read_b64_tr_b16 v[182:183], v15 offset:37120
    v_lshlrev_b32 v62, 4, v62
    v_mul_u32_u24 v61, 896, v60
    v_add_u32 v61, v61, v62
    v_mfma_f32_32x32x16_bf16 v[64:79], v[156:159], v[152:155], v[64:79]
    ds_read_b128 v[184:187], v12 offset:16384
    s_lshl_b32 s76, s58, 7
    ds_read_b64_tr_b16 v[188:189], v16 offset:36864
    v_add_u32 v235, s76, v61
    ds_read_b64_tr_b16 v[190:191], v16 offset:37120
    s_mul_i32 s75, s54, 14336
    v_add_u32 v63, s75, v235
    v_mul_u32_u24 v61, 3584, v60
    s_waitcnt lgkmcnt(0)
    v_mfma_f32_32x32x16_bf16 v[64:79], v[164:167], v[160:163], v[64:79]
    ds_read_b128 v[128:131], v9 offset:32768
    v_add_u32 v61, v61, v62
    ds_read_b64_tr_b16 v[132:133], v13 offset:24576
    s_mul_i32 s75, s55, 57344
    ds_read_b64_tr_b16 v[134:135], v13 offset:24832
    s_lshl_b32 s76, s61, 8
    s_add_u32 s75, s75, s76
    v_add_u32 v234, s75, v61
    s_lshl_b32 s76, s60, 1
    v_mfma_f32_32x32x16_bf16 v[64:79], v[172:175], v[168:171], v[64:79]
    ds_read_b128 v[136:139], v10 offset:32768
    s_add_u32 s76, s76, s61
    ds_read_b64_tr_b16 v[140:141], v14 offset:24576
    s_sub_u32 s76, s76, 14
    ds_read_b64_tr_b16 v[142:143], v14 offset:24832
    s_min_u32 s76, s76, 27
    s_lshl_b32 s76, s76, 7
    s_mul_i32 s75, s54, 57344
    v_mfma_f32_32x32x16_bf16 v[64:79], v[180:183], v[176:179], v[64:79]
    ds_read_b128 v[144:147], v11 offset:32768
    s_add_u32 s76, s76, s75
    ds_read_b64_tr_b16 v[148:149], v15 offset:24576
    v_add_u32 v61, s76, v61
    ds_read_b64_tr_b16 v[150:151], v15 offset:24832
    s_cmp_lt_u32 s61, 14
    s_cselect_b64 vcc, -1, 0
    s_mov_b32 s7, 458752
    v_mfma_f32_32x32x16_bf16 v[64:79], v[188:191], v[184:187], v[64:79]
    ds_read_b128 v[152:155], v12 offset:32768
    s_cselect_b32 s7, 114688, s7
    ds_read_b64_tr_b16 v[156:157], v16 offset:24576
    s_cselect_b32 s48, s24, s28
    ds_read_b64_tr_b16 v[158:159], v16 offset:24832
    s_cselect_b32 s49, s25, s29
    s_mov_b32 s50, 1605632
    s_cselect_b32 s50, 401408, s50
    s_waitcnt lgkmcnt(0)
    v_mfma_f32_32x32x16_bf16 v[64:79], v[132:135], v[128:131], v[64:79]
    ds_read_b128 v[160:163], v9 offset:49152
    s_mov_b32 s51, 0x20000
    ds_read_b64_tr_b16 v[164:165], v13 offset:28672
    v_cndmask_b32 v233, v61, v63, vcc
    ds_read_b64_tr_b16 v[166:167], v13 offset:28928
    v_bfe_u32 v60, v1, 2, 2
    v_lshl_add_u32 v60, v3, 2, v60
    v_bfe_u32 v61, v1, 4, 1
    v_mfma_f32_32x32x16_bf16 v[64:79], v[140:143], v[136:139], v[64:79]
    ds_read_b128 v[168:171], v10 offset:49152
    v_lshlrev_b32 v61, 5, v61
    ds_read_b64_tr_b16 v[172:173], v14 offset:28672
    v_and_b32 v62, 3, v1
    ds_read_b64_tr_b16 v[174:175], v14 offset:28928
    v_lshl_add_u32 v61, v62, 3, v61
    v_lshl_add_u32 v232, v60, 6, v61
    s_lshr_b32 s75, s54, 1
    v_mfma_f32_32x32x16_bf16 v[64:79], v[148:151], v[144:147], v[64:79]
    ds_read_b128 v[176:179], v11 offset:49152
    s_lshl_b32 s76, s52, 2
    ds_read_b64_tr_b16 v[180:181], v15 offset:28672
    s_add_u32 s75, s75, s76
    ds_read_b64_tr_b16 v[182:183], v15 offset:28928
    s_lshl_b32 s75, s75, 4
    s_add_u32 s75, s75, s53
    s_lshl_b32 s75, s75, 1
    v_mfma_f32_32x32x16_bf16 v[64:79], v[156:159], v[152:155], v[64:79]
    ds_read_b128 v[184:187], v12 offset:49152
    s_and_b32 s76, s54, 1
    ds_read_b64_tr_b16 v[188:189], v16 offset:28672
    s_add_u32 s75, s75, s76
    ds_read_b64_tr_b16 v[190:191], v16 offset:28928
    s_lshl_b32 s75, s75, 10
    s_add_u32 s63, s75, 4259840
    s_waitcnt lgkmcnt(0)
    s_waitcnt vmcnt(1)
    v_mov_b32 v26, 161792
    v_mov_b32 v28, 1
    s_mov_b64 exec, 1
    ds_add_rtn_u32 v28, v26, v28 offset:4
    s_waitcnt lgkmcnt(0)
    v_readfirstlane_b32 s68, v28
    s_mov_b64 exec, -1
    s_cmp_lg_u32 s68, 7
    s_cbranch_scc1 L_mk_f1_8
    s_mov_b64 exec, 1
    s_or_b32 s77, s67, 1
    s_or_b32 s77, s77, s82
    v_mov_b32 v26, s77
    s_lshl_b32 s77, s52, 4
    s_add_u32 s77, s77, s53
    s_lshl_b32 s77, s77, 7
    s_add_u32 s77, s77, 18939904
    buffer_store_dword v26, v237, s[16:19], s77 offen sc1
    s_mov_b64 exec, -1
L_mk_f1_8:
    v_mfma_f32_32x32x16_bf16 v[64:79], v[164:167], v[160:163], v[64:79]
    v_add_u32 v9, 0x10000, v9
    v_add_u32 v10, 0x10000, v10
    v_add_u32 v11, 0x10000, v11
    v_add_u32 v12, 0x10000, v12
    v_mfma_f32_32x32x16_bf16 v[64:79], v[172:175], v[168:171], v[64:79]
    ds_read_b128 v[128:131], v9 offset:0
    ds_read_b64_tr_b16 v[132:133], v13 offset:0
    ds_read_b64_tr_b16 v[134:135], v13 offset:256
    ds_read_b128 v[136:139], v10 offset:0
    v_mfma_f32_32x32x16_bf16 v[64:79], v[180:183], v[176:179], v[64:79]
    ds_read_b64_tr_b16 v[140:141], v14 offset:0
    ds_read_b64_tr_b16 v[142:143], v14 offset:256
    ds_read_b128 v[144:147], v11 offset:0
    ds_read_b64_tr_b16 v[148:149], v15 offset:0
    v_mfma_f32_32x32x16_bf16 v[64:79], v[188:191], v[184:187], v[64:79]
    ds_read_b64_tr_b16 v[150:151], v15 offset:256
    ds_read_b128 v[152:155], v12 offset:0
    ds_read_b64_tr_b16 v[156:157], v16 offset:0
    ds_read_b64_tr_b16 v[158:159], v16 offset:256
    s_waitcnt lgkmcnt(0)
    v_mfma_f32_32x32x16_bf16 v[64:79], v[132:135], v[128:131], v[64:79]
    ds_read_b128 v[160:163], v9 offset:16384
    ds_read_b64_tr_b16 v[164:165], v13 offset:4096
    ds_read_b64_tr_b16 v[166:167], v13 offset:4352
    v_mfma_f32_32x32x16_bf16 v[64:79], v[140:143], v[136:139], v[64:79]
    ds_read_b128 v[168:171], v10 offset:16384
    ds_read_b64_tr_b16 v[172:173], v14 offset:4096
    ds_read_b64_tr_b16 v[174:175], v14 offset:4352
    v_mfma_f32_32x32x16_bf16 v[64:79], v[148:151], v[144:147], v[64:79]
    ds_read_b128 v[176:179], v11 offset:16384
    ds_read_b64_tr_b16 v[180:181], v15 offset:4096
    ds_read_b64_tr_b16 v[182:183], v15 offset:4352
    v_mfma_f32_32x32x16_bf16 v[64:79], v[156:159], v[152:155], v[64:79]
    ds_read_b128 v[184:187], v12 offset:16384
    ds_read_b64_tr_b16 v[188:189], v16 offset:4096
    ds_read_b64_tr_b16 v[190:191], v16 offset:4352
    s_waitcnt lgkmcnt(0)
    v_mfma_f32_32x32x16_bf16 v[64:79], v[164:167], v[160:163], v[64:79]
    ds_read_b128 v[128:131], v9 offset:32768
    ds_read_b64_tr_b16 v[132:133], v13 offset:40960
    ds_read_b64_tr_b16 v[134:135], v13 offset:41216
    v_mfma_f32_32x32x16_bf16 v[64:79], v[172:175], v[168:171], v[64:79]
    ds_read_b128 v[136:139], v10 offset:32768
    ds_read_b64_tr_b16 v[140:141], v14 offset:40960
    ds_read_b64_tr_b16 v[142:143], v14 offset:41216
    v_mfma_f32_32x32x16_bf16 v[64:79], v[180:183], v[176:179], v[64:79]
    ds_read_b128 v[144:147], v11 offset:32768
    ds_read_b64_tr_b16 v[148:149], v15 offset:40960
    ds_read_b64_tr_b16 v[150:151], v15 offset:41216
    v_mfma_f32_32x32x16_bf16 v[64:79], v[188:191], v[184:187], v[64:79]
    ds_read_b128 v[152:155], v12 offset:32768
    ds_read_b64_tr_b16 v[156:157], v16 offset:40960
    ds_read_b64_tr_b16 v[158:159], v16 offset:41216
    s_waitcnt lgkmcnt(0)
    v_mfma_f32_32x32x16_bf16 v[64:79], v[132:135], v[128:131], v[64:79]
    v_mfma_f32_32x32x16_bf16 v[64:79], v[140:143], v[136:139], v[64:79]
    v_mfma_f32_32x32x16_bf16 v[64:79], v[148:151], v[144:147], v[64:79]
    v_mfma_f32_32x32x16_bf16 v[64:79], v[156:159], v[152:155], v[64:79]
    s_barrier
    ds_read_b128 v[92:95], v27 offset:1024
    v_mul_f32 v82, 0x3e8b97f6, v82
    s_lshl_b32 s68, s55, 11
    s_add_u32 s68, s68, 122880
    v_add_u32 v26, s68, v2
    v_cmp_eq_u32 vcc, 0, v3
    s_waitcnt lgkmcnt(0)
    v_add_f32 v92, v92, v93
    v_add_f32 v94, v94, v95
    v_add_f32 v30, v92, v94
    v_and_b32 v31, 0xffff0000, v30
    v_sub_f32 v30, v30, v31
    v_and_b32 v88, 0xffff0000, v30
    v_sub_f32 v30, v30, v88
    v_lshrrev_b32 v31, 16, v31
    v_or_b32 v88, v88, v31
    v_lshrrev_b32 v89, 16, v30
    s_nop 1
    v_mfma_f32_32x32x16_bf16 v[64:79], v[88:91], v[84:87], v[64:79]
    s_nop 11
    v_mul_f32 v64, v64, v82
    v_mul_f32 v65, v65, v82
    v_mul_f32 v66, v66, v82
    v_mul_f32 v67, v67, v82
    v_mul_f32 v68, v68, v82
    v_mul_f32 v69, v69, v82
    v_mul_f32 v70, v70, v82
    v_mul_f32 v71, v71, v82
    v_mul_f32 v72, v72, v82
    v_mul_f32 v73, v73, v82
    v_mul_f32 v74, v74, v82
    v_mul_f32 v75, v75, v82
    v_mul_f32 v76, v76, v82
    v_mul_f32 v77, v77, v82
    v_mul_f32 v78, v78, v82
    v_mul_f32 v79, v79, v82
    v_cvt_pk_bf16_f32 v64, v64, v65
    v_cvt_pk_bf16_f32 v65, v66, v67
    v_cvt_pk_bf16_f32 v66, v68, v69
    v_cvt_pk_bf16_f32 v67, v70, v71
    v_cvt_pk_bf16_f32 v68, v72, v73
    v_cvt_pk_bf16_f32 v69, v74, v75
    v_cvt_pk_bf16_f32 v70, v76, v77
    v_cvt_pk_bf16_f32 v71, v78, v79
    v_permlane32_swap_b32 v64, v66
    v_permlane32_swap_b32 v65, v67
    v_permlane32_swap_b32 v68, v70
    v_permlane32_swap_b32 v69, v71
    v_cndmask_b32 v70, v70, v237, s[88:89]
    v_cndmask_b32 v71, v71, v237, s[88:89]
    v_cndmask_b32 v64, v64, v237, s[90:91]
    v_cndmask_b32 v65, v65, v237, s[90:91]
    ds_write_b128 v26, v[64:67]
    ds_write_b128 v26, v[68:71] offset:1024
    s_branch L_mk_p2
L_mk_p1v3:
    s_lshl_b32 s68, s93, 5
    v_add_u32 v26, s68, v4
    v_mul_u32_u24 v27, 2341, v26
    v_lshrrev_b32 v27, 16, v27
    v_mul_u32_u24 v28, 28, v27
    v_sub_u32 v26, v26, v28
    v_lshlrev_b32 v27, 18, v27
    v_cmp_eq_u32 vcc, 24, v26
    s_nop 1
    v_cndmask_b32 v120, v237, v17, vcc
    v_cmp_le_u32 vcc, 24, v26
    v_lshl_add_u32 v26, v3, 5, v26
    v_lshl_add_u32 v21, v26, 4, v27
    v_add_u32 v21, 2048, v21
    v_mov_b32 v25, 0x7ffff000
    v_cndmask_b32 v25, v25, v21, vcc
    v_mov_b32 v121, v120
    v_mov_b32 v122, v120
    v_mov_b32 v123, v120
    s_waitcnt vmcnt(4) lgkmcnt(0)
    s_barrier
    ds_read_b128 v[48:51], v9 offset:0
    ds_read_b64_tr_b16 v[52:53], v13 offset:0
    ds_read_b64_tr_b16 v[54:55], v13 offset:512
    ds_read_b128 v[56:59], v10 offset:0
    ds_read_b64_tr_b16 v[60:61], v14 offset:0
    ds_read_b64_tr_b16 v[62:63], v14 offset:512
    ds_read_b128 v[64:67], v11 offset:0
    ds_read_b64_tr_b16 v[68:69], v15 offset:0
    ds_read_b64_tr_b16 v[70:71], v15 offset:512
    ds_read_b128 v[72:75], v12 offset:0
    ds_read_b64_tr_b16 v[76:77], v16 offset:0
    ds_read_b64_tr_b16 v[78:79], v16 offset:512
    s_not_b32 s70, s20
    s_and_b32 s70, s70, 0x80000000
    s_add_u32 s20, s20, 0x100
    s_and_b32 s20, s20, 0x7fffffff
    s_or_b32 s20, s20, s70
    s_and_b32 s82, s20, 0xffffff00
    s_ashr_i32 s86, s20, 31
    s_and_b32 s21, s86, 0x80008000
    s_add_u32 s68, s83, 2
    s_cmp_ge_u32 s68, 7
    s_cselect_b32 s75, 7, 0
    s_sub_u32 s68, s68, s75
    s_lshl_b32 s68, s68, 7
    s_add_u32 m0, s72, 32768
    s_nop 0
    buffer_load_dwordx4 v5, s[8:11], s68 offen lds
    s_add_u32 m0, s72, 33792
    s_nop 0
    buffer_load_dwordx4 v6, s[8:11], s68 offen lds
    s_add_u32 s69, s83, 2
    s_cmp_ge_u32 s69, 7
    s_cselect_b32 s75, 7, 0
    s_sub_u32 s69, s69, s75
    s_mul_i32 s69, s69, 172032
    s_add_u32 m0, s73, 131072
    s_add_u32 s69, s69, s74
    buffer_load_dwordx4 v29, s[12:15], s69 offen lds
    s_add_u32 s68, s83, 3
    s_cmp_ge_u32 s68, 7
    s_cselect_b32 s75, 7, 0
    s_sub_u32 s68, s68, s75
    s_lshl_b32 s68, s68, 7
    s_add_u32 m0, s72, 49152
    s_nop 0
    buffer_load_dwordx4 v5, s[8:11], s68 offen lds
    s_add_u32 m0, s72, 50176
    s_nop 0
    buffer_load_dwordx4 v6, s[8:11], s68 offen lds
    s_add_u32 s69, s83, 3
    s_cmp_ge_u32 s69, 7
    s_cselect_b32 s75, 7, 0
    s_sub_u32 s69, s69, s75
    s_mul_i32 s69, s69, 172032
    s_add_u32 m0, s73, 139264
    s_add_u32 s69, s69, s74
    buffer_load_dwordx4 v29, s[12:15], s69 offen lds
    s_waitcnt vmcnt(7) lgkmcnt(0)
    s_barrier
    v_dot2_f32_bf16 v18, v50, v50, v18
    v_dot2_f32_bf16 v19, v50, v17, v19
    v_dot2_f32_bf16 v18, v51, v51, v18
    v_dot2_f32_bf16 v19, v51, v17, v19
    v_dot2_f32_bf16 v18, v58, v58, v18
    v_dot2_f32_bf16 v19, v58, v17, v19
    v_dot2_f32_bf16 v18, v59, v59, v18
    v_dot2_f32_bf16 v19, v59, v17, v19
    v_dot2_f32_bf16 v18, v66, v66, v18
    v_dot2_f32_bf16 v19, v66, v17, v19
    v_dot2_f32_bf16 v18, v67, v67, v18
    v_dot2_f32_bf16 v19, v67, v17, v19
    v_dot2_f32_bf16 v18, v74, v74, v18
    v_dot2_f32_bf16 v19, v74, v17, v19
    v_dot2_f32_bf16 v18, v75, v75, v18
    v_dot2_f32_bf16 v19, v75, v17, v19
    v_mfma_f32_32x32x16_bf16 v[32:47], v[48:51], v[52:55], 0
    ds_read_b128 v[80:83], v9 offset:16384
    s_add_u32 s68, s83, 4
    ds_read_b64_tr_b16 v[84:85], v13 offset:8192
    s_cmp_ge_u32 s68, 7
    ds_read_b64_tr_b16 v[86:87], v13 offset:8704
    s_cselect_b32 s75, 7, 0
    s_sub_u32 s68, s68, s75
    v_mfma_f32_16x16x32_bf16 v[116:119], v[124:127], v[52:55], 0
    ds_read_b128 v[88:91], v10 offset:16384
    s_lshl_b32 s68, s68, 7
    ds_read_b64_tr_b16 v[92:93], v14 offset:8192
    s_add_u32 m0, s72, 65536
    ds_read_b64_tr_b16 v[94:95], v14 offset:8704
    buffer_load_dwordx4 v5, s[8:11], s68 offen lds
    v_mfma_f32_32x32x16_bf16 v[32:47], v[56:59], v[60:63], v[32:47]
    ds_read_b128 v[96:99], v11 offset:16384
    s_add_u32 m0, s72, 66560
    ds_read_b64_tr_b16 v[100:101], v15 offset:8192
    buffer_load_dwordx4 v6, s[8:11], s68 offen lds
    ds_read_b64_tr_b16 v[102:103], v15 offset:8704
    s_add_u32 s69, s83, 4
    s_cmp_ge_u32 s69, 7
    v_mfma_f32_32x32x16_bf16 v[32:47], v[64:67], v[68:71], v[32:47]
    ds_read_b128 v[104:107], v12 offset:16384
    s_cselect_b32 s75, 7, 0
    ds_read_b64_tr_b16 v[108:109], v16 offset:8192
    s_sub_u32 s69, s69, s75
    ds_read_b64_tr_b16 v[110:111], v16 offset:8704
    s_mul_i32 s69, s69, 172032
    v_mfma_f32_32x32x16_bf16 v[32:47], v[72:75], v[76:79], v[32:47]
    s_add_u32 m0, s73, 114688
    s_add_u32 s69, s69, s74
    buffer_load_dwordx4 v29, s[12:15], s69 offen lds
    s_waitcnt vmcnt(6) lgkmcnt(0)
    s_barrier
    v_dot2_f32_bf16 v18, v82, v82, v18
    v_dot2_f32_bf16 v19, v82, v17, v19
    v_dot2_f32_bf16 v18, v83, v83, v18
    v_dot2_f32_bf16 v19, v83, v17, v19
    v_dot2_f32_bf16 v18, v90, v90, v18
    v_dot2_f32_bf16 v19, v90, v17, v19
    v_dot2_f32_bf16 v18, v91, v91, v18
    v_dot2_f32_bf16 v19, v91, v17, v19
    v_dot2_f32_bf16 v18, v98, v98, v18
    v_dot2_f32_bf16 v19, v98, v17, v19
    v_dot2_f32_bf16 v18, v99, v99, v18
    v_dot2_f32_bf16 v19, v99, v17, v19
    v_dot2_f32_bf16 v18, v106, v106, v18
    v_dot2_f32_bf16 v19, v106, v17, v19
    v_dot2_f32_bf16 v18, v107, v107, v18
    v_dot2_f32_bf16 v19, v107, v17, v19
    v_mfma_f32_32x32x16_bf16 v[32:47], v[80:83], v[84:87], v[32:47]
    ds_read_b128 v[48:51], v9 offset:32768
    s_add_u32 s68, s83, 5
    ds_read_b64_tr_b16 v[52:53], v13 offset:16384
    s_cmp_ge_u32 s68, 7
    ds_read_b64_tr_b16 v[54:55], v13 offset:16896
    s_cselect_b32 s75, 7, 0
    s_sub_u32 s68, s68, s75
    v_mfma_f32_16x16x32_bf16 v[116:119], v[124:127], v[84:87], v[116:119]
    ds_read_b128 v[56:59], v10 offset:32768
    s_lshl_b32 s68, s68, 7
    ds_read_b64_tr_b16 v[60:61], v14 offset:16384
    s_add_u32 m0, s72, 81920
    ds_read_b64_tr_b16 v[62:63], v14 offset:16896
    buffer_load_dwordx4 v5, s[8:11], s68 offen lds
    v_mfma_f32_32x32x16_bf16 v[32:47], v[88:91], v[92:95], v[32:47]
    ds_read_b128 v[64:67], v11 offset:32768
    s_add_u32 m0, s72, 82944
    ds_read_b64_tr_b16 v[68:69], v15 offset:16384
    buffer_load_dwordx4 v6, s[8:11], s68 offen lds
    ds_read_b64_tr_b16 v[70:71], v15 offset:16896
    s_add_u32 s69, s83, 5
    s_cmp_ge_u32 s69, 7
    v_mfma_f32_32x32x16_bf16 v[32:47], v[96:99], v[100:103], v[32:47]
    ds_read_b128 v[72:75], v12 offset:32768
    s_cselect_b32 s75, 7, 0
    ds_read_b64_tr_b16 v[76:77], v16 offset:16384
    s_sub_u32 s69, s69, s75
    ds_read_b64_tr_b16 v[78:79], v16 offset:16896
    s_mul_i32 s69, s69, 172032
    v_mfma_f32_32x32x16_bf16 v[32:47], v[104:107], v[108:111], v[32:47]
    s_add_u32 m0, s73, 122880
    s_add_u32 s69, s69, s74
    buffer_load_dwordx4 v29, s[12:15], s69 offen lds
    s_waitcnt vmcnt(6) lgkmcnt(0)
    s_barrier
    v_dot2_f32_bf16 v18, v50, v50, v18
    v_dot2_f32_bf16 v19, v50, v17, v19
    v_dot2_f32_bf16 v18, v51, v51, v18
    v_dot2_f32_bf16 v19, v51, v17, v19
    v_dot2_f32_bf16 v18, v58, v58, v18
    v_dot2_f32_bf16 v19, v58, v17, v19
    v_dot2_f32_bf16 v18, v59, v59, v18
    v_dot2_f32_bf16 v19, v59, v17, v19
    v_dot2_f32_bf16 v18, v66, v66, v18
    v_dot2_f32_bf16 v19, v66, v17, v19
    v_dot2_f32_bf16 v18, v67, v67, v18
    v_dot2_f32_bf16 v19, v67, v17, v19
    v_dot2_f32_bf16 v18, v74, v74, v18
    v_dot2_f32_bf16 v19, v74, v17, v19
    v_dot2_f32_bf16 v18, v75, v75, v18
    v_dot2_f32_bf16 v19, v75, v17, v19
    v_mfma_f32_32x32x16_bf16 v[32:47], v[48:51], v[52:55], v[32:47]
    ds_read_b128 v[80:83], v9 offset:49152
    s_add_u32 s68, s83, 6
    ds_read_b64_tr_b16 v[84:85], v13 offset:24576
    s_cmp_ge_u32 s68, 7
    ds_read_b64_tr_b16 v[86:87], v13 offset:25088
    s_cselect_b32 s75, 7, 0
    s_sub_u32 s68, s68, s75
    v_mfma_f32_16x16x32_bf16 v[116:119], v[124:127], v[52:55], v[116:119]
    ds_read_b128 v[88:91], v10 offset:49152
    s_lshl_b32 s68, s68, 7
    ds_read_b64_tr_b16 v[92:93], v14 offset:24576
    s_add_u32 m0, s72, 98304
    ds_read_b64_tr_b16 v[94:95], v14 offset:25088
    buffer_load_dwordx4 v5, s[8:11], s68 offen lds
    v_mfma_f32_32x32x16_bf16 v[32:47], v[56:59], v[60:63], v[32:47]
    ds_read_b128 v[96:99], v11 offset:49152
    s_add_u32 m0, s72, 99328
    ds_read_b64_tr_b16 v[100:101], v15 offset:24576
    buffer_load_dwordx4 v6, s[8:11], s68 offen lds
    ds_read_b64_tr_b16 v[102:103], v15 offset:25088
    s_add_u32 s69, s83, 6
    s_cmp_ge_u32 s69, 7
    v_mfma_f32_32x32x16_bf16 v[32:47], v[64:67], v[68:71], v[32:47]
    ds_read_b128 v[104:107], v12 offset:49152
    s_cselect_b32 s75, 7, 0
    ds_read_b64_tr_b16 v[108:109], v16 offset:24576
    s_sub_u32 s69, s69, s75
    ds_read_b64_tr_b16 v[110:111], v16 offset:25088
    s_mul_i32 s69, s69, 172032
    v_mfma_f32_32x32x16_bf16 v[32:47], v[72:75], v[76:79], v[32:47]
    s_add_u32 m0, s73, 131072
    s_add_u32 s69, s69, s74
    buffer_load_dwordx4 v29, s[12:15], s69 offen lds
    s_waitcnt vmcnt(6) lgkmcnt(0)
    s_barrier
    v_dot2_f32_bf16 v18, v82, v82, v18
    v_dot2_f32_bf16 v19, v82, v17, v19
    v_dot2_f32_bf16 v18, v83, v83, v18
    v_dot2_f32_bf16 v19, v83, v17, v19
    v_dot2_f32_bf16 v18, v90, v90, v18
    v_dot2_f32_bf16 v19, v90, v17, v19
    v_dot2_f32_bf16 v18, v91, v91, v18
    v_dot2_f32_bf16 v19, v91, v17, v19
    v_dot2_f32_bf16 v18, v98, v98, v18
    v_dot2_f32_bf16 v19, v98, v17, v19
    v_dot2_f32_bf16 v18, v99, v99, v18
    v_dot2_f32_bf16 v19, v99, v17, v19
    v_dot2_f32_bf16 v18, v106, v106, v18
    v_dot2_f32_bf16 v19, v106, v17, v19
    v_dot2_f32_bf16 v18, v107, v107, v18
    v_dot2_f32_bf16 v19, v107, v17, v19
    v_mfma_f32_32x32x16_bf16 v[32:47], v[80:83], v[84:87], v[32:47]
    v_add_u32 v9, 0x10000, v9
    s_lshl_b32 s68, s54, 10
    v_add_u32 v10, 0x10000, v10
    s_add_u32 s69, s83, s56
    v_add_u32 v11, 0x10000, v11
    s_add_u32 s69, s69, 0
    v_add_u32 v12, 0x10000, v12
    s_cmp_ge_u32 s69, 7
    s_cselect_b32 s70, 7, 0
    s_sub_u32 s69, s69, s70
    v_mfma_f32_16x16x32_bf16 v[116:119], v[124:127], v[84:87], v[116:119]
    ds_read_b128 v[48:51], v9 offset:0
    s_mul_i32 s69, s69, 172032
    ds_read_b64_tr_b16 v[52:53], v13 offset:0
    s_add_u32 m0, s68, 147456
    ds_read_b64_tr_b16 v[54:55], v13 offset:512
    buffer_load_dwordx4 v8, s[12:15], s69 offen lds
    ds_read_b128 v[56:59], v10 offset:0
    s_add_u32 s69, s83, s56
    s_add_u32 s69, s69, 2
    s_cmp_ge_u32 s69, 7
    v_mfma_f32_32x32x16_bf16 v[32:47], v[88:91], v[92:95], v[32:47]
    ds_read_b64_tr_b16 v[60:61], v14 offset:0
    s_cselect_b32 s70, 7, 0
    ds_read_b64_tr_b16 v[62:63], v14 offset:512
    s_sub_u32 s69, s69, s70
    ds_read_b128 v[64:67], v11 offset:0
    s_mul_i32 s69, s69, 172032
    ds_read_b64_tr_b16 v[68:69], v15 offset:0
    s_add_u32 m0, s68, 139264
    s_nop 0
    buffer_load_dwordx4 v8, s[12:15], s69 offen lds
    v_mfma_f32_32x32x16_bf16 v[32:47], v[96:99], v[100:103], v[32:47]
    ds_read_b64_tr_b16 v[70:71], v15 offset:512
    s_add_u32 s69, s83, 6
    ds_read_b128 v[72:75], v12 offset:0
    s_cmp_ge_u32 s69, 7
    ds_read_b64_tr_b16 v[76:77], v16 offset:0
    s_cselect_b32 s70, 7, 0
    ds_read_b64_tr_b16 v[78:79], v16 offset:512
    s_sub_u32 s69, s69, s70
    s_mul_i32 s69, s69, 172032
    s_mul_i32 s70, s56, 21504
    v_mfma_f32_32x32x16_bf16 v[32:47], v[104:107], v[108:111], v[32:47]
    s_add_u32 s69, s69, s70
    s_lshl_b32 s70, s55, 10
    s_lshl_b32 s71, s56, 9
    s_add_u32 s70, s70, s71
    s_add_u32 m0, s70, 155648
    s_mov_b32 exec_hi, 0
    buffer_load_dwordx4 v8, s[12:15], s69 offen lds
    s_mov_b32 exec_hi, -1
    s_waitcnt vmcnt(6) lgkmcnt(0)
    s_barrier
    v_dot2_f32_bf16 v18, v50, v50, v18
    v_dot2_f32_bf16 v19, v50, v17, v19
    v_dot2_f32_bf16 v18, v51, v51, v18
    v_dot2_f32_bf16 v19, v51, v17, v19
    v_dot2_f32_bf16 v18, v58, v58, v18
    v_dot2_f32_bf16 v19, v58, v17, v19
    v_dot2_f32_bf16 v18, v59, v59, v18
    v_dot2_f32_bf16 v19, v59, v17, v19
    v_dot2_f32_bf16 v18, v66, v66, v18
    v_dot2_f32_bf16 v19, v66, v17, v19
    v_dot2_f32_bf16 v18, v67, v67, v18
    v_dot2_f32_bf16 v19, v67, v17, v19
    v_dot2_f32_bf16 v18, v74, v74, v18
    v_dot2_f32_bf16 v19, v74, v17, v19
    v_dot2_f32_bf16 v18, v75, v75, v18
    v_dot2_f32_bf16 v19, v75, v17, v19
    v_mfma_f32_32x32x16_bf16 v[32:47], v[48:51], v[52:55], v[32:47]
    ds_read_b128 v[80:83], v9 offset:16384
    s_mul_i32 s69, s54, 14
    ds_read_b64_tr_b16 v[84:85], v13 offset:8192
    s_and_b32 s70, s59, 3
    ds_read_b64_tr_b16 v[86:87], v13 offset:8704
    s_mul_i32 s70, s70, 112
    s_add_u32 s69, s69, s70
    v_min_u32 v30, 13, v1
    v_add_u32 v30, s69, v30
    v_mfma_f32_16x16x32_bf16 v[116:119], v[124:127], v[52:55], v[116:119]
    ds_read_b128 v[88:91], v10 offset:16384
    v_mul_u32_u24 v30, 896, v30
    ds_read_b64_tr_b16 v[92:93], v14 offset:8192
    s_lshl_b32 s69, s58, 7
    ds_read_b64_tr_b16 v[94:95], v14 offset:8704
    buffer_load_dword v253, v30, s[24:27], s69 offen
    s_lshl_b32 s69, s54, 4
    s_and_b32 s70, s60, 1
    v_mfma_f32_32x32x16_bf16 v[32:47], v[56:59], v[60:63], v[32:47]
    ds_read_b128 v[96:99], v11 offset:16384
    s_lshl_b32 s70, s70, 7
    ds_read_b64_tr_b16 v[100:101], v15 offset:8192
    s_add_u32 s69, s69, s70
    ds_read_b64_tr_b16 v[102:103], v15 offset:8704
    v_min_u32 v31, 15, v1
    v_add_u32 v31, s69, v31
    v_mul_u32_u24 v31, 3584, v31
    s_lshl_b32 s69, s61, 8
    v_mfma_f32_32x32x16_bf16 v[32:47], v[64:67], v[68:71], v[32:47]
    ds_read_b128 v[104:107], v12 offset:16384
    buffer_load_dword v252, v31, s[28:31], s69 offen
    ds_read_b64_tr_b16 v[108:109], v16 offset:8192
    s_lshl_b32 s68, s54, 10
    ds_read_b64_tr_b16 v[110:111], v16 offset:8704
    s_add_u32 s69, s83, s56
    s_add_u32 s69, s69, 4
    s_cmp_ge_u32 s69, 7
    v_mfma_f32_32x32x16_bf16 v[32:47], v[72:75], v[76:79], v[32:47]
    s_cselect_b32 s70, 7, 0
    s_sub_u32 s69, s69, s70
    s_mul_i32 s69, s69, 172032
    s_add_u32 m0, s68, 114688
    s_nop 0
    buffer_load_dwordx4 v8, s[12:15], s69 offen lds
    s_waitcnt vmcnt(6) lgkmcnt(0)
    s_barrier
    s_setprio 1
    v_dot2_f32_bf16 v18, v82, v82, v18
    v_dot2_f32_bf16 v19, v82, v17, v19
    v_dot2_f32_bf16 v18, v83, v83, v18
    v_dot2_f32_bf16 v19, v83, v17, v19
    v_dot2_f32_bf16 v18, v90, v90, v18
    v_dot2_f32_bf16 v19, v90, v17, v19
    v_dot2_f32_bf16 v18, v91, v91, v18
    v_dot2_f32_bf16 v19, v91, v17, v19
    v_dot2_f32_bf16 v18, v98, v98, v18
    v_dot2_f32_bf16 v19, v98, v17, v19
    v_dot2_f32_bf16 v18, v99, v99, v18
    v_dot2_f32_bf16 v19, v99, v17, v19
    v_dot2_f32_bf16 v18, v106, v106, v18
    v_dot2_f32_bf16 v19, v106, v17, v19
    v_dot2_f32_bf16 v18, v107, v107, v18
    v_dot2_f32_bf16 v19, v107, v17, v19
    v_mfma_f32_32x32x16_bf16 v[32:47], v[80:83], v[84:87], v[32:47]
    ds_read_b128 v[48:51], v9 offset:32768
    ds_read_b64_tr_b16 v[52:53], v13 offset:16384
    ds_read_b64_tr_b16 v[54:55], v13 offset:16896
    v_mfma_f32_16x16x32_bf16 v[116:119], v[124:127], v[84:87], v[116:119]
    ds_read_b128 v[56:59], v10 offset:32768
    ds_read_b64_tr_b16 v[60:61], v14 offset:16384
    ds_read_b64_tr_b16 v[62:63], v14 offset:16896
    v_mfma_f32_32x32x16_bf16 v[32:47], v[88:91], v[92:95], v[32:47]
    ds_read_b128 v[64:67], v11 offset:32768
    ds_read_b64_tr_b16 v[68:69], v15 offset:16384
    ds_read_b64_tr_b16 v[70:71], v15 offset:16896
    v_mfma_f32_32x32x16_bf16 v[32:47], v[96:99], v[100:103], v[32:47]
    ds_read_b128 v[72:75], v12 offset:32768
    ds_read_b64_tr_b16 v[76:77], v16 offset:16384
    ds_read_b64_tr_b16 v[78:79], v16 offset:16896
    v_mfma_f32_32x32x16_bf16 v[32:47], v[104:107], v[108:111], v[32:47]
    s_waitcnt lgkmcnt(0)
    v_mfma_f32_16x16x32_bf16 v[116:119], v[124:127], v[52:55], v[116:119]
    v_dot2_f32_bf16 v18, v50, v50, v18
    v_dot2_f32_bf16 v19, v50, v17, v19
    v_dot2_f32_bf16 v18, v51, v51, v18
    v_dot2_f32_bf16 v19, v51, v17, v19
    v_dot2_f32_bf16 v18, v58, v58, v18
    v_dot2_f32_bf16 v19, v58, v17, v19
    v_dot2_f32_bf16 v18, v59, v59, v18
    v_dot2_f32_bf16 v19, v59, v17, v19
    v_dot2_f32_bf16 v18, v66, v66, v18
    v_dot2_f32_bf16 v19, v66, v17, v19
    v_dot2_f32_bf16 v18, v67, v67, v18
    v_dot2_f32_bf16 v19, v67, v17, v19
    v_dot2_f32_bf16 v18, v74, v74, v18
    v_dot2_f32_bf16 v19, v74, v17, v19
    v_dot2_f32_bf16 v18, v75, v75, v18
    v_dot2_f32_bf16 v19, v75, v17, v19
    s_lshl_b32 s68, s55, 10
    s_add_u32 s68, s68, 122880
    v_lshl_add_u32 v26, v4, 5, s68
    v_lshl_add_u32 v28, v3, 2, v26
    v_lshlrev_b32 v27, 4, v4
    v_add_u32 v27, 159744, v27
    s_lshl_b32 s68, s55, 2
    v_add_u32 v20, s68, v27
    ds_write_b32 v28, v18 offset:8
    ds_write_b32 v28, v19 offset:24
    s_mov_b64 exec, 0xffff
    ds_write_b32 v20, v116 offset:512
    ds_write_b32 v20, v117 offset:768
    s_mov_b64 exec, -1
    v_mov_b32 v86, 0
    v_mov_b32 v87, 0
    v_mov_b32 v90, 0
    v_mov_b32 v91, 0
    v_cmp_eq_u32 vcc, 0, v3
    s_lshl_b32 s69, s57, 12
    s_add_u32 s69, s69, 65536
    s_waitcnt lgkmcnt(0)
    s_barrier
    ds_read_b128 v[92:95], v26
    ds_read_b128 v[100:103], v26 offset:16
    ds_read_b128 v[96:99], v27 offset:512
    v_mfma_f32_32x32x16_bf16 v[32:47], v[48:51], v[52:55], v[32:47]
    s_waitcnt lgkmcnt(1)
    v_add_f32 v92, v92, v93
    v_add_f32 v100, v100, v101
    v_add_f32 v94, v94, v95
    v_add_f32 v102, v102, v103
    v_add_f32 v29, v92, v94
    v_add_f32 v28, v100, v102
    s_waitcnt lgkmcnt(0)
    v_add_f32 v96, v96, v97
    v_add_f32 v98, v98, v99
    v_add_f32 v30, v96, v98
    v_and_b32 v31, 0xffff0000, v30
    v_mfma_f32_32x32x16_bf16 v[32:47], v[56:59], v[60:63], v[32:47]
    v_sub_f32 v30, v30, v31
    v_and_b32 v88, 0xffff0000, v30
    v_sub_f32 v30, v30, v88
    v_lshrrev_b32 v31, 16, v31
    v_or_b32 v88, v88, v31
    v_lshrrev_b32 v89, 16, v30
    v_mul_f32 v80, 0x3b124925, v28
    v_mul_f32 v83, 0x3b124925, v29
    v_fma_f32 v83, -v80, v80, v83
    v_max_f32 v83, 0, v83
    v_cvt_pk_bf16_f32 v83, v83, v80
    v_and_b32 v80, 0xffff0000, v83
    v_mfma_f32_32x32x16_bf16 v[32:47], v[64:67], v[68:71], v[32:47]
    v_lshlrev_b32 v83, 16, v83
    v_add_f32 v83, 0x3727c5ac, v83
    v_cvt_pk_bf16_f32 v83, v83, v83
    v_lshlrev_b32 v83, 16, v83
    v_sqrt_f32 v83, v83
    s_nop 0
    v_cvt_pk_bf16_f32 v83, v83, v83
    v_lshlrev_b32 v81, 16, v83
    v_rcp_f32 v82, v81
    s_lshl_b32 s68, s55, 7
    s_add_u32 s68, s68, 161280
    v_lshl_add_u32 v26, v4, 2, s68
    ds_write_b32 v26, v82
    v_mfma_f32_32x32x16_bf16 v[32:47], v[72:75], v[76:79], v[32:47]
    v_lshl_add_u32 v26, v3, 4, s68
    v_xor_b32 v80, 0x80000000, v80
    v_lshrrev_b32 v85, 16, v80
    v_or_b32 v84, v80, v85
    v_cndmask_b32 v84, v237, v84, vcc
    v_cndmask_b32 v85, v237, v85, vcc
    s_waitcnt lgkmcnt(0)
    ds_read_b128 v[96:99], v26 offset:0
    ds_read_b128 v[100:103], v26 offset:32
    ds_read_b128 v[104:107], v26 offset:64
    ds_read_b128 v[108:111], v26 offset:96
    v_mfma_f32_32x32x16_bf16 v[32:47], v[84:87], v[88:91], v[32:47]
    s_waitcnt lgkmcnt(0)
    s_nop 10
    v_mul_f32 v32, v32, v96
    v_mul_f32 v33, v33, v97
    v_mul_f32 v34, v34, v98
    v_mul_f32 v35, v35, v99
    v_mul_f32 v36, v36, v100
    v_mul_f32 v37, v37, v101
    v_mul_f32 v38, v38, v102
    v_mul_f32 v39, v39, v103
    v_mul_f32 v40, v40, v104
    v_mul_f32 v41, v41, v105
    v_mul_f32 v42, v42, v106
    v_mul_f32 v43, v43, v107
    v_mul_f32 v44, v44, v108
    v_mul_f32 v45, v45, v109
    v_mul_f32 v46, v46, v110
    v_mul_f32 v47, v47, v111
    v_cvt_pk_bf16_f32 v32, v32, v33
    v_cvt_pk_bf16_f32 v33, v34, v35
    v_cvt_pk_bf16_f32 v34, v36, v37
    v_cvt_pk_bf16_f32 v35, v38, v39
    v_cvt_pk_bf16_f32 v36, v40, v41
    v_cvt_pk_bf16_f32 v37, v42, v43
    v_cvt_pk_bf16_f32 v38, v44, v45
    v_cvt_pk_bf16_f32 v39, v46, v47
    s_cmp_ge_u32 s53, 14
    s_cbranch_scc1 L_mk_nokv_9
    buffer_store_dwordx4 v[32:35], v21, s[16:19], s69 offen sc1
    buffer_store_dwordx4 v[36:39], v21, s[16:19], s69 offen offset:1024 sc1
    buffer_store_dwordx4 v[120:123], v25, s[16:19], s69 offen offset:64 sc1
    buffer_store_dwordx4 v[120:123], v25, s[16:19], s69 offen offset:1088 sc1
L_mk_nokv_9:
    s_setprio 0
    s_waitcnt vmcnt(4)
    s_cmp_lt_u32 s53, 14
    s_cbranch_scc1 L_mk_nokv_9b
    s_waitcnt vmcnt(0)
L_mk_nokv_9b:
    s_barrier
    s_add_u32 s68, s55, 0
    s_and_b32 s68, s68, 3
    s_lshl_b32 s68, s68, 10
    v_add_u32 v13, s68, v190
    ds_read_b64_tr_b16 v[128:129], v13 offset:32768
    ds_read_b64_tr_b16 v[130:131], v13 offset:33024
    ds_read_b64_tr_b16 v[132:133], v13 offset:36864
    ds_read_b64_tr_b16 v[134:135], v13 offset:37120
    ds_read_b64_tr_b16 v[136:137], v13 offset:24576
    ds_read_b64_tr_b16 v[138:139], v13 offset:24832
    ds_read_b64_tr_b16 v[140:141], v13 offset:28672
    ds_read_b64_tr_b16 v[142:143], v13 offset:28928
    ds_read_b64_tr_b16 v[144:145], v13 offset:0
    ds_read_b64_tr_b16 v[146:147], v13 offset:256
    ds_read_b64_tr_b16 v[148:149], v13 offset:4096
    ds_read_b64_tr_b16 v[150:151], v13 offset:4352
    ds_read_b64_tr_b16 v[152:153], v13 offset:40960
    ds_read_b64_tr_b16 v[154:155], v13 offset:41216
    s_waitcnt lgkmcnt(0)
    v_mfma_f32_16x16x32_bf16 v[116:119], v[124:127], v[128:131], 0
    v_mfma_f32_16x16x32_bf16 v[116:119], v[124:127], v[132:135], v[116:119]
    v_mfma_f32_16x16x32_bf16 v[116:119], v[124:127], v[136:139], v[116:119]
    v_mfma_f32_16x16x32_bf16 v[116:119], v[124:127], v[140:143], v[116:119]
    v_mfma_f32_16x16x32_bf16 v[116:119], v[124:127], v[144:147], v[116:119]
    v_mfma_f32_16x16x32_bf16 v[116:119], v[124:127], v[148:151], v[116:119]
    v_mfma_f32_16x16x32_bf16 v[116:119], v[124:127], v[152:155], v[116:119]
    s_mov_b64 exec, 0xffff
    s_nop 6
    ds_write_b32 v20, v116 offset:1024
    ds_write_b32 v20, v117 offset:1280
    s_mov_b64 exec, -1
    v_and_b32 v60, 15, v1
    s_lshr_b32 s75, s2, 7
    s_lshl_b32 s75, s75, 4
    v_add_u32 v61, s75, v60
    v_lshrrev_b32 v62, 2, v61
    s_and_b32 s75, s2, 1
    s_lshl_b32 s75, s75, 3
    v_add_u32 v62, s75, v62
    v_and_b32 v61, 3, v61
    s_and_b32 s75, s2, 6
    s_lshl_b32 s75, s75, 1
    v_add_u32 v61, s75, v61
    v_lshl_add_u32 v61, v62, 4, v61
    s_lshl_b32 s75, s60, 4
    v_add_u32 v60, s75, v60
    v_cmp_eq_u32 vcc, 0, v3
    s_mul_i32 s75, s53, 7
    s_lshr_b32 s75, s75, 3
    s_lshl_b32 s76, s54, 4
    v_and_b32 v62, 1, v1
    v_add_u32 v62, s75, v62
    v_lshrrev_b32 v62, 1, v62
    v_bfe_u32 v63, v1, 1, 1
    v_mad_u32_u24 v62, v63, 7, v62
    v_and_b32 v63, 4, v1
    v_lshl_add_u32 v62, v63, 5, v62
    v_add_u32 v62, s76, v62
    v_cndmask_b32 v60, v61, v60, vcc
    v_cndmask_b32 v62, v61, v62, vcc
    v_lshlrev_b32 v239, 7, v60
    v_lshlrev_b32 v238, 7, v62
    s_mov_b32 s77, 18939904
    buffer_load_dword v6, v238, s[16:19], s77 offen sc1
    s_mul_i32 s62, s60, 655360
    s_add_u32 s62, s62, 6356992
    v_lshrrev_b32 v60, 2, v1
    v_and_b32 v62, 3, v1
    v_lshlrev_b32 v62, 4, v62
    v_mul_u32_u24 v61, 896, v60
    v_add_u32 v61, v61, v62
    s_lshl_b32 s76, s58, 7
    v_add_u32 v235, s76, v61
    s_mul_i32 s75, s54, 14336
    v_add_u32 v63, s75, v235
    v_mul_u32_u24 v61, 3584, v60
    v_add_u32 v61, v61, v62
    s_mul_i32 s75, s55, 57344
    s_lshl_b32 s76, s61, 8
    s_add_u32 s75, s75, s76
    v_add_u32 v234, s75, v61
    s_lshl_b32 s76, s60, 1
    s_add_u32 s76, s76, s61
    s_sub_u32 s76, s76, 14
    s_min_u32 s76, s76, 27
    s_lshl_b32 s76, s76, 7
    s_mul_i32 s75, s54, 57344
    s_add_u32 s76, s76, s75
    v_add_u32 v61, s76, v61
    s_cmp_lt_u32 s61, 14
    s_cselect_b64 vcc, -1, 0
    s_mov_b32 s7, 458752
    s_cselect_b32 s7, 114688, s7
    s_cselect_b32 s48, s24, s28
    s_cselect_b32 s49, s25, s29
    s_mov_b32 s50, 1605632
    s_cselect_b32 s50, 401408, s50
    s_mov_b32 s51, 0x20000
    v_cndmask_b32 v233, v61, v63, vcc
    v_bfe_u32 v60, v1, 2, 2
    v_lshl_add_u32 v60, v3, 2, v60
    v_bfe_u32 v61, v1, 4, 1
    v_lshlrev_b32 v61, 5, v61
    v_and_b32 v62, 3, v1
    v_lshl_add_u32 v61, v62, 3, v61
    v_lshl_add_u32 v232, v60, 6, v61
    s_lshr_b32 s75, s54, 1
    s_lshl_b32 s76, s52, 2
    s_add_u32 s75, s75, s76
    s_lshl_b32 s75, s75, 4
    s_add_u32 s75, s75, s53
    s_lshl_b32 s75, s75, 1
    s_and_b32 s76, s54, 1
    s_add_u32 s75, s75, s76
    s_lshl_b32 s75, s75, 10
    s_add_u32 s63, s75, 4259840
    s_waitcnt vmcnt(1) lgkmcnt(0)
    v_mov_b32 v26, 161792
    v_mov_b32 v28, 1
    s_mov_b64 exec, 1
    ds_add_rtn_u32 v28, v26, v28 offset:4
    s_waitcnt lgkmcnt(0)
    v_readfirstlane_b32 s68, v28
    s_mov_b64 exec, -1
    s_cmp_lg_u32 s68, 7
    s_cbranch_scc1 L_mk_f1_10
    s_mov_b64 exec, 1
    s_or_b32 s77, s67, 1
    s_or_b32 s77, s77, s82
    v_mov_b32 v26, s77
    s_lshl_b32 s77, s52, 4
    s_add_u32 s77, s77, s53
    s_lshl_b32 s77, s77, 7
    s_add_u32 s77, s77, 18939904
    buffer_store_dword v26, v237, s[16:19], s77 offen sc1
    s_mov_b64 exec, -1
L_mk_f1_10:
    s_barrier
L_mk_p2:
    s_waitcnt lgkmcnt(0)
    s_barrier
    s_xor_b32 s68, s56, 1
    s_lshl_b32 s68, s68, 12
    v_add_u32 v5, 122880, v2
    v_add_u32 v7, s68, v5
    v_subrev_u32 v5, s68, v5
    ds_read_b128 v[16:19], v7 offset:0
    ds_read_b128 v[20:23], v7 offset:1024
    ds_read_b128 v[24:27], v7 offset:2048
    ds_read_b128 v[28:31], v7 offset:3072
    ds_read_b128 v[32:35], v5 offset:4096
    ds_read_b128 v[36:39], v5 offset:5120
    ds_read_b128 v[40:43], v5 offset:6144
    ds_read_b128 v[44:47], v5 offset:7168
    v_mov_b32 v224, -1
    v_mov_b32 v225, -1
    v_mov_b32 v226, -1
    v_mov_b32 v227, -1
    s_mov_b32 s66, 0
    s_mov_b32 s92, 0
    s_lshl_b32 s71, s54, 10
    s_lshl_b32 s72, s55, 10
    s_mov_b32 s73, 0
    s_lshl_b32 s74, s61, 3
    s_add_u32 s74, s74, s54
    s_lshl_b32 s74, s74, 10
    s_add_u32 s74, s74, s62
    s_mul_i32 s68, s54, 28
    v_add_u32 v9, s68, v1
    v_mul_u32_u24 v8, 3584, v9
    s_lshl_b32 s68, s61, 1
    s_and_b32 s69, s60, 1
    s_add_u32 s68, s68, s69
    s_lshl_b32 s68, s68, 7
    v_add_u32 v8, s68, v8
    s_and_b32 s68, s59, 3
    s_mul_i32 s68, s68, 448
    v_add_u32 v9, s68, v9
    v_mul_u32_u24 v9, 896, v9
    s_lshl_b32 s68, s58, 7
    v_add_u32 v9, s68, v9
    v_cmp_gt_u32 vcc, 28, v1
    v_mov_b32 v5, 0x7ff00000
    s_nop 0
    v_cndmask_b32 v8, v5, v8, vcc
    v_cndmask_b32 v9, v5, v9, vcc
    s_waitcnt lgkmcnt(0)
    s_barrier
    s_waitcnt vmcnt(0)
    s_mov_b32 s78, 0
    s_or_b32 s77, s82, 0
    s_mov_b32 s76, 18939904
    s_branch L_mk_f0_13
L_mk_fc_11:
    buffer_load_dword v6, v238, s[16:19], s76 offen sc1
    s_waitcnt vmcnt(0)
L_mk_f0_13:
    v_and_b32 v5, 0xffffff00, v6
    v_cmp_ne_u32 vcc, s77, v5
    s_nop 0
    s_cmp_eq_u32 vcc_hi, 0
    s_cbranch_scc1 L_mk_fx_12
    s_add_u32 s78, s78, 1
    s_sleep 2
    s_cmp_le_u32 s78, 20000
    s_cbranch_scc1 L_mk_fc_11
L_mk_fx_12:
    v_and_b32 v6, 0xf0, v6
    v_cmp_ne_u32 vcc, s67, v6
    s_nop 0
    s_cmp_eq_u32 vcc_hi, 0
    s_cselect_b32 s64, 1, 0
    s_mov_b64 exec, 0xff
    s_mov_b32 s78, 0
    s_or_b32 s77, s82, 1
    s_mov_b32 s76, 18939904
L_mk_fc_14:
    buffer_load_dword v6, v238, s[16:19], s76 offen sc1
    s_waitcnt vmcnt(0)
L_mk_f0_16:
    v_and_b32 v5, 0xffffff01, v6
    v_cmp_ne_u32 vcc, s77, v5
    s_nop 0
    s_cmp_eq_u32 vcc_lo, 0
    s_cbranch_scc1 L_mk_fx_15
    s_add_u32 s78, s78, 1
    s_sleep 1
    s_cmp_le_u32 s78, 20000
    s_cbranch_scc1 L_mk_fc_14
L_mk_fx_15:
    s_mov_b64 exec, -1
    s_add_u32 s70, s65, 0
    buffer_load_dwordx4 v[160:163], v2, s[16:19], s70 offen offset:0 sc1
    buffer_load_dwordx4 v[164:167], v2, s[16:19], s70 offen offset:1024 sc1
    buffer_load_dwordx4 v[168:171], v2, s[16:19], s70 offen offset:2048 sc1
    buffer_load_dwordx4 v[172:175], v2, s[16:19], s70 offen offset:3072 sc1
    s_add_u32 s70, s65, 4096
    buffer_load_dwordx4 v[176:179], v2, s[16:19], s70 offen offset:0 sc1
    buffer_load_dwordx4 v[180:183], v2, s[16:19], s70 offen offset:1024 sc1
    buffer_load_dwordx4 v[184:187], v2, s[16:19], s70 offen offset:2048 sc1
    buffer_load_dwordx4 v[188:191], v2, s[16:19], s70 offen offset:3072 sc1
    s_cmp_eq_u32 s64, 0
    s_cbranch_scc1 L_mk_clrs
    buffer_store_dwordx4 v[224:227], v2, s[16:19], s63 offen sc1
    buffer_store_dwordx4 v[224:227], v2, s[16:19], s74 offen
L_mk_clre:
    s_waitcnt vmcnt(6)
    s_branch L_mk_amain2
L_mk_amain:
    s_waitcnt vmcnt(0)
L_mk_amain2:
    s_cmp_lg_u32 s66, 0
    s_cbranch_scc1 L_mk_kf_17
L_mk_kf_17b:
    s_setprio 3
    v_mfma_f32_32x32x16_bf16 v[112:127], v[160:163], v[16:19], 0
    v_mfma_f32_32x32x16_bf16 v[112:127], v[164:167], v[20:23], v[112:127]
    s_add_u32 s70, s65, 8192
    buffer_load_dwordx4 v[192:195], v2, s[16:19], s70 offen offset:0 sc1
    buffer_load_dwordx4 v[196:199], v2, s[16:19], s70 offen offset:1024 sc1
    buffer_load_dwordx4 v[200:203], v2, s[16:19], s70 offen offset:2048 sc1
    buffer_load_dwordx4 v[204:207], v2, s[16:19], s70 offen offset:3072 sc1
    v_mfma_f32_32x32x16_bf16 v[128:143], v[160:163], v[24:27], 0
    s_nop 5
    v_exp_f32 v112, v112
    v_exp_f32 v113, v113
    v_exp_f32 v114, v114
    v_exp_f32 v115, v115
    v_cvt_pk_bf16_f32 v144, v112, v113
    v_mfma_f32_32x32x16_bf16 v[128:143], v[164:167], v[28:31], v[128:143]
    v_exp_f32 v116, v116
    v_exp_f32 v117, v117
    v_exp_f32 v118, v118
    v_exp_f32 v119, v119
    v_cvt_pk_bf16_f32 v145, v114, v115
    v_cvt_pk_bf16_f32 v146, v116, v117
    v_exp_f32 v120, v120
    v_exp_f32 v121, v121
    v_exp_f32 v122, v122
    v_exp_f32 v123, v123
    v_cvt_pk_bf16_f32 v147, v118, v119
    v_cvt_pk_bf16_f32 v148, v120, v121
    v_exp_f32 v124, v124
    v_exp_f32 v125, v125
    v_exp_f32 v126, v126
    v_exp_f32 v127, v127
    v_cvt_pk_bf16_f32 v149, v122, v123
    v_cvt_pk_bf16_f32 v150, v124, v125
    v_cvt_pk_bf16_f32 v151, v126, v127
    s_add_u32 s70, s65, 12288
    buffer_load_dwordx4 v[208:211], v2, s[16:19], s70 offen offset:0 sc1
    buffer_load_dwordx4 v[212:215], v2, s[16:19], s70 offen offset:1024 sc1
    buffer_load_dwordx4 v[216:219], v2, s[16:19], s70 offen offset:2048 sc1
    buffer_load_dwordx4 v[220:223], v2, s[16:19], s70 offen offset:3072 sc1
    v_mfma_f32_32x32x16_bf16 v[112:127], v[160:163], v[32:35], 0
    v_exp_f32 v128, v128
    v_exp_f32 v129, v129
    v_exp_f32 v130, v130
    v_exp_f32 v131, v131
    v_cvt_pk_bf16_f32 v152, v128, v129
    v_mfma_f32_32x32x16_bf16 v[48:63], v[168:171], v[144:147], 0
    v_exp_f32 v132, v132
    v_exp_f32 v133, v133
    v_exp_f32 v134, v134
    v_exp_f32 v135, v135
    v_cvt_pk_bf16_f32 v153, v130, v131
    v_cvt_pk_bf16_f32 v154, v132, v133
    v_mfma_f32_32x32x16_bf16 v[112:127], v[164:167], v[36:39], v[112:127]
    v_exp_f32 v136, v136
    v_exp_f32 v137, v137
    v_exp_f32 v138, v138
    v_exp_f32 v139, v139
    v_cvt_pk_bf16_f32 v155, v134, v135
    v_cvt_pk_bf16_f32 v156, v136, v137
    v_mfma_f32_32x32x16_bf16 v[48:63], v[172:175], v[148:151], v[48:63]
    v_exp_f32 v140, v140
    v_exp_f32 v141, v141
    v_exp_f32 v142, v142
    v_exp_f32 v143, v143
    v_cvt_pk_bf16_f32 v157, v138, v139
    v_cvt_pk_bf16_f32 v158, v140, v141
    v_cvt_pk_bf16_f32 v159, v142, v143
    v_mfma_f32_32x32x16_bf16 v[128:143], v[160:163], v[40:43], 0
    v_exp_f32 v112, v112
    v_exp_f32 v113, v113
    v_exp_f32 v114, v114
    v_exp_f32 v115, v115
    v_cvt_pk_bf16_f32 v144, v112, v113
    v_mfma_f32_32x32x16_bf16 v[64:79], v[168:171], v[152:155], 0
    v_exp_f32 v116, v116
    v_exp_f32 v117, v117
    v_exp_f32 v118, v118
    v_exp_f32 v119, v119
    v_cvt_pk_bf16_f32 v145, v114, v115
    v_cvt_pk_bf16_f32 v146, v116, v117
    v_mfma_f32_32x32x16_bf16 v[128:143], v[164:167], v[44:47], v[128:143]
    v_exp_f32 v120, v120
    v_exp_f32 v121, v121
    v_exp_f32 v122, v122
    v_exp_f32 v123, v123
    v_cvt_pk_bf16_f32 v147, v118, v119
    v_cvt_pk_bf16_f32 v148, v120, v121
    v_mfma_f32_32x32x16_bf16 v[64:79], v[172:175], v[156:159], v[64:79]
    v_exp_f32 v124, v124
    v_exp_f32 v125, v125
    v_exp_f32 v126, v126
    v_exp_f32 v127, v127
    v_cvt_pk_bf16_f32 v149, v122, v123
    v_cvt_pk_bf16_f32 v150, v124, v125
    v_cvt_pk_bf16_f32 v151, v126, v127
    s_waitcnt vmcnt(10)
    s_cmp_lg_u32 s66, 0
    s_cbranch_scc1 L_mk_kf_20
L_mk_kf_20b:
    s_nop 0
    v_mfma_f32_32x32x16_bf16 v[112:127], v[176:179], v[16:19], 0
    v_exp_f32 v128, v128
    v_exp_f32 v129, v129
    v_exp_f32 v130, v130
    v_exp_f32 v131, v131
    v_cvt_pk_bf16_f32 v152, v128, v129
    v_mfma_f32_32x32x16_bf16 v[80:95], v[168:171], v[144:147], 0
    v_exp_f32 v132, v132
    v_exp_f32 v133, v133
    v_exp_f32 v134, v134
    v_exp_f32 v135, v135
    v_cvt_pk_bf16_f32 v153, v130, v131
    v_cvt_pk_bf16_f32 v154, v132, v133
    v_mfma_f32_32x32x16_bf16 v[112:127], v[180:183], v[20:23], v[112:127]
    v_exp_f32 v136, v136
    v_exp_f32 v137, v137
    v_exp_f32 v138, v138
    v_exp_f32 v139, v139
    v_cvt_pk_bf16_f32 v155, v134, v135
    v_cvt_pk_bf16_f32 v156, v136, v137
    v_mfma_f32_32x32x16_bf16 v[80:95], v[172:175], v[148:151], v[80:95]
    v_exp_f32 v140, v140
    v_exp_f32 v141, v141
    v_exp_f32 v142, v142
    v_exp_f32 v143, v143
    v_cvt_pk_bf16_f32 v157, v138, v139
    v_cvt_pk_bf16_f32 v158, v140, v141
    v_cvt_pk_bf16_f32 v159, v142, v143
    v_mfma_f32_32x32x16_bf16 v[128:143], v[176:179], v[24:27], 0
    v_exp_f32 v112, v112
    v_exp_f32 v113, v113
    v_exp_f32 v114, v114
    v_exp_f32 v115, v115
    v_cvt_pk_bf16_f32 v144, v112, v113
    v_mfma_f32_32x32x16_bf16 v[96:111], v[168:171], v[152:155], 0
    v_exp_f32 v116, v116
    v_exp_f32 v117, v117
    v_exp_f32 v118, v118
    v_exp_f32 v119, v119
    v_cvt_pk_bf16_f32 v145, v114, v115
    v_cvt_pk_bf16_f32 v146, v116, v117
    v_mfma_f32_32x32x16_bf16 v[128:143], v[180:183], v[28:31], v[128:143]
    v_exp_f32 v120, v120
    v_exp_f32 v121, v121
    v_exp_f32 v122, v122
    v_exp_f32 v123, v123
    v_cvt_pk_bf16_f32 v147, v118, v119
    v_cvt_pk_bf16_f32 v148, v120, v121
    v_mfma_f32_32x32x16_bf16 v[96:111], v[172:175], v[156:159], v[96:111]
    v_exp_f32 v124, v124
    v_exp_f32 v125, v125
    v_exp_f32 v126, v126
    v_exp_f32 v127, v127
    v_cvt_pk_bf16_f32 v149, v122, v123
    v_cvt_pk_bf16_f32 v150, v124, v125
    v_cvt_pk_bf16_f32 v151, v126, v127
    s_add_u32 s70, s65, 131072
    buffer_load_dwordx4 v[160:163], v2, s[16:19], s70 offen offset:0 sc1
    buffer_load_dwordx4 v[164:167], v2, s[16:19], s70 offen offset:1024 sc1
    buffer_load_dwordx4 v[168:171], v2, s[16:19], s70 offen offset:2048 sc1
    buffer_load_dwordx4 v[172:175], v2, s[16:19], s70 offen offset:3072 sc1
    v_mfma_f32_32x32x16_bf16 v[112:127], v[176:179], v[32:35], 0
    v_exp_f32 v128, v128
    v_exp_f32 v129, v129
    v_exp_f32 v130, v130
    v_exp_f32 v131, v131
    v_cvt_pk_bf16_f32 v152, v128, v129
    v_mfma_f32_32x32x16_bf16 v[48:63], v[184:187], v[144:147], v[48:63]
    v_exp_f32 v132, v132
    v_exp_f32 v133, v133
    v_exp_f32 v134, v134
    v_exp_f32 v135, v135
    v_cvt_pk_bf16_f32 v153, v130, v131
    v_cvt_pk_bf16_f32 v154, v132, v133
    v_mfma_f32_32x32x16_bf16 v[112:127], v[180:183], v[36:39], v[112:127]
    v_exp_f32 v136, v136
    v_exp_f32 v137, v137
    v_exp_f32 v138, v138
    v_exp_f32 v139, v139
    v_cvt_pk_bf16_f32 v155, v134, v135
    v_cvt_pk_bf16_f32 v156, v136, v137
    v_mfma_f32_32x32x16_bf16 v[48:63], v[188:191], v[148:151], v[48:63]
    v_exp_f32 v140, v140
    v_exp_f32 v141, v141
    v_exp_f32 v142, v142
    v_exp_f32 v143, v143
    v_cvt_pk_bf16_f32 v157, v138, v139
    v_cvt_pk_bf16_f32 v158, v140, v141
    v_cvt_pk_bf16_f32 v159, v142, v143
    s_cmp_lg_u32 s66, 0
    s_cbranch_scc1 L_mk_exs_22
    s_add_u32 m0, s71, 98304
    s_nop 0
    buffer_load_dwordx4 v233, s[48:51], s73 offen lds
    s_add_u32 m0, s71, 126912
    s_nop 0
    buffer_load_dwordx4 v233, s[48:51], s73 offen offset:64 lds
    s_add_u32 s73, s73, s7
L_mk_ex_21:
    s_mov_b32 s68, 0
    buffer_load_dword v253, v8, s[28:31], s68 offen
    v_mfma_f32_32x32x16_bf16 v[128:143], v[176:179], v[40:43], 0
    v_exp_f32 v112, v112
    v_exp_f32 v113, v113
    v_exp_f32 v114, v114
    v_exp_f32 v115, v115
    v_cvt_pk_bf16_f32 v144, v112, v113
    v_mfma_f32_32x32x16_bf16 v[64:79], v[184:187], v[152:155], v[64:79]
    v_exp_f32 v116, v116
    v_exp_f32 v117, v117
    v_exp_f32 v118, v118
    v_exp_f32 v119, v119
    v_cvt_pk_bf16_f32 v145, v114, v115
    v_cvt_pk_bf16_f32 v146, v116, v117
    v_mfma_f32_32x32x16_bf16 v[128:143], v[180:183], v[44:47], v[128:143]
    v_exp_f32 v120, v120
    v_exp_f32 v121, v121
    v_exp_f32 v122, v122
    v_exp_f32 v123, v123
    v_cvt_pk_bf16_f32 v147, v118, v119
    v_cvt_pk_bf16_f32 v148, v120, v121
    v_mfma_f32_32x32x16_bf16 v[64:79], v[188:191], v[156:159], v[64:79]
    v_exp_f32 v124, v124
    v_exp_f32 v125, v125
    v_exp_f32 v126, v126
    v_exp_f32 v127, v127
    v_cvt_pk_bf16_f32 v149, v122, v123
    v_cvt_pk_bf16_f32 v150, v124, v125
    v_cvt_pk_bf16_f32 v151, v126, v127
    s_waitcnt vmcnt(11)
    s_cmp_lg_u32 s66, 0
    s_cbranch_scc1 L_mk_kf_23
L_mk_kf_23b:
    s_cmp_lg_u32 s66, 0
    s_cbranch_scc1 L_mk_f2p_24
    v_mov_b32 v5, 161792
    v_mov_b32 v7, 1
    s_mov_b64 exec, 1
    ds_add_rtn_u32 v7, v5, v7
    s_waitcnt lgkmcnt(0)
    v_readfirstlane_b32 s68, v7
    s_mov_b64 exec, -1
    s_cmp_lg_u32 s68, 7
    s_cbranch_scc1 L_mk_f2_25
    s_mov_b64 exec, 1
    s_or_b32 s77, s67, 3
    s_or_b32 s77, s77, s82
    v_mov_b32 v5, s77
    s_lshl_b32 s77, s52, 4
    s_add_u32 s77, s77, s53
    s_lshl_b32 s77, s77, 7
    s_add_u32 s77, s77, 18939904
    buffer_store_dword v5, v237, s[16:19], s77 offen sc1
    s_mov_b64 exec, -1
L_mk_f2_25:
L_mk_f2p_24:
    v_mfma_f32_32x32x16_bf16 v[112:127], v[192:195], v[16:19], 0
    v_exp_f32 v128, v128
    v_exp_f32 v129, v129
    v_exp_f32 v130, v130
    v_exp_f32 v131, v131
    v_cvt_pk_bf16_f32 v152, v128, v129
    v_mfma_f32_32x32x16_bf16 v[80:95], v[184:187], v[144:147], v[80:95]
    v_exp_f32 v132, v132
    v_exp_f32 v133, v133
    v_exp_f32 v134, v134
    v_exp_f32 v135, v135
    v_cvt_pk_bf16_f32 v153, v130, v131
    v_cvt_pk_bf16_f32 v154, v132, v133
    v_mfma_f32_32x32x16_bf16 v[112:127], v[196:199], v[20:23], v[112:127]
    v_exp_f32 v136, v136
    v_exp_f32 v137, v137
    v_exp_f32 v138, v138
    v_exp_f32 v139, v139
    v_cvt_pk_bf16_f32 v155, v134, v135
    v_cvt_pk_bf16_f32 v156, v136, v137
    v_mfma_f32_32x32x16_bf16 v[80:95], v[188:191], v[148:151], v[80:95]
    v_exp_f32 v140, v140
    v_exp_f32 v141, v141
    v_exp_f32 v142, v142
    v_exp_f32 v143, v143
    v_cvt_pk_bf16_f32 v157, v138, v139
    v_cvt_pk_bf16_f32 v158, v140, v141
    v_cvt_pk_bf16_f32 v159, v142, v143
    v_mfma_f32_32x32x16_bf16 v[128:143], v[192:195], v[24:27], 0
    v_exp_f32 v112, v112
    v_exp_f32 v113, v113
    v_exp_f32 v114, v114
    v_exp_f32 v115, v115
    v_cvt_pk_bf16_f32 v144, v112, v113
    v_mfma_f32_32x32x16_bf16 v[96:111], v[184:187], v[152:155], v[96:111]
    v_exp_f32 v116, v116
    v_exp_f32 v117, v117
    v_exp_f32 v118, v118
    v_exp_f32 v119, v119
    v_cvt_pk_bf16_f32 v145, v114, v115
    v_cvt_pk_bf16_f32 v146, v116, v117
    v_mfma_f32_32x32x16_bf16 v[128:143], v[196:199], v[28:31], v[128:143]
    v_exp_f32 v120, v120
    v_exp_f32 v121, v121
    v_exp_f32 v122, v122
    v_exp_f32 v123, v123
    v_cvt_pk_bf16_f32 v147, v118, v119
    v_cvt_pk_bf16_f32 v148, v120, v121
    v_mfma_f32_32x32x16_bf16 v[96:111], v[188:191], v[156:159], v[96:111]
    v_exp_f32 v124, v124
    v_exp_f32 v125, v125
    v_exp_f32 v126, v126
    v_exp_f32 v127, v127
    v_cvt_pk_bf16_f32 v149, v122, v123
    v_cvt_pk_bf16_f32 v150, v124, v125
    v_cvt_pk_bf16_f32 v151, v126, v127
    s_add_u32 s70, s65, 135168
    buffer_load_dwordx4 v[176:179], v2, s[16:19], s70 offen offset:0 sc1
    buffer_load_dwordx4 v[180:183], v2, s[16:19], s70 offen offset:1024 sc1
    buffer_load_dwordx4 v[184:187], v2, s[16:19], s70 offen offset:2048 sc1
    buffer_load_dwordx4 v[188:191], v2, s[16:19], s70 offen offset:3072 sc1
    v_mfma_f32_32x32x16_bf16 v[112:127], v[192:195], v[32:35], 0
    v_exp_f32 v128, v128
    v_exp_f32 v129, v129
    v_exp_f32 v130, v130
    v_exp_f32 v131, v131
    v_cvt_pk_bf16_f32 v152, v128, v129
    v_mfma_f32_32x32x16_bf16 v[48:63], v[200:203], v[144:147], v[48:63]
    v_exp_f32 v132, v132
    v_exp_f32 v133, v133
    v_exp_f32 v134, v134
    v_exp_f32 v135, v135
    v_cvt_pk_bf16_f32 v153, v130, v131
    v_cvt_pk_bf16_f32 v154, v132, v133
    v_mfma_f32_32x32x16_bf16 v[112:127], v[196:199], v[36:39], v[112:127]
    v_exp_f32 v136, v136
    v_exp_f32 v137, v137
    v_exp_f32 v138, v138
    v_exp_f32 v139, v139
    v_cvt_pk_bf16_f32 v155, v134, v135
    v_cvt_pk_bf16_f32 v156, v136, v137
    v_mfma_f32_32x32x16_bf16 v[48:63], v[204:207], v[148:151], v[48:63]
    v_exp_f32 v140, v140
    v_exp_f32 v141, v141
    v_exp_f32 v142, v142
    v_exp_f32 v143, v143
    v_cvt_pk_bf16_f32 v157, v138, v139
    v_cvt_pk_bf16_f32 v158, v140, v141
    v_cvt_pk_bf16_f32 v159, v142, v143
    s_cmp_lg_u32 s66, 0
    s_cbranch_scc1 L_mk_exs_27
    s_add_u32 m0, s71, 106496
    s_nop 0
    buffer_load_dwordx4 v233, s[48:51], s73 offen lds
    s_add_u32 m0, s71, 135104
    s_nop 0
    buffer_load_dwordx4 v233, s[48:51], s73 offen offset:64 lds
    s_add_u32 s73, s73, s7
L_mk_ex_26:
    v_mfma_f32_32x32x16_bf16 v[128:143], v[192:195], v[40:43], 0
    v_exp_f32 v112, v112
    v_exp_f32 v113, v113
    v_exp_f32 v114, v114
    v_exp_f32 v115, v115
    v_cvt_pk_bf16_f32 v144, v112, v113
    v_mfma_f32_32x32x16_bf16 v[64:79], v[200:203], v[152:155], v[64:79]
    v_exp_f32 v116, v116
    v_exp_f32 v117, v117
    v_exp_f32 v118, v118
    v_exp_f32 v119, v119
    v_cvt_pk_bf16_f32 v145, v114, v115
    v_cvt_pk_bf16_f32 v146, v116, v117
    v_mfma_f32_32x32x16_bf16 v[128:143], v[196:199], v[44:47], v[128:143]
    v_exp_f32 v120, v120
    v_exp_f32 v121, v121
    v_exp_f32 v122, v122
    v_exp_f32 v123, v123
    v_cvt_pk_bf16_f32 v147, v118, v119
    v_cvt_pk_bf16_f32 v148, v120, v121
    v_mfma_f32_32x32x16_bf16 v[64:79], v[204:207], v[156:159], v[64:79]
    v_exp_f32 v124, v124
    v_exp_f32 v125, v125
    v_exp_f32 v126, v126
    v_exp_f32 v127, v127
    v_cvt_pk_bf16_f32 v149, v122, v123
    v_cvt_pk_bf16_f32 v150, v124, v125
    v_cvt_pk_bf16_f32 v151, v126, v127
    s_waitcnt vmcnt(13)
    s_cmp_lg_u32 s66, 0
    s_cbranch_scc1 L_mk_kf_28
L_mk_kf_28b:
    s_nop 0
    v_mfma_f32_32x32x16_bf16 v[112:127], v[208:211], v[16:19], 0
    v_exp_f32 v128, v128
    v_exp_f32 v129, v129
    v_exp_f32 v130, v130
    v_exp_f32 v131, v131
    v_cvt_pk_bf16_f32 v152, v128, v129
    v_mfma_f32_32x32x16_bf16 v[80:95], v[200:203], v[144:147], v[80:95]
    v_exp_f32 v132, v132
    v_exp_f32 v133, v133
    v_exp_f32 v134, v134
    v_exp_f32 v135, v135
    v_cvt_pk_bf16_f32 v153, v130, v131
    v_cvt_pk_bf16_f32 v154, v132, v133
    v_mfma_f32_32x32x16_bf16 v[112:127], v[212:215], v[20:23], v[112:127]
    v_exp_f32 v136, v136
    v_exp_f32 v137, v137
    v_exp_f32 v138, v138
    v_exp_f32 v139, v139
    v_cvt_pk_bf16_f32 v155, v134, v135
    v_cvt_pk_bf16_f32 v156, v136, v137
    v_mfma_f32_32x32x16_bf16 v[80:95], v[204:207], v[148:151], v[80:95]
    v_exp_f32 v140, v140
    v_exp_f32 v141, v141
    v_exp_f32 v142, v142
    v_exp_f32 v143, v143
    v_cvt_pk_bf16_f32 v157, v138, v139
    v_cvt_pk_bf16_f32 v158, v140, v141
    v_cvt_pk_bf16_f32 v159, v142, v143
    v_mfma_f32_32x32x16_bf16 v[128:143], v[208:211], v[24:27], 0
    v_exp_f32 v112, v112
    v_exp_f32 v113, v113
    v_exp_f32 v114, v114
    v_exp_f32 v115, v115
    v_cvt_pk_bf16_f32 v144, v112, v113
    v_mfma_f32_32x32x16_bf16 v[96:111], v[200:203], v[152:155], v[96:111]
    v_exp_f32 v116, v116
    v_exp_f32 v117, v117
    v_exp_f32 v118, v118
    v_exp_f32 v119, v119
    v_cvt_pk_bf16_f32 v145, v114, v115
    v_cvt_pk_bf16_f32 v146, v116, v117
    v_mfma_f32_32x32x16_bf16 v[128:143], v[212:215], v[28:31], v[128:143]
    v_exp_f32 v120, v120
    v_exp_f32 v121, v121
    v_exp_f32 v122, v122
    v_exp_f32 v123, v123
    v_cvt_pk_bf16_f32 v147, v118, v119
    v_cvt_pk_bf16_f32 v148, v120, v121
    v_mfma_f32_32x32x16_bf16 v[96:111], v[204:207], v[156:159], v[96:111]
    v_exp_f32 v124, v124
    v_exp_f32 v125, v125
    v_exp_f32 v126, v126
    v_exp_f32 v127, v127
    v_cvt_pk_bf16_f32 v149, v122, v123
    v_cvt_pk_bf16_f32 v150, v124, v125
    v_cvt_pk_bf16_f32 v151, v126, v127
    s_add_u32 s70, s65, 139264
    buffer_load_dwordx4 v[192:195], v2, s[16:19], s70 offen offset:0 sc1
    buffer_load_dwordx4 v[196:199], v2, s[16:19], s70 offen offset:1024 sc1
    buffer_load_dwordx4 v[200:203], v2, s[16:19], s70 offen offset:2048 sc1
    buffer_load_dwordx4 v[204:207], v2, s[16:19], s70 offen offset:3072 sc1
    v_mfma_f32_32x32x16_bf16 v[112:127], v[208:211], v[32:35], 0
    v_exp_f32 v128, v128
    v_exp_f32 v129, v129
    v_exp_f32 v130, v130
    v_exp_f32 v131, v131
    v_cvt_pk_bf16_f32 v152, v128, v129
    v_mfma_f32_32x32x16_bf16 v[48:63], v[216:219], v[144:147], v[48:63]
    v_exp_f32 v132, v132
    v_exp_f32 v133, v133
    v_exp_f32 v134, v134
    v_exp_f32 v135, v135
    v_cvt_pk_bf16_f32 v153, v130, v131
    v_cvt_pk_bf16_f32 v154, v132, v133
    v_mfma_f32_32x32x16_bf16 v[112:127], v[212:215], v[36:39], v[112:127]
    v_exp_f32 v136, v136
    v_exp_f32 v137, v137
    v_exp_f32 v138, v138
    v_exp_f32 v139, v139
    v_cvt_pk_bf16_f32 v155, v134, v135
    v_cvt_pk_bf16_f32 v156, v136, v137
    v_mfma_f32_32x32x16_bf16 v[48:63], v[220:223], v[148:151], v[48:63]
    v_exp_f32 v140, v140
    v_exp_f32 v141, v141
    v_exp_f32 v142, v142
    v_exp_f32 v143, v143
    v_cvt_pk_bf16_f32 v157, v138, v139
    v_cvt_pk_bf16_f32 v158, v140, v141
    v_cvt_pk_bf16_f32 v159, v142, v143
    s_cmp_lg_u32 s66, 0
    s_cbranch_scc1 L_mk_exs_30
    s_add_u32 m0, s71, 114688
    s_nop 0
    buffer_load_dwordx4 v233, s[48:51], s73 offen lds
    s_add_u32 m0, s71, 143296
    s_nop 0
    buffer_load_dwordx4 v233, s[48:51], s73 offen offset:64 lds
    s_add_u32 s73, s73, s7
L_mk_ex_29:
    s_mov_b32 s68, 802816
    buffer_load_dword v253, v8, s[28:31], s68 offen
    v_mfma_f32_32x32x16_bf16 v[128:143], v[208:211], v[40:43], 0
    v_exp_f32 v112, v112
    v_exp_f32 v113, v113
    v_exp_f32 v114, v114
    v_exp_f32 v115, v115
    v_cvt_pk_bf16_f32 v144, v112, v113
    v_mfma_f32_32x32x16_bf16 v[64:79], v[216:219], v[152:155], v[64:79]
    v_exp_f32 v116, v116
    v_exp_f32 v117, v117
    v_exp_f32 v118, v118
    v_exp_f32 v119, v119
    v_cvt_pk_bf16_f32 v145, v114, v115
    v_cvt_pk_bf16_f32 v146, v116, v117
    v_mfma_f32_32x32x16_bf16 v[128:143], v[212:215], v[44:47], v[128:143]
    v_exp_f32 v120, v120
    v_exp_f32 v121, v121
    v_exp_f32 v122, v122
    v_exp_f32 v123, v123
    v_cvt_pk_bf16_f32 v147, v118, v119
    v_cvt_pk_bf16_f32 v148, v120, v121
    v_mfma_f32_32x32x16_bf16 v[64:79], v[220:223], v[156:159], v[64:79]
    v_exp_f32 v124, v124
    v_exp_f32 v125, v125
    v_exp_f32 v126, v126
    v_exp_f32 v127, v127
    v_cvt_pk_bf16_f32 v149, v122, v123
    v_cvt_pk_bf16_f32 v150, v124, v125
    v_cvt_pk_bf16_f32 v151, v126, v127
    s_waitcnt vmcnt(16)
    s_cmp_lg_u32 s66, 0
    s_cbranch_scc1 L_mk_kf_31
L_mk_kf_31b:
    s_nop 0
    v_mfma_f32_32x32x16_bf16 v[112:127], v[160:163], v[16:19], 0
    v_exp_f32 v128, v128
    v_exp_f32 v129, v129
    v_exp_f32 v130, v130
    v_exp_f32 v131, v131
    v_cvt_pk_bf16_f32 v152, v128, v129
    v_mfma_f32_32x32x16_bf16 v[80:95], v[216:219], v[144:147], v[80:95]
    v_exp_f32 v132, v132
    v_exp_f32 v133, v133
    v_exp_f32 v134, v134
    v_exp_f32 v135, v135
    v_cvt_pk_bf16_f32 v153, v130, v131
    v_cvt_pk_bf16_f32 v154, v132, v133
    v_mfma_f32_32x32x16_bf16 v[112:127], v[164:167], v[20:23], v[112:127]
    v_exp_f32 v136, v136
    v_exp_f32 v137, v137
    v_exp_f32 v138, v138
    v_exp_f32 v139, v139
    v_cvt_pk_bf16_f32 v155, v134, v135
    v_cvt_pk_bf16_f32 v156, v136, v137
    v_mfma_f32_32x32x16_bf16 v[80:95], v[220:223], v[148:151], v[80:95]
    v_exp_f32 v140, v140
    v_exp_f32 v141, v141
    v_exp_f32 v142, v142
    v_exp_f32 v143, v143
    v_cvt_pk_bf16_f32 v157, v138, v139
    v_cvt_pk_bf16_f32 v158, v140, v141
    v_cvt_pk_bf16_f32 v159, v142, v143
    v_mfma_f32_32x32x16_bf16 v[128:143], v[160:163], v[24:27], 0
    v_exp_f32 v112, v112
    v_exp_f32 v113, v113
    v_exp_f32 v114, v114
    v_exp_f32 v115, v115
    v_cvt_pk_bf16_f32 v144, v112, v113
    v_mfma_f32_32x32x16_bf16 v[96:111], v[216:219], v[152:155], v[96:111]
    v_exp_f32 v116, v116
    v_exp_f32 v117, v117
    v_exp_f32 v118, v118
    v_exp_f32 v119, v119
    v_cvt_pk_bf16_f32 v145, v114, v115
    v_cvt_pk_bf16_f32 v146, v116, v117
    v_mfma_f32_32x32x16_bf16 v[128:143], v[164:167], v[28:31], v[128:143]
    v_exp_f32 v120, v120
    v_exp_f32 v121, v121
    v_exp_f32 v122, v122
    v_exp_f32 v123, v123
    v_cvt_pk_bf16_f32 v147, v118, v119
    v_cvt_pk_bf16_f32 v148, v120, v121
    v_mfma_f32_32x32x16_bf16 v[96:111], v[220:223], v[156:159], v[96:111]
    v_exp_f32 v124, v124
    v_exp_f32 v125, v125
    v_exp_f32 v126, v126
    v_exp_f32 v127, v127
    v_cvt_pk_bf16_f32 v149, v122, v123
    v_cvt_pk_bf16_f32 v150, v124, v125
    v_cvt_pk_bf16_f32 v151, v126, v127
    s_add_u32 s70, s65, 143360
    buffer_load_dwordx4 v[208:211], v2, s[16:19], s70 offen offset:0 sc1
    buffer_load_dwordx4 v[212:215], v2, s[16:19], s70 offen offset:1024 sc1
    buffer_load_dwordx4 v[216:219], v2, s[16:19], s70 offen offset:2048 sc1
    buffer_load_dwordx4 v[220:223], v2, s[16:19], s70 offen offset:3072 sc1
    v_mfma_f32_32x32x16_bf16 v[112:127], v[160:163], v[32:35], 0
    v_exp_f32 v128, v128
    v_exp_f32 v129, v129
    v_exp_f32 v130, v130
    v_exp_f32 v131, v131
    v_cvt_pk_bf16_f32 v152, v128, v129
    v_mfma_f32_32x32x16_bf16 v[48:63], v[168:171], v[144:147], v[48:63]
    v_exp_f32 v132, v132
    v_exp_f32 v133, v133
    v_exp_f32 v134, v134
    v_exp_f32 v135, v135
    v_cvt_pk_bf16_f32 v153, v130, v131
    v_cvt_pk_bf16_f32 v154, v132, v133
    v_mfma_f32_32x32x16_bf16 v[112:127], v[164:167], v[36:39], v[112:127]
    v_exp_f32 v136, v136
    v_exp_f32 v137, v137
    v_exp_f32 v138, v138
    v_exp_f32 v139, v139
    v_cvt_pk_bf16_f32 v155, v134, v135
    v_cvt_pk_bf16_f32 v156, v136, v137
    v_mfma_f32_32x32x16_bf16 v[48:63], v[172:175], v[148:151], v[48:63]
    v_exp_f32 v140, v140
    v_exp_f32 v141, v141
    v_exp_f32 v142, v142
    v_exp_f32 v143, v143
    v_cvt_pk_bf16_f32 v157, v138, v139
    v_cvt_pk_bf16_f32 v158, v140, v141
    v_cvt_pk_bf16_f32 v159, v142, v143
    s_cmp_lg_u32 s66, 0
    s_cbranch_scc1 L_mk_exs_33
    s_cmp_lg_u32 s56, 0
    s_cbranch_scc1 L_mk_ex_32
    s_add_u32 m0, s71, 122880
    s_nop 0
    buffer_load_dwordx4 v233, s[48:51], s73 offen lds
    s_add_u32 m0, s71, 151488
    s_nop 0
    buffer_load_dwordx4 v233, s[48:51], s73 offen offset:64 lds
    s_add_u32 s73, s73, s7
L_mk_ex_32:
    v_mfma_f32_32x32x16_bf16 v[128:143], v[160:163], v[40:43], 0
    v_exp_f32 v112, v112
    v_exp_f32 v113, v113
    v_exp_f32 v114, v114
    v_exp_f32 v115, v115
    v_cvt_pk_bf16_f32 v144, v112, v113
    v_mfma_f32_32x32x16_bf16 v[64:79], v[168:171], v[152:155], v[64:79]
    v_exp_f32 v116, v116
    v_exp_f32 v117, v117
    v_exp_f32 v118, v118
    v_exp_f32 v119, v119
    v_cvt_pk_bf16_f32 v145, v114, v115
    v_cvt_pk_bf16_f32 v146, v116, v117
    v_mfma_f32_32x32x16_bf16 v[128:143], v[164:167], v[44:47], v[128:143]
    v_exp_f32 v120, v120
    v_exp_f32 v121, v121
    v_exp_f32 v122, v122
    v_exp_f32 v123, v123
    v_cvt_pk_bf16_f32 v147, v118, v119
    v_cvt_pk_bf16_f32 v148, v120, v121
    v_mfma_f32_32x32x16_bf16 v[64:79], v[172:175], v[156:159], v[64:79]
    v_exp_f32 v124, v124
    v_exp_f32 v125, v125
    v_exp_f32 v126, v126
    v_exp_f32 v127, v127
    v_cvt_pk_bf16_f32 v149, v122, v123
    v_cvt_pk_bf16_f32 v150, v124, v125
    v_cvt_pk_bf16_f32 v151, v126, v127
    s_waitcnt vmcnt(13)
    s_cmp_lg_u32 s66, 0
    s_cbranch_scc1 L_mk_kf_34
L_mk_kf_34b:
    s_nop 0
    v_mfma_f32_32x32x16_bf16 v[112:127], v[176:179], v[16:19], 0
    v_exp_f32 v128, v128
    v_exp_f32 v129, v129
    v_exp_f32 v130, v130
    v_exp_f32 v131, v131
    v_cvt_pk_bf16_f32 v152, v128, v129
    v_mfma_f32_32x32x16_bf16 v[80:95], v[168:171], v[144:147], v[80:95]
    v_exp_f32 v132, v132
    v_exp_f32 v133, v133
    v_exp_f32 v134, v134
    v_exp_f32 v135, v135
    v_cvt_pk_bf16_f32 v153, v130, v131
    v_cvt_pk_bf16_f32 v154, v132, v133
    v_mfma_f32_32x32x16_bf16 v[112:127], v[180:183], v[20:23], v[112:127]
    v_exp_f32 v136, v136
    v_exp_f32 v137, v137
    v_exp_f32 v138, v138
    v_exp_f32 v139, v139
    v_cvt_pk_bf16_f32 v155, v134, v135
    v_cvt_pk_bf16_f32 v156, v136, v137
    v_mfma_f32_32x32x16_bf16 v[80:95], v[172:175], v[148:151], v[80:95]
    v_exp_f32 v140, v140
    v_exp_f32 v141, v141
    v_exp_f32 v142, v142
    v_exp_f32 v143, v143
    v_cvt_pk_bf16_f32 v157, v138, v139
    v_cvt_pk_bf16_f32 v158, v140, v141
    v_cvt_pk_bf16_f32 v159, v142, v143
    s_setprio 2
    v_mfma_f32_32x32x16_bf16 v[128:143], v[176:179], v[24:27], 0
    v_exp_f32 v112, v112
    v_exp_f32 v113, v113
    v_exp_f32 v114, v114
    v_exp_f32 v115, v115
    v_cvt_pk_bf16_f32 v144, v112, v113
    v_mfma_f32_32x32x16_bf16 v[96:111], v[168:171], v[152:155], v[96:111]
    v_exp_f32 v116, v116
    v_exp_f32 v117, v117
    v_exp_f32 v118, v118
    v_exp_f32 v119, v119
    v_cvt_pk_bf16_f32 v145, v114, v115
    v_cvt_pk_bf16_f32 v146, v116, v117
    v_mfma_f32_32x32x16_bf16 v[128:143], v[180:183], v[28:31], v[128:143]
    v_exp_f32 v120, v120
    v_exp_f32 v121, v121
    v_exp_f32 v122, v122
    v_exp_f32 v123, v123
    v_cvt_pk_bf16_f32 v147, v118, v119
    v_cvt_pk_bf16_f32 v148, v120, v121
    v_mfma_f32_32x32x16_bf16 v[96:111], v[172:175], v[156:159], v[96:111]
    v_exp_f32 v124, v124
    v_exp_f32 v125, v125
    v_exp_f32 v126, v126
    v_exp_f32 v127, v127
    v_cvt_pk_bf16_f32 v149, v122, v123
    v_cvt_pk_bf16_f32 v150, v124, v125
    v_cvt_pk_bf16_f32 v151, v126, v127
    s_cmp_eq_u32 s56, 0
    s_cbranch_scc1 L_mk_sc_35
    s_mul_i32 s69, s55, 14336
    s_add_u32 s68, s69, 1089536
    buffer_load_dwordx4 v[160:163], v235, s[32:35], s68 offen offset:0
    buffer_load_dwordx4 v[164:167], v235, s[32:35], s68 offen offset:64
    s_add_u32 s68, s69, 1204224
    buffer_load_dwordx4 v[168:171], v235, s[32:35], s68 offen offset:0
    buffer_load_dwordx4 v[172:175], v235, s[32:35], s68 offen offset:64
    s_add_u32 s68, s69, 1548288
    buffer_load_dwordx4 v[224:227], v235, s[32:35], s68 offen offset:0
    buffer_load_dwordx4 v[228:231], v235, s[32:35], s68 offen offset:64
L_mk_sc_35:
    v_mfma_f32_32x32x16_bf16 v[112:127], v[176:179], v[32:35], 0
    v_exp_f32 v128, v128
    v_exp_f32 v129, v129
    v_exp_f32 v130, v130
    v_exp_f32 v131, v131
    v_cvt_pk_bf16_f32 v152, v128, v129
    v_mfma_f32_32x32x16_bf16 v[48:63], v[184:187], v[144:147], v[48:63]
    v_exp_f32 v132, v132
    v_exp_f32 v133, v133
    v_exp_f32 v134, v134
    v_exp_f32 v135, v135
    v_cvt_pk_bf16_f32 v153, v130, v131
    v_cvt_pk_bf16_f32 v154, v132, v133
    v_mfma_f32_32x32x16_bf16 v[112:127], v[180:183], v[36:39], v[112:127]
    v_exp_f32 v136, v136
    v_exp_f32 v137, v137
    v_exp_f32 v138, v138
    v_exp_f32 v139, v139
    v_cvt_pk_bf16_f32 v155, v134, v135
    v_cvt_pk_bf16_f32 v156, v136, v137
    v_mfma_f32_32x32x16_bf16 v[48:63], v[188:191], v[148:151], v[48:63]
    v_exp_f32 v140, v140
    v_exp_f32 v141, v141
    v_exp_f32 v142, v142
    v_exp_f32 v143, v143
    v_cvt_pk_bf16_f32 v157, v138, v139
    v_cvt_pk_bf16_f32 v158, v140, v141
    v_cvt_pk_bf16_f32 v159, v142, v143
    s_cmp_lg_u32 s66, 0
    s_cbranch_scc1 L_mk_exs_37
    s_lshl_b32 s69, s56, 13
    s_add_u32 s69, s69, s72
    s_mul_i32 s68, s56, 229376
    s_add_u32 m0, s69, 65536
    s_add_u32 s68, s68, 0
    buffer_load_dwordx4 v234, s[28:31], s68 offen lds
    s_add_u32 m0, s69, 69568
    s_nop 0
    buffer_load_dwordx4 v234, s[28:31], s68 offen offset:64 lds
L_mk_ex_36:
    s_mov_b32 s68, 0
    buffer_load_dword v253, v9, s[32:35], s68 offen
    v_mfma_f32_32x32x16_bf16 v[128:143], v[176:179], v[40:43], 0
    v_exp_f32 v112, v112
    v_exp_f32 v113, v113
    v_exp_f32 v114, v114
    v_exp_f32 v115, v115
    v_cvt_pk_bf16_f32 v144, v112, v113
    v_mfma_f32_32x32x16_bf16 v[64:79], v[184:187], v[152:155], v[64:79]
    v_exp_f32 v116, v116
    v_exp_f32 v117, v117
    v_exp_f32 v118, v118
    v_exp_f32 v119, v119
    v_cvt_pk_bf16_f32 v145, v114, v115
    v_cvt_pk_bf16_f32 v146, v116, v117
    v_mfma_f32_32x32x16_bf16 v[128:143], v[180:183], v[44:47], v[128:143]
    v_exp_f32 v120, v120
    v_exp_f32 v121, v121
    v_exp_f32 v122, v122
    v_exp_f32 v123, v123
    v_cvt_pk_bf16_f32 v147, v118, v119
    v_cvt_pk_bf16_f32 v148, v120, v121
    v_mfma_f32_32x32x16_bf16 v[64:79], v[188:191], v[156:159], v[64:79]
    v_exp_f32 v124, v124
    v_exp_f32 v125, v125
    v_exp_f32 v126, v126
    v_exp_f32 v127, v127
    v_cvt_pk_bf16_f32 v149, v122, v123
    v_cvt_pk_bf16_f32 v150, v124, v125
    v_cvt_pk_bf16_f32 v151, v126, v127
    s_waitcnt vmcnt(10)
    s_cmp_lg_u32 s66, 0
    s_cbranch_scc1 L_mk_kf_38
L_mk_kf_38b:
    s_nop 0
    v_mfma_f32_32x32x16_bf16 v[112:127], v[192:195], v[16:19], 0
    v_exp_f32 v128, v128
    v_exp_f32 v129, v129
    v_exp_f32 v130, v130
    v_exp_f32 v131, v131
    v_cvt_pk_bf16_f32 v152, v128, v129
    v_mfma_f32_32x32x16_bf16 v[80:95], v[184:187], v[144:147], v[80:95]
    v_exp_f32 v132, v132
    v_exp_f32 v133, v133
    v_exp_f32 v134, v134
    v_exp_f32 v135, v135
    v_cvt_pk_bf16_f32 v153, v130, v131
    v_cvt_pk_bf16_f32 v154, v132, v133
    v_mfma_f32_32x32x16_bf16 v[112:127], v[196:199], v[20:23], v[112:127]
    v_exp_f32 v136, v136
    v_exp_f32 v137, v137
    v_exp_f32 v138, v138
    v_exp_f32 v139, v139
    v_cvt_pk_bf16_f32 v155, v134, v135
    v_cvt_pk_bf16_f32 v156, v136, v137
    v_mfma_f32_32x32x16_bf16 v[80:95], v[188:191], v[148:151], v[80:95]
    v_exp_f32 v140, v140
    v_exp_f32 v141, v141
    v_exp_f32 v142, v142
    v_exp_f32 v143, v143
    v_cvt_pk_bf16_f32 v157, v138, v139
    v_cvt_pk_bf16_f32 v158, v140, v141
    v_cvt_pk_bf16_f32 v159, v142, v143
    v_mfma_f32_32x32x16_bf16 v[128:143], v[192:195], v[24:27], 0
    v_exp_f32 v112, v112
    v_exp_f32 v113, v113
    v_exp_f32 v114, v114
    v_exp_f32 v115, v115
    v_cvt_pk_bf16_f32 v144, v112, v113
    v_mfma_f32_32x32x16_bf16 v[96:111], v[184:187], v[152:155], v[96:111]
    v_exp_f32 v116, v116
    v_exp_f32 v117, v117
    v_exp_f32 v118, v118
    v_exp_f32 v119, v119
    v_cvt_pk_bf16_f32 v145, v114, v115
    v_cvt_pk_bf16_f32 v146, v116, v117
    v_mfma_f32_32x32x16_bf16 v[128:143], v[196:199], v[28:31], v[128:143]
    v_exp_f32 v120, v120
    v_exp_f32 v121, v121
    v_exp_f32 v122, v122
    v_exp_f32 v123, v123
    v_cvt_pk_bf16_f32 v147, v118, v119
    v_cvt_pk_bf16_f32 v148, v120, v121
    v_mfma_f32_32x32x16_bf16 v[96:111], v[188:191], v[156:159], v[96:111]
    v_exp_f32 v124, v124
    v_exp_f32 v125, v125
    v_exp_f32 v126, v126
    v_exp_f32 v127, v127
    v_cvt_pk_bf16_f32 v149, v122, v123
    v_cvt_pk_bf16_f32 v150, v124, v125
    v_cvt_pk_bf16_f32 v151, v126, v127
    s_lshl_b32 s68, s59, 1
    s_add_u32 s68, s68, s56
    s_lshl_b32 s68, s68, 5
    v_add_u32 v12, s68, v4
    v_mul_u32_u24 v12, 896, v12
    v_lshl_add_u32 v12, v3, 3, v12
    v_lshlrev_b32 v13, 3, v3
    s_lshl_b32 s68, s58, 7
    s_lshl_b32 s69, s55, 5
    s_add_u32 s68, s68, s69
    buffer_load_dwordx2 v[244:245], v12, s[8:11], s68 offen
    buffer_load_dwordx2 v[246:247], v12, s[8:11], s68 offen offset:16
    buffer_load_dwordx2 v[248:249], v13, s[40:43], s68 offen
    buffer_load_dwordx2 v[250:251], v13, s[40:43], s68 offen offset:16
    s_lshl_b32 s68, s54, 13
    v_add_u32 v10, s68, v2
    v_xor_b32 v11, 0x8000, v10
    v_mfma_f32_32x32x16_bf16 v[112:127], v[192:195], v[32:35], 0
    v_exp_f32 v128, v128
    v_exp_f32 v129, v129
    v_exp_f32 v130, v130
    v_exp_f32 v131, v131
    v_cvt_pk_bf16_f32 v152, v128, v129
    v_mfma_f32_32x32x16_bf16 v[48:63], v[200:203], v[144:147], v[48:63]
    v_exp_f32 v132, v132
    v_exp_f32 v133, v133
    v_exp_f32 v134, v134
    v_exp_f32 v135, v135
    v_cvt_pk_bf16_f32 v153, v130, v131
    v_cvt_pk_bf16_f32 v154, v132, v133
    v_mfma_f32_32x32x16_bf16 v[112:127], v[196:199], v[36:39], v[112:127]
    v_exp_f32 v136, v136
    v_exp_f32 v137, v137
    v_exp_f32 v138, v138
    v_exp_f32 v139, v139
    v_cvt_pk_bf16_f32 v155, v134, v135
    v_cvt_pk_bf16_f32 v156, v136, v137
    v_mfma_f32_32x32x16_bf16 v[48:63], v[204:207], v[148:151], v[48:63]
    v_exp_f32 v140, v140
    v_exp_f32 v141, v141
    v_exp_f32 v142, v142
    v_exp_f32 v143, v143
    v_cvt_pk_bf16_f32 v157, v138, v139
    v_cvt_pk_bf16_f32 v158, v140, v141
    v_cvt_pk_bf16_f32 v159, v142, v143
    s_setprio 1
    s_cmp_lg_u32 s66, 0
    s_cbranch_scc1 L_mk_exs_40
    s_lshl_b32 s69, s56, 13
    s_add_u32 s69, s69, s72
    s_mul_i32 s68, s56, 229376
    s_add_u32 m0, s69, 81920
    s_add_u32 s68, s68, 458752
    buffer_load_dwordx4 v234, s[28:31], s68 offen lds
    s_add_u32 m0, s69, 85952
    s_nop 0
    buffer_load_dwordx4 v234, s[28:31], s68 offen offset:64 lds
L_mk_ex_39:
    s_cmp_eq_u32 s56, 0
    s_cbranch_scc1 L_mk_sc_41
    s_mul_i32 s69, s55, 14336
    s_add_u32 s68, s69, 1318912
    buffer_load_dwordx4 v[176:179], v235, s[32:35], s68 offen offset:0
    buffer_load_dwordx4 v[180:183], v235, s[32:35], s68 offen offset:64
    s_add_u32 s68, s69, 1433600
    buffer_load_dwordx4 v[184:187], v235, s[32:35], s68 offen offset:0
    buffer_load_dwordx4 v[188:191], v235, s[32:35], s68 offen offset:64
L_mk_sc_41:
    v_mfma_f32_32x32x16_bf16 v[128:143], v[192:195], v[40:43], 0
    v_exp_f32 v112, v112
    v_exp_f32 v113, v113
    v_exp_f32 v114, v114
    v_exp_f32 v115, v115
    v_cvt_pk_bf16_f32 v144, v112, v113
    v_mfma_f32_32x32x16_bf16 v[64:79], v[200:203], v[152:155], v[64:79]
    v_exp_f32 v116, v116
    v_exp_f32 v117, v117
    v_exp_f32 v118, v118
    v_exp_f32 v119, v119
    v_cvt_pk_bf16_f32 v145, v114, v115
    v_cvt_pk_bf16_f32 v146, v116, v117
    v_mfma_f32_32x32x16_bf16 v[128:143], v[196:199], v[44:47], v[128:143]
    v_exp_f32 v120, v120
    v_exp_f32 v121, v121
    v_exp_f32 v122, v122
    v_exp_f32 v123, v123
    v_cvt_pk_bf16_f32 v147, v118, v119
    v_cvt_pk_bf16_f32 v148, v120, v121
    v_mfma_f32_32x32x16_bf16 v[64:79], v[204:207], v[156:159], v[64:79]
    v_exp_f32 v124, v124
    v_exp_f32 v125, v125
    v_exp_f32 v126, v126
    v_exp_f32 v127, v127
    v_cvt_pk_bf16_f32 v149, v122, v123
    v_cvt_pk_bf16_f32 v150, v124, v125
    v_cvt_pk_bf16_f32 v151, v126, v127
    s_waitcnt vmcnt(9)
    s_cmp_lg_u32 s66, 0
    s_cbranch_scc1 L_mk_kf_42
L_mk_kf_42b:
    s_nop 0
    v_mfma_f32_32x32x16_bf16 v[112:127], v[208:211], v[16:19], 0
    v_exp_f32 v128, v128
    v_exp_f32 v129, v129
    v_exp_f32 v130, v130
    v_exp_f32 v131, v131
    v_cvt_pk_bf16_f32 v152, v128, v129
    v_mfma_f32_32x32x16_bf16 v[80:95], v[200:203], v[144:147], v[80:95]
    v_exp_f32 v132, v132
    v_exp_f32 v133, v133
    v_exp_f32 v134, v134
    v_exp_f32 v135, v135
    v_cvt_pk_bf16_f32 v153, v130, v131
    v_cvt_pk_bf16_f32 v154, v132, v133
    v_mfma_f32_32x32x16_bf16 v[112:127], v[212:215], v[20:23], v[112:127]
    v_exp_f32 v136, v136
    v_exp_f32 v137, v137
    v_exp_f32 v138, v138
    v_exp_f32 v139, v139
    v_cvt_pk_bf16_f32 v155, v134, v135
    v_cvt_pk_bf16_f32 v156, v136, v137
    v_mfma_f32_32x32x16_bf16 v[80:95], v[204:207], v[148:151], v[80:95]
    v_exp_f32 v140, v140
    v_exp_f32 v141, v141
    v_exp_f32 v142, v142
    v_exp_f32 v143, v143
    v_cvt_pk_bf16_f32 v157, v138, v139
    v_cvt_pk_bf16_f32 v158, v140, v141
    v_cvt_pk_bf16_f32 v159, v142, v143
    v_mfma_f32_32x32x16_bf16 v[128:143], v[208:211], v[24:27], 0
    v_exp_f32 v112, v112
    v_exp_f32 v113, v113
    v_exp_f32 v114, v114
    v_exp_f32 v115, v115
    v_cvt_pk_bf16_f32 v144, v112, v113
    v_mfma_f32_32x32x16_bf16 v[96:111], v[200:203], v[152:155], v[96:111]
    v_exp_f32 v116, v116
    v_exp_f32 v117, v117
    v_exp_f32 v118, v118
    v_exp_f32 v119, v119
    v_cvt_pk_bf16_f32 v145, v114, v115
    v_cvt_pk_bf16_f32 v146, v116, v117
    v_mfma_f32_32x32x16_bf16 v[128:143], v[212:215], v[28:31], v[128:143]
    v_exp_f32 v120, v120
    v_exp_f32 v121, v121
    v_exp_f32 v122, v122
    v_exp_f32 v123, v123
    v_cvt_pk_bf16_f32 v147, v118, v119
    v_cvt_pk_bf16_f32 v148, v120, v121
    v_mfma_f32_32x32x16_bf16 v[96:111], v[204:207], v[156:159], v[96:111]
    v_exp_f32 v124, v124
    v_exp_f32 v125, v125
    v_exp_f32 v126, v126
    v_exp_f32 v127, v127
    v_cvt_pk_bf16_f32 v149, v122, v123
    v_cvt_pk_bf16_f32 v150, v124, v125
    v_cvt_pk_bf16_f32 v151, v126, v127
    v_mfma_f32_32x32x16_bf16 v[112:127], v[208:211], v[32:35], 0
    v_exp_f32 v128, v128
    v_exp_f32 v129, v129
    v_exp_f32 v130, v130
    v_exp_f32 v131, v131
    v_cvt_pk_bf16_f32 v152, v128, v129
    v_mfma_f32_32x32x16_bf16 v[48:63], v[216:219], v[144:147], v[48:63]
    v_exp_f32 v132, v132
    v_exp_f32 v133, v133
    v_exp_f32 v134, v134
    v_exp_f32 v135, v135
    v_cvt_pk_bf16_f32 v153, v130, v131
    v_cvt_pk_bf16_f32 v154, v132, v133
    v_mfma_f32_32x32x16_bf16 v[112:127], v[212:215], v[36:39], v[112:127]
    v_exp_f32 v136, v136
    v_exp_f32 v137, v137
    v_exp_f32 v138, v138
    v_exp_f32 v139, v139
    v_cvt_pk_bf16_f32 v155, v134, v135
    v_cvt_pk_bf16_f32 v156, v136, v137
    v_mfma_f32_32x32x16_bf16 v[48:63], v[220:223], v[148:151], v[48:63]
    v_exp_f32 v140, v140
    v_exp_f32 v141, v141
    v_exp_f32 v142, v142
    v_exp_f32 v143, v143
    v_cvt_pk_bf16_f32 v157, v138, v139
    v_cvt_pk_bf16_f32 v158, v140, v141
    v_cvt_pk_bf16_f32 v159, v142, v143
    s_setprio 0
    s_mov_b32 s68, 200704
    buffer_load_dword v253, v9, s[32:35], s68 offen
    s_cmp_lg_u32 s54, 7
    s_cbranch_scc1 L_mk_fl_45
    s_mov_b32 s68, 18939904
    buffer_load_dword v6, v239, s[16:19], s68 offen sc1
L_mk_fl_45:
    v_mfma_f32_32x32x16_bf16 v[128:143], v[208:211], v[40:43], 0
    v_exp_f32 v112, v112
    v_exp_f32 v113, v113
    v_exp_f32 v114, v114
    v_exp_f32 v115, v115
    v_cvt_pk_bf16_f32 v144, v112, v113
    ds_write_b128 v10, v[48:51] offset:0
    v_mfma_f32_32x32x16_bf16 v[64:79], v[216:219], v[152:155], v[64:79]
    v_exp_f32 v116, v116
    v_exp_f32 v117, v117
    v_exp_f32 v118, v118
    v_exp_f32 v119, v119
    v_cvt_pk_bf16_f32 v145, v114, v115
    v_cvt_pk_bf16_f32 v146, v116, v117
    ds_write_b128 v10, v[52:55] offset:1024
    v_mfma_f32_32x32x16_bf16 v[128:143], v[212:215], v[44:47], v[128:143]
    v_exp_f32 v120, v120
    v_exp_f32 v121, v121
    v_exp_f32 v122, v122
    v_exp_f32 v123, v123
    v_cvt_pk_bf16_f32 v147, v118, v119
    v_cvt_pk_bf16_f32 v148, v120, v121
    ds_write_b128 v10, v[56:59] offset:2048
    v_mfma_f32_32x32x16_bf16 v[64:79], v[220:223], v[156:159], v[64:79]
    v_exp_f32 v124, v124
    v_exp_f32 v125, v125
    v_exp_f32 v126, v126
    v_exp_f32 v127, v127
    v_cvt_pk_bf16_f32 v149, v122, v123
    v_cvt_pk_bf16_f32 v150, v124, v125
    v_cvt_pk_bf16_f32 v151, v126, v127
    ds_write_b128 v10, v[60:63] offset:3072
    v_mfma_f32_32x32x16_bf16 v[80:95], v[216:219], v[144:147], v[80:95]
    v_exp_f32 v128, v128
    v_exp_f32 v129, v129
    v_exp_f32 v130, v130
    v_exp_f32 v131, v131
    v_cvt_pk_bf16_f32 v152, v128, v129
    ds_write_b128 v10, v[64:67] offset:4096
    v_mfma_f32_32x32x16_bf16 v[80:95], v[220:223], v[148:151], v[80:95]
    v_exp_f32 v132, v132
    v_exp_f32 v133, v133
    v_exp_f32 v134, v134
    v_exp_f32 v135, v135
    v_cvt_pk_bf16_f32 v153, v130, v131
    v_cvt_pk_bf16_f32 v154, v132, v133
    ds_write_b128 v10, v[68:71] offset:5120
    v_exp_f32 v136, v136
    v_exp_f32 v137, v137
    v_exp_f32 v138, v138
    v_exp_f32 v139, v139
    v_cvt_pk_bf16_f32 v155, v134, v135
    v_cvt_pk_bf16_f32 v156, v136, v137
    ds_write_b128 v10, v[72:75] offset:6144
    v_exp_f32 v140, v140
    v_exp_f32 v141, v141
    v_exp_f32 v142, v142
    v_exp_f32 v143, v143
    v_cvt_pk_bf16_f32 v157, v138, v139
    v_cvt_pk_bf16_f32 v158, v140, v141
    v_cvt_pk_bf16_f32 v159, v142, v143
    ds_write_b128 v10, v[76:79] offset:7168
    v_mfma_f32_32x32x16_bf16 v[96:111], v[216:219], v[152:155], v[96:111]
    v_mfma_f32_32x32x16_bf16 v[96:111], v[220:223], v[156:159], v[96:111]
    s_cmp_lg_u32 s54, 7
    s_cbranch_scc1 L_mk_fl_46
    s_waitcnt vmcnt(0)
    s_mov_b32 s78, 0
    s_or_b32 s77, s82, 2
    s_mov_b32 s76, 18939904
    s_branch L_mk_f0_49
L_mk_fc_47:
    buffer_load_dword v6, v239, s[16:19], s76 offen sc1
    s_waitcnt vmcnt(0)
L_mk_f0_49:
    v_and_b32 v5, 0xffffff02, v6
    v_cmp_ne_u32 vcc, s77, v5
    s_nop 0
    s_cbranch_vccz L_mk_fx_48
    s_add_u32 s78, s78, 1
    s_sleep 8
    s_cmp_le_u32 s78, 20000
    s_cbranch_scc1 L_mk_fc_47
L_mk_fx_48:
L_mk_fl_46:
    s_waitcnt lgkmcnt(0)
    s_barrier
    ds_read_b128 v[112:115], v11 offset:0
    ds_read_b128 v[116:119], v11 offset:1024
    ds_read_b128 v[120:123], v11 offset:2048
    ds_read_b128 v[124:127], v11 offset:3072
    ds_read_b128 v[128:131], v11 offset:4096
    ds_read_b128 v[132:135], v11 offset:5120
    ds_read_b128 v[136:139], v11 offset:6144
    ds_read_b128 v[140:143], v11 offset:7168
    s_xor_b32 s68, s56, 1
    s_lshl_b32 s68, s68, 15
    s_lshl_b32 s69, s55, 11
    s_add_u32 s69, s69, s68
    v_add_u32 v7, s69, v2
    s_lshr_b32 s69, s55, 1
    s_lshl_b32 s69, s69, 12
    s_add_u32 s69, s69, s68
    s_add_u32 s69, s69, 3072
    v_or_b32 v8, 512, v2
    v_add_u32 v8, s69, v8
    v_cmp_eq_u32 vcc, 1, v3
    s_bitcmp1_b32 s54, 0
    s_cselect_b64 s[4:5], vcc, 0
    s_cmp_eq_u32 s55, 1
    s_cbranch_scc1 L_mk_r21_51
    s_cmp_eq_u32 s55, 2
    s_cbranch_scc1 L_mk_r22_52
    s_cmp_eq_u32 s55, 3
    s_cbranch_scc1 L_mk_r23_53
L_mk_r20_50:
    s_waitcnt lgkmcnt(7)
    v_add_f32 v72, v112, v80
    v_add_f32 v73, v113, v81
    v_add_f32 v74, v114, v82
    v_add_f32 v75, v115, v83
    s_waitcnt lgkmcnt(6)
    v_add_f32 v76, v116, v84
    v_add_f32 v77, v117, v85
    v_add_f32 v78, v118, v86
    v_add_f32 v79, v119, v87
    s_waitcnt lgkmcnt(5)
    v_add_f32 v120, v120, v88
    v_add_f32 v121, v121, v89
    v_add_f32 v122, v122, v90
    v_add_f32 v123, v123, v91
    ds_write_b128 v11, v[120:123] offset:2048
    s_waitcnt lgkmcnt(5)
    v_add_f32 v124, v124, v92
    v_add_f32 v125, v125, v93
    v_add_f32 v126, v126, v94
    v_add_f32 v127, v127, v95
    ds_write_b128 v11, v[124:127] offset:3072
    s_waitcnt lgkmcnt(5)
    v_add_f32 v128, v128, v96
    v_add_f32 v129, v129, v97
    v_add_f32 v130, v130, v98
    v_add_f32 v131, v131, v99
    ds_write_b128 v11, v[128:131] offset:4096
    s_waitcnt lgkmcnt(5)
    v_add_f32 v132, v132, v100
    v_add_f32 v133, v133, v101
    v_add_f32 v134, v134, v102
    v_add_f32 v135, v135, v103
    ds_write_b128 v11, v[132:135] offset:5120
    s_waitcnt lgkmcnt(5)
    v_add_f32 v136, v136, v104
    v_add_f32 v137, v137, v105
    v_add_f32 v138, v138, v106
    v_add_f32 v139, v139, v107
    ds_write_b128 v11, v[136:139] offset:6144
    s_waitcnt lgkmcnt(5)
    v_add_f32 v140, v140, v108
    v_add_f32 v141, v141, v109
    v_add_f32 v142, v142, v110
    v_add_f32 v143, v143, v111
    ds_write_b128 v11, v[140:143] offset:7168
    v_mov_b32 v10, 0x5d800000
    s_waitcnt lgkmcnt(0)
    s_barrier
    ds_read_b32 v80, v8 offset:0
    ds_read_b32 v81, v8 offset:8192
    ds_read_b32 v82, v8 offset:16384
    ds_read_b32 v83, v8 offset:24576
    ds_read_b128 v[48:51], v7 offset:8192
    ds_read_b128 v[52:55], v7 offset:9216
    ds_read_b128 v[56:59], v7 offset:16384
    ds_read_b128 v[60:63], v7 offset:17408
    ds_read_b128 v[64:67], v7 offset:24576
    ds_read_b128 v[68:71], v7 offset:25600
    s_branch L_mk_r2e_54
L_mk_r21_51:
    s_waitcnt lgkmcnt(7)
    v_add_f32 v112, v112, v80
    v_add_f32 v113, v113, v81
    v_add_f32 v114, v114, v82
    v_add_f32 v115, v115, v83
    ds_write_b128 v11, v[112:115] offset:0
    s_waitcnt lgkmcnt(7)
    v_add_f32 v116, v116, v84
    v_add_f32 v117, v117, v85
    v_add_f32 v118, v118, v86
    v_add_f32 v119, v119, v87
    ds_write_b128 v11, v[116:119] offset:1024
    s_waitcnt lgkmcnt(7)
    v_add_f32 v72, v120, v88
    v_add_f32 v73, v121, v89
    v_add_f32 v74, v122, v90
    v_add_f32 v75, v123, v91
    s_waitcnt lgkmcnt(6)
    v_add_f32 v76, v124, v92
    v_add_f32 v77, v125, v93
    v_add_f32 v78, v126, v94
    v_add_f32 v79, v127, v95
    ds_write_b32 v11, v76 offset:3072
    s_waitcnt lgkmcnt(6)
    v_add_f32 v128, v128, v96
    v_add_f32 v129, v129, v97
    v_add_f32 v130, v130, v98
    v_add_f32 v131, v131, v99
    ds_write_b128 v11, v[128:131] offset:4096
    s_waitcnt lgkmcnt(6)
    v_add_f32 v132, v132, v100
    v_add_f32 v133, v133, v101
    v_add_f32 v134, v134, v102
    v_add_f32 v135, v135, v103
    ds_write_b128 v11, v[132:135] offset:5120
    s_waitcnt lgkmcnt(6)
    v_add_f32 v136, v136, v104
    v_add_f32 v137, v137, v105
    v_add_f32 v138, v138, v106
    v_add_f32 v139, v139, v107
    ds_write_b128 v11, v[136:139] offset:6144
    s_waitcnt lgkmcnt(6)
    v_add_f32 v140, v140, v108
    v_add_f32 v141, v141, v109
    v_add_f32 v142, v142, v110
    v_add_f32 v143, v143, v111
    ds_write_b128 v11, v[140:143] offset:7168
    v_mov_b32 v10, 0x5d800000
    s_waitcnt lgkmcnt(0)
    s_barrier
    ds_read_b32 v80, v8 offset:0
    ds_read_b32 v81, v8 offset:8192
    ds_read_b32 v82, v8 offset:16384
    ds_read_b32 v83, v8 offset:24576
    ds_read_b128 v[48:51], v7 offset:0
    ds_read_b128 v[52:55], v7 offset:1024
    ds_read_b128 v[56:59], v7 offset:16384
    ds_read_b128 v[60:63], v7 offset:17408
    ds_read_b128 v[64:67], v7 offset:24576
    ds_read_b128 v[68:71], v7 offset:25600
    s_branch L_mk_r2e_54
L_mk_r22_52:
    s_waitcnt lgkmcnt(7)
    v_add_f32 v112, v112, v80
    v_add_f32 v113, v113, v81
    v_add_f32 v114, v114, v82
    v_add_f32 v115, v115, v83
    ds_write_b128 v11, v[112:115] offset:0
    s_waitcnt lgkmcnt(7)
    v_add_f32 v116, v116, v84
    v_add_f32 v117, v117, v85
    v_add_f32 v118, v118, v86
    v_add_f32 v119, v119, v87
    ds_write_b128 v11, v[116:119] offset:1024
    s_waitcnt lgkmcnt(7)
    v_add_f32 v120, v120, v88
    v_add_f32 v121, v121, v89
    v_add_f32 v122, v122, v90
    v_add_f32 v123, v123, v91
    ds_write_b128 v11, v[120:123] offset:2048
    s_waitcnt lgkmcnt(7)
    v_add_f32 v124, v124, v92
    v_add_f32 v125, v125, v93
    v_add_f32 v126, v126, v94
    v_add_f32 v127, v127, v95
    ds_write_b128 v11, v[124:127] offset:3072
    s_waitcnt lgkmcnt(7)
    v_add_f32 v72, v128, v96
    v_add_f32 v73, v129, v97
    v_add_f32 v74, v130, v98
    v_add_f32 v75, v131, v99
    s_waitcnt lgkmcnt(6)
    v_add_f32 v76, v132, v100
    v_add_f32 v77, v133, v101
    v_add_f32 v78, v134, v102
    v_add_f32 v79, v135, v103
    s_waitcnt lgkmcnt(5)
    v_add_f32 v136, v136, v104
    v_add_f32 v137, v137, v105
    v_add_f32 v138, v138, v106
    v_add_f32 v139, v139, v107
    ds_write_b128 v11, v[136:139] offset:6144
    s_waitcnt lgkmcnt(5)
    v_add_f32 v140, v140, v108
    v_add_f32 v141, v141, v109
    v_add_f32 v142, v142, v110
    v_add_f32 v143, v143, v111
    ds_write_b128 v11, v[140:143] offset:7168
    v_mov_b32 v10, 0x5d800000
    s_waitcnt lgkmcnt(0)
    s_barrier
    ds_read_b32 v80, v8 offset:0
    ds_read_b32 v81, v8 offset:8192
    ds_read_b32 v82, v8 offset:16384
    ds_read_b32 v83, v8 offset:24576
    ds_read_b128 v[48:51], v7 offset:0
    ds_read_b128 v[52:55], v7 offset:1024
    ds_read_b128 v[56:59], v7 offset:8192
    ds_read_b128 v[60:63], v7 offset:9216
    ds_read_b128 v[64:67], v7 offset:24576
    ds_read_b128 v[68:71], v7 offset:25600
    s_branch L_mk_r2e_54
L_mk_r23_53:
    s_waitcnt lgkmcnt(7)
    v_add_f32 v112, v112, v80
    v_add_f32 v113, v113, v81
    v_add_f32 v114, v114, v82
    v_add_f32 v115, v115, v83
    ds_write_b128 v11, v[112:115] offset:0
    s_waitcnt lgkmcnt(7)
    v_add_f32 v116, v116, v84
    v_add_f32 v117, v117, v85
    v_add_f32 v118, v118, v86
    v_add_f32 v119, v119, v87
    ds_write_b128 v11, v[116:119] offset:1024
    s_waitcnt lgkmcnt(7)
    v_add_f32 v120, v120, v88
    v_add_f32 v121, v121, v89
    v_add_f32 v122, v122, v90
    v_add_f32 v123, v123, v91
    ds_write_b128 v11, v[120:123] offset:2048
    s_waitcnt lgkmcnt(7)
    v_add_f32 v124, v124, v92
    v_add_f32 v125, v125, v93
    v_add_f32 v126, v126, v94
    v_add_f32 v127, v127, v95
    ds_write_b128 v11, v[124:127] offset:3072
    s_waitcnt lgkmcnt(7)
    v_add_f32 v128, v128, v96
    v_add_f32 v129, v129, v97
    v_add_f32 v130, v130, v98
    v_add_f32 v131, v131, v99
    ds_write_b128 v11, v[128:131] offset:4096
    s_waitcnt lgkmcnt(7)
    v_add_f32 v132, v132, v100
    v_add_f32 v133, v133, v101
    v_add_f32 v134, v134, v102
    v_add_f32 v135, v135, v103
    ds_write_b128 v11, v[132:135] offset:5120
    s_waitcnt lgkmcnt(7)
    v_add_f32 v72, v136, v104
    v_add_f32 v73, v137, v105
    v_add_f32 v74, v138, v106
    v_add_f32 v75, v139, v107
    s_waitcnt lgkmcnt(6)
    v_add_f32 v76, v140, v108
    v_add_f32 v77, v141, v109
    v_add_f32 v78, v142, v110
    v_add_f32 v79, v143, v111
    ds_write_b32 v11, v76 offset:7168
    v_mov_b32 v10, 0x5d800000
    s_waitcnt lgkmcnt(0)
    s_barrier
    ds_read_b32 v80, v8 offset:0
    ds_read_b32 v81, v8 offset:8192
    ds_read_b32 v82, v8 offset:16384
    ds_read_b32 v83, v8 offset:24576
    ds_read_b128 v[48:51], v7 offset:0
    ds_read_b128 v[52:55], v7 offset:1024
    ds_read_b128 v[56:59], v7 offset:8192
    ds_read_b128 v[60:63], v7 offset:9216
    ds_read_b128 v[64:67], v7 offset:16384
    ds_read_b128 v[68:71], v7 offset:17408
L_mk_r2e_54:
    s_waitcnt lgkmcnt(6)
    v_add_f32 v80, v80, v81
    v_add_f32 v82, v82, v83
    v_add_f32 v80, v80, v82
    v_rcp_f32 v9, v80
    v_cmp_nle_f32 vcc, 0x21800000, v80
    v_cmp_nle_f32 s[6:7], v80, v10
    s_nop 0
    s_or_b64 vcc, vcc, s[6:7]
    s_waitcnt lgkmcnt(2)
    v_add_f32 v48, v48, v56
    v_add_f32 v49, v49, v57
    v_add_f32 v50, v50, v58
    v_add_f32 v51, v51, v59
    v_add_f32 v52, v52, v60
    v_add_f32 v53, v53, v61
    v_add_f32 v54, v54, v62
    v_add_f32 v55, v55, v63
    s_waitcnt lgkmcnt(0)
    v_add_f32 v64, v64, v72
    v_add_f32 v65, v65, v73
    v_add_f32 v66, v66, v74
    v_add_f32 v67, v67, v75
    v_add_f32 v68, v68, v76
    v_add_f32 v69, v69, v77
    v_add_f32 v70, v70, v78
    v_add_f32 v71, v71, v79
    v_add_f32 v48, v48, v64
    v_add_f32 v49, v49, v65
    v_add_f32 v50, v50, v66
    v_add_f32 v51, v51, v67
    v_add_f32 v52, v52, v68
    v_add_f32 v53, v53, v69
    v_add_f32 v54, v54, v70
    v_add_f32 v55, v55, v71
    v_mul_f32 v48, v48, v9
    v_mul_f32 v49, v49, v9
    v_mul_f32 v50, v50, v9
    v_mul_f32 v51, v51, v9
    v_mul_f32 v52, v52, v9
    v_mul_f32 v53, v53, v9
    v_mul_f32 v54, v54, v9
    v_mul_f32 v55, v55, v9
    v_cvt_pk_bf16_f32 v48, v48, v49
    v_cvt_pk_bf16_f32 v49, v50, v51
    v_cvt_pk_bf16_f32 v50, v52, v53
    v_cvt_pk_bf16_f32 v51, v54, v55
    v_cndmask_b32 v50, v50, v237, s[4:5]
    v_cndmask_b32 v51, v51, v237, s[4:5]
    s_cbranch_vccnz L_mk_bad
    s_cmp_eq_u32 s66, 2
    s_cbranch_scc1 L_mk_skip
L_mk_ost:
    s_mov_b32 s92, 1
    buffer_store_dwordx4 v[48:51], v2, s[16:19], s63 offen sc1
L_mk_ost2:
    v_mov_b32 v5, 161808
    s_waitcnt vmcnt(1)
    s_barrier
    ds_read_b32 v7, v5
    s_waitcnt lgkmcnt(0)
    v_readfirstlane_b32 s68, v7
    s_nop 0
    s_cmp_gt_u32 s68, s66
    s_cbranch_scc1 L_mk_fb
    s_cmp_ge_u32 s61, 14
    s_cbranch_scc1 L_mk_spare
    s_cmp_eq_u32 s64, 0
    s_cbranch_scc1 L_mk_slow
    s_mul_i32 s73, s55, 14336
    s_lshl_b32 s74, s56, 10
    s_lshl_b32 s75, s56, 6
    s_add_u32 s75, s75, s73
    s_mul_i32 s4, s55, 10240
    s_add_u32 s6, s4, 0
    s_add_u32 s4, s4, 114688
    s_mul_i32 s5, s55, 14336
    s_add_u32 s5, s5, 40960
    s_lshl_b32 s7, s55, 12
    s_add_u32 s7, s7, 98304
    s_cmp_lg_u32 s56, 0
    s_cbranch_scc1 L_mk_help_55
    s_lshl_b32 s69, s59, 16
    s_add_u32 s69, s69, 4259840
    s_lshl_b32 s71, s55, 13
    s_add_u32 s71, s71, s69
    v_and_b32 v5, 15, v1
    v_lshlrev_b32 v5, 11, v5
    v_add_u32 v5, 33792, v5
    s_mul_i32 s68, s55, 7168
    s_add_u32 s68, s68, 98304
    v_add_u32 v8, s68, v232
    ds_read_b64_tr_b16 v[80:81], v8 offset:0
    ds_read_b64_tr_b16 v[82:83], v8 offset:512
    ds_read_b64_tr_b16 v[84:85], v8 offset:28672
    ds_read_b64_tr_b16 v[86:87], v8 offset:29184
    ds_read_b64_tr_b16 v[88:89], v8 offset:1024
    ds_read_b64_tr_b16 v[90:91], v8 offset:1536
    ds_read_b64_tr_b16 v[92:93], v8 offset:29696
    ds_read_b64_tr_b16 v[94:95], v8 offset:30208
    ds_read_b64_tr_b16 v[96:97], v8 offset:1792
    ds_read_b64_tr_b16 v[98:99], v8 offset:2304
    ds_read_b64_tr_b16 v[100:101], v8 offset:30464
    ds_read_b64_tr_b16 v[102:103], v8 offset:30976
    s_waitcnt lgkmcnt(0)
    ds_read_b64_tr_b16 v[104:105], v8 offset:2816
    ds_read_b64_tr_b16 v[106:107], v8 offset:3328
    ds_read_b64_tr_b16 v[108:109], v8 offset:31488
    ds_read_b64_tr_b16 v[110:111], v8 offset:32000
    ds_read_b64_tr_b16 v[112:113], v8 offset:3584
    ds_read_b64_tr_b16 v[114:115], v8 offset:4096
    ds_read_b64_tr_b16 v[116:117], v8 offset:32256
    ds_read_b64_tr_b16 v[118:119], v8 offset:32768
    ds_read_b64_tr_b16 v[120:121], v8 offset:4608
    ds_read_b64_tr_b16 v[122:123], v8 offset:5120
    ds_read_b64_tr_b16 v[124:125], v8 offset:33280
    ds_read_b64_tr_b16 v[126:127], v8 offset:33792
    s_waitcnt lgkmcnt(0)
    ds_read_b64_tr_b16 v[128:129], v8 offset:5376
    ds_read_b64_tr_b16 v[130:131], v8 offset:5888
    ds_read_b64_tr_b16 v[132:133], v8 offset:34048
    ds_read_b64_tr_b16 v[134:135], v8 offset:34560
    ds_read_b64_tr_b16 v[136:137], v8 offset:6400
    ds_read_b64_tr_b16 v[138:139], v8 offset:6912
    ds_read_b64_tr_b16 v[140:141], v8 offset:35072
    ds_read_b64_tr_b16 v[142:143], v8 offset:35584
    v_mov_b32 v11, 161792
    v_mov_b32 v7, 1
    s_waitcnt lgkmcnt(0)
    s_mov_b64 exec, 1
    ds_add_u32 v11, v7 offset:8
    s_mov_b64 exec, -1
    s_and_b32 s70, s59, 1
    s_lshl_b32 s70, s70, 1
    s_add_u32 s70, s70, s56
    s_mul_i32 s70, s70, 28
    s_lshl_b32 s68, s58, 2
    s_add_u32 s70, s70, s68
    s_add_u32 s70, s70, s55
    s_lshl_b32 s70, s70, 10
    s_add_u32 s70, s70, s62
    v_add_u32 v9, 98304, v2
    v_mov_b32 v10, 161824
    s_lshl_b32 s68, s55, 11
    v_add_u32 v12, s68, v9
    s_cmp_lg_u32 s54, 0
    s_cbranch_scc1 L_mk_ow_57
    s_sleep 8
    s_mov_b32 s78, 0
L_mk_pr_60:
    buffer_load_dword v7, v5, s[16:19], s69 offen sc1
L_mk_pr_60f:
    s_add_u32 s78, s78, 1
    s_waitcnt vmcnt(0)
    v_cmp_eq_u32 vcc, -1, v7
    s_cmp_gt_u32 s78, 20000
    s_cbranch_scc1 L_mk_px_61
    s_cbranch_vccz L_mk_px_61
    s_sleep 2
    s_branch L_mk_pr_60
L_mk_px_61:
    v_mov_b32 v7, 1
    ds_write_b32 v10, v7
    s_branch L_mk_oe_58
L_mk_ow_57:
    s_mov_b32 s78, 0
L_mk_op_59:
    s_sleep 1
    ds_read_b32 v7, v10
    s_add_u32 s78, s78, 1
    s_waitcnt lgkmcnt(0)
    v_cmp_ne_u32 vcc, 0, v7
    s_nop 0
    s_cbranch_vccnz L_mk_oe_58
    s_cmp_lt_u32 s78, 160000
    s_cbranch_scc1 L_mk_op_59
L_mk_oe_58:
    s_add_u32 s68, s71, 32768
    buffer_load_dwordx4 v[48:51], v2, s[16:19], s68 offen offset:0 sc1
    buffer_load_dwordx4 v[52:55], v2, s[16:19], s68 offen offset:1024 sc1
    buffer_load_dwordx4 v[56:59], v2, s[16:19], s68 offen offset:2048 sc1
    buffer_load_dwordx4 v[60:63], v2, s[16:19], s68 offen offset:3072 sc1
    s_add_u32 s68, s71, 0
    buffer_load_dwordx4 v[16:19], v2, s[16:19], s68 offen offset:0 sc1
    buffer_load_dwordx4 v[20:23], v2, s[16:19], s68 offen offset:1024 sc1
    buffer_load_dwordx4 v[24:27], v2, s[16:19], s68 offen offset:2048 sc1
    buffer_load_dwordx4 v[28:31], v2, s[16:19], s68 offen offset:3072 sc1
    s_add_u32 s68, s71, 36864
    buffer_load_dwordx4 v[64:67], v2, s[16:19], s68 offen offset:0 sc1
    buffer_load_dwordx4 v[68:71], v2, s[16:19], s68 offen offset:1024 sc1
    buffer_load_dwordx4 v[72:75], v2, s[16:19], s68 offen offset:2048 sc1
    buffer_load_dwordx4 v[76:79], v2, s[16:19], s68 offen offset:3072 sc1
    s_add_u32 s68, s71, 4096
    buffer_load_dwordx4 v[32:35], v2, s[16:19], s68 offen offset:0 sc1
    buffer_load_dwordx4 v[36:39], v2, s[16:19], s68 offen offset:1024 sc1
    buffer_load_dwordx4 v[40:43], v2, s[16:19], s68 offen offset:2048 sc1
    buffer_load_dwordx4 v[44:47], v2, s[16:19], s68 offen offset:3072 sc1
    s_mov_b32 s78, 0
L_mk_wc_62:
    ds_read_b32 v7, v11 offset:8
    s_add_u32 s78, s78, 1
    s_waitcnt lgkmcnt(0)
    v_readfirstlane_b32 s68, v7
    s_cmp_gt_u32 s78, 160000
    s_cbranch_scc1 L_mk_wc_62x
    s_cmp_lt_u32 s68, 4
    s_cbranch_scc1 L_mk_wc_62
L_mk_wc_62x:
    s_waitcnt vmcnt(12)
    v_max_u32 v5, v48, v52
    v_max3_u32 v5, v56, v60, v5
    v_cmp_eq_u32 vcc, -1, v5
    s_nop 0
    s_cbranch_vccnz L_mk_rt_63
L_mk_bk_64:
    v_mfma_f32_32x32x16_bf16 v[176:191], v[80:83], v[48:51], 0
    v_mfma_f32_32x32x16_bf16 v[192:207], v[84:87], v[48:51], 0
    v_mfma_f32_32x32x16_bf16 v[176:191], v[88:91], v[52:55], v[176:191]
    v_mfma_f32_32x32x16_bf16 v[192:207], v[92:95], v[52:55], v[192:207]
    v_mfma_f32_32x32x16_bf16 v[176:191], v[96:99], v[56:59], v[176:191]
    v_mfma_f32_32x32x16_bf16 v[192:207], v[100:103], v[56:59], v[192:207]
    v_mfma_f32_32x32x16_bf16 v[176:191], v[104:107], v[60:63], v[176:191]
    v_mfma_f32_32x32x16_bf16 v[192:207], v[108:111], v[60:63], v[192:207]
    s_waitcnt vmcnt(8)
    v_max_u32 v5, v16, v20
    v_max3_u32 v5, v24, v28, v5
    v_cmp_eq_u32 vcc, -1, v5
    s_nop 0
    s_cbranch_vccnz L_mk_rt_65
L_mk_bk_66:
    v_mfma_f32_32x32x16_bf16 v[144:159], v[80:83], v[16:19], 0
    v_mfma_f32_32x32x16_bf16 v[160:175], v[84:87], v[16:19], 0
    v_mfma_f32_32x32x16_bf16 v[144:159], v[88:91], v[20:23], v[144:159]
    v_mfma_f32_32x32x16_bf16 v[160:175], v[92:95], v[20:23], v[160:175]
    v_mfma_f32_32x32x16_bf16 v[144:159], v[96:99], v[24:27], v[144:159]
    v_mfma_f32_32x32x16_bf16 v[160:175], v[100:103], v[24:27], v[160:175]
    v_mfma_f32_32x32x16_bf16 v[144:159], v[104:107], v[28:31], v[144:159]
    v_mfma_f32_32x32x16_bf16 v[160:175], v[108:111], v[28:31], v[160:175]
    s_waitcnt vmcnt(4)
    v_max_u32 v5, v64, v68
    v_max3_u32 v5, v72, v76, v5
    v_cmp_eq_u32 vcc, -1, v5
    s_nop 0
    s_cbranch_vccnz L_mk_rt_67
L_mk_bk_68:
    v_mfma_f32_32x32x16_bf16 v[176:191], v[112:115], v[64:67], v[176:191]
    v_mfma_f32_32x32x16_bf16 v[192:207], v[116:119], v[64:67], v[192:207]
    v_mfma_f32_32x32x16_bf16 v[176:191], v[120:123], v[68:71], v[176:191]
    v_mfma_f32_32x32x16_bf16 v[192:207], v[124:127], v[68:71], v[192:207]
    v_mfma_f32_32x32x16_bf16 v[176:191], v[128:131], v[72:75], v[176:191]
    v_mfma_f32_32x32x16_bf16 v[192:207], v[132:135], v[72:75], v[192:207]
    v_mfma_f32_32x32x16_bf16 v[176:191], v[136:139], v[76:79], v[176:191]
    v_mfma_f32_32x32x16_bf16 v[192:207], v[140:143], v[76:79], v[192:207]
    s_waitcnt vmcnt(0)
    v_max_u32 v5, v32, v36
    v_max3_u32 v5, v40, v44, v5
    v_cmp_eq_u32 vcc, -1, v5
    s_nop 0
    s_cbranch_vccnz L_mk_rt_69
L_mk_bk_70:
    v_mfma_f32_32x32x16_bf16 v[144:159], v[112:115], v[32:35], v[144:159]
    v_mfma_f32_32x32x16_bf16 v[160:175], v[116:119], v[32:35], v[160:175]
    v_mfma_f32_32x32x16_bf16 v[144:159], v[120:123], v[36:39], v[144:159]
    s_nop 1
    ds_write_b128 v12, v[176:179] offset:0
    ds_write_b128 v12, v[180:183] offset:1024
    v_mfma_f32_32x32x16_bf16 v[160:175], v[124:127], v[36:39], v[160:175]
    ds_write_b128 v12, v[184:187] offset:8192
    v_mfma_f32_32x32x16_bf16 v[144:159], v[128:131], v[40:43], v[144:159]
    ds_write_b128 v12, v[188:191] offset:9216
    v_mfma_f32_32x32x16_bf16 v[160:175], v[132:135], v[40:43], v[160:175]
    ds_write_b128 v12, v[192:195] offset:16384
    ds_write_b128 v12, v[196:199] offset:17408
    v_mfma_f32_32x32x16_bf16 v[144:159], v[136:139], v[44:47], v[144:159]
    ds_write_b128 v12, v[200:203] offset:24576
    v_mfma_f32_32x32x16_bf16 v[160:175], v[140:143], v[44:47], v[160:175]
    ds_write_b128 v12, v[204:207] offset:25600
    v_lshlrev_b32 v80, 16, v244
    v_and_b32 v81, 0xffff0000, v244
    v_lshlrev_b32 v82, 16, v245
    v_and_b32 v83, 0xffff0000, v245
    v_lshlrev_b32 v84, 16, v246
    v_and_b32 v85, 0xffff0000, v246
    v_lshlrev_b32 v86, 16, v247
    v_and_b32 v87, 0xffff0000, v247
    s_cmp_eq_u32 s55, 1
    s_cbranch_scc1 L_mk_rk1_73
    s_cmp_eq_u32 s55, 2
    s_cbranch_scc1 L_mk_rk2_74
    s_cmp_eq_u32 s55, 3
    s_cbranch_scc1 L_mk_rk3_75
L_mk_rk0_72:
    ds_write_b128 v9, v[152:155] offset:43008
    ds_write_b128 v9, v[156:159] offset:44032
    ds_write_b128 v9, v[160:163] offset:47104
    ds_write_b128 v9, v[164:167] offset:48128
    ds_write_b128 v9, v[168:171] offset:51200
    ds_write_b128 v9, v[172:175] offset:52224
    s_waitcnt lgkmcnt(0)
    s_barrier
    ds_read_b128 v[16:19], v9 offset:32768
    ds_read_b128 v[20:23], v9 offset:33792
    ds_read_b128 v[24:27], v9 offset:34816
    ds_read_b128 v[28:31], v9 offset:35840
    ds_read_b128 v[32:35], v9 offset:36864
    ds_read_b128 v[36:39], v9 offset:37888
    s_waitcnt lgkmcnt(4)
    v_add_f32 v16, v16, v144
    v_add_f32 v17, v17, v145
    v_add_f32 v18, v18, v146
    v_add_f32 v19, v19, v147
    v_add_f32 v20, v20, v148
    v_add_f32 v21, v21, v149
    v_add_f32 v22, v22, v150
    v_add_f32 v23, v23, v151
    s_branch L_mk_rd_71
L_mk_rk1_73:
    ds_write_b128 v9, v[144:147] offset:32768
    ds_write_b128 v9, v[148:151] offset:33792
    ds_write_b128 v9, v[160:163] offset:49152
    ds_write_b128 v9, v[164:167] offset:50176
    ds_write_b128 v9, v[168:171] offset:53248
    ds_write_b128 v9, v[172:175] offset:54272
    s_waitcnt lgkmcnt(0)
    s_barrier
    ds_read_b128 v[16:19], v9 offset:38912
    ds_read_b128 v[20:23], v9 offset:39936
    ds_read_b128 v[24:27], v9 offset:40960
    ds_read_b128 v[28:31], v9 offset:41984
    ds_read_b128 v[32:35], v9 offset:43008
    ds_read_b128 v[36:39], v9 offset:44032
    s_waitcnt lgkmcnt(4)
    v_add_f32 v16, v16, v152
    v_add_f32 v17, v17, v153
    v_add_f32 v18, v18, v154
    v_add_f32 v19, v19, v155
    v_add_f32 v20, v20, v156
    v_add_f32 v21, v21, v157
    v_add_f32 v22, v22, v158
    v_add_f32 v23, v23, v159
    s_branch L_mk_rd_71
L_mk_rk2_74:
    ds_write_b128 v9, v[144:147] offset:34816
    ds_write_b128 v9, v[148:151] offset:35840
    ds_write_b128 v9, v[152:155] offset:38912
    ds_write_b128 v9, v[156:159] offset:39936
    ds_write_b128 v9, v[168:171] offset:55296
    ds_write_b128 v9, v[172:175] offset:56320
    s_waitcnt lgkmcnt(0)
    s_barrier
    ds_read_b128 v[16:19], v9 offset:45056
    ds_read_b128 v[20:23], v9 offset:46080
    ds_read_b128 v[24:27], v9 offset:47104
    ds_read_b128 v[28:31], v9 offset:48128
    ds_read_b128 v[32:35], v9 offset:49152
    ds_read_b128 v[36:39], v9 offset:50176
    s_waitcnt lgkmcnt(4)
    v_add_f32 v16, v16, v160
    v_add_f32 v17, v17, v161
    v_add_f32 v18, v18, v162
    v_add_f32 v19, v19, v163
    v_add_f32 v20, v20, v164
    v_add_f32 v21, v21, v165
    v_add_f32 v22, v22, v166
    v_add_f32 v23, v23, v167
    s_branch L_mk_rd_71
L_mk_rk3_75:
    ds_write_b128 v9, v[144:147] offset:36864
    ds_write_b128 v9, v[148:151] offset:37888
    ds_write_b128 v9, v[152:155] offset:40960
    ds_write_b128 v9, v[156:159] offset:41984
    ds_write_b128 v9, v[160:163] offset:45056
    ds_write_b128 v9, v[164:167] offset:46080
    s_waitcnt lgkmcnt(0)
    s_barrier
    ds_read_b128 v[16:19], v9 offset:51200
    ds_read_b128 v[20:23], v9 offset:52224
    ds_read_b128 v[24:27], v9 offset:53248
    ds_read_b128 v[28:31], v9 offset:54272
    ds_read_b128 v[32:35], v9 offset:55296
    ds_read_b128 v[36:39], v9 offset:56320
    s_waitcnt lgkmcnt(4)
    v_add_f32 v16, v16, v168
    v_add_f32 v17, v17, v169
    v_add_f32 v18, v18, v170
    v_add_f32 v19, v19, v171
    v_add_f32 v20, v20, v172
    v_add_f32 v21, v21, v173
    v_add_f32 v22, v22, v174
    v_add_f32 v23, v23, v175
L_mk_rd_71:
    s_waitcnt lgkmcnt(0)
    v_add_f32 v24, v24, v32
    v_add_f32 v25, v25, v33
    v_add_f32 v26, v26, v34
    v_add_f32 v27, v27, v35
    v_add_f32 v28, v28, v36
    v_add_f32 v29, v29, v37
    v_add_f32 v30, v30, v38
    v_add_f32 v31, v31, v39
    v_add_f32 v16, v16, v24
    v_add_f32 v17, v17, v25
    v_add_f32 v18, v18, v26
    v_add_f32 v19, v19, v27
    v_add_f32 v20, v20, v28
    v_add_f32 v21, v21, v29
    v_add_f32 v22, v22, v30
    v_add_f32 v23, v23, v31
    v_cvt_pk_bf16_f32 v24, v16, v17
    v_cvt_pk_bf16_f32 v25, v18, v19
    v_cvt_pk_bf16_f32 v26, v20, v21
    v_cvt_pk_bf16_f32 v27, v22, v23
    v_lshlrev_b32 v16, 16, v24
    v_and_b32 v17, 0xffff0000, v24
    v_lshlrev_b32 v18, 16, v25
    v_and_b32 v19, 0xffff0000, v25
    v_lshlrev_b32 v20, 16, v26
    v_and_b32 v21, 0xffff0000, v26
    v_lshlrev_b32 v22, 16, v27
    v_and_b32 v23, 0xffff0000, v27
    v_add_f32 v16, v16, v80
    v_add_f32 v17, v17, v81
    v_add_f32 v18, v18, v82
    v_add_f32 v19, v19, v83
    v_add_f32 v20, v20, v84
    v_add_f32 v21, v21, v85
    v_add_f32 v22, v22, v86
    v_add_f32 v23, v23, v87
    v_cvt_pk_bf16_f32 v240, v16, v17
    v_cvt_pk_bf16_f32 v241, v18, v19
    v_cvt_pk_bf16_f32 v242, v20, v21
    v_cvt_pk_bf16_f32 v243, v22, v23
    buffer_store_dwordx4 v[240:243], v2, s[16:19], s70 offen
    v_lshlrev_b32 v16, 16, v240
    v_and_b32 v17, 0xffff0000, v240
    v_lshlrev_b32 v18, 16, v241
    v_and_b32 v19, 0xffff0000, v241
    v_lshlrev_b32 v20, 16, v242
    v_and_b32 v21, 0xffff0000, v242
    v_lshlrev_b32 v22, 16, v243
    v_and_b32 v23, 0xffff0000, v243
    v_add_f32 v10, v16, v17
    v_mul_f32 v11, v16, v16
    v_fma_f32 v11, v17, v17, v11
    v_add_f32 v10, v10, v18
    v_fma_f32 v11, v18, v18, v11
    v_add_f32 v10, v10, v19
    v_fma_f32 v11, v19, v19, v11
    v_add_f32 v10, v10, v20
    v_fma_f32 v11, v20, v20, v11
    v_add_f32 v10, v10, v21
    v_fma_f32 v11, v21, v21, v11
    v_add_f32 v10, v10, v22
    v_fma_f32 v11, v22, v22, v11
    v_add_f32 v10, v10, v23
    v_fma_f32 v11, v23, v23, v11
    s_mul_i32 s76, s55, 28672
    s_add_u32 s76, s76, s62
    v_min_u32 v14, 6, v1
    v_lshlrev_b32 v14, 12, v14
    v_add_u32 v14, 3072, v14
    buffer_load_dword v15, v14, s[16:19], s76 offen sc1
    v_mov_b32 v12, v10
    v_mov_b32 v13, v11
    s_lshl_b32 s70, s56, 10
    s_lshl_b32 s71, s55, 3
    s_add_u32 s70, s70, s71
    s_add_u32 s70, s70, 159744
    v_permlane32_swap_b32 v10, v12
    v_permlane32_swap_b32 v11, v13
    v_lshl_add_u32 v5, v4, 5, s70
    v_add_f32 v12, v10, v12
    v_add_f32 v13, v11, v13
    ds_write_b64 v5, v[12:13]
    s_waitcnt lgkmcnt(0)
    s_barrier
    s_mul_i32 s70, s55, 28672
    s_add_u32 s70, s70, s62
    v_min_u32 v5, 6, v1
    v_lshlrev_b32 v5, 12, v5
    v_add_u32 v5, 3072, v5
    v_add_u32 v8, 40960, v232
    v_add_u32 v9, 98304, v232
    s_and_b32 s71, s55, 1
    s_lshl_b32 s71, s71, 8
    v_lshl_add_u32 v10, v4, 3, s71
    v_lshl_add_u32 v11, v3, 9, v10
    v_lshlrev_b32 v12, 4, v4
    ds_read_b64_tr_b16 v[192:193], v8 offset:24576
    ds_read_b64_tr_b16 v[194:195], v8 offset:25088
    ds_read_b64_tr_b16 v[196:197], v8 offset:28672
    ds_read_b64_tr_b16 v[198:199], v8 offset:29184
    ds_read_b64_tr_b16 v[200:201], v8 offset:25600
    ds_read_b64_tr_b16 v[202:203], v8 offset:26112
    ds_read_b64_tr_b16 v[204:205], v8 offset:29696
    ds_read_b64_tr_b16 v[206:207], v8 offset:30208
    s_mov_b32 s78, 0
    s_branch L_mk_pr_76f
L_mk_pr_76:
    buffer_load_dword v15, v14, s[16:19], s70 offen sc1
L_mk_pr_76f:
    s_add_u32 s78, s78, 1
    s_waitcnt vmcnt(0)
    v_cmp_eq_u32 vcc, -1, v15
    s_cmp_gt_u32 s78, 20000
    s_cbranch_scc1 L_mk_px_77
    s_cbranch_vccz L_mk_px_77
    s_branch L_mk_pr_76
L_mk_px_77:
    s_add_u32 s71, s70, 0
    buffer_load_dwordx4 v[16:19], v2, s[16:19], s71 offen offset:0 sc1
    buffer_load_dwordx4 v[20:23], v2, s[16:19], s71 offen offset:1024 sc1
    buffer_load_dwordx4 v[24:27], v2, s[16:19], s71 offen offset:2048 sc1
    buffer_load_dwordx4 v[28:31], v2, s[16:19], s71 offen offset:3072 sc1
    s_add_u32 s71, s70, 4096
    buffer_load_dwordx4 v[32:35], v2, s[16:19], s71 offen offset:0 sc1
    buffer_load_dwordx4 v[36:39], v2, s[16:19], s71 offen offset:1024 sc1
    buffer_load_dwordx4 v[40:43], v2, s[16:19], s71 offen offset:2048 sc1
    buffer_load_dwordx4 v[44:47], v2, s[16:19], s71 offen offset:3072 sc1
    s_add_u32 s71, s70, 8192
    buffer_load_dwordx4 v[48:51], v2, s[16:19], s71 offen offset:0 sc1
    buffer_load_dwordx4 v[52:55], v2, s[16:19], s71 offen offset:1024 sc1
    buffer_load_dwordx4 v[56:59], v2, s[16:19], s71 offen offset:2048 sc1
    buffer_load_dwordx4 v[60:63], v2, s[16:19], s71 offen offset:3072 sc1
    s_waitcnt vmcnt(8)
    v_max_u32 v5, v16, v20
    v_max3_u32 v5, v24, v28, v5
    v_cmp_eq_u32 vcc, -1, v5
    s_nop 0
    s_cbranch_vccnz L_mk_rt_78
L_mk_bk_79:
    s_waitcnt lgkmcnt(4)
    v_mfma_f32_32x32x16_bf16 v[128:143], v[192:195], v[16:19], 0
    ds_read_b64_tr_b16 v[208:209], v8 offset:26624
    s_add_u32 s71, s70, 12288
    ds_read_b64_tr_b16 v[210:211], v8 offset:27136
    v_mfma_f32_32x32x16_bf16 v[144:159], v[196:199], v[16:19], 0
    ds_read_b64_tr_b16 v[212:213], v8 offset:30720
    buffer_load_dwordx4 v[64:67], v2, s[16:19], s71 offen offset:0 sc1
    ds_read_b64_tr_b16 v[214:215], v8 offset:31232
    s_waitcnt lgkmcnt(4)
    v_mfma_f32_32x32x16_bf16 v[128:143], v[200:203], v[20:23], v[128:143]
    ds_read_b64_tr_b16 v[192:193], v8 offset:27648
    buffer_load_dwordx4 v[68:71], v2, s[16:19], s71 offen offset:1024 sc1
    ds_read_b64_tr_b16 v[194:195], v8 offset:28160
    v_mfma_f32_32x32x16_bf16 v[144:159], v[204:207], v[20:23], v[144:159]
    ds_read_b64_tr_b16 v[196:197], v8 offset:31744
    ds_read_b64_tr_b16 v[198:199], v8 offset:32256
    s_waitcnt lgkmcnt(4)
    v_mfma_f32_32x32x16_bf16 v[128:143], v[208:211], v[24:27], v[128:143]
    ds_read_b64_tr_b16 v[200:201], v8 offset:32768
    buffer_load_dwordx4 v[72:75], v2, s[16:19], s71 offen offset:2048 sc1
    ds_read_b64_tr_b16 v[202:203], v8 offset:33280
    v_mfma_f32_32x32x16_bf16 v[144:159], v[212:215], v[24:27], v[144:159]
    ds_read_b64_tr_b16 v[204:205], v8 offset:36864
    ds_read_b64_tr_b16 v[206:207], v8 offset:37376
    s_waitcnt lgkmcnt(4)
    v_mfma_f32_32x32x16_bf16 v[128:143], v[192:195], v[28:31], v[128:143]
    ds_read_b64_tr_b16 v[208:209], v8 offset:33792
    buffer_load_dwordx4 v[76:79], v2, s[16:19], s71 offen offset:3072 sc1
    ds_read_b64_tr_b16 v[210:211], v8 offset:34304
    s_waitcnt vmcnt(8)
    v_max_u32 v5, v32, v36
    v_mfma_f32_32x32x16_bf16 v[144:159], v[196:199], v[28:31], v[144:159]
    ds_read_b64_tr_b16 v[212:213], v8 offset:37888
    v_max3_u32 v5, v40, v44, v5
    ds_read_b64_tr_b16 v[214:215], v8 offset:38400
    v_cmp_eq_u32 vcc, -1, v5
    s_nop 0
    s_cbranch_vccnz L_mk_rt_80
L_mk_bk_81:
    s_waitcnt lgkmcnt(4)
    v_mfma_f32_32x32x16_bf16 v[128:143], v[200:203], v[32:35], v[128:143]
    ds_read_b64_tr_b16 v[192:193], v8 offset:34816
    s_add_u32 s71, s70, 16384
    ds_read_b64_tr_b16 v[194:195], v8 offset:35328
    v_mfma_f32_32x32x16_bf16 v[144:159], v[204:207], v[32:35], v[144:159]
    ds_read_b64_tr_b16 v[196:197], v8 offset:38912
    buffer_load_dwordx4 v[80:83], v2, s[16:19], s71 offen offset:0 sc1
    ds_read_b64_tr_b16 v[198:199], v8 offset:39424
    s_waitcnt lgkmcnt(4)
    v_mfma_f32_32x32x16_bf16 v[128:143], v[208:211], v[36:39], v[128:143]
    ds_read_b64_tr_b16 v[200:201], v8 offset:35840
    buffer_load_dwordx4 v[84:87], v2, s[16:19], s71 offen offset:1024 sc1
    ds_read_b64_tr_b16 v[202:203], v8 offset:36352
    v_mfma_f32_32x32x16_bf16 v[144:159], v[212:215], v[36:39], v[144:159]
    ds_read_b64_tr_b16 v[204:205], v8 offset:39936
    ds_read_b64_tr_b16 v[206:207], v8 offset:40448
    s_waitcnt lgkmcnt(4)
    v_mfma_f32_32x32x16_bf16 v[128:143], v[192:195], v[40:43], v[128:143]
    ds_read_b64_tr_b16 v[208:209], v8 offset:40960
    buffer_load_dwordx4 v[88:91], v2, s[16:19], s71 offen offset:2048 sc1
    ds_read_b64_tr_b16 v[210:211], v8 offset:41472
    v_mfma_f32_32x32x16_bf16 v[144:159], v[196:199], v[40:43], v[144:159]
    ds_read_b64_tr_b16 v[212:213], v8 offset:45056
    ds_read_b64_tr_b16 v[214:215], v8 offset:45568
    s_waitcnt lgkmcnt(4)
    v_mfma_f32_32x32x16_bf16 v[128:143], v[200:203], v[44:47], v[128:143]
    ds_read_b64_tr_b16 v[192:193], v8 offset:41984
    buffer_load_dwordx4 v[92:95], v2, s[16:19], s71 offen offset:3072 sc1
    ds_read_b64_tr_b16 v[194:195], v8 offset:42496
    s_waitcnt vmcnt(8)
    v_max_u32 v5, v48, v52
    v_mfma_f32_32x32x16_bf16 v[144:159], v[204:207], v[44:47], v[144:159]
    ds_read_b64_tr_b16 v[196:197], v8 offset:46080
    v_max3_u32 v5, v56, v60, v5
    ds_read_b64_tr_b16 v[198:199], v8 offset:46592
    v_cmp_eq_u32 vcc, -1, v5
    s_nop 0
    s_cbranch_vccnz L_mk_rt_82
L_mk_bk_83:
    s_waitcnt lgkmcnt(4)
    v_mfma_f32_32x32x16_bf16 v[128:143], v[208:211], v[48:51], v[128:143]
    ds_read_b64_tr_b16 v[200:201], v8 offset:43008
    s_add_u32 s71, s70, 20480
    ds_read_b64_tr_b16 v[202:203], v8 offset:43520
    v_mfma_f32_32x32x16_bf16 v[144:159], v[212:215], v[48:51], v[144:159]
    ds_read_b64_tr_b16 v[204:205], v8 offset:47104
    buffer_load_dwordx4 v[96:99], v2, s[16:19], s71 offen offset:0 sc1
    ds_read_b64_tr_b16 v[206:207], v8 offset:47616
    s_waitcnt lgkmcnt(4)
    v_mfma_f32_32x32x16_bf16 v[128:143], v[192:195], v[52:55], v[128:143]
    ds_read_b64_tr_b16 v[208:209], v8 offset:44032
    buffer_load_dwordx4 v[100:103], v2, s[16:19], s71 offen offset:1024 sc1
    ds_read_b64_tr_b16 v[210:211], v8 offset:44544
    v_mfma_f32_32x32x16_bf16 v[144:159], v[196:199], v[52:55], v[144:159]
    ds_read_b64_tr_b16 v[212:213], v8 offset:48128
    ds_read_b64_tr_b16 v[214:215], v8 offset:48640
    s_waitcnt lgkmcnt(4)
    v_mfma_f32_32x32x16_bf16 v[128:143], v[200:203], v[56:59], v[128:143]
    ds_read_b64_tr_b16 v[192:193], v8 offset:49152
    buffer_load_dwordx4 v[104:107], v2, s[16:19], s71 offen offset:2048 sc1
    ds_read_b64_tr_b16 v[194:195], v8 offset:49664
    v_mfma_f32_32x32x16_bf16 v[144:159], v[204:207], v[56:59], v[144:159]
    ds_read_b64_tr_b16 v[196:197], v8 offset:53248
    ds_read_b64_tr_b16 v[198:199], v8 offset:53760
    s_waitcnt lgkmcnt(4)
    v_mfma_f32_32x32x16_bf16 v[128:143], v[208:211], v[60:63], v[128:143]
    ds_read_b64_tr_b16 v[200:201], v8 offset:50176
    buffer_load_dwordx4 v[108:111], v2, s[16:19], s71 offen offset:3072 sc1
    ds_read_b64_tr_b16 v[202:203], v8 offset:50688
    s_lshr_b32 s76, s55, 1
    s_mul_i32 s76, s76, 3584
    s_add_u32 s76, s76, s62
    s_add_u32 s76, s76, 114688
    s_lshl_b32 s69, s61, 11
    v_mfma_f32_32x32x16_bf16 v[144:159], v[212:215], v[60:63], v[144:159]
    ds_read_b64_tr_b16 v[204:205], v8 offset:54272
    s_add_u32 s69, s69, 17891328
    ds_read_b64_tr_b16 v[206:207], v8 offset:54784
    s_waitcnt vmcnt(8)
    v_max_u32 v5, v64, v68
    v_max3_u32 v5, v72, v76, v5
    v_cmp_eq_u32 vcc, -1, v5
    s_nop 0
    s_cbranch_vccnz L_mk_rt_84
L_mk_bk_85:
    s_waitcnt lgkmcnt(4)
    v_mfma_f32_32x32x16_bf16 v[128:143], v[192:195], v[64:67], v[128:143]
    ds_read_b64_tr_b16 v[208:209], v8 offset:51200
    s_add_u32 s71, s70, 24576
    ds_read_b64_tr_b16 v[210:211], v8 offset:51712
    buffer_load_dwordx4 v[112:115], v2, s[16:19], s71 offen offset:0 sc1
    v_mfma_f32_32x32x16_bf16 v[144:159], v[196:199], v[64:67], v[144:159]
    ds_read_b64_tr_b16 v[212:213], v8 offset:55296
    buffer_load_dwordx2 v[160:161], v11, s[16:19], s76 offen offset:0 sc1
    ds_read_b64_tr_b16 v[214:215], v8 offset:55808
    buffer_load_dwordx2 v[162:163], v11, s[16:19], s76 offen offset:1024 sc1
    s_waitcnt lgkmcnt(4)
    v_mfma_f32_32x32x16_bf16 v[128:143], v[200:203], v[68:71], v[128:143]
    ds_read_b64_tr_b16 v[192:193], v8 offset:52224
    buffer_load_dwordx4 v[116:119], v2, s[16:19], s71 offen offset:1024 sc1
    ds_read_b64_tr_b16 v[194:195], v8 offset:52736
    buffer_load_dwordx2 v[164:165], v11, s[16:19], s76 offen offset:2048 sc1
    v_mfma_f32_32x32x16_bf16 v[144:159], v[204:207], v[68:71], v[144:159]
    ds_read_b64_tr_b16 v[196:197], v8 offset:56320
    buffer_load_dwordx2 v[166:167], v10, s[16:19], s76 offen offset:3072 sc1
    ds_read_b64_tr_b16 v[198:199], v8 offset:56832
    s_waitcnt lgkmcnt(4)
    v_mfma_f32_32x32x16_bf16 v[128:143], v[208:211], v[72:75], v[128:143]
    ds_read_b64_tr_b16 v[200:201], v8 offset:0
    buffer_load_dwordx4 v[120:123], v2, s[16:19], s71 offen offset:2048 sc1
    ds_read_b64_tr_b16 v[202:203], v8 offset:512
    buffer_load_dwordx4 v[216:219], v12, s[16:19], s69 offen offset:0 sc1
    v_mfma_f32_32x32x16_bf16 v[144:159], v[212:215], v[72:75], v[144:159]
    ds_read_b64_tr_b16 v[204:205], v8 offset:4096
    buffer_load_dwordx4 v[220:223], v12, s[16:19], s69 offen offset:512 sc1
    ds_read_b64_tr_b16 v[206:207], v8 offset:4608
    s_waitcnt lgkmcnt(4)
    v_mfma_f32_32x32x16_bf16 v[128:143], v[192:195], v[76:79], v[128:143]
    ds_read_b64_tr_b16 v[208:209], v8 offset:1024
    buffer_load_dwordx4 v[124:127], v2, s[16:19], s71 offen offset:3072 sc1
    ds_read_b64_tr_b16 v[210:211], v8 offset:1536
    buffer_load_dwordx4 v[224:227], v12, s[16:19], s69 offen offset:1024 sc1
    buffer_load_dwordx4 v[228:231], v12, s[16:19], s69 offen offset:1536 sc1
    s_waitcnt vmcnt(16)
    v_mfma_f32_32x32x16_bf16 v[144:159], v[196:199], v[76:79], v[144:159]
    ds_read_b64_tr_b16 v[212:213], v8 offset:5120
    v_max_u32 v5, v80, v84
    ds_read_b64_tr_b16 v[214:215], v8 offset:5632
    v_max3_u32 v5, v88, v92, v5
    v_cmp_eq_u32 vcc, -1, v5
    s_nop 0
    s_cbranch_vccnz L_mk_rt_86
L_mk_bk_87:
    s_waitcnt lgkmcnt(4)
    v_mfma_f32_32x32x16_bf16 v[128:143], v[200:203], v[80:83], v[128:143]
    ds_read_b64_tr_b16 v[192:193], v8 offset:2048
    ds_read_b64_tr_b16 v[194:195], v8 offset:2560
    v_mfma_f32_32x32x16_bf16 v[144:159], v[204:207], v[80:83], v[144:159]
    ds_read_b64_tr_b16 v[196:197], v8 offset:6144
    ds_read_b64_tr_b16 v[198:199], v8 offset:6656
    s_waitcnt lgkmcnt(4)
    v_mfma_f32_32x32x16_bf16 v[128:143], v[208:211], v[84:87], v[128:143]
    ds_read_b64_tr_b16 v[200:201], v8 offset:3072
    ds_read_b64_tr_b16 v[202:203], v8 offset:3584
    v_mfma_f32_32x32x16_bf16 v[144:159], v[212:215], v[84:87], v[144:159]
    ds_read_b64_tr_b16 v[204:205], v8 offset:7168
    ds_read_b64_tr_b16 v[206:207], v8 offset:7680
    s_waitcnt lgkmcnt(4)
    v_mfma_f32_32x32x16_bf16 v[128:143], v[192:195], v[88:91], v[128:143]
    ds_read_b64_tr_b16 v[208:209], v8 offset:8192
    ds_read_b64_tr_b16 v[210:211], v8 offset:8704
    v_mfma_f32_32x32x16_bf16 v[144:159], v[196:199], v[88:91], v[144:159]
    ds_read_b64_tr_b16 v[212:213], v8 offset:12288
    ds_read_b64_tr_b16 v[214:215], v8 offset:12800
    s_waitcnt lgkmcnt(4)
    v_mfma_f32_32x32x16_bf16 v[128:143], v[200:203], v[92:95], v[128:143]
    ds_read_b64_tr_b16 v[192:193], v8 offset:9216
    s_waitcnt vmcnt(0)
    ds_read_b64_tr_b16 v[194:195], v8 offset:9728
    v_max_u32 v5, v96, v100
    v_max3_u32 v5, v104, v108, v5
    v_mfma_f32_32x32x16_bf16 v[144:159], v[204:207], v[92:95], v[144:159]
    ds_read_b64_tr_b16 v[196:197], v8 offset:13312
    v_cmp_eq_u32 vcc, -1, v5
    ds_read_b64_tr_b16 v[198:199], v8 offset:13824
    s_cbranch_vccnz L_mk_rt_88
L_mk_bk_89:
    s_waitcnt lgkmcnt(4)
    v_mfma_f32_32x32x16_bf16 v[128:143], v[208:211], v[96:99], v[128:143]
    ds_read_b64_tr_b16 v[200:201], v8 offset:10240
    v_xor_b32 v218, s82, v218
    ds_read_b64_tr_b16 v[202:203], v8 offset:10752
    v_xor_b32 v219, s82, v219
    v_xor_b32 v222, s82, v222
    v_xor_b32 v223, s82, v223
    v_xor_b32 v226, s82, v226
    v_xor_b32 v227, s82, v227
    v_xor_b32 v230, s82, v230
    v_xor_b32 v231, s82, v231
    v_mfma_f32_32x32x16_bf16 v[144:159], v[212:215], v[96:99], v[144:159]
    ds_read_b64_tr_b16 v[204:205], v8 offset:14336
    v_or_b32 v7, v218, v222
    ds_read_b64_tr_b16 v[206:207], v8 offset:14848
    v_or3_b32 v7, v226, v230, v7
    v_cmp_ne_u32 vcc, 0, v7
    s_nop 0
    s_cbranch_vccnz L_mk_xr_90
L_mk_xb_91:
    v_max_u32 v5, v160, v162
    v_max3_u32 v5, v164, v166, v5
    v_cmp_eq_u32 vcc, -1, v5
    s_nop 0
    s_cbranch_vccnz L_mk_rt_92
L_mk_bk_93:
    s_waitcnt lgkmcnt(4)
    v_mfma_f32_32x32x16_bf16 v[128:143], v[192:195], v[100:103], v[128:143]
    ds_read_b64_tr_b16 v[208:209], v8 offset:11264
    v_cmp_eq_u32 s[22:23], 0, v3
    ds_read_b64_tr_b16 v[210:211], v8 offset:11776
    v_add_f32 v160, v160, v162
    v_add_f32 v161, v161, v163
    v_mfma_f32_32x32x16_bf16 v[144:159], v[196:199], v[100:103], v[144:159]
    ds_read_b64_tr_b16 v[212:213], v8 offset:15360
    v_cndmask_b32 v166, v237, v166, s[22:23]
    ds_read_b64_tr_b16 v[214:215], v8 offset:15872
    v_cndmask_b32 v167, v237, v167, s[22:23]
    v_add_f32 v164, v164, v166
    s_waitcnt lgkmcnt(4)
    v_mfma_f32_32x32x16_bf16 v[128:143], v[200:203], v[104:107], v[128:143]
    ds_read_b64_tr_b16 v[192:193], v8 offset:16384
    v_add_f32 v165, v165, v167
    ds_read_b64_tr_b16 v[194:195], v8 offset:16896
    v_add_f32 v160, v160, v164
    v_add_f32 v161, v161, v165
    v_mfma_f32_32x32x16_bf16 v[144:159], v[204:207], v[104:107], v[144:159]
    ds_read_b64_tr_b16 v[196:197], v8 offset:20480
    v_mov_b32 v162, v160
    ds_read_b64_tr_b16 v[198:199], v8 offset:20992
    v_mov_b32 v163, v161
    v_mov_b32 v14, 0
    s_waitcnt lgkmcnt(4)
    v_mfma_f32_32x32x16_bf16 v[128:143], v[208:211], v[108:111], v[128:143]
    ds_read_b64_tr_b16 v[200:201], v8 offset:17408
    s_waitcnt vmcnt(0)
    ds_read_b64_tr_b16 v[202:203], v8 offset:17920
    v_max_u32 v5, v112, v116
    v_max3_u32 v5, v120, v124, v5
    v_cmp_eq_u32 vcc, -1, v5
    s_nop 0
    s_cbranch_vccnz L_mk_rt_94
L_mk_bk_95:
    v_mov_b32 v15, 0
    v_mfma_f32_32x32x16_bf16 v[144:159], v[212:215], v[108:111], v[144:159]
    ds_read_b64_tr_b16 v[204:205], v8 offset:21504
    v_permlane32_swap_b32 v160, v162
    ds_read_b64_tr_b16 v[206:207], v8 offset:22016
    v_permlane32_swap_b32 v161, v163
    v_add_f32 v160, v160, v162
    v_add_f32 v161, v161, v163
    v_mul_f32 v162, 0x3b124925, v160
    s_waitcnt lgkmcnt(4)
    v_mfma_f32_32x32x16_bf16 v[128:143], v[192:195], v[112:115], v[128:143]
    ds_read_b64_tr_b16 v[208:209], v8 offset:18432
    v_mul_f32 v165, 0x3b124925, v161
    ds_read_b64_tr_b16 v[210:211], v8 offset:18944
    v_fma_f32 v165, -v162, v162, v165
    v_max_f32 v165, 0, v165
    v_mfma_f32_32x32x16_bf16 v[144:159], v[196:199], v[112:115], v[144:159]
    ds_read_b64_tr_b16 v[212:213], v8 offset:22528
    v_cvt_pk_bf16_f32 v165, v165, v162
    ds_read_b64_tr_b16 v[214:215], v8 offset:23040
    v_and_b32 v162, 0xffff0000, v165
    v_lshlrev_b32 v165, 16, v165
    s_waitcnt lgkmcnt(4)
    v_mfma_f32_32x32x16_bf16 v[128:143], v[200:203], v[116:119], v[128:143]
    ds_read_b64_tr_b16 v[192:193], v8 offset:19456
    v_add_f32 v165, 0x3727c5ac, v165
    ds_read_b64_tr_b16 v[194:195], v8 offset:19968
    v_cvt_pk_bf16_f32 v165, v165, v165
    v_lshlrev_b32 v165, 16, v165
    v_mfma_f32_32x32x16_bf16 v[144:159], v[204:207], v[116:119], v[144:159]
    ds_read_b64_tr_b16 v[196:197], v8 offset:23552
    v_sqrt_f32 v165, v165
    ds_read_b64_tr_b16 v[198:199], v8 offset:24064
    v_cvt_pk_bf16_f32 v165, v165, v165
    v_lshlrev_b32 v163, 16, v165
    s_waitcnt lgkmcnt(4)
    v_mfma_f32_32x32x16_bf16 v[128:143], v[208:211], v[120:123], v[128:143]
    v_rcp_f32 v164, v163
    v_xor_b32 v162, 0x80000000, v162
    v_lshrrev_b32 v13, 16, v162
    v_mfma_f32_32x32x16_bf16 v[144:159], v[212:215], v[120:123], v[144:159]
    v_or_b32 v12, v162, v13
    v_or_b32 v13, v13, v163
    v_cndmask_b32 v12, v237, v12, s[22:23]
    s_waitcnt lgkmcnt(0)
    s_barrier
    v_mfma_f32_32x32x16_bf16 v[128:143], v[192:195], v[124:127], v[128:143]
    ds_read_b64_tr_b16 v[200:201], v232 offset:0
    v_cndmask_b32 v13, v237, v13, s[22:23]
    ds_read_b64_tr_b16 v[202:203], v232 offset:512
    v_mul_f32 v164, v164, v164
    ds_read_b64_tr_b16 v[204:205], v232 offset:4096
    v_mov_b32 v6, v164
    ds_read_b64_tr_b16 v[206:207], v232 offset:4608
    v_mfma_f32_32x32x16_bf16 v[144:159], v[196:199], v[124:127], v[144:159]
    ds_read_b64_tr_b16 v[208:209], v232 offset:1024
    s_lshl_b32 s76, s55, 7
    ds_read_b64_tr_b16 v[210:211], v232 offset:1536
    s_add_u32 s76, s76, 162304
    ds_read_b64_tr_b16 v[212:213], v232 offset:5120
    v_lshl_add_u32 v7, v4, 2, s76
    ds_read_b64_tr_b16 v[214:215], v232 offset:5632
    v_mfma_f32_32x32x16_bf16 v[128:143], v[216:219], v[12:15], v[128:143]
    v_mfma_f32_32x32x16_bf16 v[144:159], v[220:223], v[12:15], v[144:159]
    ds_write_b32 v7, v6
    s_mul_i32 s70, s55, 112
    s_add_u32 s70, s70, s61
    s_lshl_b32 s70, s70, 10
    s_add_u32 s70, s70, s62
    s_add_u32 s70, s70, 131072
    s_and_b32 s71, s59, 1
    s_lshl_b32 s71, s71, 1
    s_add_u32 s71, s71, s56
    s_lshl_b32 s71, s71, 2
    s_add_u32 s71, s71, s55
    s_mul_i32 s71, s71, 28672
    s_add_u32 s71, s71, s62
    s_add_u32 s71, s71, 131072
    s_waitcnt lgkmcnt(0)
    v_mfma_f32_32x32x16_bf16 v[160:175], v[200:203], v[16:19], 0
    ds_read_b64_tr_b16 v[192:193], v232 offset:2048
    ds_read_b64_tr_b16 v[194:195], v232 offset:2560
    v_mfma_f32_32x32x16_bf16 v[176:191], v[204:207], v[16:19], 0
    ds_read_b64_tr_b16 v[196:197], v232 offset:6144
    ds_read_b64_tr_b16 v[198:199], v232 offset:6656
    v_mfma_f32_32x32x16_bf16 v[160:175], v[208:211], v[20:23], v[160:175]
    ds_read_b64_tr_b16 v[200:201], v232 offset:3072
    v_mul_f32 v128, v128, |v128|
    ds_read_b64_tr_b16 v[202:203], v232 offset:3584
    v_mul_f32 v129, v129, |v129|
    v_mul_f32 v130, v130, |v130|
    v_mul_f32 v131, v131, |v131|
    v_mul_f32 v132, v132, |v132|
    v_mul_f32 v133, v133, |v133|
    v_mfma_f32_32x32x16_bf16 v[176:191], v[212:215], v[20:23], v[176:191]
    ds_read_b64_tr_b16 v[204:205], v232 offset:7168
    v_mul_f32 v134, v134, |v134|
    ds_read_b64_tr_b16 v[206:207], v232 offset:7680
    v_mul_f32 v135, v135, |v135|
    v_cvt_pk_bf16_f32 v128, v128, v129
    v_cvt_pk_bf16_f32 v129, v130, v131
    v_cvt_pk_bf16_f32 v130, v132, v133
    v_cvt_pk_bf16_f32 v131, v134, v135
    s_waitcnt lgkmcnt(4)
    v_mfma_f32_32x32x16_bf16 v[160:175], v[192:195], v[24:27], v[160:175]
    ds_read_b64_tr_b16 v[208:209], v232 offset:8192
    v_perm_b32 v132, v128, v128, s87
    ds_read_b64_tr_b16 v[210:211], v232 offset:8704
    v_perm_b32 v133, v129, v129, s87
    v_perm_b32 v134, v130, v130, s87
    v_perm_b32 v135, v131, v131, s87
    v_bitop3_b32 v128, v128, v132, s21 bitop3:0x9a
    v_bitop3_b32 v129, v129, v133, 0 bitop3:0x9a
    v_mfma_f32_32x32x16_bf16 v[176:191], v[196:199], v[24:27], v[176:191]
    ds_read_b64_tr_b16 v[212:213], v232 offset:12288
    v_bitop3_b32 v130, v130, v134, 0 bitop3:0x9a
    ds_read_b64_tr_b16 v[214:215], v232 offset:12800
    v_bitop3_b32 v131, v131, v135, s21 bitop3:0x9a
    buffer_store_dwordx4 v[128:131], v2, s[16:19], s70 offen sc1
    s_add_u32 s70, s70, 28672
    v_mul_f32 v136, v136, |v136|
    v_mul_f32 v137, v137, |v137|
    s_waitcnt lgkmcnt(4)
    v_mfma_f32_32x32x16_bf16 v[160:175], v[200:203], v[28:31], v[160:175]
    ds_read_b64_tr_b16 v[192:193], v232 offset:9216
    v_mul_f32 v138, v138, |v138|
    ds_read_b64_tr_b16 v[194:195], v232 offset:9728
    v_mul_f32 v139, v139, |v139|
    v_mul_f32 v140, v140, |v140|
    v_mul_f32 v141, v141, |v141|
    v_mul_f32 v142, v142, |v142|
    v_mul_f32 v143, v143, |v143|
    v_mfma_f32_32x32x16_bf16 v[176:191], v[204:207], v[28:31], v[176:191]
    ds_read_b64_tr_b16 v[196:197], v232 offset:13312
    v_cvt_pk_bf16_f32 v136, v136, v137
    ds_read_b64_tr_b16 v[198:199], v232 offset:13824
    v_cvt_pk_bf16_f32 v137, v138, v139
    v_cvt_pk_bf16_f32 v138, v140, v141
    v_cvt_pk_bf16_f32 v139, v142, v143
    v_perm_b32 v140, v136, v136, s87
    v_perm_b32 v141, v137, v137, s87
    s_waitcnt lgkmcnt(4)
    v_mfma_f32_32x32x16_bf16 v[160:175], v[208:211], v[32:35], v[160:175]
    ds_read_b64_tr_b16 v[200:201], v232 offset:10240
    v_perm_b32 v142, v138, v138, s87
    ds_read_b64_tr_b16 v[202:203], v232 offset:10752
    v_perm_b32 v143, v139, v139, s87
    v_bitop3_b32 v136, v136, v140, s21 bitop3:0x9a
    v_bitop3_b32 v137, v137, v141, 0 bitop3:0x9a
    v_bitop3_b32 v138, v138, v142, 0 bitop3:0x9a
    v_bitop3_b32 v139, v139, v143, s21 bitop3:0x9a
    v_mfma_f32_32x32x16_bf16 v[176:191], v[212:215], v[32:35], v[176:191]
    ds_read_b64_tr_b16 v[204:205], v232 offset:14336
    buffer_store_dwordx4 v[136:139], v2, s[16:19], s70 offen sc1
    ds_read_b64_tr_b16 v[206:207], v232 offset:14848
    s_add_u32 s70, s70, 28672
    v_mul_f32 v144, v144, |v144|
    v_mul_f32 v145, v145, |v145|
    v_mul_f32 v146, v146, |v146|
    v_mul_f32 v147, v147, |v147|
    s_waitcnt lgkmcnt(4)
    v_mfma_f32_32x32x16_bf16 v[160:175], v[192:195], v[36:39], v[160:175]
    ds_read_b64_tr_b16 v[208:209], v232 offset:11264
    v_mul_f32 v148, v148, |v148|
    ds_read_b64_tr_b16 v[210:211], v232 offset:11776
    v_mul_f32 v149, v149, |v149|
    v_mul_f32 v150, v150, |v150|
    v_mul_f32 v151, v151, |v151|
    v_cvt_pk_bf16_f32 v144, v144, v145
    v_cvt_pk_bf16_f32 v145, v146, v147
    v_mfma_f32_32x32x16_bf16 v[176:191], v[196:199], v[36:39], v[176:191]
    ds_read_b64_tr_b16 v[212:213], v232 offset:15360
    v_cvt_pk_bf16_f32 v146, v148, v149
    ds_read_b64_tr_b16 v[214:215], v232 offset:15872
    v_cvt_pk_bf16_f32 v147, v150, v151
    v_perm_b32 v148, v144, v144, s87
    v_perm_b32 v149, v145, v145, s87
    v_perm_b32 v150, v146, v146, s87
    v_perm_b32 v151, v147, v147, s87
    s_waitcnt lgkmcnt(4)
    v_mfma_f32_32x32x16_bf16 v[160:175], v[200:203], v[40:43], v[160:175]
    ds_read_b64_tr_b16 v[192:193], v232 offset:16384
    v_bitop3_b32 v144, v144, v148, s21 bitop3:0x9a
    ds_read_b64_tr_b16 v[194:195], v232 offset:16896
    v_bitop3_b32 v145, v145, v149, 0 bitop3:0x9a
    v_bitop3_b32 v146, v146, v150, 0 bitop3:0x9a
    v_bitop3_b32 v147, v147, v151, s21 bitop3:0x9a
    buffer_store_dwordx4 v[144:147], v2, s[16:19], s70 offen sc1
    s_add_u32 s70, s70, 28672
    v_mfma_f32_32x32x16_bf16 v[176:191], v[204:207], v[40:43], v[176:191]
    ds_read_b64_tr_b16 v[196:197], v232 offset:20480
    v_mul_f32 v152, v152, |v152|
    ds_read_b64_tr_b16 v[198:199], v232 offset:20992
    v_mul_f32 v153, v153, |v153|
    v_mul_f32 v154, v154, |v154|
    v_mul_f32 v155, v155, |v155|
    v_mul_f32 v156, v156, |v156|
    v_mul_f32 v157, v157, |v157|
    s_waitcnt lgkmcnt(4)
    v_mfma_f32_32x32x16_bf16 v[160:175], v[208:211], v[44:47], v[160:175]
    ds_read_b64_tr_b16 v[200:201], v232 offset:17408
    v_mul_f32 v158, v158, |v158|
    ds_read_b64_tr_b16 v[202:203], v232 offset:17920
    v_mul_f32 v159, v159, |v159|
    v_cvt_pk_bf16_f32 v152, v152, v153
    v_cvt_pk_bf16_f32 v153, v154, v155
    v_cvt_pk_bf16_f32 v154, v156, v157
    v_cvt_pk_bf16_f32 v155, v158, v159
    v_mfma_f32_32x32x16_bf16 v[176:191], v[212:215], v[44:47], v[176:191]
    ds_read_b64_tr_b16 v[204:205], v232 offset:21504
    v_perm_b32 v156, v152, v152, s87
    ds_read_b64_tr_b16 v[206:207], v232 offset:22016
    v_perm_b32 v157, v153, v153, s87
    v_perm_b32 v158, v154, v154, s87
    v_perm_b32 v159, v155, v155, s87
    v_bitop3_b32 v152, v152, v156, s21 bitop3:0x9a
    v_bitop3_b32 v153, v153, v157, 0 bitop3:0x9a
    s_waitcnt lgkmcnt(4)
    v_mfma_f32_32x32x16_bf16 v[160:175], v[192:195], v[48:51], v[160:175]
    ds_read_b64_tr_b16 v[208:209], v232 offset:18432
    v_bitop3_b32 v154, v154, v158, 0 bitop3:0x9a
    ds_read_b64_tr_b16 v[210:211], v232 offset:18944
    v_bitop3_b32 v155, v155, v159, s21 bitop3:0x9a
    v_mfma_f32_32x32x16_bf16 v[176:191], v[196:199], v[48:51], v[176:191]
    ds_read_b64_tr_b16 v[212:213], v232 offset:22528
    buffer_store_dwordx4 v[152:155], v2, s[16:19], s70 offen sc1
    ds_read_b64_tr_b16 v[214:215], v232 offset:23040
    s_add_u32 s70, s70, 28672
    s_waitcnt lgkmcnt(4)
    v_mfma_f32_32x32x16_bf16 v[160:175], v[200:203], v[52:55], v[160:175]
    ds_read_b64_tr_b16 v[192:193], v232 offset:19456
    ds_read_b64_tr_b16 v[194:195], v232 offset:19968
    v_mfma_f32_32x32x16_bf16 v[176:191], v[204:207], v[52:55], v[176:191]
    ds_read_b64_tr_b16 v[196:197], v232 offset:23552
    ds_read_b64_tr_b16 v[198:199], v232 offset:24064
    s_waitcnt lgkmcnt(4)
    v_mfma_f32_32x32x16_bf16 v[160:175], v[208:211], v[56:59], v[160:175]
    ds_read_b64_tr_b16 v[200:201], v232 offset:24576
    ds_read_b64_tr_b16 v[202:203], v232 offset:25088
    v_mfma_f32_32x32x16_bf16 v[176:191], v[212:215], v[56:59], v[176:191]
    ds_read_b64_tr_b16 v[204:205], v232 offset:28672
    ds_read_b64_tr_b16 v[206:207], v232 offset:29184
    s_waitcnt lgkmcnt(4)
    v_mfma_f32_32x32x16_bf16 v[160:175], v[192:195], v[60:63], v[160:175]
    ds_read_b64_tr_b16 v[208:209], v232 offset:25600
    ds_read_b64_tr_b16 v[210:211], v232 offset:26112
    v_mfma_f32_32x32x16_bf16 v[176:191], v[196:199], v[60:63], v[176:191]
    ds_read_b64_tr_b16 v[212:213], v232 offset:29696
    ds_read_b64_tr_b16 v[214:215], v232 offset:30208
    s_waitcnt lgkmcnt(4)
    v_mfma_f32_32x32x16_bf16 v[160:175], v[200:203], v[64:67], v[160:175]
    ds_read_b64_tr_b16 v[192:193], v232 offset:26624
    ds_read_b64_tr_b16 v[194:195], v232 offset:27136
    v_mfma_f32_32x32x16_bf16 v[176:191], v[204:207], v[64:67], v[176:191]
    ds_read_b64_tr_b16 v[196:197], v232 offset:30720
    ds_read_b64_tr_b16 v[198:199], v232 offset:31232
    s_waitcnt lgkmcnt(4)
    v_mfma_f32_32x32x16_bf16 v[160:175], v[208:211], v[68:71], v[160:175]
    ds_read_b64_tr_b16 v[200:201], v232 offset:27648
    ds_read_b64_tr_b16 v[202:203], v232 offset:28160
    v_mfma_f32_32x32x16_bf16 v[176:191], v[212:215], v[68:71], v[176:191]
    ds_read_b64_tr_b16 v[204:205], v232 offset:31744
    ds_read_b64_tr_b16 v[206:207], v232 offset:32256
    s_waitcnt lgkmcnt(4)
    v_mfma_f32_32x32x16_bf16 v[160:175], v[192:195], v[72:75], v[160:175]
    ds_read_b64_tr_b16 v[208:209], v232 offset:32768
    ds_read_b64_tr_b16 v[210:211], v232 offset:33280
    v_mfma_f32_32x32x16_bf16 v[176:191], v[196:199], v[72:75], v[176:191]
    ds_read_b64_tr_b16 v[212:213], v232 offset:36864
    ds_read_b64_tr_b16 v[214:215], v232 offset:37376
    s_waitcnt lgkmcnt(4)
    v_mfma_f32_32x32x16_bf16 v[160:175], v[200:203], v[76:79], v[160:175]
    ds_read_b64_tr_b16 v[192:193], v232 offset:33792
    ds_read_b64_tr_b16 v[194:195], v232 offset:34304
    v_mfma_f32_32x32x16_bf16 v[176:191], v[204:207], v[76:79], v[176:191]
    ds_read_b64_tr_b16 v[196:197], v232 offset:37888
    ds_read_b64_tr_b16 v[198:199], v232 offset:38400
    s_waitcnt lgkmcnt(4)
    v_mfma_f32_32x32x16_bf16 v[160:175], v[208:211], v[80:83], v[160:175]
    ds_read_b64_tr_b16 v[200:201], v232 offset:34816
    ds_read_b64_tr_b16 v[202:203], v232 offset:35328
    v_mfma_f32_32x32x16_bf16 v[176:191], v[212:215], v[80:83], v[176:191]
    ds_read_b64_tr_b16 v[204:205], v232 offset:38912
    ds_read_b64_tr_b16 v[206:207], v232 offset:39424
    s_waitcnt lgkmcnt(4)
    v_mfma_f32_32x32x16_bf16 v[160:175], v[192:195], v[84:87], v[160:175]
    ds_read_b64_tr_b16 v[208:209], v232 offset:35840
    ds_read_b64_tr_b16 v[210:211], v232 offset:36352
    v_mfma_f32_32x32x16_bf16 v[176:191], v[196:199], v[84:87], v[176:191]
    ds_read_b64_tr_b16 v[212:213], v232 offset:39936
    ds_read_b64_tr_b16 v[214:215], v232 offset:40448
    s_waitcnt lgkmcnt(4)
    v_mfma_f32_32x32x16_bf16 v[160:175], v[200:203], v[88:91], v[160:175]
    ds_read_b64_tr_b16 v[192:193], v9 offset:0
    ds_read_b64_tr_b16 v[194:195], v9 offset:512
    v_mfma_f32_32x32x16_bf16 v[176:191], v[204:207], v[88:91], v[176:191]
    ds_read_b64_tr_b16 v[196:197], v9 offset:4096
    ds_read_b64_tr_b16 v[198:199], v9 offset:4608
    s_waitcnt lgkmcnt(4)
    s_barrier
    v_mfma_f32_32x32x16_bf16 v[160:175], v[208:211], v[92:95], v[160:175]
    ds_read_b64_tr_b16 v[200:201], v9 offset:1024
    s_add_u32 s77, s71, 0
    ds_read_b64_tr_b16 v[202:203], v9 offset:1536
    v_mfma_f32_32x32x16_bf16 v[176:191], v[212:215], v[92:95], v[176:191]
    ds_read_b64_tr_b16 v[204:205], v9 offset:5120
    buffer_load_dwordx4 v[16:19], v2, s[16:19], s77 offen offset:0 sc1
    ds_read_b64_tr_b16 v[206:207], v9 offset:5632
    s_waitcnt lgkmcnt(4)
    v_mfma_f32_32x32x16_bf16 v[160:175], v[192:195], v[96:99], v[160:175]
    ds_read_b64_tr_b16 v[208:209], v9 offset:2048
    buffer_load_dwordx4 v[20:23], v2, s[16:19], s77 offen offset:1024 sc1
    ds_read_b64_tr_b16 v[210:211], v9 offset:2560
    v_mfma_f32_32x32x16_bf16 v[176:191], v[196:199], v[96:99], v[176:191]
    ds_read_b64_tr_b16 v[212:213], v9 offset:6144
    ds_read_b64_tr_b16 v[214:215], v9 offset:6656
    s_waitcnt lgkmcnt(4)
    v_mfma_f32_32x32x16_bf16 v[160:175], v[200:203], v[100:103], v[160:175]
    ds_read_b64_tr_b16 v[192:193], v9 offset:3072
    buffer_load_dwordx4 v[24:27], v2, s[16:19], s77 offen offset:2048 sc1
    ds_read_b64_tr_b16 v[194:195], v9 offset:3584
    v_mfma_f32_32x32x16_bf16 v[176:191], v[204:207], v[100:103], v[176:191]
    ds_read_b64_tr_b16 v[196:197], v9 offset:7168
    ds_read_b64_tr_b16 v[198:199], v9 offset:7680
    s_waitcnt lgkmcnt(4)
    v_mfma_f32_32x32x16_bf16 v[160:175], v[208:211], v[104:107], v[160:175]
    ds_read_b64_tr_b16 v[200:201], v9 offset:8192
    buffer_load_dwordx4 v[28:31], v2, s[16:19], s77 offen offset:3072 sc1
    ds_read_b64_tr_b16 v[202:203], v9 offset:8704
    v_mfma_f32_32x32x16_bf16 v[176:191], v[212:215], v[104:107], v[176:191]
    ds_read_b64_tr_b16 v[204:205], v9 offset:12288
    ds_read_b64_tr_b16 v[206:207], v9 offset:12800
    s_waitcnt lgkmcnt(4)
    v_mfma_f32_32x32x16_bf16 v[160:175], v[192:195], v[108:111], v[160:175]
    ds_read_b64_tr_b16 v[208:209], v9 offset:9216
    s_add_u32 s77, s71, 4096
    ds_read_b64_tr_b16 v[210:211], v9 offset:9728
    v_mfma_f32_32x32x16_bf16 v[176:191], v[196:199], v[108:111], v[176:191]
    ds_read_b64_tr_b16 v[212:213], v9 offset:13312
    buffer_load_dwordx4 v[32:35], v2, s[16:19], s77 offen offset:0 sc1
    ds_read_b64_tr_b16 v[214:215], v9 offset:13824
    s_waitcnt lgkmcnt(4)
    v_mfma_f32_32x32x16_bf16 v[160:175], v[200:203], v[112:115], v[160:175]
    ds_read_b64_tr_b16 v[192:193], v9 offset:10240
    buffer_load_dwordx4 v[36:39], v2, s[16:19], s77 offen offset:1024 sc1
    ds_read_b64_tr_b16 v[194:195], v9 offset:10752
    v_mfma_f32_32x32x16_bf16 v[176:191], v[204:207], v[112:115], v[176:191]
    ds_read_b64_tr_b16 v[196:197], v9 offset:14336
    ds_read_b64_tr_b16 v[198:199], v9 offset:14848
    s_waitcnt lgkmcnt(4)
    v_mfma_f32_32x32x16_bf16 v[160:175], v[208:211], v[116:119], v[160:175]
    ds_read_b64_tr_b16 v[200:201], v9 offset:11264
    buffer_load_dwordx4 v[40:43], v2, s[16:19], s77 offen offset:2048 sc1
    ds_read_b64_tr_b16 v[202:203], v9 offset:11776
    v_mfma_f32_32x32x16_bf16 v[176:191], v[212:215], v[116:119], v[176:191]
    ds_read_b64_tr_b16 v[204:205], v9 offset:15360
    ds_read_b64_tr_b16 v[206:207], v9 offset:15872
    s_waitcnt lgkmcnt(4)
    v_mfma_f32_32x32x16_bf16 v[160:175], v[192:195], v[120:123], v[160:175]
    buffer_load_dwordx4 v[44:47], v2, s[16:19], s77 offen offset:3072 sc1
    v_mfma_f32_32x32x16_bf16 v[176:191], v[196:199], v[120:123], v[176:191]
    s_waitcnt lgkmcnt(0)
    v_mfma_f32_32x32x16_bf16 v[160:175], v[200:203], v[124:127], v[160:175]
    s_add_u32 s77, s71, 8192
    v_mfma_f32_32x32x16_bf16 v[176:191], v[204:207], v[124:127], v[176:191]
    buffer_load_dwordx4 v[48:51], v2, s[16:19], s77 offen offset:0 sc1
    v_mfma_f32_32x32x16_bf16 v[160:175], v[224:227], v[12:15], v[160:175]
    v_mfma_f32_32x32x16_bf16 v[176:191], v[228:231], v[12:15], v[176:191]
    s_sub_u32 s70, s70, 100352
    v_add_u32 v208, s4, v232
    v_add_u32 v209, s5, v232
    v_add_u32 v210, s6, v232
    v_add_u32 v211, s7, v232
    ds_read_b64_tr_b16 v[192:193], v208 offset:0
    ds_read_b64_tr_b16 v[194:195], v208 offset:512
    ds_read_b64_tr_b16 v[196:197], v208 offset:1024
    ds_read_b64_tr_b16 v[198:199], v208 offset:1536
    ds_read_b64_tr_b16 v[200:201], v208 offset:2048
    ds_read_b64_tr_b16 v[202:203], v208 offset:2560
    ds_read_b64_tr_b16 v[204:205], v208 offset:3072
    ds_read_b64_tr_b16 v[206:207], v208 offset:3584
    s_waitcnt vmcnt(7)
    v_xor_b32 v16, s21, v16
    v_xor_b32 v19, s21, v19
    v_or_b32 v5, v16, v19
    v_xor_b32 v20, s21, v20
    v_xor_b32 v23, s21, v23
    v_or3_b32 v5, v20, v23, v5
    v_and_b32 v5, 0x80008000, v5
    v_cmp_ne_u32 vcc, 0, v5
    s_nop 0
    s_cbranch_vccnz L_mk_rt_96
L_mk_bk_97:
    s_barrier
    s_waitcnt lgkmcnt(4)
    v_mfma_f32_32x32x16_bf16 v[128:143], v[192:195], v[16:19], 0
    ds_read_b64_tr_b16 v[216:217], v208 offset:4096
    v_mul_f32 v160, v160, |v160|
    ds_read_b64_tr_b16 v[218:219], v208 offset:4608
    v_mul_f32 v161, v161, |v161|
    v_mul_f32 v162, v162, |v162|
    v_mul_f32 v163, v163, |v163|
    v_mul_f32 v164, v164, |v164|
    v_mul_f32 v165, v165, |v165|
    v_mul_f32 v166, v166, |v166|
    v_mul_f32 v167, v167, |v167|
    v_cvt_pk_bf16_f32 v160, v160, v161
    v_cvt_pk_bf16_f32 v161, v162, v163
    v_cvt_pk_bf16_f32 v162, v164, v165
    v_cvt_pk_bf16_f32 v163, v166, v167
    v_perm_b32 v164, v160, v160, s87
    v_perm_b32 v165, v161, v161, s87
    v_mfma_f32_32x32x16_bf16 v[144:159], v[196:199], v[16:19], 0
    ds_read_b64_tr_b16 v[220:221], v208 offset:5120
    v_perm_b32 v166, v162, v162, s87
    ds_read_b64_tr_b16 v[222:223], v208 offset:5632
    v_perm_b32 v167, v163, v163, s87
    v_bitop3_b32 v160, v160, v164, s21 bitop3:0x9a
    v_bitop3_b32 v161, v161, v165, 0 bitop3:0x9a
    v_bitop3_b32 v162, v162, v166, 0 bitop3:0x9a
    v_bitop3_b32 v163, v163, v167, s21 bitop3:0x9a
    buffer_store_dwordx4 v[160:163], v2, s[16:19], s70 offen sc1
    s_add_u32 s70, s70, 28672
    v_mul_f32 v168, v168, |v168|
    v_mul_f32 v169, v169, |v169|
    v_mul_f32 v170, v170, |v170|
    v_mul_f32 v171, v171, |v171|
    buffer_load_dwordx4 v[52:55], v2, s[16:19], s77 offen offset:1024 sc1
    s_waitcnt lgkmcnt(4)
    v_mfma_f32_32x32x16_bf16 v[128:143], v[200:203], v[20:23], v[128:143]
    ds_read_b64_tr_b16 v[192:193], v208 offset:6144
    v_mul_f32 v172, v172, |v172|
    ds_read_b64_tr_b16 v[194:195], v208 offset:6656
    v_mul_f32 v173, v173, |v173|
    v_mul_f32 v174, v174, |v174|
    v_mul_f32 v175, v175, |v175|
    v_cvt_pk_bf16_f32 v168, v168, v169
    v_cvt_pk_bf16_f32 v169, v170, v171
    v_cvt_pk_bf16_f32 v170, v172, v173
    v_cvt_pk_bf16_f32 v171, v174, v175
    v_perm_b32 v172, v168, v168, s87
    v_perm_b32 v173, v169, v169, s87
    v_perm_b32 v174, v170, v170, s87
    v_perm_b32 v175, v171, v171, s87
    v_bitop3_b32 v168, v168, v172, s21 bitop3:0x9a
    v_bitop3_b32 v169, v169, v173, 0 bitop3:0x9a
    v_bitop3_b32 v170, v170, v174, 0 bitop3:0x9a
    v_bitop3_b32 v171, v171, v175, s21 bitop3:0x9a
    buffer_store_dwordx4 v[168:171], v2, s[16:19], s70 offen sc1
    s_add_u32 s70, s70, 28672
    v_mul_f32 v176, v176, |v176|
    v_mfma_f32_32x32x16_bf16 v[144:159], v[204:207], v[20:23], v[144:159]
    ds_read_b64_tr_b16 v[196:197], v208 offset:7168
    v_mul_f32 v177, v177, |v177|
    ds_read_b64_tr_b16 v[198:199], v208 offset:7680
    v_mul_f32 v178, v178, |v178|
    v_mul_f32 v179, v179, |v179|
    v_mul_f32 v180, v180, |v180|
    v_mul_f32 v181, v181, |v181|
    v_mul_f32 v182, v182, |v182|
    v_mul_f32 v183, v183, |v183|
    buffer_load_dwordx4 v[56:59], v2, s[16:19], s77 offen offset:2048 sc1
    s_waitcnt vmcnt(9)
    v_xor_b32 v24, s21, v24
    v_xor_b32 v27, s21, v27
    v_or_b32 v5, v24, v27
    v_xor_b32 v28, s21, v28
    v_xor_b32 v31, s21, v31
    v_or3_b32 v5, v28, v31, v5
    v_and_b32 v5, 0x80008000, v5
    v_cmp_ne_u32 vcc, 0, v5
    s_nop 0
    s_cbranch_vccnz L_mk_rt_98
L_mk_bk_99:
    s_waitcnt lgkmcnt(4)
    v_mfma_f32_32x32x16_bf16 v[128:143], v[216:219], v[24:27], v[128:143]
    ds_read_b64_tr_b16 v[200:201], v208 offset:8192
    v_cvt_pk_bf16_f32 v176, v176, v177
    ds_read_b64_tr_b16 v[202:203], v208 offset:8704
    v_cvt_pk_bf16_f32 v177, v178, v179
    v_cvt_pk_bf16_f32 v178, v180, v181
    v_cvt_pk_bf16_f32 v179, v182, v183
    v_perm_b32 v180, v176, v176, s87
    v_perm_b32 v181, v177, v177, s87
    v_perm_b32 v182, v178, v178, s87
    v_perm_b32 v183, v179, v179, s87
    v_bitop3_b32 v176, v176, v180, s21 bitop3:0x9a
    v_bitop3_b32 v177, v177, v181, 0 bitop3:0x9a
    v_bitop3_b32 v178, v178, v182, 0 bitop3:0x9a
    v_bitop3_b32 v179, v179, v183, s21 bitop3:0x9a
    buffer_store_dwordx4 v[176:179], v2, s[16:19], s70 offen sc1
    s_add_u32 s70, s70, 28672
    v_mfma_f32_32x32x16_bf16 v[144:159], v[220:223], v[24:27], v[144:159]
    ds_read_b64_tr_b16 v[204:205], v208 offset:9216
    v_mul_f32 v184, v184, |v184|
    ds_read_b64_tr_b16 v[206:207], v208 offset:9728
    v_mul_f32 v185, v185, |v185|
    v_mul_f32 v186, v186, |v186|
    v_mul_f32 v187, v187, |v187|
    v_mul_f32 v188, v188, |v188|
    v_mul_f32 v189, v189, |v189|
    v_mul_f32 v190, v190, |v190|
    v_mul_f32 v191, v191, |v191|
    v_cvt_pk_bf16_f32 v184, v184, v185
    v_cvt_pk_bf16_f32 v185, v186, v187
    v_cvt_pk_bf16_f32 v186, v188, v189
    v_cvt_pk_bf16_f32 v187, v190, v191
    buffer_load_dwordx4 v[60:63], v2, s[16:19], s77 offen offset:3072 sc1
    s_waitcnt lgkmcnt(4)
    v_mfma_f32_32x32x16_bf16 v[128:143], v[192:195], v[28:31], v[128:143]
    ds_read_b64_tr_b16 v[216:217], v209 offset:0
    v_perm_b32 v188, v184, v184, s87
    ds_read_b64_tr_b16 v[218:219], v209 offset:512
    v_perm_b32 v189, v185, v185, s87
    v_perm_b32 v190, v186, v186, s87
    v_perm_b32 v191, v187, v187, s87
    v_bitop3_b32 v184, v184, v188, s21 bitop3:0x9a
    v_bitop3_b32 v185, v185, v189, 0 bitop3:0x9a
    v_bitop3_b32 v186, v186, v190, 0 bitop3:0x9a
    v_bitop3_b32 v187, v187, v191, s21 bitop3:0x9a
    buffer_store_dwordx4 v[184:187], v2, s[16:19], s70 offen sc1
    s_add_u32 s70, s70, 28672
    s_add_u32 s77, s71, 12288
    v_mfma_f32_32x32x16_bf16 v[144:159], v[196:199], v[28:31], v[144:159]
    ds_read_b64_tr_b16 v[220:221], v209 offset:1024
    buffer_load_dwordx4 v[64:67], v2, s[16:19], s77 offen offset:0 sc1
    ds_read_b64_tr_b16 v[222:223], v209 offset:1536
    s_waitcnt vmcnt(11)
    v_xor_b32 v32, s21, v32
    v_xor_b32 v35, s21, v35
    v_or_b32 v5, v32, v35
    v_xor_b32 v36, s21, v36
    v_xor_b32 v39, s21, v39
    v_or3_b32 v5, v36, v39, v5
    v_and_b32 v5, 0x80008000, v5
    v_cmp_ne_u32 vcc, 0, v5
    s_nop 0
    s_cbranch_vccnz L_mk_rt_100
L_mk_bk_101:
    s_waitcnt lgkmcnt(4)
    v_mfma_f32_32x32x16_bf16 v[128:143], v[200:203], v[32:35], v[128:143]
    ds_read_b64_tr_b16 v[192:193], v209 offset:2048
    buffer_load_dwordx4 v[68:71], v2, s[16:19], s77 offen offset:1024 sc1
    ds_read_b64_tr_b16 v[194:195], v209 offset:2560
    v_mfma_f32_32x32x16_bf16 v[144:159], v[204:207], v[32:35], v[144:159]
    ds_read_b64_tr_b16 v[196:197], v209 offset:3072
    ds_read_b64_tr_b16 v[198:199], v209 offset:3584
    s_waitcnt lgkmcnt(4)
    v_mfma_f32_32x32x16_bf16 v[128:143], v[216:219], v[36:39], v[128:143]
    ds_read_b64_tr_b16 v[200:201], v209 offset:4096
    s_waitcnt vmcnt(10)
    ds_read_b64_tr_b16 v[202:203], v209 offset:4608
    v_xor_b32 v40, s21, v40
    v_xor_b32 v43, s21, v43
    v_or_b32 v5, v40, v43
    v_xor_b32 v44, s21, v44
    v_mfma_f32_32x32x16_bf16 v[144:159], v[220:223], v[36:39], v[144:159]
    ds_read_b64_tr_b16 v[204:205], v209 offset:5120
    v_xor_b32 v47, s21, v47
    ds_read_b64_tr_b16 v[206:207], v209 offset:5632
    v_or3_b32 v5, v44, v47, v5
    v_and_b32 v5, 0x80008000, v5
    v_cmp_ne_u32 vcc, 0, v5
    s_nop 0
    s_cbranch_vccnz L_mk_rt_102
L_mk_bk_103:
    s_waitcnt lgkmcnt(4)
    v_mfma_f32_32x32x16_bf16 v[128:143], v[192:195], v[40:43], v[128:143]
    ds_read_b64_tr_b16 v[216:217], v209 offset:6144
    ds_read_b64_tr_b16 v[218:219], v209 offset:6656
    v_mfma_f32_32x32x16_bf16 v[144:159], v[196:199], v[40:43], v[144:159]
    ds_read_b64_tr_b16 v[220:221], v209 offset:7168
    ds_read_b64_tr_b16 v[222:223], v209 offset:7680
    s_waitcnt lgkmcnt(4)
    v_mfma_f32_32x32x16_bf16 v[128:143], v[200:203], v[44:47], v[128:143]
    ds_read_b64_tr_b16 v[192:193], v209 offset:8192
    s_waitcnt vmcnt(7)
    ds_read_b64_tr_b16 v[194:195], v209 offset:8704
    v_xor_b32 v48, s21, v48
    v_xor_b32 v51, s21, v51
    v_or_b32 v5, v48, v51
    v_xor_b32 v52, s21, v52
    v_mfma_f32_32x32x16_bf16 v[144:159], v[204:207], v[44:47], v[144:159]
    ds_read_b64_tr_b16 v[196:197], v209 offset:9216
    v_xor_b32 v55, s21, v55
    ds_read_b64_tr_b16 v[198:199], v209 offset:9728
    v_or3_b32 v5, v52, v55, v5
    v_and_b32 v5, 0x80008000, v5
    v_cmp_ne_u32 vcc, 0, v5
    s_nop 0
    s_cbranch_vccnz L_mk_rt_104
L_mk_bk_105:
    s_waitcnt lgkmcnt(4)
    v_mfma_f32_32x32x16_bf16 v[128:143], v[216:219], v[48:51], v[128:143]
    ds_read_b64_tr_b16 v[200:201], v209 offset:10240
    ds_read_b64_tr_b16 v[202:203], v209 offset:10752
    v_mfma_f32_32x32x16_bf16 v[144:159], v[220:223], v[48:51], v[144:159]
    ds_read_b64_tr_b16 v[204:205], v209 offset:11264
    ds_read_b64_tr_b16 v[206:207], v209 offset:11776
    s_waitcnt lgkmcnt(4)
    s_barrier
    v_mfma_f32_32x32x16_bf16 v[128:143], v[192:195], v[52:55], v[128:143]
    ds_read_b64_tr_b16 v[216:217], v209 offset:12288
    s_add_u32 s77, s71, 14336
    ds_read_b64_tr_b16 v[218:219], v209 offset:12800
    buffer_load_dwordx4 v[72:75], v2, s[16:19], s77 offen offset:0 sc1
    s_waitcnt vmcnt(4)
    v_xor_b32 v56, s21, v56
    v_xor_b32 v59, s21, v59
    v_or_b32 v5, v56, v59
    v_mfma_f32_32x32x16_bf16 v[144:159], v[196:199], v[52:55], v[144:159]
    ds_read_b64_tr_b16 v[220:221], v209 offset:13312
    v_xor_b32 v60, s21, v60
    ds_read_b64_tr_b16 v[222:223], v209 offset:13824
    v_xor_b32 v63, s21, v63
    v_or3_b32 v5, v60, v63, v5
    v_and_b32 v5, 0x80008000, v5
    v_cmp_ne_u32 vcc, 0, v5
    s_nop 0
    s_cbranch_vccnz L_mk_rt_106
L_mk_bk_107:
    s_waitcnt lgkmcnt(4)
    v_mfma_f32_32x32x16_bf16 v[128:143], v[200:203], v[56:59], v[128:143]
    ds_read_b64_tr_b16 v[192:193], v210 offset:0
    buffer_load_dwordx4 v[76:79], v2, s[16:19], s77 offen offset:1024 sc1
    ds_read_b64_tr_b16 v[194:195], v210 offset:512
    v_mfma_f32_32x32x16_bf16 v[144:159], v[204:207], v[56:59], v[144:159]
    ds_read_b64_tr_b16 v[196:197], v210 offset:1024
    ds_read_b64_tr_b16 v[198:199], v210 offset:1536
    s_waitcnt lgkmcnt(4)
    v_mfma_f32_32x32x16_bf16 v[128:143], v[216:219], v[60:63], v[128:143]
    ds_read_b64_tr_b16 v[200:201], v210 offset:2048
    buffer_load_dwordx4 v[80:83], v2, s[16:19], s77 offen offset:2048 sc1
    ds_read_b64_tr_b16 v[202:203], v210 offset:2560
    s_waitcnt vmcnt(3)
    v_xor_b32 v64, s21, v64
    v_xor_b32 v67, s21, v67
    v_or_b32 v5, v64, v67
    v_xor_b32 v68, s21, v68
    v_mfma_f32_32x32x16_bf16 v[144:159], v[220:223], v[60:63], v[144:159]
    ds_read_b64_tr_b16 v[204:205], v210 offset:3072
    v_xor_b32 v71, s21, v71
    ds_read_b64_tr_b16 v[206:207], v210 offset:3584
    v_or3_b32 v5, v68, v71, v5
    v_and_b32 v5, 0x80008000, v5
    v_cmp_ne_u32 vcc, 0, v5
    s_nop 0
    s_cbranch_vccnz L_mk_rt_108
L_mk_bk_109:
    s_waitcnt lgkmcnt(4)
    v_mfma_f32_32x32x16_bf16 v[128:143], v[192:195], v[64:67], v[128:143]
    ds_read_b64_tr_b16 v[216:217], v210 offset:4096
    buffer_load_dwordx4 v[84:87], v2, s[16:19], s77 offen offset:3072 sc1
    ds_read_b64_tr_b16 v[218:219], v210 offset:4608
    v_mfma_f32_32x32x16_bf16 v[144:159], v[196:199], v[64:67], v[144:159]
    ds_read_b64_tr_b16 v[220:221], v210 offset:5120
    ds_read_b64_tr_b16 v[222:223], v210 offset:5632
    s_waitcnt lgkmcnt(4)
    v_mfma_f32_32x32x16_bf16 v[128:143], v[200:203], v[68:71], v[128:143]
    ds_read_b64_tr_b16 v[192:193], v210 offset:6144
    s_add_u32 s77, s71, 18432
    ds_read_b64_tr_b16 v[194:195], v210 offset:6656
    buffer_load_dwordx4 v[88:91], v2, s[16:19], s77 offen offset:0 sc1
    s_waitcnt vmcnt(3)
    v_xor_b32 v72, s21, v72
    v_xor_b32 v75, s21, v75
    v_or_b32 v5, v72, v75
    v_mfma_f32_32x32x16_bf16 v[144:159], v[204:207], v[68:71], v[144:159]
    ds_read_b64_tr_b16 v[196:197], v210 offset:7168
    v_xor_b32 v76, s21, v76
    ds_read_b64_tr_b16 v[198:199], v210 offset:7680
    v_xor_b32 v79, s21, v79
    v_or3_b32 v5, v76, v79, v5
    v_and_b32 v5, 0x80008000, v5
    v_cmp_ne_u32 vcc, 0, v5
    s_nop 0
    s_cbranch_vccnz L_mk_rt_110
L_mk_bk_111:
    s_waitcnt lgkmcnt(4)
    v_mfma_f32_32x32x16_bf16 v[128:143], v[216:219], v[72:75], v[128:143]
    ds_read_b64_tr_b16 v[200:201], v210 offset:8192
    buffer_load_dwordx4 v[92:95], v2, s[16:19], s77 offen offset:1024 sc1
    ds_read_b64_tr_b16 v[202:203], v210 offset:8704
    v_mfma_f32_32x32x16_bf16 v[144:159], v[220:223], v[72:75], v[144:159]
    ds_read_b64_tr_b16 v[204:205], v210 offset:9216
    ds_read_b64_tr_b16 v[206:207], v210 offset:9728
    s_waitcnt lgkmcnt(4)
    v_mfma_f32_32x32x16_bf16 v[128:143], v[192:195], v[76:79], v[128:143]
    ds_read_b64_tr_b16 v[216:217], v211 offset:0
    buffer_load_dwordx4 v[96:99], v2, s[16:19], s77 offen offset:2048 sc1
    ds_read_b64_tr_b16 v[218:219], v211 offset:512
    s_waitcnt vmcnt(3)
    v_xor_b32 v80, s21, v80
    v_xor_b32 v83, s21, v83
    v_or_b32 v5, v80, v83
    v_xor_b32 v84, s21, v84
    v_mfma_f32_32x32x16_bf16 v[144:159], v[196:199], v[76:79], v[144:159]
    ds_read_b64_tr_b16 v[220:221], v211 offset:1024
    v_xor_b32 v87, s21, v87
    ds_read_b64_tr_b16 v[222:223], v211 offset:1536
    v_or3_b32 v5, v84, v87, v5
    v_and_b32 v5, 0x80008000, v5
    v_cmp_ne_u32 vcc, 0, v5
    s_nop 0
    s_cbranch_vccnz L_mk_rt_112
L_mk_bk_113:
    s_waitcnt lgkmcnt(4)
    v_mfma_f32_32x32x16_bf16 v[128:143], v[200:203], v[80:83], v[128:143]
    ds_read_b64_tr_b16 v[192:193], v211 offset:2048
    buffer_load_dwordx4 v[100:103], v2, s[16:19], s77 offen offset:3072 sc1
    ds_read_b64_tr_b16 v[194:195], v211 offset:2560
    v_mfma_f32_32x32x16_bf16 v[144:159], v[204:207], v[80:83], v[144:159]
    ds_read_b64_tr_b16 v[196:197], v211 offset:3072
    ds_read_b64_tr_b16 v[198:199], v211 offset:3584
    s_waitcnt lgkmcnt(4)
    s_barrier
    v_mfma_f32_32x32x16_bf16 v[128:143], v[216:219], v[84:87], v[128:143]
    ds_read_b64_tr_b16 v[200:201], v208 offset:0
    s_add_u32 s77, s71, 22528
    ds_read_b64_tr_b16 v[202:203], v208 offset:512
    buffer_load_dwordx4 v[104:107], v2, s[16:19], s77 offen offset:0 sc1
    s_waitcnt vmcnt(3)
    v_xor_b32 v88, s21, v88
    v_xor_b32 v91, s21, v91
    v_or_b32 v5, v88, v91
    v_mfma_f32_32x32x16_bf16 v[144:159], v[220:223], v[84:87], v[144:159]
    ds_read_b64_tr_b16 v[204:205], v208 offset:1024
    v_xor_b32 v92, s21, v92
    ds_read_b64_tr_b16 v[206:207], v208 offset:1536
    v_xor_b32 v95, s21, v95
    v_or3_b32 v5, v92, v95, v5
    v_and_b32 v5, 0x80008000, v5
    v_cmp_ne_u32 vcc, 0, v5
    s_nop 0
    s_cbranch_vccnz L_mk_rt_114
L_mk_bk_115:
    s_waitcnt lgkmcnt(4)
    v_mfma_f32_32x32x16_bf16 v[128:143], v[192:195], v[88:91], v[128:143]
    ds_read_b64_tr_b16 v[216:217], v208 offset:2048
    buffer_load_dwordx4 v[108:111], v2, s[16:19], s77 offen offset:1024 sc1
    ds_read_b64_tr_b16 v[218:219], v208 offset:2560
    v_mfma_f32_32x32x16_bf16 v[144:159], v[196:199], v[88:91], v[144:159]
    ds_read_b64_tr_b16 v[220:221], v208 offset:3072
    ds_read_b64_tr_b16 v[222:223], v208 offset:3584
    s_waitcnt lgkmcnt(4)
    v_mfma_f32_32x32x16_bf16 v[128:143], v[200:203], v[92:95], v[128:143]
    ds_read_b64_tr_b16 v[192:193], v208 offset:4096
    buffer_load_dwordx4 v[112:115], v2, s[16:19], s77 offen offset:2048 sc1
    ds_read_b64_tr_b16 v[194:195], v208 offset:4608
    s_waitcnt vmcnt(3)
    v_xor_b32 v96, s21, v96
    v_xor_b32 v99, s21, v99
    v_or_b32 v5, v96, v99
    v_xor_b32 v100, s21, v100
    v_mfma_f32_32x32x16_bf16 v[144:159], v[204:207], v[92:95], v[144:159]
    ds_read_b64_tr_b16 v[196:197], v208 offset:5120
    v_xor_b32 v103, s21, v103
    ds_read_b64_tr_b16 v[198:199], v208 offset:5632
    v_or3_b32 v5, v100, v103, v5
    v_and_b32 v5, 0x80008000, v5
    v_cmp_ne_u32 vcc, 0, v5
    s_nop 0
    s_cbranch_vccnz L_mk_rt_116
L_mk_bk_117:
    s_waitcnt lgkmcnt(4)
    v_mfma_f32_32x32x16_bf16 v[128:143], v[216:219], v[96:99], v[128:143]
    ds_read_b64_tr_b16 v[200:201], v208 offset:6144
    buffer_load_dwordx4 v[116:119], v2, s[16:19], s77 offen offset:3072 sc1
    ds_read_b64_tr_b16 v[202:203], v208 offset:6656
    v_mfma_f32_32x32x16_bf16 v[144:159], v[220:223], v[96:99], v[144:159]
    ds_read_b64_tr_b16 v[204:205], v208 offset:7168
    ds_read_b64_tr_b16 v[206:207], v208 offset:7680
    s_waitcnt lgkmcnt(4)
    s_barrier
    v_mfma_f32_32x32x16_bf16 v[128:143], v[192:195], v[100:103], v[128:143]
    ds_read_b64_tr_b16 v[216:217], v208 offset:8192
    s_add_u32 s77, s71, 26624
    ds_read_b64_tr_b16 v[218:219], v208 offset:8704
    buffer_load_dwordx4 v[120:123], v2, s[16:19], s77 offen offset:0 sc1
    s_waitcnt vmcnt(3)
    v_xor_b32 v104, s21, v104
    v_xor_b32 v107, s21, v107
    v_or_b32 v5, v104, v107
    v_mfma_f32_32x32x16_bf16 v[144:159], v[196:199], v[100:103], v[144:159]
    ds_read_b64_tr_b16 v[220:221], v208 offset:9216
    v_xor_b32 v108, s21, v108
    ds_read_b64_tr_b16 v[222:223], v208 offset:9728
    v_xor_b32 v111, s21, v111
    v_or3_b32 v5, v108, v111, v5
    v_and_b32 v5, 0x80008000, v5
    v_cmp_ne_u32 vcc, 0, v5
    s_nop 0
    s_cbranch_vccnz L_mk_rt_118
L_mk_bk_119:
    s_waitcnt lgkmcnt(4)
    v_mfma_f32_32x32x16_bf16 v[128:143], v[200:203], v[104:107], v[128:143]
    ds_read_b64_tr_b16 v[192:193], v209 offset:0
    buffer_load_dwordx4 v[124:127], v2, s[16:19], s77 offen offset:1024 sc1
    ds_read_b64_tr_b16 v[194:195], v209 offset:512
    s_and_b32 s70, s59, 1
    s_lshl_b32 s70, s70, 8
    s_lshl_b32 s76, s56, 7
    s_add_u32 s70, s70, s76
    s_add_u32 s70, s70, 162304
    v_mfma_f32_32x32x16_bf16 v[144:159], v[204:207], v[104:107], v[144:159]
    ds_read_b64_tr_b16 v[196:197], v209 offset:1024
    v_lshl_add_u32 v8, v4, 2, s70
    ds_read_b64_tr_b16 v[198:199], v209 offset:1536
    s_lshl_b32 s70, s59, 1
    s_add_u32 s70, s70, s56
    s_lshl_b32 s70, s70, 5
    v_add_u32 v12, s70, v4
    s_waitcnt lgkmcnt(4)
    v_mfma_f32_32x32x16_bf16 v[128:143], v[216:219], v[108:111], v[128:143]
    ds_read_b64_tr_b16 v[200:201], v209 offset:2048
    s_waitcnt vmcnt(2)
    ds_read_b64_tr_b16 v[202:203], v209 offset:2560
    v_xor_b32 v112, s21, v112
    v_xor_b32 v115, s21, v115
    v_or_b32 v5, v112, v115
    v_xor_b32 v116, s21, v116
    v_xor_b32 v119, s21, v119
    v_or3_b32 v5, v116, v119, v5
    v_and_b32 v5, 0x80008000, v5
    v_cmp_ne_u32 vcc, 0, v5
    s_nop 0
    s_cbranch_vccnz L_mk_rt_120
L_mk_bk_121:
    v_mfma_f32_32x32x16_bf16 v[144:159], v[220:223], v[108:111], v[144:159]
    ds_read_b64_tr_b16 v[204:205], v209 offset:3072
    v_mul_u32_u24 v12, 896, v12
    ds_read_b64_tr_b16 v[206:207], v209 offset:3584
    v_lshl_add_u32 v12, v3, 4, v12
    s_lshl_b32 s70, s58, 7
    s_lshl_b32 s76, s55, 5
    s_add_u32 s70, s70, s76
    v_lshlrev_b32 v10, 16, v248
    v_lshlrev_b32 v11, 16, v240
    v_add_f32 v16, v10, v11
    v_and_b32 v10, 0xffff0000, v248
    v_and_b32 v11, 0xffff0000, v240
    s_waitcnt lgkmcnt(4)
    v_mfma_f32_32x32x16_bf16 v[128:143], v[192:195], v[112:115], v[128:143]
    ds_read_b64_tr_b16 v[216:217], v209 offset:4096
    v_add_f32 v17, v10, v11
    ds_read_b64_tr_b16 v[218:219], v209 offset:4608
    v_lshlrev_b32 v10, 16, v249
    v_lshlrev_b32 v11, 16, v241
    v_add_f32 v18, v10, v11
    v_and_b32 v10, 0xffff0000, v249
    v_mfma_f32_32x32x16_bf16 v[144:159], v[196:199], v[112:115], v[144:159]
    ds_read_b64_tr_b16 v[220:221], v209 offset:5120
    v_and_b32 v11, 0xffff0000, v241
    ds_read_b64_tr_b16 v[222:223], v209 offset:5632
    v_add_f32 v19, v10, v11
    v_lshlrev_b32 v10, 16, v250
    v_lshlrev_b32 v11, 16, v242
    v_add_f32 v20, v10, v11
    s_waitcnt lgkmcnt(4)
    v_mfma_f32_32x32x16_bf16 v[128:143], v[200:203], v[116:119], v[128:143]
    ds_read_b64_tr_b16 v[192:193], v209 offset:6144
    s_waitcnt vmcnt(0)
    ds_read_b64_tr_b16 v[194:195], v209 offset:6656
    v_xor_b32 v120, s21, v120
    ds_read_b64_tr_b16 v[196:197], v209 offset:7168
    v_xor_b32 v123, s21, v123
    ds_read_b64_tr_b16 v[198:199], v209 offset:7680
    v_or_b32 v5, v120, v123
    v_xor_b32 v124, s21, v124
    v_xor_b32 v127, s21, v127
    v_or3_b32 v5, v124, v127, v5
    v_and_b32 v5, 0x80008000, v5
    v_cmp_ne_u32 vcc, 0, v5
    s_nop 0
    s_cbranch_vccnz L_mk_rt_122
L_mk_bk_123:
    v_and_b32 v10, 0xffff0000, v250
    v_and_b32 v11, 0xffff0000, v242
    v_add_f32 v21, v10, v11
    v_lshlrev_b32 v10, 16, v251
    v_lshlrev_b32 v11, 16, v243
    v_add_f32 v22, v10, v11
    v_and_b32 v10, 0xffff0000, v251
    v_and_b32 v11, 0xffff0000, v243
    v_add_f32 v23, v10, v11
    s_waitcnt lgkmcnt(4)
    v_mfma_f32_32x32x16_bf16 v[128:143], v[216:219], v[120:123], v[128:143]
    ds_read_b32 v9, v8
    s_waitcnt lgkmcnt(0)
    v_mfma_f32_32x32x16_bf16 v[128:143], v[192:195], v[124:127], v[128:143]
    s_mul_i32 s68, s56, 24576
    v_add_u32 v5, s68, v2
    s_mul_i32 s68, s56, 86016
    s_add_u32 s68, s68, 12288
    v_add_u32 v6, s68, v2
    s_branch L_mk_f2e_56
L_mk_help_55:
    s_add_u32 m0, s72, 40960
    s_mov_b32 s68, 917504
    buffer_load_dwordx4 v234, s[28:31], s68 offen lds
    s_add_u32 m0, s72, 44992
    s_nop 0
    buffer_load_dwordx4 v234, s[28:31], s68 offen offset:64 lds
    s_add_u32 m0, s72, 49152
    s_mov_b32 s68, 1146880
    buffer_load_dwordx4 v234, s[28:31], s68 offen lds
    s_add_u32 m0, s72, 53184
    s_nop 0
    buffer_load_dwordx4 v234, s[28:31], s68 offen offset:64 lds
    s_add_u32 m0, s72, 57344
    s_mov_b32 s68, 1376256
    buffer_load_dwordx4 v234, s[28:31], s68 offen lds
    s_add_u32 m0, s72, 61376
    s_nop 0
    buffer_load_dwordx4 v234, s[28:31], s68 offen offset:64 lds
    s_add_u32 m0, s72, 0
    s_mov_b32 s68, 128
    buffer_load_dwordx4 v234, s[28:31], s68 offen lds
    s_add_u32 m0, s72, 4032
    s_nop 0
    buffer_load_dwordx4 v234, s[28:31], s68 offen offset:64 lds
    s_add_u32 m0, s72, 8192
    s_mov_b32 s68, 229504
    buffer_load_dwordx4 v234, s[28:31], s68 offen lds
    s_add_u32 m0, s72, 12224
    s_nop 0
    buffer_load_dwordx4 v234, s[28:31], s68 offen offset:64 lds
    s_add_u32 m0, s72, 16384
    s_mov_b32 s68, 458880
    buffer_load_dwordx4 v234, s[28:31], s68 offen lds
    s_add_u32 m0, s72, 20416
    s_nop 0
    buffer_load_dwordx4 v234, s[28:31], s68 offen offset:64 lds
    s_add_u32 m0, s72, 24576
    s_mov_b32 s68, 688256
    buffer_load_dwordx4 v234, s[28:31], s68 offen lds
    s_add_u32 m0, s72, 28608
    s_nop 0
    buffer_load_dwordx4 v234, s[28:31], s68 offen offset:64 lds
    s_add_u32 m0, s72, 32768
    s_mov_b32 s68, 917632
    buffer_load_dwordx4 v234, s[28:31], s68 offen lds
    s_add_u32 m0, s72, 36800
    s_nop 0
    buffer_load_dwordx4 v234, s[28:31], s68 offen offset:64 lds
    s_mov_b32 s68, 1147008
    buffer_load_dwordx4 v[16:19], v234, s[28:31], s68 offen offset:0
    buffer_load_dwordx4 v[20:23], v234, s[28:31], s68 offen offset:64
    s_mov_b32 s68, 1376384
    buffer_load_dwordx4 v[24:27], v234, s[28:31], s68 offen offset:0
    buffer_load_dwordx4 v[28:31], v234, s[28:31], s68 offen offset:64
    s_add_u32 s68, s73, 0
    buffer_load_dwordx4 v[32:35], v235, s[32:35], s68 offen offset:0
    buffer_load_dwordx4 v[36:39], v235, s[32:35], s68 offen offset:64
    s_add_u32 s68, s73, 114688
    buffer_load_dwordx4 v[40:43], v235, s[32:35], s68 offen offset:0
    buffer_load_dwordx4 v[44:47], v235, s[32:35], s68 offen offset:64
    s_add_u32 s68, s73, 229376
    buffer_load_dwordx4 v[48:51], v235, s[32:35], s68 offen offset:0
    buffer_load_dwordx4 v[52:55], v235, s[32:35], s68 offen offset:64
    s_add_u32 s68, s73, 344064
    buffer_load_dwordx4 v[56:59], v235, s[32:35], s68 offen offset:0
    buffer_load_dwordx4 v[60:63], v235, s[32:35], s68 offen offset:64
    s_add_u32 s68, s73, 458752
    buffer_load_dwordx4 v[64:67], v235, s[32:35], s68 offen offset:0
    buffer_load_dwordx4 v[68:71], v235, s[32:35], s68 offen offset:64
    s_add_u32 s68, s73, 1376256
    buffer_load_dwordx4 v[72:75], v235, s[32:35], s68 offen offset:0
    buffer_load_dwordx4 v[76:79], v235, s[32:35], s68 offen offset:64
    s_add_u32 s68, s73, 1490944
    buffer_load_dwordx4 v[80:83], v235, s[32:35], s68 offen offset:0
    buffer_load_dwordx4 v[84:87], v235, s[32:35], s68 offen offset:64
    s_add_u32 s68, s73, 57344
    buffer_load_dwordx4 v[88:91], v235, s[32:35], s68 offen offset:0
    buffer_load_dwordx4 v[92:95], v235, s[32:35], s68 offen offset:64
    s_add_u32 s68, s73, 172032
    buffer_load_dwordx4 v[96:99], v235, s[32:35], s68 offen offset:0
    buffer_load_dwordx4 v[100:103], v235, s[32:35], s68 offen offset:64
    s_add_u32 s68, s73, 286720
    buffer_load_dwordx4 v[104:107], v235, s[32:35], s68 offen offset:0
    buffer_load_dwordx4 v[108:111], v235, s[32:35], s68 offen offset:64
    s_add_u32 s68, s73, 401408
    buffer_load_dwordx4 v[112:115], v235, s[32:35], s68 offen offset:0
    buffer_load_dwordx4 v[116:119], v235, s[32:35], s68 offen offset:64
    s_add_u32 s68, s73, 516096
    buffer_load_dwordx4 v[120:123], v235, s[32:35], s68 offen offset:0
    buffer_load_dwordx4 v[124:127], v235, s[32:35], s68 offen offset:64
    v_add_u32 v212, s4, v2
    v_add_u32 v213, s5, v2
    v_add_u32 v214, s6, v2
    v_add_u32 v215, s7, v2
    s_add_u32 s68, s72, 98304
    v_add_u32 v9, s68, v2
    s_and_b32 s70, s59, 1
    s_lshl_b32 s70, s70, 1
    s_add_u32 s70, s70, s56
    s_mul_i32 s70, s70, 28
    s_lshl_b32 s68, s58, 2
    s_add_u32 s70, s70, s68
    s_add_u32 s70, s70, s55
    s_lshl_b32 s70, s70, 10
    s_add_u32 s70, s70, s62
    v_lshlrev_b32 v192, 16, v244
    v_and_b32 v193, 0xffff0000, v244
    v_lshlrev_b32 v194, 16, v245
    v_and_b32 v195, 0xffff0000, v245
    v_lshlrev_b32 v196, 16, v246
    v_and_b32 v197, 0xffff0000, v246
    v_lshlrev_b32 v198, 16, v247
    v_and_b32 v199, 0xffff0000, v247
    s_lshl_b32 s68, s55, 13
    s_add_u32 s68, s68, 98304
    v_add_u32 v7, s68, v2
    s_waitcnt vmcnt(28)
    s_barrier
    ds_read_b128 v[128:131], v7 offset:0
    ds_read_b128 v[132:135], v7 offset:1024
    ds_read_b128 v[136:139], v7 offset:2048
    ds_read_b128 v[140:143], v7 offset:3072
    ds_read_b128 v[144:147], v7 offset:4096
    ds_read_b128 v[148:151], v7 offset:5120
    ds_read_b128 v[152:155], v7 offset:6144
    ds_read_b128 v[156:159], v7 offset:7168
    s_waitcnt lgkmcnt(4)
    v_add_f32 v128, v128, v136
    v_add_f32 v129, v129, v137
    v_add_f32 v130, v130, v138
    v_add_f32 v131, v131, v139
    v_add_f32 v132, v132, v140
    v_add_f32 v133, v133, v141
    v_add_f32 v134, v134, v142
    v_add_f32 v135, v135, v143
    s_waitcnt lgkmcnt(0)
    v_add_f32 v144, v144, v152
    v_add_f32 v145, v145, v153
    v_add_f32 v146, v146, v154
    v_add_f32 v147, v147, v155
    v_add_f32 v148, v148, v156
    v_add_f32 v149, v149, v157
    v_add_f32 v150, v150, v158
    v_add_f32 v151, v151, v159
    v_add_f32 v128, v128, v144
    v_add_f32 v129, v129, v145
    v_add_f32 v130, v130, v146
    v_add_f32 v131, v131, v147
    v_add_f32 v132, v132, v148
    v_add_f32 v133, v133, v149
    v_add_f32 v134, v134, v150
    v_add_f32 v135, v135, v151
    v_cvt_pk_bf16_f32 v136, v128, v129
    v_cvt_pk_bf16_f32 v137, v130, v131
    v_cvt_pk_bf16_f32 v138, v132, v133
    v_cvt_pk_bf16_f32 v139, v134, v135
    v_lshlrev_b32 v128, 16, v136
    v_and_b32 v129, 0xffff0000, v136
    v_lshlrev_b32 v130, 16, v137
    v_and_b32 v131, 0xffff0000, v137
    v_lshlrev_b32 v132, 16, v138
    v_and_b32 v133, 0xffff0000, v138
    v_lshlrev_b32 v134, 16, v139
    v_and_b32 v135, 0xffff0000, v139
    v_add_f32 v128, v128, v192
    v_add_f32 v129, v129, v193
    v_add_f32 v130, v130, v194
    v_add_f32 v131, v131, v195
    v_add_f32 v132, v132, v196
    v_add_f32 v133, v133, v197
    v_add_f32 v134, v134, v198
    v_add_f32 v135, v135, v199
    v_cvt_pk_bf16_f32 v240, v128, v129
    v_cvt_pk_bf16_f32 v241, v130, v131
    v_cvt_pk_bf16_f32 v242, v132, v133
    v_cvt_pk_bf16_f32 v243, v134, v135
    buffer_store_dwordx4 v[240:243], v2, s[16:19], s70 offen
    v_lshlrev_b32 v128, 16, v240
    v_and_b32 v129, 0xffff0000, v240
    v_lshlrev_b32 v130, 16, v241
    v_and_b32 v131, 0xffff0000, v241
    v_lshlrev_b32 v132, 16, v242
    v_and_b32 v133, 0xffff0000, v242
    v_lshlrev_b32 v134, 16, v243
    v_and_b32 v135, 0xffff0000, v243
    v_add_f32 v10, v128, v129
    v_mul_f32 v11, v128, v128
    v_fma_f32 v11, v129, v129, v11
    v_add_f32 v10, v10, v130
    v_fma_f32 v11, v130, v130, v11
    v_add_f32 v10, v10, v131
    v_fma_f32 v11, v131, v131, v11
    v_add_f32 v10, v10, v132
    v_fma_f32 v11, v132, v132, v11
    v_add_f32 v10, v10, v133
    v_fma_f32 v11, v133, v133, v11
    v_add_f32 v10, v10, v134
    v_fma_f32 v11, v134, v134, v11
    v_add_f32 v10, v10, v135
    v_fma_f32 v11, v135, v135, v11
    v_mov_b32 v12, v10
    v_mov_b32 v13, v11
    s_lshl_b32 s70, s56, 10
    s_lshl_b32 s71, s55, 3
    s_add_u32 s70, s70, s71
    s_add_u32 s70, s70, 159744
    v_permlane32_swap_b32 v10, v12
    v_permlane32_swap_b32 v11, v13
    v_lshl_add_u32 v5, v4, 5, s70
    v_add_f32 v12, v10, v12
    v_add_f32 v13, v11, v13
    ds_write_b64 v5, v[12:13]
    s_waitcnt lgkmcnt(0)
    s_barrier
    s_cmp_lg_u32 s54, 4
    s_cbranch_scc1 L_mk_p4_124
    v_lshlrev_b32 v5, 3, v1
    v_lshlrev_b32 v7, 5, v1
    v_add_u32 v7, 159744, v7
    ds_read_b128 v[128:131], v7
    ds_read_b128 v[132:135], v7 offset:16
    s_and_b32 s70, s59, 1
    s_mul_i32 s70, s70, 7
    s_add_u32 s70, s70, s58
    s_lshl_b32 s70, s70, 9
    s_add_u32 s70, s70, s62
    s_add_u32 s70, s70, 114688
    s_waitcnt lgkmcnt(0)
    v_add_f32 v128, v128, v130
    v_add_f32 v129, v129, v131
    v_add_f32 v132, v132, v134
    v_add_f32 v133, v133, v135
    v_add_f32 v10, v128, v132
    v_add_f32 v11, v129, v133
    buffer_store_dwordx2 v[10:11], v5, s[16:19], s70 offen
L_mk_p4_124:
    s_waitcnt vmcnt(15)
    ds_write_b128 v9, v[16:19] offset:0
    ds_write_b128 v9, v[20:23] offset:4096
    ds_write_b128 v9, v[24:27] offset:8192
    ds_write_b128 v9, v[28:31] offset:12288
    ds_write_b128 v212, v[32:35] offset:0
    ds_write_b128 v212, v[36:39] offset:1024
    ds_write_b128 v212, v[40:43] offset:2048
    ds_write_b128 v212, v[44:47] offset:3072
    ds_write_b128 v212, v[48:51] offset:4096
    ds_write_b128 v212, v[52:55] offset:5120
    s_waitcnt lgkmcnt(0)
    ds_write_b128 v212, v[56:59] offset:6144
    ds_write_b128 v212, v[60:63] offset:7168
    ds_write_b128 v212, v[64:67] offset:8192
    ds_write_b128 v212, v[68:71] offset:9216
    s_waitcnt lgkmcnt(0)
    s_barrier
    s_add_u32 m0, s5, 0
    s_add_u32 s68, s73, 573440
    buffer_load_dwordx4 v235, s[32:35], s68 offen lds
    s_add_u32 m0, s5, 960
    s_nop 0
    buffer_load_dwordx4 v235, s[32:35], s68 offen offset:64 lds
    s_add_u32 m0, s5, 2048
    s_add_u32 s68, s73, 688128
    buffer_load_dwordx4 v235, s[32:35], s68 offen lds
    s_add_u32 m0, s5, 3008
    s_nop 0
    buffer_load_dwordx4 v235, s[32:35], s68 offen offset:64 lds
    s_add_u32 m0, s5, 4096
    s_add_u32 s68, s73, 802816
    buffer_load_dwordx4 v235, s[32:35], s68 offen lds
    s_add_u32 m0, s5, 5056
    s_nop 0
    buffer_load_dwordx4 v235, s[32:35], s68 offen offset:64 lds
    s_add_u32 m0, s5, 6144
    s_add_u32 s68, s73, 917504
    buffer_load_dwordx4 v235, s[32:35], s68 offen lds
    s_add_u32 m0, s5, 7104
    s_nop 0
    buffer_load_dwordx4 v235, s[32:35], s68 offen offset:64 lds
    s_add_u32 m0, s5, 8192
    s_add_u32 s68, s73, 1032192
    buffer_load_dwordx4 v235, s[32:35], s68 offen lds
    s_add_u32 m0, s5, 9152
    s_nop 0
    buffer_load_dwordx4 v235, s[32:35], s68 offen offset:64 lds
    s_add_u32 m0, s5, 10240
    s_add_u32 s68, s73, 1146880
    buffer_load_dwordx4 v235, s[32:35], s68 offen lds
    s_add_u32 m0, s5, 11200
    s_nop 0
    buffer_load_dwordx4 v235, s[32:35], s68 offen offset:64 lds
    s_add_u32 m0, s5, 12288
    s_add_u32 s68, s73, 1261568
    buffer_load_dwordx4 v235, s[32:35], s68 offen lds
    s_add_u32 m0, s5, 13248
    s_nop 0
    buffer_load_dwordx4 v235, s[32:35], s68 offen offset:64 lds
    s_and_b32 s71, s59, 1
    s_lshl_b32 s71, s71, 1
    s_add_u32 s71, s71, s56
    s_lshl_b32 s71, s71, 2
    s_add_u32 s71, s71, s55
    s_mul_i32 s71, s71, 28672
    s_add_u32 s71, s71, s62
    s_add_u32 s71, s71, 131072
    s_waitcnt vmcnt(14)
    s_barrier
    s_add_u32 s77, s71, 0
    buffer_load_dwordx4 v[16:19], v2, s[16:19], s77 offen offset:0 sc1
    ds_write_b128 v214, v[72:75] offset:0
    ds_write_b128 v214, v[76:79] offset:1024
    buffer_load_dwordx4 v[20:23], v2, s[16:19], s77 offen offset:1024 sc1
    ds_write_b128 v214, v[80:83] offset:2048
    ds_write_b128 v214, v[84:87] offset:3072
    buffer_load_dwordx4 v[24:27], v2, s[16:19], s77 offen offset:2048 sc1
    ds_write_b128 v214, v[88:91] offset:4096
    ds_write_b128 v214, v[92:95] offset:5120
    buffer_load_dwordx4 v[28:31], v2, s[16:19], s77 offen offset:3072 sc1
    ds_write_b128 v214, v[96:99] offset:6144
    ds_write_b128 v214, v[100:103] offset:7168
    s_add_u32 s77, s71, 4096
    buffer_load_dwordx4 v[32:35], v2, s[16:19], s77 offen offset:0 sc1
    ds_write_b128 v214, v[104:107] offset:8192
    ds_write_b128 v214, v[108:111] offset:9216
    buffer_load_dwordx4 v[36:39], v2, s[16:19], s77 offen offset:1024 sc1
    buffer_load_dwordx4 v[40:43], v2, s[16:19], s77 offen offset:2048 sc1
    buffer_load_dwordx4 v[44:47], v2, s[16:19], s77 offen offset:3072 sc1
    s_waitcnt lgkmcnt(0)
    v_add_u32 v208, s4, v232
    v_add_u32 v209, s5, v232
    v_add_u32 v210, s6, v232
    v_add_u32 v211, s7, v232
    ds_read_b64_tr_b16 v[192:193], v208 offset:0
    ds_read_b64_tr_b16 v[194:195], v208 offset:512
    ds_read_b64_tr_b16 v[196:197], v208 offset:1024
    ds_read_b64_tr_b16 v[198:199], v208 offset:1536
    ds_read_b64_tr_b16 v[200:201], v208 offset:2048
    ds_read_b64_tr_b16 v[202:203], v208 offset:2560
    ds_read_b64_tr_b16 v[204:205], v208 offset:3072
    ds_read_b64_tr_b16 v[206:207], v208 offset:3584
    s_waitcnt vmcnt(6)
    v_xor_b32 v16, s21, v16
    v_xor_b32 v19, s21, v19
    v_or_b32 v5, v16, v19
    v_xor_b32 v20, s21, v20
    v_xor_b32 v23, s21, v23
    v_or3_b32 v5, v20, v23, v5
    v_and_b32 v5, 0x80008000, v5
    v_cmp_ne_u32 vcc, 0, v5
    s_nop 0
    s_cbranch_vccnz L_mk_rt_125
L_mk_bk_126:
    s_barrier
    s_waitcnt lgkmcnt(4)
    v_mfma_f32_32x32x16_bf16 v[128:143], v[192:195], v[16:19], 0
    ds_write_b128 v215, v[112:115] offset:0
    s_add_u32 s77, s71, 8192
    ds_read_b64_tr_b16 v[216:217], v208 offset:4096
    ds_read_b64_tr_b16 v[218:219], v208 offset:4608
    v_mfma_f32_32x32x16_bf16 v[144:159], v[196:199], v[16:19], 0
    ds_read_b64_tr_b16 v[220:221], v208 offset:5120
    buffer_load_dwordx4 v[48:51], v2, s[16:19], s77 offen offset:0 sc1
    ds_read_b64_tr_b16 v[222:223], v208 offset:5632
    s_waitcnt lgkmcnt(5)
    v_mfma_f32_32x32x16_bf16 v[128:143], v[200:203], v[20:23], v[128:143]
    ds_write_b128 v215, v[116:119] offset:1024
    buffer_load_dwordx4 v[52:55], v2, s[16:19], s77 offen offset:1024 sc1
    ds_read_b64_tr_b16 v[192:193], v208 offset:6144
    s_waitcnt vmcnt(6)
    ds_read_b64_tr_b16 v[194:195], v208 offset:6656
    v_xor_b32 v24, s21, v24
    v_xor_b32 v27, s21, v27
    v_or_b32 v5, v24, v27
    v_xor_b32 v28, s21, v28
    v_mfma_f32_32x32x16_bf16 v[144:159], v[204:207], v[20:23], v[144:159]
    ds_read_b64_tr_b16 v[196:197], v208 offset:7168
    v_xor_b32 v31, s21, v31
    ds_read_b64_tr_b16 v[198:199], v208 offset:7680
    v_or3_b32 v5, v28, v31, v5
    v_and_b32 v5, 0x80008000, v5
    v_cmp_ne_u32 vcc, 0, v5
    s_nop 0
    s_cbranch_vccnz L_mk_rt_127
L_mk_bk_128:
    s_waitcnt lgkmcnt(5)
    v_mfma_f32_32x32x16_bf16 v[128:143], v[216:219], v[24:27], v[128:143]
    ds_write_b128 v215, v[120:123] offset:2048
    buffer_load_dwordx4 v[56:59], v2, s[16:19], s77 offen offset:2048 sc1
    ds_read_b64_tr_b16 v[200:201], v208 offset:8192
    ds_read_b64_tr_b16 v[202:203], v208 offset:8704
    v_mfma_f32_32x32x16_bf16 v[144:159], v[220:223], v[24:27], v[144:159]
    ds_read_b64_tr_b16 v[204:205], v208 offset:9216
    ds_read_b64_tr_b16 v[206:207], v208 offset:9728
    s_waitcnt lgkmcnt(5)
    v_mfma_f32_32x32x16_bf16 v[128:143], v[192:195], v[28:31], v[128:143]
    ds_write_b128 v215, v[124:127] offset:3072
    buffer_load_dwordx4 v[60:63], v2, s[16:19], s77 offen offset:3072 sc1
    ds_read_b64_tr_b16 v[216:217], v209 offset:0
    s_waitcnt vmcnt(6)
    ds_read_b64_tr_b16 v[218:219], v209 offset:512
    v_xor_b32 v32, s21, v32
    v_xor_b32 v35, s21, v35
    v_or_b32 v5, v32, v35
    v_xor_b32 v36, s21, v36
    v_mfma_f32_32x32x16_bf16 v[144:159], v[196:199], v[28:31], v[144:159]
    ds_read_b64_tr_b16 v[220:221], v209 offset:1024
    v_xor_b32 v39, s21, v39
    ds_read_b64_tr_b16 v[222:223], v209 offset:1536
    v_or3_b32 v5, v36, v39, v5
    v_and_b32 v5, 0x80008000, v5
    v_cmp_ne_u32 vcc, 0, v5
    s_nop 0
    s_cbranch_vccnz L_mk_rt_129
L_mk_bk_130:
    s_waitcnt lgkmcnt(5)
    v_mfma_f32_32x32x16_bf16 v[128:143], v[200:203], v[32:35], v[128:143]
    ds_read_b64_tr_b16 v[192:193], v209 offset:2048
    s_add_u32 s77, s71, 12288
    ds_read_b64_tr_b16 v[194:195], v209 offset:2560
    v_mfma_f32_32x32x16_bf16 v[144:159], v[204:207], v[32:35], v[144:159]
    ds_read_b64_tr_b16 v[196:197], v209 offset:3072
    buffer_load_dwordx4 v[64:67], v2, s[16:19], s77 offen offset:0 sc1
    ds_read_b64_tr_b16 v[198:199], v209 offset:3584
    s_waitcnt lgkmcnt(4)
    v_mfma_f32_32x32x16_bf16 v[128:143], v[216:219], v[36:39], v[128:143]
    ds_read_b64_tr_b16 v[200:201], v209 offset:4096
    buffer_load_dwordx4 v[68:71], v2, s[16:19], s77 offen offset:1024 sc1
    ds_read_b64_tr_b16 v[202:203], v209 offset:4608
    s_waitcnt vmcnt(6)
    v_xor_b32 v40, s21, v40
    v_xor_b32 v43, s21, v43
    v_or_b32 v5, v40, v43
    v_xor_b32 v44, s21, v44
    v_mfma_f32_32x32x16_bf16 v[144:159], v[220:223], v[36:39], v[144:159]
    ds_read_b64_tr_b16 v[204:205], v209 offset:5120
    v_xor_b32 v47, s21, v47
    ds_read_b64_tr_b16 v[206:207], v209 offset:5632
    v_or3_b32 v5, v44, v47, v5
    v_and_b32 v5, 0x80008000, v5
    v_cmp_ne_u32 vcc, 0, v5
    s_nop 0
    s_cbranch_vccnz L_mk_rt_131
L_mk_bk_132:
    s_waitcnt lgkmcnt(4)
    v_mfma_f32_32x32x16_bf16 v[128:143], v[192:195], v[40:43], v[128:143]
    ds_read_b64_tr_b16 v[216:217], v209 offset:6144
    ds_read_b64_tr_b16 v[218:219], v209 offset:6656
    v_mfma_f32_32x32x16_bf16 v[144:159], v[196:199], v[40:43], v[144:159]
    ds_read_b64_tr_b16 v[220:221], v209 offset:7168
    ds_read_b64_tr_b16 v[222:223], v209 offset:7680
    s_waitcnt lgkmcnt(4)
    v_mfma_f32_32x32x16_bf16 v[128:143], v[200:203], v[44:47], v[128:143]
    ds_read_b64_tr_b16 v[192:193], v209 offset:8192
    s_waitcnt vmcnt(4)
    ds_read_b64_tr_b16 v[194:195], v209 offset:8704
    v_xor_b32 v48, s21, v48
    v_xor_b32 v51, s21, v51
    v_or_b32 v5, v48, v51
    v_xor_b32 v52, s21, v52
    v_mfma_f32_32x32x16_bf16 v[144:159], v[204:207], v[44:47], v[144:159]
    ds_read_b64_tr_b16 v[196:197], v209 offset:9216
    v_xor_b32 v55, s21, v55
    ds_read_b64_tr_b16 v[198:199], v209 offset:9728
    v_or3_b32 v5, v52, v55, v5
    v_and_b32 v5, 0x80008000, v5
    v_cmp_ne_u32 vcc, 0, v5
    s_nop 0
    s_cbranch_vccnz L_mk_rt_133
L_mk_bk_134:
    s_waitcnt lgkmcnt(4)
    v_mfma_f32_32x32x16_bf16 v[128:143], v[216:219], v[48:51], v[128:143]
    ds_read_b64_tr_b16 v[200:201], v209 offset:10240
    ds_read_b64_tr_b16 v[202:203], v209 offset:10752
    v_mfma_f32_32x32x16_bf16 v[144:159], v[220:223], v[48:51], v[144:159]
    ds_read_b64_tr_b16 v[204:205], v209 offset:11264
    ds_read_b64_tr_b16 v[206:207], v209 offset:11776
    s_waitcnt lgkmcnt(4)
    s_barrier
    v_mfma_f32_32x32x16_bf16 v[128:143], v[192:195], v[52:55], v[128:143]
    ds_write_b128 v212, v[160:163] offset:8192
    s_add_u32 m0, s4, 0
    ds_read_b64_tr_b16 v[216:217], v209 offset:12288
    s_add_u32 s68, s73, 630784
    ds_read_b64_tr_b16 v[218:219], v209 offset:12800
    buffer_load_dwordx4 v235, s[32:35], s68 offen lds
    s_add_u32 m0, s4, 960
    s_nop 0
    buffer_load_dwordx4 v235, s[32:35], s68 offen offset:64 lds
    s_add_u32 s77, s71, 14336
    buffer_load_dwordx4 v[72:75], v2, s[16:19], s77 offen offset:0 sc1
    s_waitcnt vmcnt(5)
    v_xor_b32 v56, s21, v56
    v_mfma_f32_32x32x16_bf16 v[144:159], v[196:199], v[52:55], v[144:159]
    ds_read_b64_tr_b16 v[220:221], v209 offset:13312
    v_xor_b32 v59, s21, v59
    ds_read_b64_tr_b16 v[222:223], v209 offset:13824
    v_or_b32 v5, v56, v59
    v_xor_b32 v60, s21, v60
    v_xor_b32 v63, s21, v63
    v_or3_b32 v5, v60, v63, v5
    v_and_b32 v5, 0x80008000, v5
    v_cmp_ne_u32 vcc, 0, v5
    s_nop 0
    s_cbranch_vccnz L_mk_rt_135
L_mk_bk_136:
    s_waitcnt lgkmcnt(5)
    v_mfma_f32_32x32x16_bf16 v[128:143], v[200:203], v[56:59], v[128:143]
    ds_write_b128 v212, v[164:167] offset:9216
    s_add_u32 m0, s4, 2048
    ds_read_b64_tr_b16 v[192:193], v210 offset:0
    s_add_u32 s68, s73, 745472
    ds_read_b64_tr_b16 v[194:195], v210 offset:512
    buffer_load_dwordx4 v235, s[32:35], s68 offen lds
    v_mfma_f32_32x32x16_bf16 v[144:159], v[204:207], v[56:59], v[144:159]
    ds_read_b64_tr_b16 v[196:197], v210 offset:1024
    s_add_u32 m0, s4, 3008
    ds_read_b64_tr_b16 v[198:199], v210 offset:1536
    buffer_load_dwordx4 v235, s[32:35], s68 offen offset:64 lds
    buffer_load_dwordx4 v[76:79], v2, s[16:19], s77 offen offset:1024 sc1
    s_waitcnt lgkmcnt(5)
    v_mfma_f32_32x32x16_bf16 v[128:143], v[216:219], v[60:63], v[128:143]
    ds_write_b128 v213, v[168:171] offset:0
    s_add_u32 m0, s4, 4096
    ds_read_b64_tr_b16 v[200:201], v210 offset:2048
    s_add_u32 s68, s73, 860160
    ds_read_b64_tr_b16 v[202:203], v210 offset:2560
    buffer_load_dwordx4 v235, s[32:35], s68 offen lds
    s_add_u32 m0, s4, 5056
    s_nop 0
    buffer_load_dwordx4 v235, s[32:35], s68 offen offset:64 lds
    buffer_load_dwordx4 v[80:83], v2, s[16:19], s77 offen offset:2048 sc1
    s_waitcnt vmcnt(9)
    v_xor_b32 v64, s21, v64
    v_mfma_f32_32x32x16_bf16 v[144:159], v[220:223], v[60:63], v[144:159]
    ds_read_b64_tr_b16 v[204:205], v210 offset:3072
    v_xor_b32 v67, s21, v67
    ds_read_b64_tr_b16 v[206:207], v210 offset:3584
    v_or_b32 v5, v64, v67
    v_xor_b32 v68, s21, v68
    v_xor_b32 v71, s21, v71
    v_or3_b32 v5, v68, v71, v5
    v_and_b32 v5, 0x80008000, v5
    v_cmp_ne_u32 vcc, 0, v5
    s_nop 0
    s_cbranch_vccnz L_mk_rt_137
L_mk_bk_138:
    s_waitcnt lgkmcnt(5)
    v_mfma_f32_32x32x16_bf16 v[128:143], v[192:195], v[64:67], v[128:143]
    ds_write_b128 v213, v[172:175] offset:1024
    s_add_u32 m0, s4, 6144
    ds_read_b64_tr_b16 v[216:217], v210 offset:4096
    s_add_u32 s68, s73, 974848
    ds_read_b64_tr_b16 v[218:219], v210 offset:4608
    buffer_load_dwordx4 v235, s[32:35], s68 offen lds
    v_mfma_f32_32x32x16_bf16 v[144:159], v[196:199], v[64:67], v[144:159]
    ds_read_b64_tr_b16 v[220:221], v210 offset:5120
    s_add_u32 m0, s4, 7104
    ds_read_b64_tr_b16 v[222:223], v210 offset:5632
    buffer_load_dwordx4 v235, s[32:35], s68 offen offset:64 lds
    buffer_load_dwordx4 v[84:87], v2, s[16:19], s77 offen offset:3072 sc1
    s_waitcnt lgkmcnt(5)
    v_mfma_f32_32x32x16_bf16 v[128:143], v[200:203], v[68:71], v[128:143]
    ds_write_b128 v213, v[176:179] offset:2048
    s_add_u32 s77, s71, 18432
    ds_read_b64_tr_b16 v[192:193], v210 offset:6144
    buffer_load_dwordx4 v[88:91], v2, s[16:19], s77 offen offset:0 sc1
    ds_read_b64_tr_b16 v[194:195], v210 offset:6656
    s_waitcnt vmcnt(7)
    v_xor_b32 v72, s21, v72
    v_xor_b32 v75, s21, v75
    v_or_b32 v5, v72, v75
    v_mfma_f32_32x32x16_bf16 v[144:159], v[204:207], v[68:71], v[144:159]
    ds_read_b64_tr_b16 v[196:197], v210 offset:7168
    v_xor_b32 v76, s21, v76
    ds_read_b64_tr_b16 v[198:199], v210 offset:7680
    v_xor_b32 v79, s21, v79
    v_or3_b32 v5, v76, v79, v5
    v_and_b32 v5, 0x80008000, v5
    v_cmp_ne_u32 vcc, 0, v5
    s_nop 0
    s_cbranch_vccnz L_mk_rt_139
L_mk_bk_140:
    s_waitcnt lgkmcnt(5)
    v_mfma_f32_32x32x16_bf16 v[128:143], v[216:219], v[72:75], v[128:143]
    ds_write_b128 v213, v[180:183] offset:3072
    buffer_load_dwordx4 v[92:95], v2, s[16:19], s77 offen offset:1024 sc1
    ds_read_b64_tr_b16 v[200:201], v210 offset:8192
    ds_read_b64_tr_b16 v[202:203], v210 offset:8704
    v_mfma_f32_32x32x16_bf16 v[144:159], v[220:223], v[72:75], v[144:159]
    ds_read_b64_tr_b16 v[204:205], v210 offset:9216
    ds_read_b64_tr_b16 v[206:207], v210 offset:9728
    s_waitcnt lgkmcnt(5)
    v_mfma_f32_32x32x16_bf16 v[128:143], v[192:195], v[76:79], v[128:143]
    ds_write_b128 v213, v[184:187] offset:4096
    buffer_load_dwordx4 v[96:99], v2, s[16:19], s77 offen offset:2048 sc1
    ds_read_b64_tr_b16 v[216:217], v211 offset:0
    s_waitcnt vmcnt(3)
    ds_read_b64_tr_b16 v[218:219], v211 offset:512
    v_xor_b32 v80, s21, v80
    v_xor_b32 v83, s21, v83
    v_or_b32 v5, v80, v83
    v_xor_b32 v84, s21, v84
    v_mfma_f32_32x32x16_bf16 v[144:159], v[196:199], v[76:79], v[144:159]
    ds_read_b64_tr_b16 v[220:221], v211 offset:1024
    v_xor_b32 v87, s21, v87
    ds_read_b64_tr_b16 v[222:223], v211 offset:1536
    v_or3_b32 v5, v84, v87, v5
    v_and_b32 v5, 0x80008000, v5
    v_cmp_ne_u32 vcc, 0, v5
    s_nop 0
    s_cbranch_vccnz L_mk_rt_141
L_mk_bk_142:
    s_waitcnt lgkmcnt(5)
    v_mfma_f32_32x32x16_bf16 v[128:143], v[200:203], v[80:83], v[128:143]
    ds_write_b128 v213, v[188:191] offset:5120
    buffer_load_dwordx4 v[100:103], v2, s[16:19], s77 offen offset:3072 sc1
    ds_read_b64_tr_b16 v[192:193], v211 offset:2048
    ds_read_b64_tr_b16 v[194:195], v211 offset:2560
    v_mfma_f32_32x32x16_bf16 v[144:159], v[204:207], v[80:83], v[144:159]
    ds_read_b64_tr_b16 v[196:197], v211 offset:3072
    ds_read_b64_tr_b16 v[198:199], v211 offset:3584
    s_waitcnt lgkmcnt(5)
    s_waitcnt vmcnt(5)
    s_barrier
    v_mfma_f32_32x32x16_bf16 v[128:143], v[216:219], v[84:87], v[128:143]
    ds_write_b128 v213, v[224:227] offset:6144
    s_add_u32 s77, s71, 22528
    ds_read_b64_tr_b16 v[200:201], v208 offset:0
    buffer_load_dwordx4 v[104:107], v2, s[16:19], s77 offen offset:0 sc1
    ds_read_b64_tr_b16 v[202:203], v208 offset:512
    s_waitcnt vmcnt(3)
    v_xor_b32 v88, s21, v88
    v_xor_b32 v91, s21, v91
    v_or_b32 v5, v88, v91
    v_mfma_f32_32x32x16_bf16 v[144:159], v[220:223], v[84:87], v[144:159]
    ds_read_b64_tr_b16 v[204:205], v208 offset:1024
    v_xor_b32 v92, s21, v92
    ds_read_b64_tr_b16 v[206:207], v208 offset:1536
    v_xor_b32 v95, s21, v95
    v_or3_b32 v5, v92, v95, v5
    v_and_b32 v5, 0x80008000, v5
    v_cmp_ne_u32 vcc, 0, v5
    s_nop 0
    s_cbranch_vccnz L_mk_rt_143
L_mk_bk_144:
    s_waitcnt lgkmcnt(5)
    v_mfma_f32_32x32x16_bf16 v[128:143], v[192:195], v[88:91], v[128:143]
    ds_write_b128 v213, v[228:231] offset:7168
    buffer_load_dwordx4 v[108:111], v2, s[16:19], s77 offen offset:1024 sc1
    ds_read_b64_tr_b16 v[216:217], v208 offset:2048
    ds_read_b64_tr_b16 v[218:219], v208 offset:2560
    v_mfma_f32_32x32x16_bf16 v[144:159], v[196:199], v[88:91], v[144:159]
    ds_read_b64_tr_b16 v[220:221], v208 offset:3072
    ds_read_b64_tr_b16 v[222:223], v208 offset:3584
    s_waitcnt lgkmcnt(5)
    v_mfma_f32_32x32x16_bf16 v[128:143], v[200:203], v[92:95], v[128:143]
    ds_read_b64_tr_b16 v[192:193], v208 offset:4096
    buffer_load_dwordx4 v[112:115], v2, s[16:19], s77 offen offset:2048 sc1
    ds_read_b64_tr_b16 v[194:195], v208 offset:4608
    s_waitcnt vmcnt(3)
    v_xor_b32 v96, s21, v96
    v_xor_b32 v99, s21, v99
    v_or_b32 v5, v96, v99
    v_xor_b32 v100, s21, v100
    v_mfma_f32_32x32x16_bf16 v[144:159], v[204:207], v[92:95], v[144:159]
    ds_read_b64_tr_b16 v[196:197], v208 offset:5120
    v_xor_b32 v103, s21, v103
    ds_read_b64_tr_b16 v[198:199], v208 offset:5632
    v_or3_b32 v5, v100, v103, v5
    v_and_b32 v5, 0x80008000, v5
    v_cmp_ne_u32 vcc, 0, v5
    s_nop 0
    s_cbranch_vccnz L_mk_rt_145
L_mk_bk_146:
    s_waitcnt lgkmcnt(4)
    v_mfma_f32_32x32x16_bf16 v[128:143], v[216:219], v[96:99], v[128:143]
    ds_read_b64_tr_b16 v[200:201], v208 offset:6144
    buffer_load_dwordx4 v[116:119], v2, s[16:19], s77 offen offset:3072 sc1
    ds_read_b64_tr_b16 v[202:203], v208 offset:6656
    v_mfma_f32_32x32x16_bf16 v[144:159], v[220:223], v[96:99], v[144:159]
    ds_read_b64_tr_b16 v[204:205], v208 offset:7168
    ds_read_b64_tr_b16 v[206:207], v208 offset:7680
    s_waitcnt lgkmcnt(4)
    s_barrier
    v_mfma_f32_32x32x16_bf16 v[128:143], v[192:195], v[100:103], v[128:143]
    ds_read_b64_tr_b16 v[216:217], v208 offset:8192
    s_add_u32 s77, s71, 26624
    ds_read_b64_tr_b16 v[218:219], v208 offset:8704
    buffer_load_dwordx4 v[120:123], v2, s[16:19], s77 offen offset:0 sc1
    s_waitcnt vmcnt(3)
    v_xor_b32 v104, s21, v104
    v_xor_b32 v107, s21, v107
    v_or_b32 v5, v104, v107
    v_mfma_f32_32x32x16_bf16 v[144:159], v[196:199], v[100:103], v[144:159]
    ds_read_b64_tr_b16 v[220:221], v208 offset:9216
    v_xor_b32 v108, s21, v108
    ds_read_b64_tr_b16 v[222:223], v208 offset:9728
    v_xor_b32 v111, s21, v111
    v_or3_b32 v5, v108, v111, v5
    v_and_b32 v5, 0x80008000, v5
    v_cmp_ne_u32 vcc, 0, v5
    s_nop 0
    s_cbranch_vccnz L_mk_rt_147
L_mk_bk_148:
    s_waitcnt lgkmcnt(4)
    v_mfma_f32_32x32x16_bf16 v[128:143], v[200:203], v[104:107], v[128:143]
    ds_read_b64_tr_b16 v[192:193], v209 offset:0
    buffer_load_dwordx4 v[124:127], v2, s[16:19], s77 offen offset:1024 sc1
    ds_read_b64_tr_b16 v[194:195], v209 offset:512
    s_and_b32 s70, s59, 1
    s_lshl_b32 s70, s70, 8
    s_lshl_b32 s76, s56, 7
    s_add_u32 s70, s70, s76
    s_add_u32 s70, s70, 162304
    v_mfma_f32_32x32x16_bf16 v[144:159], v[204:207], v[104:107], v[144:159]
    ds_read_b64_tr_b16 v[196:197], v209 offset:1024
    v_lshl_add_u32 v8, v4, 2, s70
    ds_read_b64_tr_b16 v[198:199], v209 offset:1536
    s_lshl_b32 s70, s59, 1
    s_add_u32 s70, s70, s56
    s_lshl_b32 s70, s70, 5
    v_add_u32 v12, s70, v4
    s_waitcnt lgkmcnt(4)
    v_mfma_f32_32x32x16_bf16 v[128:143], v[216:219], v[108:111], v[128:143]
    ds_read_b64_tr_b16 v[200:201], v209 offset:2048
    s_waitcnt vmcnt(2)
    ds_read_b64_tr_b16 v[202:203], v209 offset:2560
    v_xor_b32 v112, s21, v112
    v_xor_b32 v115, s21, v115
    v_or_b32 v5, v112, v115
    v_xor_b32 v116, s21, v116
    v_xor_b32 v119, s21, v119
    v_or3_b32 v5, v116, v119, v5
    v_and_b32 v5, 0x80008000, v5
    v_cmp_ne_u32 vcc, 0, v5
    s_nop 0
    s_cbranch_vccnz L_mk_rt_149
L_mk_bk_150:
    v_mfma_f32_32x32x16_bf16 v[144:159], v[220:223], v[108:111], v[144:159]
    ds_read_b64_tr_b16 v[204:205], v209 offset:3072
    v_mul_u32_u24 v12, 896, v12
    ds_read_b64_tr_b16 v[206:207], v209 offset:3584
    v_lshl_add_u32 v12, v3, 4, v12
    s_lshl_b32 s70, s58, 7
    s_lshl_b32 s76, s55, 5
    s_add_u32 s70, s70, s76
    v_lshlrev_b32 v10, 16, v248
    v_lshlrev_b32 v11, 16, v240
    v_add_f32 v16, v10, v11
    v_and_b32 v10, 0xffff0000, v248
    v_and_b32 v11, 0xffff0000, v240
    s_waitcnt lgkmcnt(4)
    v_mfma_f32_32x32x16_bf16 v[128:143], v[192:195], v[112:115], v[128:143]
    ds_read_b64_tr_b16 v[216:217], v209 offset:4096
    v_add_f32 v17, v10, v11
    ds_read_b64_tr_b16 v[218:219], v209 offset:4608
    v_lshlrev_b32 v10, 16, v249
    v_lshlrev_b32 v11, 16, v241
    v_add_f32 v18, v10, v11
    v_and_b32 v10, 0xffff0000, v249
    v_mfma_f32_32x32x16_bf16 v[144:159], v[196:199], v[112:115], v[144:159]
    ds_read_b64_tr_b16 v[220:221], v209 offset:5120
    v_and_b32 v11, 0xffff0000, v241
    ds_read_b64_tr_b16 v[222:223], v209 offset:5632
    v_add_f32 v19, v10, v11
    v_lshlrev_b32 v10, 16, v250
    v_lshlrev_b32 v11, 16, v242
    v_add_f32 v20, v10, v11
    s_waitcnt lgkmcnt(4)
    v_mfma_f32_32x32x16_bf16 v[128:143], v[200:203], v[116:119], v[128:143]
    ds_read_b64_tr_b16 v[192:193], v209 offset:6144
    s_waitcnt vmcnt(0)
    ds_read_b64_tr_b16 v[194:195], v209 offset:6656
    v_xor_b32 v120, s21, v120
    ds_read_b64_tr_b16 v[196:197], v209 offset:7168
    v_xor_b32 v123, s21, v123
    ds_read_b64_tr_b16 v[198:199], v209 offset:7680
    v_or_b32 v5, v120, v123
    v_xor_b32 v124, s21, v124
    v_xor_b32 v127, s21, v127
    v_or3_b32 v5, v124, v127, v5
    v_and_b32 v5, 0x80008000, v5
    v_cmp_ne_u32 vcc, 0, v5
    s_nop 0
    s_cbranch_vccnz L_mk_rt_151
L_mk_bk_152:
    v_and_b32 v10, 0xffff0000, v250
    v_and_b32 v11, 0xffff0000, v242
    v_add_f32 v21, v10, v11
    v_lshlrev_b32 v10, 16, v251
    v_lshlrev_b32 v11, 16, v243
    v_add_f32 v22, v10, v11
    v_and_b32 v10, 0xffff0000, v251
    v_and_b32 v11, 0xffff0000, v243
    v_add_f32 v23, v10, v11
    s_waitcnt lgkmcnt(4)
    v_mfma_f32_32x32x16_bf16 v[128:143], v[216:219], v[120:123], v[128:143]
    ds_read_b32 v9, v8
    s_waitcnt lgkmcnt(0)
    v_mfma_f32_32x32x16_bf16 v[128:143], v[192:195], v[124:127], v[128:143]
    s_mul_i32 s68, s56, 24576
    v_add_u32 v5, s68, v2
    s_mul_i32 s68, s56, 86016
    s_add_u32 s68, s68, 12288
    v_add_u32 v6, s68, v2
L_mk_f2e_56:
    s_cmp_eq_u32 s55, 1
    s_cbranch_scc1 L_mk_rk1_155
    s_cmp_eq_u32 s55, 2
    s_cbranch_scc1 L_mk_rk2_156
    s_cmp_eq_u32 s55, 3
    s_cbranch_scc1 L_mk_rk3_157
L_mk_rk0_154:
    v_mfma_f32_32x32x16_bf16 v[144:159], v[204:207], v[116:119], v[144:159]
    v_mfma_f32_32x32x16_bf16 v[144:159], v[220:223], v[120:123], v[144:159]
    ds_write_b128 v5, v[136:139] offset:10240
    ds_write_b128 v5, v[140:143] offset:11264
    v_mfma_f32_32x32x16_bf16 v[144:159], v[196:199], v[124:127], v[144:159]
    s_nop 11
    ds_write_b128 v6, v[144:147] offset:2048
    ds_write_b128 v6, v[148:151] offset:3072
    ds_write_b128 v6, v[152:155] offset:6144
    ds_write_b128 v6, v[156:159] offset:7168
    s_waitcnt lgkmcnt(0)
    s_barrier
    ds_read_b128 v[96:99], v5 offset:0
    ds_read_b128 v[100:103], v5 offset:1024
    ds_read_b128 v[104:107], v5 offset:2048
    ds_read_b128 v[108:111], v5 offset:3072
    ds_read_b128 v[112:115], v5 offset:4096
    ds_read_b128 v[116:119], v5 offset:5120
    s_waitcnt lgkmcnt(4)
    v_add_f32 v96, v96, v128
    v_add_f32 v97, v97, v129
    v_add_f32 v98, v98, v130
    v_add_f32 v99, v99, v131
    v_add_f32 v100, v100, v132
    v_add_f32 v101, v101, v133
    v_add_f32 v102, v102, v134
    v_add_f32 v103, v103, v135
    s_branch L_mk_rd_153
L_mk_rk1_155:
    v_mfma_f32_32x32x16_bf16 v[144:159], v[204:207], v[116:119], v[144:159]
    v_mfma_f32_32x32x16_bf16 v[144:159], v[220:223], v[120:123], v[144:159]
    s_nop 2
    ds_write_b128 v5, v[128:131] offset:0
    ds_write_b128 v5, v[132:135] offset:1024
    v_mfma_f32_32x32x16_bf16 v[144:159], v[196:199], v[124:127], v[144:159]
    s_nop 11
    ds_write_b128 v6, v[144:147] offset:4096
    ds_write_b128 v6, v[148:151] offset:5120
    ds_write_b128 v6, v[152:155] offset:8192
    ds_write_b128 v6, v[156:159] offset:9216
    s_waitcnt lgkmcnt(0)
    s_barrier
    ds_read_b128 v[96:99], v5 offset:6144
    ds_read_b128 v[100:103], v5 offset:7168
    ds_read_b128 v[104:107], v5 offset:8192
    ds_read_b128 v[108:111], v5 offset:9216
    ds_read_b128 v[112:115], v5 offset:10240
    ds_read_b128 v[116:119], v5 offset:11264
    s_waitcnt lgkmcnt(4)
    v_add_f32 v96, v96, v136
    v_add_f32 v97, v97, v137
    v_add_f32 v98, v98, v138
    v_add_f32 v99, v99, v139
    v_add_f32 v100, v100, v140
    v_add_f32 v101, v101, v141
    v_add_f32 v102, v102, v142
    v_add_f32 v103, v103, v143
    s_branch L_mk_rd_153
L_mk_rk2_156:
    v_mfma_f32_32x32x16_bf16 v[144:159], v[204:207], v[116:119], v[144:159]
    v_mfma_f32_32x32x16_bf16 v[144:159], v[220:223], v[120:123], v[144:159]
    s_nop 0
    ds_write_b128 v5, v[128:131] offset:2048
    ds_write_b128 v5, v[132:135] offset:3072
    v_mfma_f32_32x32x16_bf16 v[144:159], v[196:199], v[124:127], v[144:159]
    ds_write_b128 v5, v[136:139] offset:6144
    ds_write_b128 v5, v[140:143] offset:7168
    s_nop 9
    ds_write_b128 v6, v[152:155] offset:10240
    ds_write_b128 v6, v[156:159] offset:11264
    s_waitcnt lgkmcnt(0)
    s_barrier
    ds_read_b128 v[96:99], v6 offset:0
    ds_read_b128 v[100:103], v6 offset:1024
    ds_read_b128 v[104:107], v6 offset:2048
    ds_read_b128 v[108:111], v6 offset:3072
    ds_read_b128 v[112:115], v6 offset:4096
    ds_read_b128 v[116:119], v6 offset:5120
    s_waitcnt lgkmcnt(4)
    v_add_f32 v96, v96, v144
    v_add_f32 v97, v97, v145
    v_add_f32 v98, v98, v146
    v_add_f32 v99, v99, v147
    v_add_f32 v100, v100, v148
    v_add_f32 v101, v101, v149
    v_add_f32 v102, v102, v150
    v_add_f32 v103, v103, v151
    s_branch L_mk_rd_153
L_mk_rk3_157:
    v_mfma_f32_32x32x16_bf16 v[144:159], v[204:207], v[116:119], v[144:159]
    v_mfma_f32_32x32x16_bf16 v[144:159], v[220:223], v[120:123], v[144:159]
    ds_write_b128 v5, v[128:131] offset:4096
    ds_write_b128 v5, v[132:135] offset:5120
    v_mfma_f32_32x32x16_bf16 v[144:159], v[196:199], v[124:127], v[144:159]
    ds_write_b128 v5, v[136:139] offset:8192
    ds_write_b128 v5, v[140:143] offset:9216
    s_nop 9
    ds_write_b128 v6, v[144:147] offset:0
    ds_write_b128 v6, v[148:151] offset:1024
    s_waitcnt lgkmcnt(0)
    s_barrier
    ds_read_b128 v[96:99], v6 offset:6144
    ds_read_b128 v[100:103], v6 offset:7168
    ds_read_b128 v[104:107], v6 offset:8192
    ds_read_b128 v[108:111], v6 offset:9216
    ds_read_b128 v[112:115], v6 offset:10240
    ds_read_b128 v[116:119], v6 offset:11264
    s_waitcnt lgkmcnt(4)
    v_add_f32 v96, v96, v152
    v_add_f32 v97, v97, v153
    v_add_f32 v98, v98, v154
    v_add_f32 v99, v99, v155
    v_add_f32 v100, v100, v156
    v_add_f32 v101, v101, v157
    v_add_f32 v102, v102, v158
    v_add_f32 v103, v103, v159
L_mk_rd_153:
    s_waitcnt lgkmcnt(0)
    v_add_f32 v104, v104, v112
    v_add_f32 v105, v105, v113
    v_add_f32 v106, v106, v114
    v_add_f32 v107, v107, v115
    v_add_f32 v108, v108, v116
    v_add_f32 v109, v109, v117
    v_add_f32 v110, v110, v118
    v_add_f32 v111, v111, v119
    v_add_f32 v96, v96, v104
    v_add_f32 v97, v97, v105
    v_add_f32 v98, v98, v106
    v_add_f32 v99, v99, v107
    v_add_f32 v100, v100, v108
    v_add_f32 v101, v101, v109
    v_add_f32 v102, v102, v110
    v_add_f32 v103, v103, v111
    v_fma_f32 v96, v96, v9, v16
    v_fma_f32 v97, v97, v9, v17
    v_cvt_pk_bf16_f32 v104, v96, v97
    v_fma_f32 v98, v98, v9, v18
    v_fma_f32 v99, v99, v9, v19
    v_cvt_pk_bf16_f32 v105, v98, v99
    v_fma_f32 v100, v100, v9, v20
    v_fma_f32 v101, v101, v9, v21
    v_cvt_pk_bf16_f32 v106, v100, v101
    v_fma_f32 v102, v102, v9, v22
    v_fma_f32 v103, v103, v9, v23
    v_cvt_pk_bf16_f32 v107, v102, v103
    v_permlane32_swap_b32 v104, v106
    s_nop 0
    v_permlane32_swap_b32 v105, v107
    buffer_store_dwordx4 v[104:107], v12, s[36:39], s70 offen
L_mk_fin:
L_mk_end:
    s_endpgm
L_mk_clrs:
    buffer_store_dwordx4 v[224:227], v2, s[16:19], s63 offen sc1
    buffer_store_dwordx4 v[224:227], v2, s[16:19], s74 offen sc1
    s_branch L_mk_clre
L_mk_kf_17:
    v_mov_b32 v5, 0x3f803f80
    v_mov_b32 v7, 0x3f80
    v_cndmask_b32 v166, v166, v5, s[88:89]
    v_cndmask_b32 v167, v167, v7, s[88:89]
    v_cndmask_b32 v160, v160, v5, s[90:91]
    v_cndmask_b32 v161, v161, v7, s[90:91]
    s_branch L_mk_kf_17b
L_mk_kf_20:
    v_mov_b32 v5, 0x3f803f80
    v_mov_b32 v7, 0x3f80
    v_cndmask_b32 v182, v182, v5, s[88:89]
    v_cndmask_b32 v183, v183, v7, s[88:89]
    v_cndmask_b32 v176, v176, v5, s[90:91]
    v_cndmask_b32 v177, v177, v7, s[90:91]
    s_branch L_mk_kf_20b
L_mk_exs_22:
    s_waitcnt vmcnt(0)
    s_branch L_mk_ex_21
L_mk_kf_23:
    v_mov_b32 v5, 0x3f803f80
    v_mov_b32 v7, 0x3f80
    v_cndmask_b32 v198, v198, v5, s[88:89]
    v_cndmask_b32 v199, v199, v7, s[88:89]
    v_cndmask_b32 v192, v192, v5, s[90:91]
    v_cndmask_b32 v193, v193, v7, s[90:91]
    s_branch L_mk_kf_23b
L_mk_exs_27:
    s_waitcnt vmcnt(0)
    s_branch L_mk_ex_26
L_mk_kf_28:
    v_mov_b32 v5, 0x3f803f80
    v_mov_b32 v7, 0x3f80
    v_cndmask_b32 v214, v214, v5, s[88:89]
    v_cndmask_b32 v215, v215, v7, s[88:89]
    v_cndmask_b32 v208, v208, v5, s[90:91]
    v_cndmask_b32 v209, v209, v7, s[90:91]
    s_branch L_mk_kf_28b
L_mk_exs_30:
    s_waitcnt vmcnt(0)
    s_branch L_mk_ex_29
L_mk_kf_31:
    v_mov_b32 v5, 0x3f803f80
    v_mov_b32 v7, 0x3f80
    v_cndmask_b32 v166, v166, v5, s[88:89]
    v_cndmask_b32 v167, v167, v7, s[88:89]
    v_cndmask_b32 v160, v160, v5, s[90:91]
    v_cndmask_b32 v161, v161, v7, s[90:91]
    s_branch L_mk_kf_31b
L_mk_exs_33:
    s_waitcnt vmcnt(0)
    s_branch L_mk_ex_32
L_mk_kf_34:
    v_mov_b32 v5, 0x3f803f80
    v_mov_b32 v7, 0x3f80
    v_cndmask_b32 v182, v182, v5, s[88:89]
    v_cndmask_b32 v183, v183, v7, s[88:89]
    v_cndmask_b32 v176, v176, v5, s[90:91]
    v_cndmask_b32 v177, v177, v7, s[90:91]
    s_branch L_mk_kf_34b
L_mk_exs_37:
    s_waitcnt vmcnt(0)
    s_branch L_mk_ex_36
L_mk_kf_38:
    v_mov_b32 v5, 0x3f803f80
    v_mov_b32 v7, 0x3f80
    v_cndmask_b32 v198, v198, v5, s[88:89]
    v_cndmask_b32 v199, v199, v7, s[88:89]
    v_cndmask_b32 v192, v192, v5, s[90:91]
    v_cndmask_b32 v193, v193, v7, s[90:91]
    s_branch L_mk_kf_38b
L_mk_exs_40:
    s_waitcnt vmcnt(0)
    s_branch L_mk_ex_39
L_mk_kf_42:
    v_mov_b32 v5, 0x3f803f80
    v_mov_b32 v7, 0x3f80
    v_cndmask_b32 v214, v214, v5, s[88:89]
    v_cndmask_b32 v215, v215, v7, s[88:89]
    v_cndmask_b32 v208, v208, v5, s[90:91]
    v_cndmask_b32 v209, v209, v7, s[90:91]
    s_branch L_mk_kf_42b
L_mk_skip:
    s_waitcnt vmcnt(0)
    s_branch L_mk_ost2
L_mk_bad:
    s_cmp_eq_u32 s66, 2
    s_cbranch_scc1 L_mk_skip
    s_cmp_lg_u32 s66, 0
    s_cbranch_scc1 L_mk_ost
    v_mov_b32 v5, 161808
    v_mov_b32 v7, 1
    ds_write_b32 v5, v7
    s_waitcnt vmcnt(0) lgkmcnt(0)
    s_branch L_mk_ost2
L_mk_fb:
    s_add_u32 s66, s92, 1
    v_mov_b32 v144, 0xff800000
    v_mov_b32 v145, 0xff800000
    v_mov_b32 v146, 0xff800000
    v_mov_b32 v147, 0xff800000
    s_mov_b32 s69, 0
L_mk_mx:
    s_add_u32 s70, s65, s69
    buffer_load_dwordx4 v[160:163], v2, s[16:19], s70 offen offset:0 sc1
    buffer_load_dwordx4 v[164:167], v2, s[16:19], s70 offen offset:1024 sc1
    s_waitcnt vmcnt(0)
    v_mfma_f32_32x32x16_bf16 v[112:127], v[160:163], v[16:19], 0
    v_mfma_f32_32x32x16_bf16 v[112:127], v[164:167], v[20:23], v[112:127]
    s_nop 11
    v_max3_f32 v144, v112, v113, v144
    v_max3_f32 v144, v114, v115, v144
    v_max3_f32 v144, v116, v117, v144
    v_max3_f32 v144, v118, v119, v144
    v_max3_f32 v144, v120, v121, v144
    v_max3_f32 v144, v122, v123, v144
    v_max3_f32 v144, v124, v125, v144
    v_max3_f32 v144, v126, v127, v144
    v_mfma_f32_32x32x16_bf16 v[112:127], v[160:163], v[24:27], 0
    v_mfma_f32_32x32x16_bf16 v[112:127], v[164:167], v[28:31], v[112:127]
    s_nop 11
    v_max3_f32 v145, v112, v113, v145
    v_max3_f32 v145, v114, v115, v145
    v_max3_f32 v145, v116, v117, v145
    v_max3_f32 v145, v118, v119, v145
    v_max3_f32 v145, v120, v121, v145
    v_max3_f32 v145, v122, v123, v145
    v_max3_f32 v145, v124, v125, v145
    v_max3_f32 v145, v126, v127, v145
    v_mfma_f32_32x32x16_bf16 v[112:127], v[160:163], v[32:35], 0
    v_mfma_f32_32x32x16_bf16 v[112:127], v[164:167], v[36:39], v[112:127]
    s_nop 11
    v_max3_f32 v146, v112, v113, v146
    v_max3_f32 v146, v114, v115, v146
    v_max3_f32 v146, v116, v117, v146
    v_max3_f32 v146, v118, v119, v146
    v_max3_f32 v146, v120, v121, v146
    v_max3_f32 v146, v122, v123, v146
    v_max3_f32 v146, v124, v125, v146
    v_max3_f32 v146, v126, v127, v146
    v_mfma_f32_32x32x16_bf16 v[112:127], v[160:163], v[40:43], 0
    v_mfma_f32_32x32x16_bf16 v[112:127], v[164:167], v[44:47], v[112:127]
    s_nop 11
    v_max3_f32 v147, v112, v113, v147
    v_max3_f32 v147, v114, v115, v147
    v_max3_f32 v147, v116, v117, v147
    v_max3_f32 v147, v118, v119, v147
    v_max3_f32 v147, v120, v121, v147
    v_max3_f32 v147, v122, v123, v147
    v_max3_f32 v147, v124, v125, v147
    v_max3_f32 v147, v126, v127, v147
    s_add_u32 s69, s69, 4096
    s_cmp_eq_u32 s69, 16384
    s_cselect_b32 s69, 131072, s69
    s_cmp_lt_u32 s69, 147456
    s_cbranch_scc1 L_mk_mx
    s_lshl_b32 s68, s54, 10
    v_add_u32 v5, s68, v236
    s_xor_b32 s68, s56, 1
    s_lshl_b32 s68, s68, 9
    v_add_u32 v10, s68, v5
    v_add_u32 v5, 512, v5
    v_subrev_u32 v11, s68, v5
    ds_write_b32 v10, v144 offset:0
    ds_write_b32 v10, v145 offset:256
    ds_write_b32 v11, v146 offset:0
    ds_write_b32 v11, v147 offset:256
    s_waitcnt lgkmcnt(0)
    s_barrier
    v_lshlrev_b32 v5, 2, v4
    v_add_u32 v10, s68, v5
    v_add_u32 v5, 512, v5
    v_subrev_u32 v11, s68, v5
    ds_read_b32 v112, v10 offset:0
    ds_read_b32 v113, v10 offset:128
    ds_read_b32 v114, v10 offset:1024
    ds_read_b32 v115, v10 offset:1152
    ds_read_b32 v116, v10 offset:2048
    ds_read_b32 v117, v10 offset:2176
    ds_read_b32 v118, v10 offset:3072
    ds_read_b32 v119, v10 offset:3200
    s_waitcnt lgkmcnt(0)
    ds_read_b32 v120, v10 offset:4096
    ds_read_b32 v121, v10 offset:4224
    ds_read_b32 v122, v10 offset:5120
    ds_read_b32 v123, v10 offset:5248
    ds_read_b32 v124, v10 offset:6144
    ds_read_b32 v125, v10 offset:6272
    ds_read_b32 v126, v10 offset:7168
    ds_read_b32 v127, v10 offset:7296
    s_waitcnt lgkmcnt(0)
    v_max3_f32 v144, v112, v113, v144
    v_max3_f32 v144, v114, v115, v144
    v_max3_f32 v144, v116, v117, v144
    v_max3_f32 v144, v118, v119, v144
    v_max3_f32 v144, v120, v121, v144
    v_max3_f32 v144, v122, v123, v144
    v_max3_f32 v144, v124, v125, v144
    v_max3_f32 v144, v126, v127, v144
    v_sub_f32 v6, 0, v144
    v_and_b32 v9, 0xffff0000, v6
    v_sub_f32 v6, v6, v9
    v_and_b32 v7, 0xffff0000, v6
    v_sub_f32 v6, v6, v7
    v_lshrrev_b32 v9, 16, v9
    v_or_b32 v7, v7, v9
    v_lshrrev_b32 v8, 16, v6
    v_cndmask_b32 v22, v22, v7, s[88:89]
    v_cndmask_b32 v23, v23, v8, s[88:89]
    v_cndmask_b32 v16, v16, v7, s[90:91]
    v_cndmask_b32 v17, v17, v8, s[90:91]
    ds_read_b32 v112, v10 offset:256
    ds_read_b32 v113, v10 offset:384
    ds_read_b32 v114, v10 offset:1280
    ds_read_b32 v115, v10 offset:1408
    ds_read_b32 v116, v10 offset:2304
    ds_read_b32 v117, v10 offset:2432
    ds_read_b32 v118, v10 offset:3328
    ds_read_b32 v119, v10 offset:3456
    s_waitcnt lgkmcnt(0)
    ds_read_b32 v120, v10 offset:4352
    ds_read_b32 v121, v10 offset:4480
    ds_read_b32 v122, v10 offset:5376
    ds_read_b32 v123, v10 offset:5504
    ds_read_b32 v124, v10 offset:6400
    ds_read_b32 v125, v10 offset:6528
    ds_read_b32 v126, v10 offset:7424
    ds_read_b32 v127, v10 offset:7552
    s_waitcnt lgkmcnt(0)
    v_max3_f32 v145, v112, v113, v145
    v_max3_f32 v145, v114, v115, v145
    v_max3_f32 v145, v116, v117, v145
    v_max3_f32 v145, v118, v119, v145
    v_max3_f32 v145, v120, v121, v145
    v_max3_f32 v145, v122, v123, v145
    v_max3_f32 v145, v124, v125, v145
    v_max3_f32 v145, v126, v127, v145
    v_sub_f32 v6, 0, v145
    v_and_b32 v9, 0xffff0000, v6
    v_sub_f32 v6, v6, v9
    v_and_b32 v7, 0xffff0000, v6
    v_sub_f32 v6, v6, v7
    v_lshrrev_b32 v9, 16, v9
    v_or_b32 v7, v7, v9
    v_lshrrev_b32 v8, 16, v6
    v_cndmask_b32 v30, v30, v7, s[88:89]
    v_cndmask_b32 v31, v31, v8, s[88:89]
    v_cndmask_b32 v24, v24, v7, s[90:91]
    v_cndmask_b32 v25, v25, v8, s[90:91]
    ds_read_b32 v112, v11 offset:0
    ds_read_b32 v113, v11 offset:128
    ds_read_b32 v114, v11 offset:1024
    ds_read_b32 v115, v11 offset:1152
    ds_read_b32 v116, v11 offset:2048
    ds_read_b32 v117, v11 offset:2176
    ds_read_b32 v118, v11 offset:3072
    ds_read_b32 v119, v11 offset:3200
    s_waitcnt lgkmcnt(0)
    ds_read_b32 v120, v11 offset:4096
    ds_read_b32 v121, v11 offset:4224
    ds_read_b32 v122, v11 offset:5120
    ds_read_b32 v123, v11 offset:5248
    ds_read_b32 v124, v11 offset:6144
    ds_read_b32 v125, v11 offset:6272
    ds_read_b32 v126, v11 offset:7168
    ds_read_b32 v127, v11 offset:7296
    s_waitcnt lgkmcnt(0)
    v_max3_f32 v146, v112, v113, v146
    v_max3_f32 v146, v114, v115, v146
    v_max3_f32 v146, v116, v117, v146
    v_max3_f32 v146, v118, v119, v146
    v_max3_f32 v146, v120, v121, v146
    v_max3_f32 v146, v122, v123, v146
    v_max3_f32 v146, v124, v125, v146
    v_max3_f32 v146, v126, v127, v146
    v_sub_f32 v6, 0, v146
    v_and_b32 v9, 0xffff0000, v6
    v_sub_f32 v6, v6, v9
    v_and_b32 v7, 0xffff0000, v6
    v_sub_f32 v6, v6, v7
    v_lshrrev_b32 v9, 16, v9
    v_or_b32 v7, v7, v9
    v_lshrrev_b32 v8, 16, v6
    v_cndmask_b32 v38, v38, v7, s[88:89]
    v_cndmask_b32 v39, v39, v8, s[88:89]
    v_cndmask_b32 v32, v32, v7, s[90:91]
    v_cndmask_b32 v33, v33, v8, s[90:91]
    ds_read_b32 v112, v11 offset:256
    ds_read_b32 v113, v11 offset:384
    ds_read_b32 v114, v11 offset:1280
    ds_read_b32 v115, v11 offset:1408
    ds_read_b32 v116, v11 offset:2304
    ds_read_b32 v117, v11 offset:2432
    ds_read_b32 v118, v11 offset:3328
    ds_read_b32 v119, v11 offset:3456
    s_waitcnt lgkmcnt(0)
    ds_read_b32 v120, v11 offset:4352
    ds_read_b32 v121, v11 offset:4480
    ds_read_b32 v122, v11 offset:5376
    ds_read_b32 v123, v11 offset:5504
    ds_read_b32 v124, v11 offset:6400
    ds_read_b32 v125, v11 offset:6528
    ds_read_b32 v126, v11 offset:7424
    ds_read_b32 v127, v11 offset:7552
    s_waitcnt lgkmcnt(0)
    v_max3_f32 v147, v112, v113, v147
    v_max3_f32 v147, v114, v115, v147
    v_max3_f32 v147, v116, v117, v147
    v_max3_f32 v147, v118, v119, v147
    v_max3_f32 v147, v120, v121, v147
    v_max3_f32 v147, v122, v123, v147
    v_max3_f32 v147, v124, v125, v147
    v_max3_f32 v147, v126, v127, v147
    v_sub_f32 v6, 0, v147
    v_and_b32 v9, 0xffff0000, v6
    v_sub_f32 v6, v6, v9
    v_and_b32 v7, 0xffff0000, v6
    v_sub_f32 v6, v6, v7
    v_lshrrev_b32 v9, 16, v9
    v_or_b32 v7, v7, v9
    v_lshrrev_b32 v8, 16, v6
    v_cndmask_b32 v46, v46, v7, s[88:89]
    v_cndmask_b32 v47, v47, v8, s[88:89]
    v_cndmask_b32 v40, v40, v7, s[90:91]
    v_cndmask_b32 v41, v41, v8, s[90:91]
    s_barrier
    s_add_u32 s70, s65, 0
    buffer_load_dwordx4 v[160:163], v2, s[16:19], s70 offen offset:0 sc1
    buffer_load_dwordx4 v[164:167], v2, s[16:19], s70 offen offset:1024 sc1
    buffer_load_dwordx4 v[168:171], v2, s[16:19], s70 offen offset:2048 sc1
    buffer_load_dwordx4 v[172:175], v2, s[16:19], s70 offen offset:3072 sc1
    s_add_u32 s70, s65, 4096
    buffer_load_dwordx4 v[176:179], v2, s[16:19], s70 offen offset:0 sc1
    buffer_load_dwordx4 v[180:183], v2, s[16:19], s70 offen offset:1024 sc1
    buffer_load_dwordx4 v[184:187], v2, s[16:19], s70 offen offset:2048 sc1
    buffer_load_dwordx4 v[188:191], v2, s[16:19], s70 offen offset:3072 sc1
    s_branch L_mk_amain
L_mk_rt_63:
    s_mov_b32 s78, 0
L_mk_rl_158:
    s_sleep 2
    s_add_u32 s68, s71, 32768
    buffer_load_dwordx4 v[48:51], v2, s[16:19], s68 offen offset:0 sc1
    buffer_load_dwordx4 v[52:55], v2, s[16:19], s68 offen offset:1024 sc1
    buffer_load_dwordx4 v[56:59], v2, s[16:19], s68 offen offset:2048 sc1
    buffer_load_dwordx4 v[60:63], v2, s[16:19], s68 offen offset:3072 sc1
    s_waitcnt vmcnt(0)
    s_add_u32 s78, s78, 1
    s_cmp_gt_u32 s78, 20000
    s_cbranch_scc1 L_mk_bk_64
    v_max_u32 v5, v48, v52
    v_max3_u32 v5, v56, v60, v5
    v_cmp_eq_u32 vcc, -1, v5
    s_nop 0
    s_cbranch_vccnz L_mk_rl_158
    s_branch L_mk_bk_64
L_mk_rt_65:
    s_mov_b32 s78, 0
L_mk_rl_159:
    s_sleep 2
    s_add_u32 s68, s71, 0
    buffer_load_dwordx4 v[16:19], v2, s[16:19], s68 offen offset:0 sc1
    buffer_load_dwordx4 v[20:23], v2, s[16:19], s68 offen offset:1024 sc1
    buffer_load_dwordx4 v[24:27], v2, s[16:19], s68 offen offset:2048 sc1
    buffer_load_dwordx4 v[28:31], v2, s[16:19], s68 offen offset:3072 sc1
    s_waitcnt vmcnt(0)
    s_add_u32 s78, s78, 1
    s_cmp_gt_u32 s78, 20000
    s_cbranch_scc1 L_mk_bk_66
    v_max_u32 v5, v16, v20
    v_max3_u32 v5, v24, v28, v5
    v_cmp_eq_u32 vcc, -1, v5
    s_nop 0
    s_cbranch_vccnz L_mk_rl_159
    s_branch L_mk_bk_66
L_mk_rt_67:
    s_mov_b32 s78, 0
L_mk_rl_160:
    s_sleep 2
    s_add_u32 s68, s71, 36864
    buffer_load_dwordx4 v[64:67], v2, s[16:19], s68 offen offset:0 sc1
    buffer_load_dwordx4 v[68:71], v2, s[16:19], s68 offen offset:1024 sc1
    buffer_load_dwordx4 v[72:75], v2, s[16:19], s68 offen offset:2048 sc1
    buffer_load_dwordx4 v[76:79], v2, s[16:19], s68 offen offset:3072 sc1
    s_waitcnt vmcnt(0)
    s_add_u32 s78, s78, 1
    s_cmp_gt_u32 s78, 20000
    s_cbranch_scc1 L_mk_bk_68
    v_max_u32 v5, v64, v68
    v_max3_u32 v5, v72, v76, v5
    v_cmp_eq_u32 vcc, -1, v5
    s_nop 0
    s_cbranch_vccnz L_mk_rl_160
    s_branch L_mk_bk_68
L_mk_rt_69:
    s_mov_b32 s78, 0
L_mk_rl_161:
    s_sleep 2
    s_add_u32 s68, s71, 4096
    buffer_load_dwordx4 v[32:35], v2, s[16:19], s68 offen offset:0 sc1
    buffer_load_dwordx4 v[36:39], v2, s[16:19], s68 offen offset:1024 sc1
    buffer_load_dwordx4 v[40:43], v2, s[16:19], s68 offen offset:2048 sc1
    buffer_load_dwordx4 v[44:47], v2, s[16:19], s68 offen offset:3072 sc1
    s_waitcnt vmcnt(0)
    s_add_u32 s78, s78, 1
    s_cmp_gt_u32 s78, 20000
    s_cbranch_scc1 L_mk_bk_70
    v_max_u32 v5, v32, v36
    v_max3_u32 v5, v40, v44, v5
    v_cmp_eq_u32 vcc, -1, v5
    s_nop 0
    s_cbranch_vccnz L_mk_rl_161
    s_branch L_mk_bk_70
L_mk_rt_78:
    s_mov_b32 s78, 0
L_mk_rl_162:
    s_sleep 2
    s_add_u32 s71, s70, 0
    buffer_load_dwordx4 v[16:19], v2, s[16:19], s71 offen offset:0 sc1
    buffer_load_dwordx4 v[20:23], v2, s[16:19], s71 offen offset:1024 sc1
    buffer_load_dwordx4 v[24:27], v2, s[16:19], s71 offen offset:2048 sc1
    buffer_load_dwordx4 v[28:31], v2, s[16:19], s71 offen offset:3072 sc1
    s_waitcnt vmcnt(0)
    s_add_u32 s78, s78, 1
    s_cmp_gt_u32 s78, 20000
    s_cbranch_scc1 L_mk_bk_79
    v_max_u32 v5, v16, v20
    v_max3_u32 v5, v24, v28, v5
    v_cmp_eq_u32 vcc, -1, v5
    s_nop 0
    s_cbranch_vccnz L_mk_rl_162
    s_branch L_mk_bk_79
L_mk_rt_80:
    s_mov_b32 s78, 0
L_mk_rl_163:
    s_sleep 2
    s_add_u32 s71, s70, 4096
    buffer_load_dwordx4 v[32:35], v2, s[16:19], s71 offen offset:0 sc1
    buffer_load_dwordx4 v[36:39], v2, s[16:19], s71 offen offset:1024 sc1
    buffer_load_dwordx4 v[40:43], v2, s[16:19], s71 offen offset:2048 sc1
    buffer_load_dwordx4 v[44:47], v2, s[16:19], s71 offen offset:3072 sc1
    s_waitcnt vmcnt(0)
    s_add_u32 s78, s78, 1
    s_cmp_gt_u32 s78, 20000
    s_cbranch_scc1 L_mk_bk_81
    v_max_u32 v5, v32, v36
    v_max3_u32 v5, v40, v44, v5
    v_cmp_eq_u32 vcc, -1, v5
    s_nop 0
    s_cbranch_vccnz L_mk_rl_163
    s_branch L_mk_bk_81
L_mk_rt_82:
    s_mov_b32 s78, 0
L_mk_rl_164:
    s_sleep 2
    s_add_u32 s71, s70, 8192
    buffer_load_dwordx4 v[48:51], v2, s[16:19], s71 offen offset:0 sc1
    buffer_load_dwordx4 v[52:55], v2, s[16:19], s71 offen offset:1024 sc1
    buffer_load_dwordx4 v[56:59], v2, s[16:19], s71 offen offset:2048 sc1
    buffer_load_dwordx4 v[60:63], v2, s[16:19], s71 offen offset:3072 sc1
    s_waitcnt vmcnt(0)
    s_add_u32 s78, s78, 1
    s_cmp_gt_u32 s78, 20000
    s_cbranch_scc1 L_mk_bk_83
    v_max_u32 v5, v48, v52
    v_max3_u32 v5, v56, v60, v5
    v_cmp_eq_u32 vcc, -1, v5
    s_nop 0
    s_cbranch_vccnz L_mk_rl_164
    s_branch L_mk_bk_83
L_mk_rt_84:
    s_mov_b32 s78, 0
L_mk_rl_165:
    s_sleep 2
    s_add_u32 s71, s70, 12288
    buffer_load_dwordx4 v[64:67], v2, s[16:19], s71 offen offset:0 sc1
    buffer_load_dwordx4 v[68:71], v2, s[16:19], s71 offen offset:1024 sc1
    buffer_load_dwordx4 v[72:75], v2, s[16:19], s71 offen offset:2048 sc1
    buffer_load_dwordx4 v[76:79], v2, s[16:19], s71 offen offset:3072 sc1
    s_waitcnt vmcnt(0)
    s_add_u32 s78, s78, 1
    s_cmp_gt_u32 s78, 20000
    s_cbranch_scc1 L_mk_bk_85
    v_max_u32 v5, v64, v68
    v_max3_u32 v5, v72, v76, v5
    v_cmp_eq_u32 vcc, -1, v5
    s_nop 0
    s_cbranch_vccnz L_mk_rl_165
    s_branch L_mk_bk_85
L_mk_rt_86:
    s_mov_b32 s78, 0
L_mk_rl_166:
    s_sleep 2
    s_add_u32 s71, s70, 16384
    buffer_load_dwordx4 v[80:83], v2, s[16:19], s71 offen offset:0 sc1
    buffer_load_dwordx4 v[84:87], v2, s[16:19], s71 offen offset:1024 sc1
    buffer_load_dwordx4 v[88:91], v2, s[16:19], s71 offen offset:2048 sc1
    buffer_load_dwordx4 v[92:95], v2, s[16:19], s71 offen offset:3072 sc1
    s_waitcnt vmcnt(0)
    s_add_u32 s78, s78, 1
    s_cmp_gt_u32 s78, 20000
    s_cbranch_scc1 L_mk_bk_87
    v_max_u32 v5, v80, v84
    v_max3_u32 v5, v88, v92, v5
    v_cmp_eq_u32 vcc, -1, v5
    s_nop 0
    s_cbranch_vccnz L_mk_rl_166
    s_branch L_mk_bk_87
L_mk_rt_88:
    s_mov_b32 s78, 0
L_mk_rl_167:
    s_sleep 2
    s_add_u32 s71, s70, 20480
    buffer_load_dwordx4 v[96:99], v2, s[16:19], s71 offen offset:0 sc1
    buffer_load_dwordx4 v[100:103], v2, s[16:19], s71 offen offset:1024 sc1
    buffer_load_dwordx4 v[104:107], v2, s[16:19], s71 offen offset:2048 sc1
    buffer_load_dwordx4 v[108:111], v2, s[16:19], s71 offen offset:3072 sc1
    s_waitcnt vmcnt(0)
    s_add_u32 s78, s78, 1
    s_cmp_gt_u32 s78, 20000
    s_cbranch_scc1 L_mk_bk_89
    v_max_u32 v5, v96, v100
    v_max3_u32 v5, v104, v108, v5
    v_cmp_eq_u32 vcc, -1, v5
    s_nop 0
    s_cbranch_vccnz L_mk_rl_167
    s_branch L_mk_bk_89
L_mk_xr_90:
    s_mov_b32 s78, 0
L_mk_xl_168:
    s_sleep 2
    buffer_load_dwordx4 v[216:219], v12, s[16:19], s69 offen offset:0 sc1
    buffer_load_dwordx4 v[220:223], v12, s[16:19], s69 offen offset:512 sc1
    buffer_load_dwordx4 v[224:227], v12, s[16:19], s69 offen offset:1024 sc1
    buffer_load_dwordx4 v[228:231], v12, s[16:19], s69 offen offset:1536 sc1
    s_waitcnt vmcnt(0)
    v_xor_b32 v218, s82, v218
    v_xor_b32 v219, s82, v219
    v_xor_b32 v222, s82, v222
    v_xor_b32 v223, s82, v223
    v_xor_b32 v226, s82, v226
    v_xor_b32 v227, s82, v227
    v_xor_b32 v230, s82, v230
    v_xor_b32 v231, s82, v231
    s_add_u32 s78, s78, 1
    s_cmp_gt_u32 s78, 20000
    s_cbranch_scc1 L_mk_xb_91
    v_or_b32 v7, v218, v222
    v_or3_b32 v7, v226, v230, v7
    v_cmp_ne_u32 vcc, 0, v7
    s_nop 0
    s_cbranch_vccnz L_mk_xl_168
    s_branch L_mk_xb_91
L_mk_rt_92:
    s_mov_b32 s78, 0
L_mk_rl_169:
    s_sleep 2
    buffer_load_dwordx2 v[160:161], v11, s[16:19], s76 offen offset:0 sc1
    buffer_load_dwordx2 v[162:163], v11, s[16:19], s76 offen offset:1024 sc1
    buffer_load_dwordx2 v[164:165], v11, s[16:19], s76 offen offset:2048 sc1
    buffer_load_dwordx2 v[166:167], v10, s[16:19], s76 offen offset:3072 sc1
    s_waitcnt vmcnt(0)
    s_add_u32 s78, s78, 1
    s_cmp_gt_u32 s78, 20000
    s_cbranch_scc1 L_mk_bk_93
    v_max_u32 v5, v160, v162
    v_max3_u32 v5, v164, v166, v5
    v_cmp_eq_u32 vcc, -1, v5
    s_nop 0
    s_cbranch_vccnz L_mk_rl_169
    s_branch L_mk_bk_93
L_mk_rt_94:
    s_mov_b32 s78, 0
L_mk_rl_170:
    s_sleep 2
    s_add_u32 s71, s70, 24576
    buffer_load_dwordx4 v[112:115], v2, s[16:19], s71 offen offset:0 sc1
    buffer_load_dwordx4 v[116:119], v2, s[16:19], s71 offen offset:1024 sc1
    buffer_load_dwordx4 v[120:123], v2, s[16:19], s71 offen offset:2048 sc1
    buffer_load_dwordx4 v[124:127], v2, s[16:19], s71 offen offset:3072 sc1
    s_waitcnt vmcnt(0)
    s_add_u32 s78, s78, 1
    s_cmp_gt_u32 s78, 20000
    s_cbranch_scc1 L_mk_bk_95
    v_max_u32 v5, v112, v116
    v_max3_u32 v5, v120, v124, v5
    v_cmp_eq_u32 vcc, -1, v5
    s_nop 0
    s_cbranch_vccnz L_mk_rl_170
    s_branch L_mk_bk_95
L_mk_rt_96:
    s_mov_b32 s78, 0
L_mk_rl_171:
    s_sleep 2
    s_add_u32 s68, s71, 0
    buffer_load_dwordx4 v[16:19], v2, s[16:19], s68 offen sc1
    s_add_u32 s68, s71, 1024
    buffer_load_dwordx4 v[20:23], v2, s[16:19], s68 offen sc1
    s_waitcnt vmcnt(0)
    s_add_u32 s78, s78, 1
    s_cmp_gt_u32 s78, 20000
    s_cbranch_scc1 L_mk_bk_97
    v_xor_b32 v16, s21, v16
    v_xor_b32 v19, s21, v19
    v_or_b32 v5, v16, v19
    v_xor_b32 v20, s21, v20
    v_xor_b32 v23, s21, v23
    v_or3_b32 v5, v20, v23, v5
    v_and_b32 v5, 0x80008000, v5
    v_cmp_ne_u32 vcc, 0, v5
    s_nop 0
    s_cbranch_vccnz L_mk_rl_171
    s_branch L_mk_bk_97
L_mk_rt_98:
    s_mov_b32 s78, 0
L_mk_rl_172:
    s_sleep 2
    s_add_u32 s68, s71, 2048
    buffer_load_dwordx4 v[24:27], v2, s[16:19], s68 offen sc1
    s_add_u32 s68, s71, 3072
    buffer_load_dwordx4 v[28:31], v2, s[16:19], s68 offen sc1
    s_waitcnt vmcnt(0)
    s_add_u32 s78, s78, 1
    s_cmp_gt_u32 s78, 20000
    s_cbranch_scc1 L_mk_bk_99
    v_xor_b32 v24, s21, v24
    v_xor_b32 v27, s21, v27
    v_or_b32 v5, v24, v27
    v_xor_b32 v28, s21, v28
    v_xor_b32 v31, s21, v31
    v_or3_b32 v5, v28, v31, v5
    v_and_b32 v5, 0x80008000, v5
    v_cmp_ne_u32 vcc, 0, v5
    s_nop 0
    s_cbranch_vccnz L_mk_rl_172
    s_branch L_mk_bk_99
L_mk_rt_100:
    s_mov_b32 s78, 0
L_mk_rl_173:
    s_sleep 2
    s_add_u32 s68, s71, 4096
    buffer_load_dwordx4 v[32:35], v2, s[16:19], s68 offen sc1
    s_add_u32 s68, s71, 5120
    buffer_load_dwordx4 v[36:39], v2, s[16:19], s68 offen sc1
    s_waitcnt vmcnt(0)
    s_add_u32 s78, s78, 1
    s_cmp_gt_u32 s78, 20000
    s_cbranch_scc1 L_mk_bk_101
    v_xor_b32 v32, s21, v32
    v_xor_b32 v35, s21, v35
    v_or_b32 v5, v32, v35
    v_xor_b32 v36, s21, v36
    v_xor_b32 v39, s21, v39
    v_or3_b32 v5, v36, v39, v5
    v_and_b32 v5, 0x80008000, v5
    v_cmp_ne_u32 vcc, 0, v5
    s_nop 0
    s_cbranch_vccnz L_mk_rl_173
    s_branch L_mk_bk_101
L_mk_rt_102:
    s_mov_b32 s78, 0
L_mk_rl_174:
    s_sleep 2
    s_add_u32 s68, s71, 6144
    buffer_load_dwordx4 v[40:43], v2, s[16:19], s68 offen sc1
    s_add_u32 s68, s71, 7168
    buffer_load_dwordx4 v[44:47], v2, s[16:19], s68 offen sc1
    s_waitcnt vmcnt(0)
    s_add_u32 s78, s78, 1
    s_cmp_gt_u32 s78, 20000
    s_cbranch_scc1 L_mk_bk_103
    v_xor_b32 v40, s21, v40
    v_xor_b32 v43, s21, v43
    v_or_b32 v5, v40, v43
    v_xor_b32 v44, s21, v44
    v_xor_b32 v47, s21, v47
    v_or3_b32 v5, v44, v47, v5
    v_and_b32 v5, 0x80008000, v5
    v_cmp_ne_u32 vcc, 0, v5
    s_nop 0
    s_cbranch_vccnz L_mk_rl_174
    s_branch L_mk_bk_103
L_mk_rt_104:
    s_mov_b32 s78, 0
L_mk_rl_175:
    s_sleep 2
    s_add_u32 s68, s71, 8192
    buffer_load_dwordx4 v[48:51], v2, s[16:19], s68 offen sc1
    s_add_u32 s68, s71, 9216
    buffer_load_dwordx4 v[52:55], v2, s[16:19], s68 offen sc1
    s_waitcnt vmcnt(0)
    s_add_u32 s78, s78, 1
    s_cmp_gt_u32 s78, 20000
    s_cbranch_scc1 L_mk_bk_105
    v_xor_b32 v48, s21, v48
    v_xor_b32 v51, s21, v51
    v_or_b32 v5, v48, v51
    v_xor_b32 v52, s21, v52
    v_xor_b32 v55, s21, v55
    v_or3_b32 v5, v52, v55, v5
    v_and_b32 v5, 0x80008000, v5
    v_cmp_ne_u32 vcc, 0, v5
    s_nop 0
    s_cbranch_vccnz L_mk_rl_175
    s_branch L_mk_bk_105
L_mk_rt_106:
    s_mov_b32 s78, 0
L_mk_rl_176:
    s_sleep 2
    s_add_u32 s68, s71, 10240
    buffer_load_dwordx4 v[56:59], v2, s[16:19], s68 offen sc1
    s_add_u32 s68, s71, 11264
    buffer_load_dwordx4 v[60:63], v2, s[16:19], s68 offen sc1
    s_waitcnt vmcnt(0)
    s_add_u32 s78, s78, 1
    s_cmp_gt_u32 s78, 20000
    s_cbranch_scc1 L_mk_bk_107
    v_xor_b32 v56, s21, v56
    v_xor_b32 v59, s21, v59
    v_or_b32 v5, v56, v59
    v_xor_b32 v60, s21, v60
    v_xor_b32 v63, s21, v63
    v_or3_b32 v5, v60, v63, v5
    v_and_b32 v5, 0x80008000, v5
    v_cmp_ne_u32 vcc, 0, v5
    s_nop 0
    s_cbranch_vccnz L_mk_rl_176
    s_branch L_mk_bk_107
L_mk_rt_108:
    s_mov_b32 s78, 0
L_mk_rl_177:
    s_sleep 2
    s_add_u32 s68, s71, 12288
    buffer_load_dwordx4 v[64:67], v2, s[16:19], s68 offen sc1
    s_add_u32 s68, s71, 13312
    buffer_load_dwordx4 v[68:71], v2, s[16:19], s68 offen sc1
    s_waitcnt vmcnt(0)
    s_add_u32 s78, s78, 1
    s_cmp_gt_u32 s78, 20000
    s_cbranch_scc1 L_mk_bk_109
    v_xor_b32 v64, s21, v64
    v_xor_b32 v67, s21, v67
    v_or_b32 v5, v64, v67
    v_xor_b32 v68, s21, v68
    v_xor_b32 v71, s21, v71
    v_or3_b32 v5, v68, v71, v5
    v_and_b32 v5, 0x80008000, v5
    v_cmp_ne_u32 vcc, 0, v5
    s_nop 0
    s_cbranch_vccnz L_mk_rl_177
    s_branch L_mk_bk_109
L_mk_rt_110:
    s_mov_b32 s78, 0
L_mk_rl_178:
    s_sleep 2
    s_add_u32 s68, s71, 14336
    buffer_load_dwordx4 v[72:75], v2, s[16:19], s68 offen sc1
    s_add_u32 s68, s71, 15360
    buffer_load_dwordx4 v[76:79], v2, s[16:19], s68 offen sc1
    s_waitcnt vmcnt(0)
    s_add_u32 s78, s78, 1
    s_cmp_gt_u32 s78, 20000
    s_cbranch_scc1 L_mk_bk_111
    v_xor_b32 v72, s21, v72
    v_xor_b32 v75, s21, v75
    v_or_b32 v5, v72, v75
    v_xor_b32 v76, s21, v76
    v_xor_b32 v79, s21, v79
    v_or3_b32 v5, v76, v79, v5
    v_and_b32 v5, 0x80008000, v5
    v_cmp_ne_u32 vcc, 0, v5
    s_nop 0
    s_cbranch_vccnz L_mk_rl_178
    s_branch L_mk_bk_111
L_mk_rt_112:
    s_mov_b32 s78, 0
L_mk_rl_179:
    s_sleep 2
    s_add_u32 s68, s71, 16384
    buffer_load_dwordx4 v[80:83], v2, s[16:19], s68 offen sc1
    s_add_u32 s68, s71, 17408
    buffer_load_dwordx4 v[84:87], v2, s[16:19], s68 offen sc1
    s_waitcnt vmcnt(0)
    s_add_u32 s78, s78, 1
    s_cmp_gt_u32 s78, 20000
    s_cbranch_scc1 L_mk_bk_113
    v_xor_b32 v80, s21, v80
    v_xor_b32 v83, s21, v83
    v_or_b32 v5, v80, v83
    v_xor_b32 v84, s21, v84
    v_xor_b32 v87, s21, v87
    v_or3_b32 v5, v84, v87, v5
    v_and_b32 v5, 0x80008000, v5
    v_cmp_ne_u32 vcc, 0, v5
    s_nop 0
    s_cbranch_vccnz L_mk_rl_179
    s_branch L_mk_bk_113
L_mk_rt_114:
    s_mov_b32 s78, 0
L_mk_rl_180:
    s_sleep 2
    s_add_u32 s68, s71, 18432
    buffer_load_dwordx4 v[88:91], v2, s[16:19], s68 offen sc1
    s_add_u32 s68, s71, 19456
    buffer_load_dwordx4 v[92:95], v2, s[16:19], s68 offen sc1
    s_waitcnt vmcnt(0)
    s_add_u32 s78, s78, 1
    s_cmp_gt_u32 s78, 20000
    s_cbranch_scc1 L_mk_bk_115
    v_xor_b32 v88, s21, v88
    v_xor_b32 v91, s21, v91
    v_or_b32 v5, v88, v91
    v_xor_b32 v92, s21, v92
    v_xor_b32 v95, s21, v95
    v_or3_b32 v5, v92, v95, v5
    v_and_b32 v5, 0x80008000, v5
    v_cmp_ne_u32 vcc, 0, v5
    s_nop 0
    s_cbranch_vccnz L_mk_rl_180
    s_branch L_mk_bk_115
L_mk_rt_116:
    s_mov_b32 s78, 0
L_mk_rl_181:
    s_sleep 2
    s_add_u32 s68, s71, 20480
    buffer_load_dwordx4 v[96:99], v2, s[16:19], s68 offen sc1
    s_add_u32 s68, s71, 21504
    buffer_load_dwordx4 v[100:103], v2, s[16:19], s68 offen sc1
    s_waitcnt vmcnt(0)
    s_add_u32 s78, s78, 1
    s_cmp_gt_u32 s78, 20000
    s_cbranch_scc1 L_mk_bk_117
    v_xor_b32 v96, s21, v96
    v_xor_b32 v99, s21, v99
    v_or_b32 v5, v96, v99
    v_xor_b32 v100, s21, v100
    v_xor_b32 v103, s21, v103
    v_or3_b32 v5, v100, v103, v5
    v_and_b32 v5, 0x80008000, v5
    v_cmp_ne_u32 vcc, 0, v5
    s_nop 0
    s_cbranch_vccnz L_mk_rl_181
    s_branch L_mk_bk_117
L_mk_rt_118:
    s_mov_b32 s78, 0
L_mk_rl_182:
    s_sleep 2
    s_add_u32 s68, s71, 22528
    buffer_load_dwordx4 v[104:107], v2, s[16:19], s68 offen sc1
    s_add_u32 s68, s71, 23552
    buffer_load_dwordx4 v[108:111], v2, s[16:19], s68 offen sc1
    s_waitcnt vmcnt(0)
    s_add_u32 s78, s78, 1
    s_cmp_gt_u32 s78, 20000
    s_cbranch_scc1 L_mk_bk_119
    v_xor_b32 v104, s21, v104
    v_xor_b32 v107, s21, v107
    v_or_b32 v5, v104, v107
    v_xor_b32 v108, s21, v108
    v_xor_b32 v111, s21, v111
    v_or3_b32 v5, v108, v111, v5
    v_and_b32 v5, 0x80008000, v5
    v_cmp_ne_u32 vcc, 0, v5
    s_nop 0
    s_cbranch_vccnz L_mk_rl_182
    s_branch L_mk_bk_119
L_mk_rt_120:
    s_mov_b32 s78, 0
L_mk_rl_183:
    s_sleep 2
    s_add_u32 s68, s71, 24576
    buffer_load_dwordx4 v[112:115], v2, s[16:19], s68 offen sc1
    s_add_u32 s68, s71, 25600
    buffer_load_dwordx4 v[116:119], v2, s[16:19], s68 offen sc1
    s_waitcnt vmcnt(0)
    s_add_u32 s78, s78, 1
    s_cmp_gt_u32 s78, 20000
    s_cbranch_scc1 L_mk_bk_121
    v_xor_b32 v112, s21, v112
    v_xor_b32 v115, s21, v115
    v_or_b32 v5, v112, v115
    v_xor_b32 v116, s21, v116
    v_xor_b32 v119, s21, v119
    v_or3_b32 v5, v116, v119, v5
    v_and_b32 v5, 0x80008000, v5
    v_cmp_ne_u32 vcc, 0, v5
    s_nop 0
    s_cbranch_vccnz L_mk_rl_183
    s_branch L_mk_bk_121
L_mk_rt_122:
    s_mov_b32 s78, 0
L_mk_rl_184:
    s_sleep 2
    s_add_u32 s68, s71, 26624
    buffer_load_dwordx4 v[120:123], v2, s[16:19], s68 offen sc1
    s_add_u32 s68, s71, 27648
    buffer_load_dwordx4 v[124:127], v2, s[16:19], s68 offen sc1
    s_waitcnt vmcnt(0)
    s_add_u32 s78, s78, 1
    s_cmp_gt_u32 s78, 20000
    s_cbranch_scc1 L_mk_bk_123
    v_xor_b32 v120, s21, v120
    v_xor_b32 v123, s21, v123
    v_or_b32 v5, v120, v123
    v_xor_b32 v124, s21, v124
    v_xor_b32 v127, s21, v127
    v_or3_b32 v5, v124, v127, v5
    v_and_b32 v5, 0x80008000, v5
    v_cmp_ne_u32 vcc, 0, v5
    s_nop 0
    s_cbranch_vccnz L_mk_rl_184
    s_branch L_mk_bk_123
L_mk_rt_125:
    s_mov_b32 s78, 0
L_mk_rl_185:
    s_sleep 2
    s_add_u32 s68, s71, 0
    buffer_load_dwordx4 v[16:19], v2, s[16:19], s68 offen sc1
    s_add_u32 s68, s71, 1024
    buffer_load_dwordx4 v[20:23], v2, s[16:19], s68 offen sc1
    s_waitcnt vmcnt(0)
    s_add_u32 s78, s78, 1
    s_cmp_gt_u32 s78, 20000
    s_cbranch_scc1 L_mk_bk_126
    v_xor_b32 v16, s21, v16
    v_xor_b32 v19, s21, v19
    v_or_b32 v5, v16, v19
    v_xor_b32 v20, s21, v20
    v_xor_b32 v23, s21, v23
    v_or3_b32 v5, v20, v23, v5
    v_and_b32 v5, 0x80008000, v5
    v_cmp_ne_u32 vcc, 0, v5
    s_nop 0
    s_cbranch_vccnz L_mk_rl_185
    s_branch L_mk_bk_126
L_mk_rt_127:
    s_mov_b32 s78, 0
L_mk_rl_186:
    s_sleep 2
    s_add_u32 s68, s71, 2048
    buffer_load_dwordx4 v[24:27], v2, s[16:19], s68 offen sc1
    s_add_u32 s68, s71, 3072
    buffer_load_dwordx4 v[28:31], v2, s[16:19], s68 offen sc1
    s_waitcnt vmcnt(0)
    s_add_u32 s78, s78, 1
    s_cmp_gt_u32 s78, 20000
    s_cbranch_scc1 L_mk_bk_128
    v_xor_b32 v24, s21, v24
    v_xor_b32 v27, s21, v27
    v_or_b32 v5, v24, v27
    v_xor_b32 v28, s21, v28
    v_xor_b32 v31, s21, v31
    v_or3_b32 v5, v28, v31, v5
    v_and_b32 v5, 0x80008000, v5
    v_cmp_ne_u32 vcc, 0, v5
    s_nop 0
    s_cbranch_vccnz L_mk_rl_186
    s_branch L_mk_bk_128
L_mk_rt_129:
    s_mov_b32 s78, 0
L_mk_rl_187:
    s_sleep 2
    s_add_u32 s68, s71, 4096
    buffer_load_dwordx4 v[32:35], v2, s[16:19], s68 offen sc1
    s_add_u32 s68, s71, 5120
    buffer_load_dwordx4 v[36:39], v2, s[16:19], s68 offen sc1
    s_waitcnt vmcnt(0)
    s_add_u32 s78, s78, 1
    s_cmp_gt_u32 s78, 20000
    s_cbranch_scc1 L_mk_bk_130
    v_xor_b32 v32, s21, v32
    v_xor_b32 v35, s21, v35
    v_or_b32 v5, v32, v35
    v_xor_b32 v36, s21, v36
    v_xor_b32 v39, s21, v39
    v_or3_b32 v5, v36, v39, v5
    v_and_b32 v5, 0x80008000, v5
    v_cmp_ne_u32 vcc, 0, v5
    s_nop 0
    s_cbranch_vccnz L_mk_rl_187
    s_branch L_mk_bk_130
L_mk_rt_131:
    s_mov_b32 s78, 0
L_mk_rl_188:
    s_sleep 2
    s_add_u32 s68, s71, 6144
    buffer_load_dwordx4 v[40:43], v2, s[16:19], s68 offen sc1
    s_add_u32 s68, s71, 7168
    buffer_load_dwordx4 v[44:47], v2, s[16:19], s68 offen sc1
    s_waitcnt vmcnt(0)
    s_add_u32 s78, s78, 1
    s_cmp_gt_u32 s78, 20000
    s_cbranch_scc1 L_mk_bk_132
    v_xor_b32 v40, s21, v40
    v_xor_b32 v43, s21, v43
    v_or_b32 v5, v40, v43
    v_xor_b32 v44, s21, v44
    v_xor_b32 v47, s21, v47
    v_or3_b32 v5, v44, v47, v5
    v_and_b32 v5, 0x80008000, v5
    v_cmp_ne_u32 vcc, 0, v5
    s_nop 0
    s_cbranch_vccnz L_mk_rl_188
    s_branch L_mk_bk_132
L_mk_rt_133:
    s_mov_b32 s78, 0
L_mk_rl_189:
    s_sleep 2
    s_add_u32 s68, s71, 8192
    buffer_load_dwordx4 v[48:51], v2, s[16:19], s68 offen sc1
    s_add_u32 s68, s71, 9216
    buffer_load_dwordx4 v[52:55], v2, s[16:19], s68 offen sc1
    s_waitcnt vmcnt(0)
    s_add_u32 s78, s78, 1
    s_cmp_gt_u32 s78, 20000
    s_cbranch_scc1 L_mk_bk_134
    v_xor_b32 v48, s21, v48
    v_xor_b32 v51, s21, v51
    v_or_b32 v5, v48, v51
    v_xor_b32 v52, s21, v52
    v_xor_b32 v55, s21, v55
    v_or3_b32 v5, v52, v55, v5
    v_and_b32 v5, 0x80008000, v5
    v_cmp_ne_u32 vcc, 0, v5
    s_nop 0
    s_cbranch_vccnz L_mk_rl_189
    s_branch L_mk_bk_134
L_mk_rt_135:
    s_mov_b32 s78, 0
L_mk_rl_190:
    s_sleep 2
    s_add_u32 s68, s71, 10240
    buffer_load_dwordx4 v[56:59], v2, s[16:19], s68 offen sc1
    s_add_u32 s68, s71, 11264
    buffer_load_dwordx4 v[60:63], v2, s[16:19], s68 offen sc1
    s_waitcnt vmcnt(0)
    s_add_u32 s78, s78, 1
    s_cmp_gt_u32 s78, 20000
    s_cbranch_scc1 L_mk_bk_136
    v_xor_b32 v56, s21, v56
    v_xor_b32 v59, s21, v59
    v_or_b32 v5, v56, v59
    v_xor_b32 v60, s21, v60
    v_xor_b32 v63, s21, v63
    v_or3_b32 v5, v60, v63, v5
    v_and_b32 v5, 0x80008000, v5
    v_cmp_ne_u32 vcc, 0, v5
    s_nop 0
    s_cbranch_vccnz L_mk_rl_190
    s_branch L_mk_bk_136
L_mk_rt_137:
    s_mov_b32 s78, 0
L_mk_rl_191:
    s_sleep 2
    s_add_u32 s68, s71, 12288
    buffer_load_dwordx4 v[64:67], v2, s[16:19], s68 offen sc1
    s_add_u32 s68, s71, 13312
    buffer_load_dwordx4 v[68:71], v2, s[16:19], s68 offen sc1
    s_waitcnt vmcnt(0)
    s_add_u32 s78, s78, 1
    s_cmp_gt_u32 s78, 20000
    s_cbranch_scc1 L_mk_bk_138
    v_xor_b32 v64, s21, v64
    v_xor_b32 v67, s21, v67
    v_or_b32 v5, v64, v67
    v_xor_b32 v68, s21, v68
    v_xor_b32 v71, s21, v71
    v_or3_b32 v5, v68, v71, v5
    v_and_b32 v5, 0x80008000, v5
    v_cmp_ne_u32 vcc, 0, v5
    s_nop 0
    s_cbranch_vccnz L_mk_rl_191
    s_branch L_mk_bk_138
L_mk_rt_139:
    s_mov_b32 s78, 0
L_mk_rl_192:
    s_sleep 2
    s_add_u32 s68, s71, 14336
    buffer_load_dwordx4 v[72:75], v2, s[16:19], s68 offen sc1
    s_add_u32 s68, s71, 15360
    buffer_load_dwordx4 v[76:79], v2, s[16:19], s68 offen sc1
    s_waitcnt vmcnt(0)
    s_add_u32 s78, s78, 1
    s_cmp_gt_u32 s78, 20000
    s_cbranch_scc1 L_mk_bk_140
    v_xor_b32 v72, s21, v72
    v_xor_b32 v75, s21, v75
    v_or_b32 v5, v72, v75
    v_xor_b32 v76, s21, v76
    v_xor_b32 v79, s21, v79
    v_or3_b32 v5, v76, v79, v5
    v_and_b32 v5, 0x80008000, v5
    v_cmp_ne_u32 vcc, 0, v5
    s_nop 0
    s_cbranch_vccnz L_mk_rl_192
    s_branch L_mk_bk_140
L_mk_rt_141:
    s_mov_b32 s78, 0
L_mk_rl_193:
    s_sleep 2
    s_add_u32 s68, s71, 16384
    buffer_load_dwordx4 v[80:83], v2, s[16:19], s68 offen sc1
    s_add_u32 s68, s71, 17408
    buffer_load_dwordx4 v[84:87], v2, s[16:19], s68 offen sc1
    s_waitcnt vmcnt(0)
    s_add_u32 s78, s78, 1
    s_cmp_gt_u32 s78, 20000
    s_cbranch_scc1 L_mk_bk_142
    v_xor_b32 v80, s21, v80
    v_xor_b32 v83, s21, v83
    v_or_b32 v5, v80, v83
    v_xor_b32 v84, s21, v84
    v_xor_b32 v87, s21, v87
    v_or3_b32 v5, v84, v87, v5
    v_and_b32 v5, 0x80008000, v5
    v_cmp_ne_u32 vcc, 0, v5
    s_nop 0
    s_cbranch_vccnz L_mk_rl_193
    s_branch L_mk_bk_142
L_mk_rt_143:
    s_mov_b32 s78, 0
L_mk_rl_194:
    s_sleep 2
    s_add_u32 s68, s71, 18432
    buffer_load_dwordx4 v[88:91], v2, s[16:19], s68 offen sc1
    s_add_u32 s68, s71, 19456
    buffer_load_dwordx4 v[92:95], v2, s[16:19], s68 offen sc1
    s_waitcnt vmcnt(0)
    s_add_u32 s78, s78, 1
    s_cmp_gt_u32 s78, 20000
    s_cbranch_scc1 L_mk_bk_144
    v_xor_b32 v88, s21, v88
    v_xor_b32 v91, s21, v91
    v_or_b32 v5, v88, v91
    v_xor_b32 v92, s21, v92
    v_xor_b32 v95, s21, v95
    v_or3_b32 v5, v92, v95, v5
    v_and_b32 v5, 0x80008000, v5
    v_cmp_ne_u32 vcc, 0, v5
    s_nop 0
    s_cbranch_vccnz L_mk_rl_194
    s_branch L_mk_bk_144
L_mk_rt_145:
    s_mov_b32 s78, 0
L_mk_rl_195:
    s_sleep 2
    s_add_u32 s68, s71, 20480
    buffer_load_dwordx4 v[96:99], v2, s[16:19], s68 offen sc1
    s_add_u32 s68, s71, 21504
    buffer_load_dwordx4 v[100:103], v2, s[16:19], s68 offen sc1
    s_waitcnt vmcnt(0)
    s_add_u32 s78, s78, 1
    s_cmp_gt_u32 s78, 20000
    s_cbranch_scc1 L_mk_bk_146
    v_xor_b32 v96, s21, v96
    v_xor_b32 v99, s21, v99
    v_or_b32 v5, v96, v99
    v_xor_b32 v100, s21, v100
    v_xor_b32 v103, s21, v103
    v_or3_b32 v5, v100, v103, v5
    v_and_b32 v5, 0x80008000, v5
    v_cmp_ne_u32 vcc, 0, v5
    s_nop 0
    s_cbranch_vccnz L_mk_rl_195
    s_branch L_mk_bk_146
L_mk_rt_147:
    s_mov_b32 s78, 0
L_mk_rl_196:
    s_sleep 2
    s_add_u32 s68, s71, 22528
    buffer_load_dwordx4 v[104:107], v2, s[16:19], s68 offen sc1
    s_add_u32 s68, s71, 23552
    buffer_load_dwordx4 v[108:111], v2, s[16:19], s68 offen sc1
    s_waitcnt vmcnt(0)
    s_add_u32 s78, s78, 1
    s_cmp_gt_u32 s78, 20000
    s_cbranch_scc1 L_mk_bk_148
    v_xor_b32 v104, s21, v104
    v_xor_b32 v107, s21, v107
    v_or_b32 v5, v104, v107
    v_xor_b32 v108, s21, v108
    v_xor_b32 v111, s21, v111
    v_or3_b32 v5, v108, v111, v5
    v_and_b32 v5, 0x80008000, v5
    v_cmp_ne_u32 vcc, 0, v5
    s_nop 0
    s_cbranch_vccnz L_mk_rl_196
    s_branch L_mk_bk_148
L_mk_rt_149:
    s_mov_b32 s78, 0
L_mk_rl_197:
    s_sleep 2
    s_add_u32 s68, s71, 24576
    buffer_load_dwordx4 v[112:115], v2, s[16:19], s68 offen sc1
    s_add_u32 s68, s71, 25600
    buffer_load_dwordx4 v[116:119], v2, s[16:19], s68 offen sc1
    s_waitcnt vmcnt(0)
    s_add_u32 s78, s78, 1
    s_cmp_gt_u32 s78, 20000
    s_cbranch_scc1 L_mk_bk_150
    v_xor_b32 v112, s21, v112
    v_xor_b32 v115, s21, v115
    v_or_b32 v5, v112, v115
    v_xor_b32 v116, s21, v116
    v_xor_b32 v119, s21, v119
    v_or3_b32 v5, v116, v119, v5
    v_and_b32 v5, 0x80008000, v5
    v_cmp_ne_u32 vcc, 0, v5
    s_nop 0
    s_cbranch_vccnz L_mk_rl_197
    s_branch L_mk_bk_150
L_mk_rt_151:
    s_mov_b32 s78, 0
L_mk_rl_198:
    s_sleep 2
    s_add_u32 s68, s71, 26624
    buffer_load_dwordx4 v[120:123], v2, s[16:19], s68 offen sc1
    s_add_u32 s68, s71, 27648
    buffer_load_dwordx4 v[124:127], v2, s[16:19], s68 offen sc1
    s_waitcnt vmcnt(0)
    s_add_u32 s78, s78, 1
    s_cmp_gt_u32 s78, 20000
    s_cbranch_scc1 L_mk_bk_152
    v_xor_b32 v120, s21, v120
    v_xor_b32 v123, s21, v123
    v_or_b32 v5, v120, v123
    v_xor_b32 v124, s21, v124
    v_xor_b32 v127, s21, v127
    v_or3_b32 v5, v124, v127, v5
    v_and_b32 v5, 0x80008000, v5
    v_cmp_ne_u32 vcc, 0, v5
    s_nop 0
    s_cbranch_vccnz L_mk_rl_198
    s_branch L_mk_bk_152
L_mk_spare:
    s_and_b32 s69, s54, 1
    s_mul_i32 s70, s69, 28672
    s_lshr_b32 s71, s54, 1
    s_mul_i32 s71, s71, 7168
    s_add_u32 s70, s70, s71
    s_add_u32 s70, s70, 98304
    v_add_u32 v8, s70, v232
    s_lshl_b32 s71, s60, 1
    s_add_u32 s71, s71, s61
    s_sub_u32 s71, s71, 14
    s_lshl_b32 s73, s71, 7
    v_lshlrev_b32 v5, 1, v1
    buffer_load_ushort v12, v5, s[44:47], s73 offen
    v_mov_b32 v9, 0x3f803f80
    v_bfe_u32 v10, v1, 4, 1
    v_and_b32 v11, 15, v1
    v_cmp_eq_u32 vcc, v10, v11
    s_nop 1
    v_cndmask_b32 v48, v237, v9, vcc
    v_mov_b32 v49, v48
    v_mov_b32 v50, v48
    v_mov_b32 v51, v48
    ds_read_b64_tr_b16 v[16:17], v8 offset:0
    ds_read_b64_tr_b16 v[18:19], v8 offset:512
    ds_read_b64_tr_b16 v[20:21], v8 offset:1024
    ds_read_b64_tr_b16 v[22:23], v8 offset:1536
    ds_read_b64_tr_b16 v[24:25], v8 offset:2048
    ds_read_b64_tr_b16 v[26:27], v8 offset:2560
    ds_read_b64_tr_b16 v[28:29], v8 offset:3072
    ds_read_b64_tr_b16 v[30:31], v8 offset:3584
    ds_read_b64_tr_b16 v[32:33], v8 offset:4096
    ds_read_b64_tr_b16 v[34:35], v8 offset:4608
    ds_read_b64_tr_b16 v[36:37], v8 offset:5120
    ds_read_b64_tr_b16 v[38:39], v8 offset:5632
    ds_read_b64_tr_b16 v[40:41], v8 offset:6144
    ds_read_b64_tr_b16 v[42:43], v8 offset:6656
    s_waitcnt lgkmcnt(0)
    v_mfma_f32_16x16x32_bf16 v[52:55], v[48:51], v[16:19], 0
    v_mfma_f32_16x16x32_bf16 v[52:55], v[48:51], v[20:23], v[52:55]
    v_mfma_f32_16x16x32_bf16 v[52:55], v[48:51], v[24:27], v[52:55]
    v_mfma_f32_16x16x32_bf16 v[52:55], v[48:51], v[28:31], v[52:55]
    v_mfma_f32_16x16x32_bf16 v[52:55], v[48:51], v[32:35], v[52:55]
    v_mfma_f32_16x16x32_bf16 v[52:55], v[48:51], v[36:39], v[52:55]
    v_mfma_f32_16x16x32_bf16 v[52:55], v[48:51], v[40:43], v[52:55]
    s_lshl_b32 s70, s69, 9
    s_lshr_b32 s74, s54, 1
    s_lshl_b32 s74, s74, 2
    s_add_u32 s70, s70, s74
    s_add_u32 s70, s70, 159744
    v_lshl_add_u32 v5, v4, 4, s70
    s_mov_b64 exec, 0xffff
    s_nop 0
    ds_write_b32 v5, v52
    ds_write_b32 v5, v53 offset:256
    s_mov_b64 exec, -1
    s_waitcnt lgkmcnt(0)
    s_barrier
    s_cmp_lg_u32 s54, 0
    s_cbranch_scc1 L_mk_fin
    s_cmp_ge_u32 s71, 28
    s_cbranch_scc1 L_mk_epoch
    v_add_u32 v5, 159744, v2
    ds_read_b128 v[20:23], v5
    s_waitcnt vmcnt(0) lgkmcnt(0)
    v_add_f32 v20, v20, v21
    v_add_f32 v22, v22, v23
    v_add_f32 v10, v20, v22
    v_and_b32 v11, 0xffff0000, v10
    v_sub_f32 v10, v10, v11
    v_and_b32 v16, 0xffff0000, v10
    v_sub_f32 v10, v10, v16
    v_lshrrev_b32 v11, 16, v11
    v_or_b32 v16, v16, v11
    v_lshrrev_b32 v17, 16, v10
    v_lshl_or_b32 v17, v12, 16, v17
    v_mov_b32 v18, s82
    v_mov_b32 v19, s82
    s_lshl_b32 s73, s71, 10
    s_add_u32 s73, s73, 17891328
    buffer_store_dwordx4 v[16:19], v2, s[16:19], s73 offen sc1
    s_branch L_mk_wb
L_mk_epoch:
    s_cmp_lg_u32 s71, 31
    s_cbranch_scc1 L_mk_wb
    v_lshlrev_b32 v8, 7, v1
    s_mov_b32 s78, 0
    s_or_b32 s77, s82, 1
    s_mov_b32 s76, 18939904
L_mk_fc_199:
    buffer_load_dword v6, v8, s[16:19], s76 offen sc1
    s_waitcnt vmcnt(0)
L_mk_f0_201:
    v_and_b32 v5, 0xffffff01, v6
    v_cmp_ne_u32 vcc, s77, v5
    s_nop 0
    s_cbranch_vccz L_mk_fx_200
    s_add_u32 s78, s78, 1
    s_sleep 8
    s_cmp_le_u32 s78, 20000
    s_cbranch_scc1 L_mk_fc_199
L_mk_fx_200:
    v_add_u32 v8, 8192, v8
    s_mov_b32 s78, 0
    s_or_b32 s77, s82, 1
    s_mov_b32 s76, 18939904
L_mk_fc_202:
    buffer_load_dword v6, v8, s[16:19], s76 offen sc1
    s_waitcnt vmcnt(0)
L_mk_f0_204:
    v_and_b32 v5, 0xffffff01, v6
    v_cmp_ne_u32 vcc, s77, v5
    s_nop 0
    s_cbranch_vccz L_mk_fx_203
    s_add_u32 s78, s78, 1
    s_sleep 8
    s_cmp_le_u32 s78, 20000
    s_cbranch_scc1 L_mk_fc_202
L_mk_fx_203:
    v_add_u32 v8, 8192, v8
    s_mov_b32 s78, 0
    s_or_b32 s77, s82, 1
    s_mov_b32 s76, 18939904
L_mk_fc_205:
    buffer_load_dword v6, v8, s[16:19], s76 offen sc1
    s_waitcnt vmcnt(0)
L_mk_f0_207:
    v_and_b32 v5, 0xffffff01, v6
    v_cmp_ne_u32 vcc, s77, v5
    s_nop 0
    s_cbranch_vccz L_mk_fx_206
    s_add_u32 s78, s78, 1
    s_sleep 8
    s_cmp_le_u32 s78, 20000
    s_cbranch_scc1 L_mk_fc_205
L_mk_fx_206:
    v_add_u32 v8, 8192, v8
    s_mov_b32 s78, 0
    s_or_b32 s77, s82, 1
    s_mov_b32 s76, 18939904
L_mk_fc_208:
    buffer_load_dword v6, v8, s[16:19], s76 offen sc1
    s_waitcnt vmcnt(0)
L_mk_f0_210:
    v_and_b32 v5, 0xffffff01, v6
    v_cmp_ne_u32 vcc, s77, v5
    s_nop 0
    s_cbranch_vccz L_mk_fx_209
    s_add_u32 s78, s78, 1
    s_sleep 8
    s_cmp_le_u32 s78, 20000
    s_cbranch_scc1 L_mk_fc_208
L_mk_fx_209:
    v_add_u32 v8, 8192, v8
    s_mov_b64 exec, 1
    v_mov_b32 v5, s20
    s_mov_b32 s68, 19005440
    buffer_store_dword v5, v237, s[16:19], s68 offen
    s_mov_b64 exec, -1
L_mk_wb:
    s_branch L_mk_fin
L_mk_hotend:
L_mk_slow:
    s_mul_i32 s73, s55, 14336
    s_lshl_b32 s74, s56, 10
    s_lshl_b32 s75, s56, 6
    s_add_u32 s75, s75, s73
    s_mul_i32 s4, s55, 10240
    s_add_u32 s6, s4, 0
    s_add_u32 s4, s4, 114688
    s_mul_i32 s5, s55, 14336
    s_add_u32 s5, s5, 40960
    s_lshl_b32 s7, s55, 12
    s_add_u32 s7, s7, 98304
    s_cmp_lg_u32 s56, 0
    s_cbranch_scc1 L_mk_help_211
    s_lshl_b32 s69, s59, 16
    s_add_u32 s69, s69, 4259840
    s_lshl_b32 s71, s55, 13
    s_add_u32 s71, s71, s69
    v_and_b32 v5, 15, v1
    v_lshlrev_b32 v5, 11, v5
    v_add_u32 v5, 33792, v5
    s_mul_i32 s68, s55, 7168
    s_add_u32 s68, s68, 98304
    v_add_u32 v8, s68, v232
    ds_read_b64_tr_b16 v[80:81], v8 offset:0
    ds_read_b64_tr_b16 v[82:83], v8 offset:512
    ds_read_b64_tr_b16 v[84:85], v8 offset:28672
    ds_read_b64_tr_b16 v[86:87], v8 offset:29184
    ds_read_b64_tr_b16 v[88:89], v8 offset:1024
    ds_read_b64_tr_b16 v[90:91], v8 offset:1536
    ds_read_b64_tr_b16 v[92:93], v8 offset:29696
    ds_read_b64_tr_b16 v[94:95], v8 offset:30208
    ds_read_b64_tr_b16 v[96:97], v8 offset:1792
    ds_read_b64_tr_b16 v[98:99], v8 offset:2304
    ds_read_b64_tr_b16 v[100:101], v8 offset:30464
    ds_read_b64_tr_b16 v[102:103], v8 offset:30976
    s_waitcnt lgkmcnt(0)
    ds_read_b64_tr_b16 v[104:105], v8 offset:2816
    ds_read_b64_tr_b16 v[106:107], v8 offset:3328
    ds_read_b64_tr_b16 v[108:109], v8 offset:31488
    ds_read_b64_tr_b16 v[110:111], v8 offset:32000
    ds_read_b64_tr_b16 v[112:113], v8 offset:3584
    ds_read_b64_tr_b16 v[114:115], v8 offset:4096
    ds_read_b64_tr_b16 v[116:117], v8 offset:32256
    ds_read_b64_tr_b16 v[118:119], v8 offset:32768
    ds_read_b64_tr_b16 v[120:121], v8 offset:4608
    ds_read_b64_tr_b16 v[122:123], v8 offset:5120
    ds_read_b64_tr_b16 v[124:125], v8 offset:33280
    ds_read_b64_tr_b16 v[126:127], v8 offset:33792
    s_waitcnt lgkmcnt(0)
    ds_read_b64_tr_b16 v[128:129], v8 offset:5376
    ds_read_b64_tr_b16 v[130:131], v8 offset:5888
    ds_read_b64_tr_b16 v[132:133], v8 offset:34048
    ds_read_b64_tr_b16 v[134:135], v8 offset:34560
    ds_read_b64_tr_b16 v[136:137], v8 offset:6400
    ds_read_b64_tr_b16 v[138:139], v8 offset:6912
    ds_read_b64_tr_b16 v[140:141], v8 offset:35072
    ds_read_b64_tr_b16 v[142:143], v8 offset:35584
    v_mov_b32 v11, 161792
    v_mov_b32 v7, 1
    s_waitcnt lgkmcnt(0)
    s_mov_b64 exec, 1
    ds_add_u32 v11, v7 offset:8
    s_mov_b64 exec, -1
    s_and_b32 s70, s59, 1
    s_lshl_b32 s70, s70, 1
    s_add_u32 s70, s70, s56
    s_mul_i32 s70, s70, 28
    s_lshl_b32 s68, s58, 2
    s_add_u32 s70, s70, s68
    s_add_u32 s70, s70, s55
    s_lshl_b32 s70, s70, 10
    s_add_u32 s70, s70, s62
    v_add_u32 v9, 98304, v2
    v_mov_b32 v10, 161824
    s_lshl_b32 s68, s55, 11
    v_add_u32 v12, s68, v9
    s_cmp_lg_u32 s54, 0
    s_cbranch_scc1 L_mk_ow_213
    s_sleep 8
    s_mov_b32 s78, 0
L_mk_pr_216:
    buffer_load_dword v7, v5, s[16:19], s69 offen sc1
L_mk_pr_216f:
    s_add_u32 s78, s78, 1
    s_waitcnt vmcnt(0)
    v_cmp_eq_u32 vcc, -1, v7
    s_cmp_gt_u32 s78, 20000
    s_cbranch_scc1 L_mk_px_217
    s_cbranch_vccz L_mk_px_217
    s_sleep 2
    s_branch L_mk_pr_216
L_mk_px_217:
    v_mov_b32 v7, 1
    ds_write_b32 v10, v7
    s_branch L_mk_oe_214
L_mk_ow_213:
    s_mov_b32 s78, 0
L_mk_op_215:
    s_sleep 1
    ds_read_b32 v7, v10
    s_add_u32 s78, s78, 1
    s_waitcnt lgkmcnt(0)
    v_cmp_ne_u32 vcc, 0, v7
    s_nop 0
    s_cbranch_vccnz L_mk_oe_214
    s_cmp_lt_u32 s78, 160000
    s_cbranch_scc1 L_mk_op_215
L_mk_oe_214:
    s_add_u32 s68, s71, 32768
    buffer_load_dwordx4 v[48:51], v2, s[16:19], s68 offen offset:0 sc1
    buffer_load_dwordx4 v[52:55], v2, s[16:19], s68 offen offset:1024 sc1
    buffer_load_dwordx4 v[56:59], v2, s[16:19], s68 offen offset:2048 sc1
    buffer_load_dwordx4 v[60:63], v2, s[16:19], s68 offen offset:3072 sc1
    s_add_u32 s68, s71, 0
    buffer_load_dwordx4 v[16:19], v2, s[16:19], s68 offen offset:0 sc1
    buffer_load_dwordx4 v[20:23], v2, s[16:19], s68 offen offset:1024 sc1
    buffer_load_dwordx4 v[24:27], v2, s[16:19], s68 offen offset:2048 sc1
    buffer_load_dwordx4 v[28:31], v2, s[16:19], s68 offen offset:3072 sc1
    s_add_u32 s68, s71, 36864
    buffer_load_dwordx4 v[64:67], v2, s[16:19], s68 offen offset:0 sc1
    buffer_load_dwordx4 v[68:71], v2, s[16:19], s68 offen offset:1024 sc1
    buffer_load_dwordx4 v[72:75], v2, s[16:19], s68 offen offset:2048 sc1
    buffer_load_dwordx4 v[76:79], v2, s[16:19], s68 offen offset:3072 sc1
    s_add_u32 s68, s71, 4096
    buffer_load_dwordx4 v[32:35], v2, s[16:19], s68 offen offset:0 sc1
    buffer_load_dwordx4 v[36:39], v2, s[16:19], s68 offen offset:1024 sc1
    buffer_load_dwordx4 v[40:43], v2, s[16:19], s68 offen offset:2048 sc1
    buffer_load_dwordx4 v[44:47], v2, s[16:19], s68 offen offset:3072 sc1
    s_mov_b32 s78, 0
L_mk_wc_218:
    ds_read_b32 v7, v11 offset:8
    s_add_u32 s78, s78, 1
    s_waitcnt lgkmcnt(0)
    v_readfirstlane_b32 s68, v7
    s_cmp_gt_u32 s78, 160000
    s_cbranch_scc1 L_mk_wc_218x
    s_cmp_lt_u32 s68, 4
    s_cbranch_scc1 L_mk_wc_218
L_mk_wc_218x:
    s_waitcnt vmcnt(12)
    v_max_u32 v5, v48, v52
    v_max3_u32 v5, v56, v60, v5
    v_cmp_eq_u32 vcc, -1, v5
    s_nop 0
    s_cbranch_vccnz L_mk_rt_219
L_mk_bk_220:
    v_mfma_f32_32x32x16_bf16 v[176:191], v[80:83], v[48:51], 0
    v_mfma_f32_32x32x16_bf16 v[192:207], v[84:87], v[48:51], 0
    v_mfma_f32_32x32x16_bf16 v[176:191], v[88:91], v[52:55], v[176:191]
    v_mfma_f32_32x32x16_bf16 v[192:207], v[92:95], v[52:55], v[192:207]
    v_mfma_f32_32x32x16_bf16 v[176:191], v[96:99], v[56:59], v[176:191]
    v_mfma_f32_32x32x16_bf16 v[192:207], v[100:103], v[56:59], v[192:207]
    v_mfma_f32_32x32x16_bf16 v[176:191], v[104:107], v[60:63], v[176:191]
    v_mfma_f32_32x32x16_bf16 v[192:207], v[108:111], v[60:63], v[192:207]
    s_waitcnt vmcnt(8)
    v_max_u32 v5, v16, v20
    v_max3_u32 v5, v24, v28, v5
    v_cmp_eq_u32 vcc, -1, v5
    s_nop 0
    s_cbranch_vccnz L_mk_rt_221
L_mk_bk_222:
    v_mfma_f32_32x32x16_bf16 v[144:159], v[80:83], v[16:19], 0
    v_mfma_f32_32x32x16_bf16 v[160:175], v[84:87], v[16:19], 0
    v_mfma_f32_32x32x16_bf16 v[144:159], v[88:91], v[20:23], v[144:159]
    v_mfma_f32_32x32x16_bf16 v[160:175], v[92:95], v[20:23], v[160:175]
    v_mfma_f32_32x32x16_bf16 v[144:159], v[96:99], v[24:27], v[144:159]
    v_mfma_f32_32x32x16_bf16 v[160:175], v[100:103], v[24:27], v[160:175]
    v_mfma_f32_32x32x16_bf16 v[144:159], v[104:107], v[28:31], v[144:159]
    v_mfma_f32_32x32x16_bf16 v[160:175], v[108:111], v[28:31], v[160:175]
    s_waitcnt vmcnt(4)
    v_max_u32 v5, v64, v68
    v_max3_u32 v5, v72, v76, v5
    v_cmp_eq_u32 vcc, -1, v5
    s_nop 0
    s_cbranch_vccnz L_mk_rt_223
L_mk_bk_224:
    v_mfma_f32_32x32x16_bf16 v[176:191], v[112:115], v[64:67], v[176:191]
    v_mfma_f32_32x32x16_bf16 v[192:207], v[116:119], v[64:67], v[192:207]
    v_mfma_f32_32x32x16_bf16 v[176:191], v[120:123], v[68:71], v[176:191]
    v_mfma_f32_32x32x16_bf16 v[192:207], v[124:127], v[68:71], v[192:207]
    v_mfma_f32_32x32x16_bf16 v[176:191], v[128:131], v[72:75], v[176:191]
    v_mfma_f32_32x32x16_bf16 v[192:207], v[132:135], v[72:75], v[192:207]
    v_mfma_f32_32x32x16_bf16 v[176:191], v[136:139], v[76:79], v[176:191]
    v_mfma_f32_32x32x16_bf16 v[192:207], v[140:143], v[76:79], v[192:207]
    s_waitcnt vmcnt(0)
    v_max_u32 v5, v32, v36
    v_max3_u32 v5, v40, v44, v5
    v_cmp_eq_u32 vcc, -1, v5
    s_nop 0
    s_cbranch_vccnz L_mk_rt_225
L_mk_bk_226:
    v_mfma_f32_32x32x16_bf16 v[144:159], v[112:115], v[32:35], v[144:159]
    v_mfma_f32_32x32x16_bf16 v[160:175], v[116:119], v[32:35], v[160:175]
    v_mfma_f32_32x32x16_bf16 v[144:159], v[120:123], v[36:39], v[144:159]
    s_nop 1
    ds_write_b128 v12, v[176:179] offset:0
    ds_write_b128 v12, v[180:183] offset:1024
    v_mfma_f32_32x32x16_bf16 v[160:175], v[124:127], v[36:39], v[160:175]
    ds_write_b128 v12, v[184:187] offset:8192
    v_mfma_f32_32x32x16_bf16 v[144:159], v[128:131], v[40:43], v[144:159]
    ds_write_b128 v12, v[188:191] offset:9216
    v_mfma_f32_32x32x16_bf16 v[160:175], v[132:135], v[40:43], v[160:175]
    ds_write_b128 v12, v[192:195] offset:16384
    ds_write_b128 v12, v[196:199] offset:17408
    v_mfma_f32_32x32x16_bf16 v[144:159], v[136:139], v[44:47], v[144:159]
    ds_write_b128 v12, v[200:203] offset:24576
    v_mfma_f32_32x32x16_bf16 v[160:175], v[140:143], v[44:47], v[160:175]
    ds_write_b128 v12, v[204:207] offset:25600
    v_lshlrev_b32 v80, 16, v244
    v_and_b32 v81, 0xffff0000, v244
    v_lshlrev_b32 v82, 16, v245
    v_and_b32 v83, 0xffff0000, v245
    v_lshlrev_b32 v84, 16, v246
    v_and_b32 v85, 0xffff0000, v246
    v_lshlrev_b32 v86, 16, v247
    v_and_b32 v87, 0xffff0000, v247
    s_cmp_eq_u32 s55, 1
    s_cbranch_scc1 L_mk_rk1_229
    s_cmp_eq_u32 s55, 2
    s_cbranch_scc1 L_mk_rk2_230
    s_cmp_eq_u32 s55, 3
    s_cbranch_scc1 L_mk_rk3_231
L_mk_rk0_228:
    ds_write_b128 v9, v[152:155] offset:43008
    ds_write_b128 v9, v[156:159] offset:44032
    ds_write_b128 v9, v[160:163] offset:47104
    ds_write_b128 v9, v[164:167] offset:48128
    ds_write_b128 v9, v[168:171] offset:51200
    ds_write_b128 v9, v[172:175] offset:52224
    s_waitcnt lgkmcnt(0)
    s_barrier
    ds_read_b128 v[16:19], v9 offset:32768
    ds_read_b128 v[20:23], v9 offset:33792
    ds_read_b128 v[24:27], v9 offset:34816
    ds_read_b128 v[28:31], v9 offset:35840
    ds_read_b128 v[32:35], v9 offset:36864
    ds_read_b128 v[36:39], v9 offset:37888
    s_waitcnt lgkmcnt(4)
    v_add_f32 v16, v16, v144
    v_add_f32 v17, v17, v145
    v_add_f32 v18, v18, v146
    v_add_f32 v19, v19, v147
    v_add_f32 v20, v20, v148
    v_add_f32 v21, v21, v149
    v_add_f32 v22, v22, v150
    v_add_f32 v23, v23, v151
    s_branch L_mk_rd_227
L_mk_rk1_229:
    ds_write_b128 v9, v[144:147] offset:32768
    ds_write_b128 v9, v[148:151] offset:33792
    ds_write_b128 v9, v[160:163] offset:49152
    ds_write_b128 v9, v[164:167] offset:50176
    ds_write_b128 v9, v[168:171] offset:53248
    ds_write_b128 v9, v[172:175] offset:54272
    s_waitcnt lgkmcnt(0)
    s_barrier
    ds_read_b128 v[16:19], v9 offset:38912
    ds_read_b128 v[20:23], v9 offset:39936
    ds_read_b128 v[24:27], v9 offset:40960
    ds_read_b128 v[28:31], v9 offset:41984
    ds_read_b128 v[32:35], v9 offset:43008
    ds_read_b128 v[36:39], v9 offset:44032
    s_waitcnt lgkmcnt(4)
    v_add_f32 v16, v16, v152
    v_add_f32 v17, v17, v153
    v_add_f32 v18, v18, v154
    v_add_f32 v19, v19, v155
    v_add_f32 v20, v20, v156
    v_add_f32 v21, v21, v157
    v_add_f32 v22, v22, v158
    v_add_f32 v23, v23, v159
    s_branch L_mk_rd_227
L_mk_rk2_230:
    ds_write_b128 v9, v[144:147] offset:34816
    ds_write_b128 v9, v[148:151] offset:35840
    ds_write_b128 v9, v[152:155] offset:38912
    ds_write_b128 v9, v[156:159] offset:39936
    ds_write_b128 v9, v[168:171] offset:55296
    ds_write_b128 v9, v[172:175] offset:56320
    s_waitcnt lgkmcnt(0)
    s_barrier
    ds_read_b128 v[16:19], v9 offset:45056
    ds_read_b128 v[20:23], v9 offset:46080
    ds_read_b128 v[24:27], v9 offset:47104
    ds_read_b128 v[28:31], v9 offset:48128
    ds_read_b128 v[32:35], v9 offset:49152
    ds_read_b128 v[36:39], v9 offset:50176
    s_waitcnt lgkmcnt(4)
    v_add_f32 v16, v16, v160
    v_add_f32 v17, v17, v161
    v_add_f32 v18, v18, v162
    v_add_f32 v19, v19, v163
    v_add_f32 v20, v20, v164
    v_add_f32 v21, v21, v165
    v_add_f32 v22, v22, v166
    v_add_f32 v23, v23, v167
    s_branch L_mk_rd_227
L_mk_rk3_231:
    ds_write_b128 v9, v[144:147] offset:36864
    ds_write_b128 v9, v[148:151] offset:37888
    ds_write_b128 v9, v[152:155] offset:40960
    ds_write_b128 v9, v[156:159] offset:41984
    ds_write_b128 v9, v[160:163] offset:45056
    ds_write_b128 v9, v[164:167] offset:46080
    s_waitcnt lgkmcnt(0)
    s_barrier
    ds_read_b128 v[16:19], v9 offset:51200
    ds_read_b128 v[20:23], v9 offset:52224
    ds_read_b128 v[24:27], v9 offset:53248
    ds_read_b128 v[28:31], v9 offset:54272
    ds_read_b128 v[32:35], v9 offset:55296
    ds_read_b128 v[36:39], v9 offset:56320
    s_waitcnt lgkmcnt(4)
    v_add_f32 v16, v16, v168
    v_add_f32 v17, v17, v169
    v_add_f32 v18, v18, v170
    v_add_f32 v19, v19, v171
    v_add_f32 v20, v20, v172
    v_add_f32 v21, v21, v173
    v_add_f32 v22, v22, v174
    v_add_f32 v23, v23, v175
L_mk_rd_227:
    s_waitcnt lgkmcnt(0)
    v_add_f32 v24, v24, v32
    v_add_f32 v25, v25, v33
    v_add_f32 v26, v26, v34
    v_add_f32 v27, v27, v35
    v_add_f32 v28, v28, v36
    v_add_f32 v29, v29, v37
    v_add_f32 v30, v30, v38
    v_add_f32 v31, v31, v39
    v_add_f32 v16, v16, v24
    v_add_f32 v17, v17, v25
    v_add_f32 v18, v18, v26
    v_add_f32 v19, v19, v27
    v_add_f32 v20, v20, v28
    v_add_f32 v21, v21, v29
    v_add_f32 v22, v22, v30
    v_add_f32 v23, v23, v31
    v_cvt_pk_bf16_f32 v24, v16, v17
    v_cvt_pk_bf16_f32 v25, v18, v19
    v_cvt_pk_bf16_f32 v26, v20, v21
    v_cvt_pk_bf16_f32 v27, v22, v23
    v_lshlrev_b32 v16, 16, v24
    v_and_b32 v17, 0xffff0000, v24
    v_lshlrev_b32 v18, 16, v25
    v_and_b32 v19, 0xffff0000, v25
    v_lshlrev_b32 v20, 16, v26
    v_and_b32 v21, 0xffff0000, v26
    v_lshlrev_b32 v22, 16, v27
    v_and_b32 v23, 0xffff0000, v27
    v_add_f32 v16, v16, v80
    v_add_f32 v17, v17, v81
    v_add_f32 v18, v18, v82
    v_add_f32 v19, v19, v83
    v_add_f32 v20, v20, v84
    v_add_f32 v21, v21, v85
    v_add_f32 v22, v22, v86
    v_add_f32 v23, v23, v87
    v_cvt_pk_bf16_f32 v240, v16, v17
    v_cvt_pk_bf16_f32 v241, v18, v19
    v_cvt_pk_bf16_f32 v242, v20, v21
    v_cvt_pk_bf16_f32 v243, v22, v23
    buffer_store_dwordx4 v[240:243], v2, s[16:19], s70 offen sc1
    v_lshlrev_b32 v16, 16, v240
    v_and_b32 v17, 0xffff0000, v240
    v_lshlrev_b32 v18, 16, v241
    v_and_b32 v19, 0xffff0000, v241
    v_lshlrev_b32 v20, 16, v242
    v_and_b32 v21, 0xffff0000, v242
    v_lshlrev_b32 v22, 16, v243
    v_and_b32 v23, 0xffff0000, v243
    v_add_f32 v10, v16, v17
    v_mul_f32 v11, v16, v16
    v_fma_f32 v11, v17, v17, v11
    v_add_f32 v10, v10, v18
    v_fma_f32 v11, v18, v18, v11
    v_add_f32 v10, v10, v19
    v_fma_f32 v11, v19, v19, v11
    v_add_f32 v10, v10, v20
    v_fma_f32 v11, v20, v20, v11
    v_add_f32 v10, v10, v21
    v_fma_f32 v11, v21, v21, v11
    v_add_f32 v10, v10, v22
    v_fma_f32 v11, v22, v22, v11
    v_add_f32 v10, v10, v23
    v_fma_f32 v11, v23, v23, v11
    s_mul_i32 s76, s55, 28672
    s_add_u32 s76, s76, s62
    v_min_u32 v14, 6, v1
    v_lshlrev_b32 v14, 12, v14
    v_add_u32 v14, 3072, v14
    buffer_load_dword v15, v14, s[16:19], s76 offen sc1
    v_mov_b32 v12, v10
    v_mov_b32 v13, v11
    s_lshl_b32 s70, s56, 10
    s_lshl_b32 s71, s55, 3
    s_add_u32 s70, s70, s71
    s_add_u32 s70, s70, 159744
    v_permlane32_swap_b32 v10, v12
    v_permlane32_swap_b32 v11, v13
    v_lshl_add_u32 v5, v4, 5, s70
    v_add_f32 v12, v10, v12
    v_add_f32 v13, v11, v13
    ds_write_b64 v5, v[12:13]
    s_waitcnt lgkmcnt(0)
    s_barrier
    s_mul_i32 s70, s55, 28672
    s_add_u32 s70, s70, s62
    v_min_u32 v5, 6, v1
    v_lshlrev_b32 v5, 12, v5
    v_add_u32 v5, 3072, v5
    v_add_u32 v8, 40960, v232
    v_add_u32 v9, 98304, v232
    s_and_b32 s71, s55, 1
    s_lshl_b32 s71, s71, 8
    v_lshl_add_u32 v10, v4, 3, s71
    v_lshl_add_u32 v11, v3, 9, v10
    v_lshlrev_b32 v12, 4, v4
    ds_read_b64_tr_b16 v[192:193], v8 offset:24576
    ds_read_b64_tr_b16 v[194:195], v8 offset:25088
    ds_read_b64_tr_b16 v[196:197], v8 offset:28672
    ds_read_b64_tr_b16 v[198:199], v8 offset:29184
    ds_read_b64_tr_b16 v[200:201], v8 offset:25600
    ds_read_b64_tr_b16 v[202:203], v8 offset:26112
    ds_read_b64_tr_b16 v[204:205], v8 offset:29696
    ds_read_b64_tr_b16 v[206:207], v8 offset:30208
    s_mov_b32 s78, 0
    s_branch L_mk_pr_232f
L_mk_pr_232:
    buffer_load_dword v15, v14, s[16:19], s70 offen sc1
L_mk_pr_232f:
    s_add_u32 s78, s78, 1
    s_waitcnt vmcnt(0)
    v_cmp_eq_u32 vcc, -1, v15
    s_cmp_gt_u32 s78, 20000
    s_cbranch_scc1 L_mk_px_233
    s_cbranch_vccz L_mk_px_233
    s_branch L_mk_pr_232
L_mk_px_233:
    s_add_u32 s71, s70, 0
    buffer_load_dwordx4 v[16:19], v2, s[16:19], s71 offen offset:0 sc1
    buffer_load_dwordx4 v[20:23], v2, s[16:19], s71 offen offset:1024 sc1
    buffer_load_dwordx4 v[24:27], v2, s[16:19], s71 offen offset:2048 sc1
    buffer_load_dwordx4 v[28:31], v2, s[16:19], s71 offen offset:3072 sc1
    s_add_u32 s71, s70, 4096
    buffer_load_dwordx4 v[32:35], v2, s[16:19], s71 offen offset:0 sc1
    buffer_load_dwordx4 v[36:39], v2, s[16:19], s71 offen offset:1024 sc1
    buffer_load_dwordx4 v[40:43], v2, s[16:19], s71 offen offset:2048 sc1
    buffer_load_dwordx4 v[44:47], v2, s[16:19], s71 offen offset:3072 sc1
    s_add_u32 s71, s70, 8192
    buffer_load_dwordx4 v[48:51], v2, s[16:19], s71 offen offset:0 sc1
    buffer_load_dwordx4 v[52:55], v2, s[16:19], s71 offen offset:1024 sc1
    buffer_load_dwordx4 v[56:59], v2, s[16:19], s71 offen offset:2048 sc1
    buffer_load_dwordx4 v[60:63], v2, s[16:19], s71 offen offset:3072 sc1
    s_waitcnt vmcnt(8)
    v_max_u32 v5, v16, v20
    v_max3_u32 v5, v24, v28, v5
    v_cmp_eq_u32 vcc, -1, v5
    s_nop 0
    s_cbranch_vccnz L_mk_rt_234
L_mk_bk_235:
    s_waitcnt lgkmcnt(4)
    v_mfma_f32_32x32x16_bf16 v[128:143], v[192:195], v[16:19], 0
    ds_read_b64_tr_b16 v[208:209], v8 offset:26624
    s_add_u32 s71, s70, 12288
    ds_read_b64_tr_b16 v[210:211], v8 offset:27136
    v_mfma_f32_32x32x16_bf16 v[144:159], v[196:199], v[16:19], 0
    ds_read_b64_tr_b16 v[212:213], v8 offset:30720
    buffer_load_dwordx4 v[64:67], v2, s[16:19], s71 offen offset:0 sc1
    ds_read_b64_tr_b16 v[214:215], v8 offset:31232
    s_waitcnt lgkmcnt(4)
    v_mfma_f32_32x32x16_bf16 v[128:143], v[200:203], v[20:23], v[128:143]
    ds_read_b64_tr_b16 v[192:193], v8 offset:27648
    buffer_load_dwordx4 v[68:71], v2, s[16:19], s71 offen offset:1024 sc1
    ds_read_b64_tr_b16 v[194:195], v8 offset:28160
    v_mfma_f32_32x32x16_bf16 v[144:159], v[204:207], v[20:23], v[144:159]
    ds_read_b64_tr_b16 v[196:197], v8 offset:31744
    ds_read_b64_tr_b16 v[198:199], v8 offset:32256
    s_waitcnt lgkmcnt(4)
    v_mfma_f32_32x32x16_bf16 v[128:143], v[208:211], v[24:27], v[128:143]
    ds_read_b64_tr_b16 v[200:201], v8 offset:32768
    buffer_load_dwordx4 v[72:75], v2, s[16:19], s71 offen offset:2048 sc1
    ds_read_b64_tr_b16 v[202:203], v8 offset:33280
    v_mfma_f32_32x32x16_bf16 v[144:159], v[212:215], v[24:27], v[144:159]
    ds_read_b64_tr_b16 v[204:205], v8 offset:36864
    ds_read_b64_tr_b16 v[206:207], v8 offset:37376
    s_waitcnt lgkmcnt(4)
    v_mfma_f32_32x32x16_bf16 v[128:143], v[192:195], v[28:31], v[128:143]
    ds_read_b64_tr_b16 v[208:209], v8 offset:33792
    buffer_load_dwordx4 v[76:79], v2, s[16:19], s71 offen offset:3072 sc1
    ds_read_b64_tr_b16 v[210:211], v8 offset:34304
    s_waitcnt vmcnt(8)
    v_max_u32 v5, v32, v36
    v_mfma_f32_32x32x16_bf16 v[144:159], v[196:199], v[28:31], v[144:159]
    ds_read_b64_tr_b16 v[212:213], v8 offset:37888
    v_max3_u32 v5, v40, v44, v5
    ds_read_b64_tr_b16 v[214:215], v8 offset:38400
    v_cmp_eq_u32 vcc, -1, v5
    s_nop 0
    s_cbranch_vccnz L_mk_rt_236
L_mk_bk_237:
    s_waitcnt lgkmcnt(4)
    v_mfma_f32_32x32x16_bf16 v[128:143], v[200:203], v[32:35], v[128:143]
    ds_read_b64_tr_b16 v[192:193], v8 offset:34816
    s_add_u32 s71, s70, 16384
    ds_read_b64_tr_b16 v[194:195], v8 offset:35328
    v_mfma_f32_32x32x16_bf16 v[144:159], v[204:207], v[32:35], v[144:159]
    ds_read_b64_tr_b16 v[196:197], v8 offset:38912
    buffer_load_dwordx4 v[80:83], v2, s[16:19], s71 offen offset:0 sc1
    ds_read_b64_tr_b16 v[198:199], v8 offset:39424
    s_waitcnt lgkmcnt(4)
    v_mfma_f32_32x32x16_bf16 v[128:143], v[208:211], v[36:39], v[128:143]
    ds_read_b64_tr_b16 v[200:201], v8 offset:35840
    buffer_load_dwordx4 v[84:87], v2, s[16:19], s71 offen offset:1024 sc1
    ds_read_b64_tr_b16 v[202:203], v8 offset:36352
    v_mfma_f32_32x32x16_bf16 v[144:159], v[212:215], v[36:39], v[144:159]
    ds_read_b64_tr_b16 v[204:205], v8 offset:39936
    ds_read_b64_tr_b16 v[206:207], v8 offset:40448
    s_waitcnt lgkmcnt(4)
    v_mfma_f32_32x32x16_bf16 v[128:143], v[192:195], v[40:43], v[128:143]
    ds_read_b64_tr_b16 v[208:209], v8 offset:40960
    buffer_load_dwordx4 v[88:91], v2, s[16:19], s71 offen offset:2048 sc1
    ds_read_b64_tr_b16 v[210:211], v8 offset:41472
    v_mfma_f32_32x32x16_bf16 v[144:159], v[196:199], v[40:43], v[144:159]
    ds_read_b64_tr_b16 v[212:213], v8 offset:45056
    ds_read_b64_tr_b16 v[214:215], v8 offset:45568
    s_waitcnt lgkmcnt(4)
    v_mfma_f32_32x32x16_bf16 v[128:143], v[200:203], v[44:47], v[128:143]
    ds_read_b64_tr_b16 v[192:193], v8 offset:41984
    buffer_load_dwordx4 v[92:95], v2, s[16:19], s71 offen offset:3072 sc1
    ds_read_b64_tr_b16 v[194:195], v8 offset:42496
    s_waitcnt vmcnt(8)
    v_max_u32 v5, v48, v52
    v_mfma_f32_32x32x16_bf16 v[144:159], v[204:207], v[44:47], v[144:159]
    ds_read_b64_tr_b16 v[196:197], v8 offset:46080
    v_max3_u32 v5, v56, v60, v5
    ds_read_b64_tr_b16 v[198:199], v8 offset:46592
    v_cmp_eq_u32 vcc, -1, v5
    s_nop 0
    s_cbranch_vccnz L_mk_rt_238
L_mk_bk_239:
    s_waitcnt lgkmcnt(4)
    v_mfma_f32_32x32x16_bf16 v[128:143], v[208:211], v[48:51], v[128:143]
    ds_read_b64_tr_b16 v[200:201], v8 offset:43008
    s_add_u32 s71, s70, 20480
    ds_read_b64_tr_b16 v[202:203], v8 offset:43520
    v_mfma_f32_32x32x16_bf16 v[144:159], v[212:215], v[48:51], v[144:159]
    ds_read_b64_tr_b16 v[204:205], v8 offset:47104
    buffer_load_dwordx4 v[96:99], v2, s[16:19], s71 offen offset:0 sc1
    ds_read_b64_tr_b16 v[206:207], v8 offset:47616
    s_waitcnt lgkmcnt(4)
    v_mfma_f32_32x32x16_bf16 v[128:143], v[192:195], v[52:55], v[128:143]
    ds_read_b64_tr_b16 v[208:209], v8 offset:44032
    buffer_load_dwordx4 v[100:103], v2, s[16:19], s71 offen offset:1024 sc1
    ds_read_b64_tr_b16 v[210:211], v8 offset:44544
    v_mfma_f32_32x32x16_bf16 v[144:159], v[196:199], v[52:55], v[144:159]
    ds_read_b64_tr_b16 v[212:213], v8 offset:48128
    ds_read_b64_tr_b16 v[214:215], v8 offset:48640
    s_waitcnt lgkmcnt(4)
    v_mfma_f32_32x32x16_bf16 v[128:143], v[200:203], v[56:59], v[128:143]
    ds_read_b64_tr_b16 v[192:193], v8 offset:49152
    buffer_load_dwordx4 v[104:107], v2, s[16:19], s71 offen offset:2048 sc1
    ds_read_b64_tr_b16 v[194:195], v8 offset:49664
    v_mfma_f32_32x32x16_bf16 v[144:159], v[204:207], v[56:59], v[144:159]
    ds_read_b64_tr_b16 v[196:197], v8 offset:53248
    ds_read_b64_tr_b16 v[198:199], v8 offset:53760
    s_waitcnt lgkmcnt(4)
    v_mfma_f32_32x32x16_bf16 v[128:143], v[208:211], v[60:63], v[128:143]
    ds_read_b64_tr_b16 v[200:201], v8 offset:50176
    buffer_load_dwordx4 v[108:111], v2, s[16:19], s71 offen offset:3072 sc1
    ds_read_b64_tr_b16 v[202:203], v8 offset:50688
    s_lshr_b32 s76, s55, 1
    s_mul_i32 s76, s76, 3584
    s_add_u32 s76, s76, s62
    s_add_u32 s76, s76, 114688
    s_lshl_b32 s69, s61, 11
    v_mfma_f32_32x32x16_bf16 v[144:159], v[212:215], v[60:63], v[144:159]
    ds_read_b64_tr_b16 v[204:205], v8 offset:54272
    s_add_u32 s69, s69, 17891328
    ds_read_b64_tr_b16 v[206:207], v8 offset:54784
    s_waitcnt vmcnt(8)
    v_max_u32 v5, v64, v68
    v_max3_u32 v5, v72, v76, v5
    v_cmp_eq_u32 vcc, -1, v5
    s_nop 0
    s_cbranch_vccnz L_mk_rt_240
L_mk_bk_241:
    s_waitcnt lgkmcnt(4)
    v_mfma_f32_32x32x16_bf16 v[128:143], v[192:195], v[64:67], v[128:143]
    ds_read_b64_tr_b16 v[208:209], v8 offset:51200
    s_add_u32 s71, s70, 24576
    ds_read_b64_tr_b16 v[210:211], v8 offset:51712
    buffer_load_dwordx4 v[112:115], v2, s[16:19], s71 offen offset:0 sc1
    v_mfma_f32_32x32x16_bf16 v[144:159], v[196:199], v[64:67], v[144:159]
    ds_read_b64_tr_b16 v[212:213], v8 offset:55296
    buffer_load_dwordx2 v[160:161], v11, s[16:19], s76 offen offset:0 sc1
    ds_read_b64_tr_b16 v[214:215], v8 offset:55808
    buffer_load_dwordx2 v[162:163], v11, s[16:19], s76 offen offset:1024 sc1
    s_waitcnt lgkmcnt(4)
    v_mfma_f32_32x32x16_bf16 v[128:143], v[200:203], v[68:71], v[128:143]
    ds_read_b64_tr_b16 v[192:193], v8 offset:52224
    buffer_load_dwordx4 v[116:119], v2, s[16:19], s71 offen offset:1024 sc1
    ds_read_b64_tr_b16 v[194:195], v8 offset:52736
    buffer_load_dwordx2 v[164:165], v11, s[16:19], s76 offen offset:2048 sc1
    v_mfma_f32_32x32x16_bf16 v[144:159], v[204:207], v[68:71], v[144:159]
    ds_read_b64_tr_b16 v[196:197], v8 offset:56320
    buffer_load_dwordx2 v[166:167], v10, s[16:19], s76 offen offset:3072 sc1
    ds_read_b64_tr_b16 v[198:199], v8 offset:56832
    s_waitcnt lgkmcnt(4)
    v_mfma_f32_32x32x16_bf16 v[128:143], v[208:211], v[72:75], v[128:143]
    ds_read_b64_tr_b16 v[200:201], v8 offset:0
    buffer_load_dwordx4 v[120:123], v2, s[16:19], s71 offen offset:2048 sc1
    ds_read_b64_tr_b16 v[202:203], v8 offset:512
    buffer_load_dwordx4 v[216:219], v12, s[16:19], s69 offen offset:0 sc1
    v_mfma_f32_32x32x16_bf16 v[144:159], v[212:215], v[72:75], v[144:159]
    ds_read_b64_tr_b16 v[204:205], v8 offset:4096
    buffer_load_dwordx4 v[220:223], v12, s[16:19], s69 offen offset:512 sc1
    ds_read_b64_tr_b16 v[206:207], v8 offset:4608
    s_waitcnt lgkmcnt(4)
    v_mfma_f32_32x32x16_bf16 v[128:143], v[192:195], v[76:79], v[128:143]
    ds_read_b64_tr_b16 v[208:209], v8 offset:1024
    buffer_load_dwordx4 v[124:127], v2, s[16:19], s71 offen offset:3072 sc1
    ds_read_b64_tr_b16 v[210:211], v8 offset:1536
    buffer_load_dwordx4 v[224:227], v12, s[16:19], s69 offen offset:1024 sc1
    buffer_load_dwordx4 v[228:231], v12, s[16:19], s69 offen offset:1536 sc1
    s_waitcnt vmcnt(16)
    v_mfma_f32_32x32x16_bf16 v[144:159], v[196:199], v[76:79], v[144:159]
    ds_read_b64_tr_b16 v[212:213], v8 offset:5120
    v_max_u32 v5, v80, v84
    ds_read_b64_tr_b16 v[214:215], v8 offset:5632
    v_max3_u32 v5, v88, v92, v5
    v_cmp_eq_u32 vcc, -1, v5
    s_nop 0
    s_cbranch_vccnz L_mk_rt_242
L_mk_bk_243:
    s_waitcnt lgkmcnt(4)
    v_mfma_f32_32x32x16_bf16 v[128:143], v[200:203], v[80:83], v[128:143]
    ds_read_b64_tr_b16 v[192:193], v8 offset:2048
    ds_read_b64_tr_b16 v[194:195], v8 offset:2560
    v_mfma_f32_32x32x16_bf16 v[144:159], v[204:207], v[80:83], v[144:159]
    ds_read_b64_tr_b16 v[196:197], v8 offset:6144
    ds_read_b64_tr_b16 v[198:199], v8 offset:6656
    s_waitcnt lgkmcnt(4)
    v_mfma_f32_32x32x16_bf16 v[128:143], v[208:211], v[84:87], v[128:143]
    ds_read_b64_tr_b16 v[200:201], v8 offset:3072
    ds_read_b64_tr_b16 v[202:203], v8 offset:3584
    v_mfma_f32_32x32x16_bf16 v[144:159], v[212:215], v[84:87], v[144:159]
    ds_read_b64_tr_b16 v[204:205], v8 offset:7168
    ds_read_b64_tr_b16 v[206:207], v8 offset:7680
    s_waitcnt lgkmcnt(4)
    v_mfma_f32_32x32x16_bf16 v[128:143], v[192:195], v[88:91], v[128:143]
    ds_read_b64_tr_b16 v[208:209], v8 offset:8192
    ds_read_b64_tr_b16 v[210:211], v8 offset:8704
    v_mfma_f32_32x32x16_bf16 v[144:159], v[196:199], v[88:91], v[144:159]
    ds_read_b64_tr_b16 v[212:213], v8 offset:12288
    ds_read_b64_tr_b16 v[214:215], v8 offset:12800
    s_waitcnt lgkmcnt(4)
    v_mfma_f32_32x32x16_bf16 v[128:143], v[200:203], v[92:95], v[128:143]
    ds_read_b64_tr_b16 v[192:193], v8 offset:9216
    s_waitcnt vmcnt(0)
    ds_read_b64_tr_b16 v[194:195], v8 offset:9728
    v_max_u32 v5, v96, v100
    v_max3_u32 v5, v104, v108, v5
    v_mfma_f32_32x32x16_bf16 v[144:159], v[204:207], v[92:95], v[144:159]
    ds_read_b64_tr_b16 v[196:197], v8 offset:13312
    v_cmp_eq_u32 vcc, -1, v5
    ds_read_b64_tr_b16 v[198:199], v8 offset:13824
    s_cbranch_vccnz L_mk_rt_244
L_mk_bk_245:
    s_waitcnt lgkmcnt(4)
    v_mfma_f32_32x32x16_bf16 v[128:143], v[208:211], v[96:99], v[128:143]
    ds_read_b64_tr_b16 v[200:201], v8 offset:10240
    v_xor_b32 v218, s82, v218
    ds_read_b64_tr_b16 v[202:203], v8 offset:10752
    v_xor_b32 v219, s82, v219
    v_xor_b32 v222, s82, v222
    v_xor_b32 v223, s82, v223
    v_xor_b32 v226, s82, v226
    v_xor_b32 v227, s82, v227
    v_xor_b32 v230, s82, v230
    v_xor_b32 v231, s82, v231
    v_mfma_f32_32x32x16_bf16 v[144:159], v[212:215], v[96:99], v[144:159]
    ds_read_b64_tr_b16 v[204:205], v8 offset:14336
    v_or_b32 v7, v218, v222
    ds_read_b64_tr_b16 v[206:207], v8 offset:14848
    v_or3_b32 v7, v226, v230, v7
    v_cmp_ne_u32 vcc, 0, v7
    s_nop 0
    s_cbranch_vccnz L_mk_xr_246
L_mk_xb_247:
    v_max_u32 v5, v160, v162
    v_max3_u32 v5, v164, v166, v5
    v_cmp_eq_u32 vcc, -1, v5
    s_nop 0
    s_cbranch_vccnz L_mk_rt_248
L_mk_bk_249:
    s_waitcnt lgkmcnt(4)
    v_mfma_f32_32x32x16_bf16 v[128:143], v[192:195], v[100:103], v[128:143]
    ds_read_b64_tr_b16 v[208:209], v8 offset:11264
    v_cmp_eq_u32 s[22:23], 0, v3
    ds_read_b64_tr_b16 v[210:211], v8 offset:11776
    v_add_f32 v160, v160, v162
    v_add_f32 v161, v161, v163
    v_mfma_f32_32x32x16_bf16 v[144:159], v[196:199], v[100:103], v[144:159]
    ds_read_b64_tr_b16 v[212:213], v8 offset:15360
    v_cndmask_b32 v166, v237, v166, s[22:23]
    ds_read_b64_tr_b16 v[214:215], v8 offset:15872
    v_cndmask_b32 v167, v237, v167, s[22:23]
    v_add_f32 v164, v164, v166
    s_waitcnt lgkmcnt(4)
    v_mfma_f32_32x32x16_bf16 v[128:143], v[200:203], v[104:107], v[128:143]
    ds_read_b64_tr_b16 v[192:193], v8 offset:16384
    v_add_f32 v165, v165, v167
    ds_read_b64_tr_b16 v[194:195], v8 offset:16896
    v_add_f32 v160, v160, v164
    v_add_f32 v161, v161, v165
    v_mfma_f32_32x32x16_bf16 v[144:159], v[204:207], v[104:107], v[144:159]
    ds_read_b64_tr_b16 v[196:197], v8 offset:20480
    v_mov_b32 v162, v160
    ds_read_b64_tr_b16 v[198:199], v8 offset:20992
    v_mov_b32 v163, v161
    v_mov_b32 v14, 0
    s_waitcnt lgkmcnt(4)
    v_mfma_f32_32x32x16_bf16 v[128:143], v[208:211], v[108:111], v[128:143]
    ds_read_b64_tr_b16 v[200:201], v8 offset:17408
    s_waitcnt vmcnt(0)
    ds_read_b64_tr_b16 v[202:203], v8 offset:17920
    v_max_u32 v5, v112, v116
    v_max3_u32 v5, v120, v124, v5
    v_cmp_eq_u32 vcc, -1, v5
    s_nop 0
    s_cbranch_vccnz L_mk_rt_250
L_mk_bk_251:
    v_mov_b32 v15, 0
    v_mfma_f32_32x32x16_bf16 v[144:159], v[212:215], v[108:111], v[144:159]
    ds_read_b64_tr_b16 v[204:205], v8 offset:21504
    v_permlane32_swap_b32 v160, v162
    ds_read_b64_tr_b16 v[206:207], v8 offset:22016
    v_permlane32_swap_b32 v161, v163
    v_add_f32 v160, v160, v162
    v_add_f32 v161, v161, v163
    v_mul_f32 v162, 0x3b124925, v160
    s_waitcnt lgkmcnt(4)
    v_mfma_f32_32x32x16_bf16 v[128:143], v[192:195], v[112:115], v[128:143]
    ds_read_b64_tr_b16 v[208:209], v8 offset:18432
    v_mul_f32 v165, 0x3b124925, v161
    ds_read_b64_tr_b16 v[210:211], v8 offset:18944
    v_fma_f32 v165, -v162, v162, v165
    v_max_f32 v165, 0, v165
    v_mfma_f32_32x32x16_bf16 v[144:159], v[196:199], v[112:115], v[144:159]
    ds_read_b64_tr_b16 v[212:213], v8 offset:22528
    v_cvt_pk_bf16_f32 v165, v165, v162
    ds_read_b64_tr_b16 v[214:215], v8 offset:23040
    v_and_b32 v162, 0xffff0000, v165
    v_lshlrev_b32 v165, 16, v165
    s_waitcnt lgkmcnt(4)
    v_mfma_f32_32x32x16_bf16 v[128:143], v[200:203], v[116:119], v[128:143]
    ds_read_b64_tr_b16 v[192:193], v8 offset:19456
    v_add_f32 v165, 0x3727c5ac, v165
    ds_read_b64_tr_b16 v[194:195], v8 offset:19968
    v_cvt_pk_bf16_f32 v165, v165, v165
    v_lshlrev_b32 v165, 16, v165
    v_mfma_f32_32x32x16_bf16 v[144:159], v[204:207], v[116:119], v[144:159]
    ds_read_b64_tr_b16 v[196:197], v8 offset:23552
    v_sqrt_f32 v165, v165
    ds_read_b64_tr_b16 v[198:199], v8 offset:24064
    v_cvt_pk_bf16_f32 v165, v165, v165
    v_lshlrev_b32 v163, 16, v165
    s_waitcnt lgkmcnt(4)
    v_mfma_f32_32x32x16_bf16 v[128:143], v[208:211], v[120:123], v[128:143]
    v_rcp_f32 v164, v163
    v_xor_b32 v162, 0x80000000, v162
    v_lshrrev_b32 v13, 16, v162
    v_mfma_f32_32x32x16_bf16 v[144:159], v[212:215], v[120:123], v[144:159]
    v_or_b32 v12, v162, v13
    v_or_b32 v13, v13, v163
    v_cndmask_b32 v12, v237, v12, s[22:23]
    s_waitcnt lgkmcnt(0)
    s_barrier
    v_mfma_f32_32x32x16_bf16 v[128:143], v[192:195], v[124:127], v[128:143]
    ds_read_b64_tr_b16 v[200:201], v232 offset:0
    v_cndmask_b32 v13, v237, v13, s[22:23]
    ds_read_b64_tr_b16 v[202:203], v232 offset:512
    v_mul_f32 v164, v164, v164
    ds_read_b64_tr_b16 v[204:205], v232 offset:4096
    v_mov_b32 v6, v164
    ds_read_b64_tr_b16 v[206:207], v232 offset:4608
    v_mfma_f32_32x32x16_bf16 v[144:159], v[196:199], v[124:127], v[144:159]
    ds_read_b64_tr_b16 v[208:209], v232 offset:1024
    s_lshl_b32 s76, s55, 7
    ds_read_b64_tr_b16 v[210:211], v232 offset:1536
    s_add_u32 s76, s76, 162304
    ds_read_b64_tr_b16 v[212:213], v232 offset:5120
    v_lshl_add_u32 v7, v4, 2, s76
    ds_read_b64_tr_b16 v[214:215], v232 offset:5632
    v_mfma_f32_32x32x16_bf16 v[128:143], v[216:219], v[12:15], v[128:143]
    v_mfma_f32_32x32x16_bf16 v[144:159], v[220:223], v[12:15], v[144:159]
    ds_write_b32 v7, v6
    s_mul_i32 s70, s55, 112
    s_add_u32 s70, s70, s61
    s_lshl_b32 s70, s70, 10
    s_add_u32 s70, s70, s62
    s_add_u32 s70, s70, 131072
    s_and_b32 s71, s59, 1
    s_lshl_b32 s71, s71, 1
    s_add_u32 s71, s71, s56
    s_lshl_b32 s71, s71, 2
    s_add_u32 s71, s71, s55
    s_mul_i32 s71, s71, 28672
    s_add_u32 s71, s71, s62
    s_add_u32 s71, s71, 131072
    s_waitcnt lgkmcnt(0)
    v_mfma_f32_32x32x16_bf16 v[160:175], v[200:203], v[16:19], 0
    ds_read_b64_tr_b16 v[192:193], v232 offset:2048
    ds_read_b64_tr_b16 v[194:195], v232 offset:2560
    v_mfma_f32_32x32x16_bf16 v[176:191], v[204:207], v[16:19], 0
    ds_read_b64_tr_b16 v[196:197], v232 offset:6144
    ds_read_b64_tr_b16 v[198:199], v232 offset:6656
    v_mfma_f32_32x32x16_bf16 v[160:175], v[208:211], v[20:23], v[160:175]
    ds_read_b64_tr_b16 v[200:201], v232 offset:3072
    v_mul_f32 v128, v128, |v128|
    ds_read_b64_tr_b16 v[202:203], v232 offset:3584
    v_mul_f32 v129, v129, |v129|
    v_mul_f32 v130, v130, |v130|
    v_mul_f32 v131, v131, |v131|
    v_mul_f32 v132, v132, |v132|
    v_mul_f32 v133, v133, |v133|
    v_mfma_f32_32x32x16_bf16 v[176:191], v[212:215], v[20:23], v[176:191]
    ds_read_b64_tr_b16 v[204:205], v232 offset:7168
    v_mul_f32 v134, v134, |v134|
    ds_read_b64_tr_b16 v[206:207], v232 offset:7680
    v_mul_f32 v135, v135, |v135|
    v_cvt_pk_bf16_f32 v128, v128, v129
    v_cvt_pk_bf16_f32 v129, v130, v131
    v_cvt_pk_bf16_f32 v130, v132, v133
    v_cvt_pk_bf16_f32 v131, v134, v135
    s_waitcnt lgkmcnt(4)
    v_mfma_f32_32x32x16_bf16 v[160:175], v[192:195], v[24:27], v[160:175]
    ds_read_b64_tr_b16 v[208:209], v232 offset:8192
    v_perm_b32 v132, v128, v128, s87
    ds_read_b64_tr_b16 v[210:211], v232 offset:8704
    v_perm_b32 v133, v129, v129, s87
    v_perm_b32 v134, v130, v130, s87
    v_perm_b32 v135, v131, v131, s87
    v_bitop3_b32 v128, v128, v132, s21 bitop3:0x9a
    v_bitop3_b32 v129, v129, v133, 0 bitop3:0x9a
    v_mfma_f32_32x32x16_bf16 v[176:191], v[196:199], v[24:27], v[176:191]
    ds_read_b64_tr_b16 v[212:213], v232 offset:12288
    v_bitop3_b32 v130, v130, v134, 0 bitop3:0x9a
    ds_read_b64_tr_b16 v[214:215], v232 offset:12800
    v_bitop3_b32 v131, v131, v135, s21 bitop3:0x9a
    buffer_store_dwordx4 v[128:131], v2, s[16:19], s70 offen sc1
    s_add_u32 s70, s70, 28672
    v_mul_f32 v136, v136, |v136|
    v_mul_f32 v137, v137, |v137|
    s_waitcnt lgkmcnt(4)
    v_mfma_f32_32x32x16_bf16 v[160:175], v[200:203], v[28:31], v[160:175]
    ds_read_b64_tr_b16 v[192:193], v232 offset:9216
    v_mul_f32 v138, v138, |v138|
    ds_read_b64_tr_b16 v[194:195], v232 offset:9728
    v_mul_f32 v139, v139, |v139|
    v_mul_f32 v140, v140, |v140|
    v_mul_f32 v141, v141, |v141|
    v_mul_f32 v142, v142, |v142|
    v_mul_f32 v143, v143, |v143|
    v_mfma_f32_32x32x16_bf16 v[176:191], v[204:207], v[28:31], v[176:191]
    ds_read_b64_tr_b16 v[196:197], v232 offset:13312
    v_cvt_pk_bf16_f32 v136, v136, v137
    ds_read_b64_tr_b16 v[198:199], v232 offset:13824
    v_cvt_pk_bf16_f32 v137, v138, v139
    v_cvt_pk_bf16_f32 v138, v140, v141
    v_cvt_pk_bf16_f32 v139, v142, v143
    v_perm_b32 v140, v136, v136, s87
    v_perm_b32 v141, v137, v137, s87
    s_waitcnt lgkmcnt(4)
    v_mfma_f32_32x32x16_bf16 v[160:175], v[208:211], v[32:35], v[160:175]
    ds_read_b64_tr_b16 v[200:201], v232 offset:10240
    v_perm_b32 v142, v138, v138, s87
    ds_read_b64_tr_b16 v[202:203], v232 offset:10752
    v_perm_b32 v143, v139, v139, s87
    v_bitop3_b32 v136, v136, v140, s21 bitop3:0x9a
    v_bitop3_b32 v137, v137, v141, 0 bitop3:0x9a
    v_bitop3_b32 v138, v138, v142, 0 bitop3:0x9a
    v_bitop3_b32 v139, v139, v143, s21 bitop3:0x9a
    v_mfma_f32_32x32x16_bf16 v[176:191], v[212:215], v[32:35], v[176:191]
    ds_read_b64_tr_b16 v[204:205], v232 offset:14336
    buffer_store_dwordx4 v[136:139], v2, s[16:19], s70 offen sc1
    ds_read_b64_tr_b16 v[206:207], v232 offset:14848
    s_add_u32 s70, s70, 28672
    v_mul_f32 v144, v144, |v144|
    v_mul_f32 v145, v145, |v145|
    v_mul_f32 v146, v146, |v146|
    v_mul_f32 v147, v147, |v147|
    s_waitcnt lgkmcnt(4)
    v_mfma_f32_32x32x16_bf16 v[160:175], v[192:195], v[36:39], v[160:175]
    ds_read_b64_tr_b16 v[208:209], v232 offset:11264
    v_mul_f32 v148, v148, |v148|
    ds_read_b64_tr_b16 v[210:211], v232 offset:11776
    v_mul_f32 v149, v149, |v149|
    v_mul_f32 v150, v150, |v150|
    v_mul_f32 v151, v151, |v151|
    v_cvt_pk_bf16_f32 v144, v144, v145
    v_cvt_pk_bf16_f32 v145, v146, v147
    v_mfma_f32_32x32x16_bf16 v[176:191], v[196:199], v[36:39], v[176:191]
    ds_read_b64_tr_b16 v[212:213], v232 offset:15360
    v_cvt_pk_bf16_f32 v146, v148, v149
    ds_read_b64_tr_b16 v[214:215], v232 offset:15872
    v_cvt_pk_bf16_f32 v147, v150, v151
    v_perm_b32 v148, v144, v144, s87
    v_perm_b32 v149, v145, v145, s87
    v_perm_b32 v150, v146, v146, s87
    v_perm_b32 v151, v147, v147, s87
    s_waitcnt lgkmcnt(4)
    v_mfma_f32_32x32x16_bf16 v[160:175], v[200:203], v[40:43], v[160:175]
    ds_read_b64_tr_b16 v[192:193], v232 offset:16384
    v_bitop3_b32 v144, v144, v148, s21 bitop3:0x9a
    ds_read_b64_tr_b16 v[194:195], v232 offset:16896
    v_bitop3_b32 v145, v145, v149, 0 bitop3:0x9a
    v_bitop3_b32 v146, v146, v150, 0 bitop3:0x9a
    v_bitop3_b32 v147, v147, v151, s21 bitop3:0x9a
    buffer_store_dwordx4 v[144:147], v2, s[16:19], s70 offen sc1
    s_add_u32 s70, s70, 28672
    v_mfma_f32_32x32x16_bf16 v[176:191], v[204:207], v[40:43], v[176:191]
    ds_read_b64_tr_b16 v[196:197], v232 offset:20480
    v_mul_f32 v152, v152, |v152|
    ds_read_b64_tr_b16 v[198:199], v232 offset:20992
    v_mul_f32 v153, v153, |v153|
    v_mul_f32 v154, v154, |v154|
    v_mul_f32 v155, v155, |v155|
    v_mul_f32 v156, v156, |v156|
    v_mul_f32 v157, v157, |v157|
    s_waitcnt lgkmcnt(4)
    v_mfma_f32_32x32x16_bf16 v[160:175], v[208:211], v[44:47], v[160:175]
    ds_read_b64_tr_b16 v[200:201], v232 offset:17408
    v_mul_f32 v158, v158, |v158|
    ds_read_b64_tr_b16 v[202:203], v232 offset:17920
    v_mul_f32 v159, v159, |v159|
    v_cvt_pk_bf16_f32 v152, v152, v153
    v_cvt_pk_bf16_f32 v153, v154, v155
    v_cvt_pk_bf16_f32 v154, v156, v157
    v_cvt_pk_bf16_f32 v155, v158, v159
    v_mfma_f32_32x32x16_bf16 v[176:191], v[212:215], v[44:47], v[176:191]
    ds_read_b64_tr_b16 v[204:205], v232 offset:21504
    v_perm_b32 v156, v152, v152, s87
    ds_read_b64_tr_b16 v[206:207], v232 offset:22016
    v_perm_b32 v157, v153, v153, s87
    v_perm_b32 v158, v154, v154, s87
    v_perm_b32 v159, v155, v155, s87
    v_bitop3_b32 v152, v152, v156, s21 bitop3:0x9a
    v_bitop3_b32 v153, v153, v157, 0 bitop3:0x9a
    s_waitcnt lgkmcnt(4)
    v_mfma_f32_32x32x16_bf16 v[160:175], v[192:195], v[48:51], v[160:175]
    ds_read_b64_tr_b16 v[208:209], v232 offset:18432
    v_bitop3_b32 v154, v154, v158, 0 bitop3:0x9a
    ds_read_b64_tr_b16 v[210:211], v232 offset:18944
    v_bitop3_b32 v155, v155, v159, s21 bitop3:0x9a
    v_mfma_f32_32x32x16_bf16 v[176:191], v[196:199], v[48:51], v[176:191]
    ds_read_b64_tr_b16 v[212:213], v232 offset:22528
    buffer_store_dwordx4 v[152:155], v2, s[16:19], s70 offen sc1
    ds_read_b64_tr_b16 v[214:215], v232 offset:23040
    s_add_u32 s70, s70, 28672
    s_waitcnt lgkmcnt(4)
    v_mfma_f32_32x32x16_bf16 v[160:175], v[200:203], v[52:55], v[160:175]
    ds_read_b64_tr_b16 v[192:193], v232 offset:19456
    ds_read_b64_tr_b16 v[194:195], v232 offset:19968
    v_mfma_f32_32x32x16_bf16 v[176:191], v[204:207], v[52:55], v[176:191]
    ds_read_b64_tr_b16 v[196:197], v232 offset:23552
    ds_read_b64_tr_b16 v[198:199], v232 offset:24064
    s_waitcnt lgkmcnt(4)
    v_mfma_f32_32x32x16_bf16 v[160:175], v[208:211], v[56:59], v[160:175]
    ds_read_b64_tr_b16 v[200:201], v232 offset:24576
    ds_read_b64_tr_b16 v[202:203], v232 offset:25088
    v_mfma_f32_32x32x16_bf16 v[176:191], v[212:215], v[56:59], v[176:191]
    ds_read_b64_tr_b16 v[204:205], v232 offset:28672
    ds_read_b64_tr_b16 v[206:207], v232 offset:29184
    s_waitcnt lgkmcnt(4)
    v_mfma_f32_32x32x16_bf16 v[160:175], v[192:195], v[60:63], v[160:175]
    ds_read_b64_tr_b16 v[208:209], v232 offset:25600
    ds_read_b64_tr_b16 v[210:211], v232 offset:26112
    v_mfma_f32_32x32x16_bf16 v[176:191], v[196:199], v[60:63], v[176:191]
    ds_read_b64_tr_b16 v[212:213], v232 offset:29696
    ds_read_b64_tr_b16 v[214:215], v232 offset:30208
    s_waitcnt lgkmcnt(4)
    v_mfma_f32_32x32x16_bf16 v[160:175], v[200:203], v[64:67], v[160:175]
    ds_read_b64_tr_b16 v[192:193], v232 offset:26624
    ds_read_b64_tr_b16 v[194:195], v232 offset:27136
    v_mfma_f32_32x32x16_bf16 v[176:191], v[204:207], v[64:67], v[176:191]
    ds_read_b64_tr_b16 v[196:197], v232 offset:30720
    ds_read_b64_tr_b16 v[198:199], v232 offset:31232
    s_waitcnt lgkmcnt(4)
    v_mfma_f32_32x32x16_bf16 v[160:175], v[208:211], v[68:71], v[160:175]
    ds_read_b64_tr_b16 v[200:201], v232 offset:27648
    ds_read_b64_tr_b16 v[202:203], v232 offset:28160
    v_mfma_f32_32x32x16_bf16 v[176:191], v[212:215], v[68:71], v[176:191]
    ds_read_b64_tr_b16 v[204:205], v232 offset:31744
    ds_read_b64_tr_b16 v[206:207], v232 offset:32256
    s_waitcnt lgkmcnt(4)
    v_mfma_f32_32x32x16_bf16 v[160:175], v[192:195], v[72:75], v[160:175]
    ds_read_b64_tr_b16 v[208:209], v232 offset:32768
    ds_read_b64_tr_b16 v[210:211], v232 offset:33280
    v_mfma_f32_32x32x16_bf16 v[176:191], v[196:199], v[72:75], v[176:191]
    ds_read_b64_tr_b16 v[212:213], v232 offset:36864
    ds_read_b64_tr_b16 v[214:215], v232 offset:37376
    s_waitcnt lgkmcnt(4)
    v_mfma_f32_32x32x16_bf16 v[160:175], v[200:203], v[76:79], v[160:175]
    ds_read_b64_tr_b16 v[192:193], v232 offset:33792
    ds_read_b64_tr_b16 v[194:195], v232 offset:34304
    v_mfma_f32_32x32x16_bf16 v[176:191], v[204:207], v[76:79], v[176:191]
    ds_read_b64_tr_b16 v[196:197], v232 offset:37888
    ds_read_b64_tr_b16 v[198:199], v232 offset:38400
    s_waitcnt lgkmcnt(4)
    v_mfma_f32_32x32x16_bf16 v[160:175], v[208:211], v[80:83], v[160:175]
    ds_read_b64_tr_b16 v[200:201], v232 offset:34816
    ds_read_b64_tr_b16 v[202:203], v232 offset:35328
    v_mfma_f32_32x32x16_bf16 v[176:191], v[212:215], v[80:83], v[176:191]
    ds_read_b64_tr_b16 v[204:205], v232 offset:38912
    ds_read_b64_tr_b16 v[206:207], v232 offset:39424
    s_waitcnt lgkmcnt(4)
    v_mfma_f32_32x32x16_bf16 v[160:175], v[192:195], v[84:87], v[160:175]
    ds_read_b64_tr_b16 v[208:209], v232 offset:35840
    ds_read_b64_tr_b16 v[210:211], v232 offset:36352
    v_mfma_f32_32x32x16_bf16 v[176:191], v[196:199], v[84:87], v[176:191]
    ds_read_b64_tr_b16 v[212:213], v232 offset:39936
    ds_read_b64_tr_b16 v[214:215], v232 offset:40448
    s_waitcnt lgkmcnt(4)
    v_mfma_f32_32x32x16_bf16 v[160:175], v[200:203], v[88:91], v[160:175]
    ds_read_b64_tr_b16 v[192:193], v9 offset:0
    ds_read_b64_tr_b16 v[194:195], v9 offset:512
    v_mfma_f32_32x32x16_bf16 v[176:191], v[204:207], v[88:91], v[176:191]
    ds_read_b64_tr_b16 v[196:197], v9 offset:4096
    ds_read_b64_tr_b16 v[198:199], v9 offset:4608
    s_waitcnt lgkmcnt(4)
    s_barrier
    v_mfma_f32_32x32x16_bf16 v[160:175], v[208:211], v[92:95], v[160:175]
    ds_read_b64_tr_b16 v[200:201], v9 offset:1024
    s_add_u32 s77, s71, 0
    ds_read_b64_tr_b16 v[202:203], v9 offset:1536
    v_mfma_f32_32x32x16_bf16 v[176:191], v[212:215], v[92:95], v[176:191]
    ds_read_b64_tr_b16 v[204:205], v9 offset:5120
    buffer_load_dwordx4 v[16:19], v2, s[16:19], s77 offen offset:0 sc1
    ds_read_b64_tr_b16 v[206:207], v9 offset:5632
    s_waitcnt lgkmcnt(4)
    v_mfma_f32_32x32x16_bf16 v[160:175], v[192:195], v[96:99], v[160:175]
    ds_read_b64_tr_b16 v[208:209], v9 offset:2048
    buffer_load_dwordx4 v[20:23], v2, s[16:19], s77 offen offset:1024 sc1
    ds_read_b64_tr_b16 v[210:211], v9 offset:2560
    v_mfma_f32_32x32x16_bf16 v[176:191], v[196:199], v[96:99], v[176:191]
    ds_read_b64_tr_b16 v[212:213], v9 offset:6144
    ds_read_b64_tr_b16 v[214:215], v9 offset:6656
    s_waitcnt lgkmcnt(4)
    v_mfma_f32_32x32x16_bf16 v[160:175], v[200:203], v[100:103], v[160:175]
    ds_read_b64_tr_b16 v[192:193], v9 offset:3072
    buffer_load_dwordx4 v[24:27], v2, s[16:19], s77 offen offset:2048 sc1
    ds_read_b64_tr_b16 v[194:195], v9 offset:3584
    v_mfma_f32_32x32x16_bf16 v[176:191], v[204:207], v[100:103], v[176:191]
    ds_read_b64_tr_b16 v[196:197], v9 offset:7168
    ds_read_b64_tr_b16 v[198:199], v9 offset:7680
    s_waitcnt lgkmcnt(4)
    v_mfma_f32_32x32x16_bf16 v[160:175], v[208:211], v[104:107], v[160:175]
    ds_read_b64_tr_b16 v[200:201], v9 offset:8192
    buffer_load_dwordx4 v[28:31], v2, s[16:19], s77 offen offset:3072 sc1
    ds_read_b64_tr_b16 v[202:203], v9 offset:8704
    v_mfma_f32_32x32x16_bf16 v[176:191], v[212:215], v[104:107], v[176:191]
    ds_read_b64_tr_b16 v[204:205], v9 offset:12288
    ds_read_b64_tr_b16 v[206:207], v9 offset:12800
    s_waitcnt lgkmcnt(4)
    v_mfma_f32_32x32x16_bf16 v[160:175], v[192:195], v[108:111], v[160:175]
    ds_read_b64_tr_b16 v[208:209], v9 offset:9216
    s_add_u32 s77, s71, 4096
    ds_read_b64_tr_b16 v[210:211], v9 offset:9728
    v_mfma_f32_32x32x16_bf16 v[176:191], v[196:199], v[108:111], v[176:191]
    ds_read_b64_tr_b16 v[212:213], v9 offset:13312
    buffer_load_dwordx4 v[32:35], v2, s[16:19], s77 offen offset:0 sc1
    ds_read_b64_tr_b16 v[214:215], v9 offset:13824
    s_waitcnt lgkmcnt(4)
    v_mfma_f32_32x32x16_bf16 v[160:175], v[200:203], v[112:115], v[160:175]
    ds_read_b64_tr_b16 v[192:193], v9 offset:10240
    buffer_load_dwordx4 v[36:39], v2, s[16:19], s77 offen offset:1024 sc1
    ds_read_b64_tr_b16 v[194:195], v9 offset:10752
    v_mfma_f32_32x32x16_bf16 v[176:191], v[204:207], v[112:115], v[176:191]
    ds_read_b64_tr_b16 v[196:197], v9 offset:14336
    ds_read_b64_tr_b16 v[198:199], v9 offset:14848
    s_waitcnt lgkmcnt(4)
    v_mfma_f32_32x32x16_bf16 v[160:175], v[208:211], v[116:119], v[160:175]
    ds_read_b64_tr_b16 v[200:201], v9 offset:11264
    buffer_load_dwordx4 v[40:43], v2, s[16:19], s77 offen offset:2048 sc1
    ds_read_b64_tr_b16 v[202:203], v9 offset:11776
    v_mfma_f32_32x32x16_bf16 v[176:191], v[212:215], v[116:119], v[176:191]
    ds_read_b64_tr_b16 v[204:205], v9 offset:15360
    ds_read_b64_tr_b16 v[206:207], v9 offset:15872
    s_waitcnt lgkmcnt(4)
    v_mfma_f32_32x32x16_bf16 v[160:175], v[192:195], v[120:123], v[160:175]
    buffer_load_dwordx4 v[44:47], v2, s[16:19], s77 offen offset:3072 sc1
    v_mfma_f32_32x32x16_bf16 v[176:191], v[196:199], v[120:123], v[176:191]
    s_waitcnt lgkmcnt(0)
    v_mfma_f32_32x32x16_bf16 v[160:175], v[200:203], v[124:127], v[160:175]
    s_add_u32 s77, s71, 8192
    v_mfma_f32_32x32x16_bf16 v[176:191], v[204:207], v[124:127], v[176:191]
    buffer_load_dwordx4 v[48:51], v2, s[16:19], s77 offen offset:0 sc1
    v_mfma_f32_32x32x16_bf16 v[160:175], v[224:227], v[12:15], v[160:175]
    v_mfma_f32_32x32x16_bf16 v[176:191], v[228:231], v[12:15], v[176:191]
    s_sub_u32 s70, s70, 100352
    v_add_u32 v208, s4, v232
    v_add_u32 v209, s5, v232
    v_add_u32 v210, s6, v232
    v_add_u32 v211, s7, v232
    ds_read_b64_tr_b16 v[192:193], v208 offset:0
    ds_read_b64_tr_b16 v[194:195], v208 offset:512
    ds_read_b64_tr_b16 v[196:197], v208 offset:1024
    ds_read_b64_tr_b16 v[198:199], v208 offset:1536
    ds_read_b64_tr_b16 v[200:201], v208 offset:2048
    ds_read_b64_tr_b16 v[202:203], v208 offset:2560
    ds_read_b64_tr_b16 v[204:205], v208 offset:3072
    ds_read_b64_tr_b16 v[206:207], v208 offset:3584
    s_waitcnt vmcnt(7)
    v_xor_b32 v16, s21, v16
    v_xor_b32 v19, s21, v19
    v_or_b32 v5, v16, v19
    v_xor_b32 v20, s21, v20
    v_xor_b32 v23, s21, v23
    v_or3_b32 v5, v20, v23, v5
    v_and_b32 v5, 0x80008000, v5
    v_cmp_ne_u32 vcc, 0, v5
    s_nop 0
    s_cbranch_vccnz L_mk_rt_252
L_mk_bk_253:
    s_barrier
    s_waitcnt lgkmcnt(4)
    v_mfma_f32_32x32x16_bf16 v[128:143], v[192:195], v[16:19], 0
    ds_read_b64_tr_b16 v[216:217], v208 offset:4096
    v_mul_f32 v160, v160, |v160|
    ds_read_b64_tr_b16 v[218:219], v208 offset:4608
    v_mul_f32 v161, v161, |v161|
    v_mul_f32 v162, v162, |v162|
    v_mul_f32 v163, v163, |v163|
    v_mul_f32 v164, v164, |v164|
    v_mul_f32 v165, v165, |v165|
    v_mul_f32 v166, v166, |v166|
    v_mul_f32 v167, v167, |v167|
    v_cvt_pk_bf16_f32 v160, v160, v161
    v_cvt_pk_bf16_f32 v161, v162, v163
    v_cvt_pk_bf16_f32 v162, v164, v165
    v_cvt_pk_bf16_f32 v163, v166, v167
    v_perm_b32 v164, v160, v160, s87
    v_perm_b32 v165, v161, v161, s87
    v_mfma_f32_32x32x16_bf16 v[144:159], v[196:199], v[16:19], 0
    ds_read_b64_tr_b16 v[220:221], v208 offset:5120
    v_perm_b32 v166, v162, v162, s87
    ds_read_b64_tr_b16 v[222:223], v208 offset:5632
    v_perm_b32 v167, v163, v163, s87
    v_bitop3_b32 v160, v160, v164, s21 bitop3:0x9a
    v_bitop3_b32 v161, v161, v165, 0 bitop3:0x9a
    v_bitop3_b32 v162, v162, v166, 0 bitop3:0x9a
    v_bitop3_b32 v163, v163, v167, s21 bitop3:0x9a
    buffer_store_dwordx4 v[160:163], v2, s[16:19], s70 offen sc1
    s_add_u32 s70, s70, 28672
    v_mul_f32 v168, v168, |v168|
    v_mul_f32 v169, v169, |v169|
    v_mul_f32 v170, v170, |v170|
    v_mul_f32 v171, v171, |v171|
    buffer_load_dwordx4 v[52:55], v2, s[16:19], s77 offen offset:1024 sc1
    s_waitcnt lgkmcnt(4)
    v_mfma_f32_32x32x16_bf16 v[128:143], v[200:203], v[20:23], v[128:143]
    ds_read_b64_tr_b16 v[192:193], v208 offset:6144
    v_mul_f32 v172, v172, |v172|
    ds_read_b64_tr_b16 v[194:195], v208 offset:6656
    v_mul_f32 v173, v173, |v173|
    v_mul_f32 v174, v174, |v174|
    v_mul_f32 v175, v175, |v175|
    v_cvt_pk_bf16_f32 v168, v168, v169
    v_cvt_pk_bf16_f32 v169, v170, v171
    v_cvt_pk_bf16_f32 v170, v172, v173
    v_cvt_pk_bf16_f32 v171, v174, v175
    v_perm_b32 v172, v168, v168, s87
    v_perm_b32 v173, v169, v169, s87
    v_perm_b32 v174, v170, v170, s87
    v_perm_b32 v175, v171, v171, s87
    v_bitop3_b32 v168, v168, v172, s21 bitop3:0x9a
    v_bitop3_b32 v169, v169, v173, 0 bitop3:0x9a
    v_bitop3_b32 v170, v170, v174, 0 bitop3:0x9a
    v_bitop3_b32 v171, v171, v175, s21 bitop3:0x9a
    buffer_store_dwordx4 v[168:171], v2, s[16:19], s70 offen sc1
    s_add_u32 s70, s70, 28672
    v_mul_f32 v176, v176, |v176|
    v_mfma_f32_32x32x16_bf16 v[144:159], v[204:207], v[20:23], v[144:159]
    ds_read_b64_tr_b16 v[196:197], v208 offset:7168
    v_mul_f32 v177, v177, |v177|
    ds_read_b64_tr_b16 v[198:199], v208 offset:7680
    v_mul_f32 v178, v178, |v178|
    v_mul_f32 v179, v179, |v179|
    v_mul_f32 v180, v180, |v180|
    v_mul_f32 v181, v181, |v181|
    v_mul_f32 v182, v182, |v182|
    v_mul_f32 v183, v183, |v183|
    buffer_load_dwordx4 v[56:59], v2, s[16:19], s77 offen offset:2048 sc1
    s_waitcnt vmcnt(9)
    v_xor_b32 v24, s21, v24
    v_xor_b32 v27, s21, v27
    v_or_b32 v5, v24, v27
    v_xor_b32 v28, s21, v28
    v_xor_b32 v31, s21, v31
    v_or3_b32 v5, v28, v31, v5
    v_and_b32 v5, 0x80008000, v5
    v_cmp_ne_u32 vcc, 0, v5
    s_nop 0
    s_cbranch_vccnz L_mk_rt_254
L_mk_bk_255:
    s_waitcnt lgkmcnt(4)
    v_mfma_f32_32x32x16_bf16 v[128:143], v[216:219], v[24:27], v[128:143]
    ds_read_b64_tr_b16 v[200:201], v208 offset:8192
    v_cvt_pk_bf16_f32 v176, v176, v177
    ds_read_b64_tr_b16 v[202:203], v208 offset:8704
    v_cvt_pk_bf16_f32 v177, v178, v179
    v_cvt_pk_bf16_f32 v178, v180, v181
    v_cvt_pk_bf16_f32 v179, v182, v183
    v_perm_b32 v180, v176, v176, s87
    v_perm_b32 v181, v177, v177, s87
    v_perm_b32 v182, v178, v178, s87
    v_perm_b32 v183, v179, v179, s87
    v_bitop3_b32 v176, v176, v180, s21 bitop3:0x9a
    v_bitop3_b32 v177, v177, v181, 0 bitop3:0x9a
    v_bitop3_b32 v178, v178, v182, 0 bitop3:0x9a
    v_bitop3_b32 v179, v179, v183, s21 bitop3:0x9a
    buffer_store_dwordx4 v[176:179], v2, s[16:19], s70 offen sc1
    s_add_u32 s70, s70, 28672
    v_mfma_f32_32x32x16_bf16 v[144:159], v[220:223], v[24:27], v[144:159]
    ds_read_b64_tr_b16 v[204:205], v208 offset:9216
    v_mul_f32 v184, v184, |v184|
    ds_read_b64_tr_b16 v[206:207], v208 offset:9728
    v_mul_f32 v185, v185, |v185|
    v_mul_f32 v186, v186, |v186|
    v_mul_f32 v187, v187, |v187|
    v_mul_f32 v188, v188, |v188|
    v_mul_f32 v189, v189, |v189|
    v_mul_f32 v190, v190, |v190|
    v_mul_f32 v191, v191, |v191|
    v_cvt_pk_bf16_f32 v184, v184, v185
    v_cvt_pk_bf16_f32 v185, v186, v187
    v_cvt_pk_bf16_f32 v186, v188, v189
    v_cvt_pk_bf16_f32 v187, v190, v191
    buffer_load_dwordx4 v[60:63], v2, s[16:19], s77 offen offset:3072 sc1
    s_waitcnt lgkmcnt(4)
    v_mfma_f32_32x32x16_bf16 v[128:143], v[192:195], v[28:31], v[128:143]
    ds_read_b64_tr_b16 v[216:217], v209 offset:0
    v_perm_b32 v188, v184, v184, s87
    ds_read_b64_tr_b16 v[218:219], v209 offset:512
    v_perm_b32 v189, v185, v185, s87
    v_perm_b32 v190, v186, v186, s87
    v_perm_b32 v191, v187, v187, s87
    v_bitop3_b32 v184, v184, v188, s21 bitop3:0x9a
    v_bitop3_b32 v185, v185, v189, 0 bitop3:0x9a
    v_bitop3_b32 v186, v186, v190, 0 bitop3:0x9a
    v_bitop3_b32 v187, v187, v191, s21 bitop3:0x9a
    buffer_store_dwordx4 v[184:187], v2, s[16:19], s70 offen sc1
    s_add_u32 s70, s70, 28672
    s_add_u32 s77, s71, 12288
    v_mfma_f32_32x32x16_bf16 v[144:159], v[196:199], v[28:31], v[144:159]
    ds_read_b64_tr_b16 v[220:221], v209 offset:1024
    buffer_load_dwordx4 v[64:67], v2, s[16:19], s77 offen offset:0 sc1
    ds_read_b64_tr_b16 v[222:223], v209 offset:1536
    s_waitcnt vmcnt(11)
    v_xor_b32 v32, s21, v32
    v_xor_b32 v35, s21, v35
    v_or_b32 v5, v32, v35
    v_xor_b32 v36, s21, v36
    v_xor_b32 v39, s21, v39
    v_or3_b32 v5, v36, v39, v5
    v_and_b32 v5, 0x80008000, v5
    v_cmp_ne_u32 vcc, 0, v5
    s_nop 0
    s_cbranch_vccnz L_mk_rt_256
L_mk_bk_257:
    s_waitcnt lgkmcnt(4)
    v_mfma_f32_32x32x16_bf16 v[128:143], v[200:203], v[32:35], v[128:143]
    ds_read_b64_tr_b16 v[192:193], v209 offset:2048
    buffer_load_dwordx4 v[68:71], v2, s[16:19], s77 offen offset:1024 sc1
    ds_read_b64_tr_b16 v[194:195], v209 offset:2560
    v_mfma_f32_32x32x16_bf16 v[144:159], v[204:207], v[32:35], v[144:159]
    ds_read_b64_tr_b16 v[196:197], v209 offset:3072
    ds_read_b64_tr_b16 v[198:199], v209 offset:3584
    s_waitcnt lgkmcnt(4)
    v_mfma_f32_32x32x16_bf16 v[128:143], v[216:219], v[36:39], v[128:143]
    ds_read_b64_tr_b16 v[200:201], v209 offset:4096
    s_waitcnt vmcnt(10)
    ds_read_b64_tr_b16 v[202:203], v209 offset:4608
    v_xor_b32 v40, s21, v40
    v_xor_b32 v43, s21, v43
    v_or_b32 v5, v40, v43
    v_xor_b32 v44, s21, v44
    v_mfma_f32_32x32x16_bf16 v[144:159], v[220:223], v[36:39], v[144:159]
    ds_read_b64_tr_b16 v[204:205], v209 offset:5120
    v_xor_b32 v47, s21, v47
    ds_read_b64_tr_b16 v[206:207], v209 offset:5632
    v_or3_b32 v5, v44, v47, v5
    v_and_b32 v5, 0x80008000, v5
    v_cmp_ne_u32 vcc, 0, v5
    s_nop 0
    s_cbranch_vccnz L_mk_rt_258
L_mk_bk_259:
    s_waitcnt lgkmcnt(4)
    v_mfma_f32_32x32x16_bf16 v[128:143], v[192:195], v[40:43], v[128:143]
    ds_read_b64_tr_b16 v[216:217], v209 offset:6144
    ds_read_b64_tr_b16 v[218:219], v209 offset:6656
    v_mfma_f32_32x32x16_bf16 v[144:159], v[196:199], v[40:43], v[144:159]
    ds_read_b64_tr_b16 v[220:221], v209 offset:7168
    ds_read_b64_tr_b16 v[222:223], v209 offset:7680
    s_waitcnt lgkmcnt(4)
    v_mfma_f32_32x32x16_bf16 v[128:143], v[200:203], v[44:47], v[128:143]
    ds_read_b64_tr_b16 v[192:193], v209 offset:8192
    s_waitcnt vmcnt(7)
    ds_read_b64_tr_b16 v[194:195], v209 offset:8704
    v_xor_b32 v48, s21, v48
    v_xor_b32 v51, s21, v51
    v_or_b32 v5, v48, v51
    v_xor_b32 v52, s21, v52
    v_mfma_f32_32x32x16_bf16 v[144:159], v[204:207], v[44:47], v[144:159]
    ds_read_b64_tr_b16 v[196:197], v209 offset:9216
    v_xor_b32 v55, s21, v55
    ds_read_b64_tr_b16 v[198:199], v209 offset:9728
    v_or3_b32 v5, v52, v55, v5
    v_and_b32 v5, 0x80008000, v5
    v_cmp_ne_u32 vcc, 0, v5
    s_nop 0
    s_cbranch_vccnz L_mk_rt_260
L_mk_bk_261:
    s_waitcnt lgkmcnt(4)
    v_mfma_f32_32x32x16_bf16 v[128:143], v[216:219], v[48:51], v[128:143]
    ds_read_b64_tr_b16 v[200:201], v209 offset:10240
    ds_read_b64_tr_b16 v[202:203], v209 offset:10752
    v_mfma_f32_32x32x16_bf16 v[144:159], v[220:223], v[48:51], v[144:159]
    ds_read_b64_tr_b16 v[204:205], v209 offset:11264
    ds_read_b64_tr_b16 v[206:207], v209 offset:11776
    s_waitcnt lgkmcnt(4)
    s_barrier
    v_mfma_f32_32x32x16_bf16 v[128:143], v[192:195], v[52:55], v[128:143]
    ds_read_b64_tr_b16 v[216:217], v209 offset:12288
    s_add_u32 s77, s71, 14336
    ds_read_b64_tr_b16 v[218:219], v209 offset:12800
    buffer_load_dwordx4 v[72:75], v2, s[16:19], s77 offen offset:0 sc1
    s_waitcnt vmcnt(4)
    v_xor_b32 v56, s21, v56
    v_xor_b32 v59, s21, v59
    v_or_b32 v5, v56, v59
    v_mfma_f32_32x32x16_bf16 v[144:159], v[196:199], v[52:55], v[144:159]
    ds_read_b64_tr_b16 v[220:221], v209 offset:13312
    v_xor_b32 v60, s21, v60
    ds_read_b64_tr_b16 v[222:223], v209 offset:13824
    v_xor_b32 v63, s21, v63
    v_or3_b32 v5, v60, v63, v5
    v_and_b32 v5, 0x80008000, v5
    v_cmp_ne_u32 vcc, 0, v5
    s_nop 0
    s_cbranch_vccnz L_mk_rt_262
L_mk_bk_263:
    s_waitcnt lgkmcnt(4)
    v_mfma_f32_32x32x16_bf16 v[128:143], v[200:203], v[56:59], v[128:143]
    ds_read_b64_tr_b16 v[192:193], v210 offset:0
    buffer_load_dwordx4 v[76:79], v2, s[16:19], s77 offen offset:1024 sc1
    ds_read_b64_tr_b16 v[194:195], v210 offset:512
    v_mfma_f32_32x32x16_bf16 v[144:159], v[204:207], v[56:59], v[144:159]
    ds_read_b64_tr_b16 v[196:197], v210 offset:1024
    ds_read_b64_tr_b16 v[198:199], v210 offset:1536
    s_waitcnt lgkmcnt(4)
    v_mfma_f32_32x32x16_bf16 v[128:143], v[216:219], v[60:63], v[128:143]
    ds_read_b64_tr_b16 v[200:201], v210 offset:2048
    buffer_load_dwordx4 v[80:83], v2, s[16:19], s77 offen offset:2048 sc1
    ds_read_b64_tr_b16 v[202:203], v210 offset:2560
    s_waitcnt vmcnt(3)
    v_xor_b32 v64, s21, v64
    v_xor_b32 v67, s21, v67
    v_or_b32 v5, v64, v67
    v_xor_b32 v68, s21, v68
    v_mfma_f32_32x32x16_bf16 v[144:159], v[220:223], v[60:63], v[144:159]
    ds_read_b64_tr_b16 v[204:205], v210 offset:3072
    v_xor_b32 v71, s21, v71
    ds_read_b64_tr_b16 v[206:207], v210 offset:3584
    v_or3_b32 v5, v68, v71, v5
    v_and_b32 v5, 0x80008000, v5
    v_cmp_ne_u32 vcc, 0, v5
    s_nop 0
    s_cbranch_vccnz L_mk_rt_264
L_mk_bk_265:
    s_waitcnt lgkmcnt(4)
    v_mfma_f32_32x32x16_bf16 v[128:143], v[192:195], v[64:67], v[128:143]
    ds_read_b64_tr_b16 v[216:217], v210 offset:4096
    buffer_load_dwordx4 v[84:87], v2, s[16:19], s77 offen offset:3072 sc1
    ds_read_b64_tr_b16 v[218:219], v210 offset:4608
    v_mfma_f32_32x32x16_bf16 v[144:159], v[196:199], v[64:67], v[144:159]
    ds_read_b64_tr_b16 v[220:221], v210 offset:5120
    ds_read_b64_tr_b16 v[222:223], v210 offset:5632
    s_waitcnt lgkmcnt(4)
    v_mfma_f32_32x32x16_bf16 v[128:143], v[200:203], v[68:71], v[128:143]
    ds_read_b64_tr_b16 v[192:193], v210 offset:6144
    s_add_u32 s77, s71, 18432
    ds_read_b64_tr_b16 v[194:195], v210 offset:6656
    buffer_load_dwordx4 v[88:91], v2, s[16:19], s77 offen offset:0 sc1
    s_waitcnt vmcnt(3)
    v_xor_b32 v72, s21, v72
    v_xor_b32 v75, s21, v75
    v_or_b32 v5, v72, v75
    v_mfma_f32_32x32x16_bf16 v[144:159], v[204:207], v[68:71], v[144:159]
    ds_read_b64_tr_b16 v[196:197], v210 offset:7168
    v_xor_b32 v76, s21, v76
    ds_read_b64_tr_b16 v[198:199], v210 offset:7680
    v_xor_b32 v79, s21, v79
    v_or3_b32 v5, v76, v79, v5
    v_and_b32 v5, 0x80008000, v5
    v_cmp_ne_u32 vcc, 0, v5
    s_nop 0
    s_cbranch_vccnz L_mk_rt_266
L_mk_bk_267:
    s_waitcnt lgkmcnt(4)
    v_mfma_f32_32x32x16_bf16 v[128:143], v[216:219], v[72:75], v[128:143]
    ds_read_b64_tr_b16 v[200:201], v210 offset:8192
    buffer_load_dwordx4 v[92:95], v2, s[16:19], s77 offen offset:1024 sc1
    ds_read_b64_tr_b16 v[202:203], v210 offset:8704
    v_mfma_f32_32x32x16_bf16 v[144:159], v[220:223], v[72:75], v[144:159]
    ds_read_b64_tr_b16 v[204:205], v210 offset:9216
    ds_read_b64_tr_b16 v[206:207], v210 offset:9728
    s_waitcnt lgkmcnt(4)
    v_mfma_f32_32x32x16_bf16 v[128:143], v[192:195], v[76:79], v[128:143]
    ds_read_b64_tr_b16 v[216:217], v211 offset:0
    buffer_load_dwordx4 v[96:99], v2, s[16:19], s77 offen offset:2048 sc1
    ds_read_b64_tr_b16 v[218:219], v211 offset:512
    s_waitcnt vmcnt(3)
    v_xor_b32 v80, s21, v80
    v_xor_b32 v83, s21, v83
    v_or_b32 v5, v80, v83
    v_xor_b32 v84, s21, v84
    v_mfma_f32_32x32x16_bf16 v[144:159], v[196:199], v[76:79], v[144:159]
    ds_read_b64_tr_b16 v[220:221], v211 offset:1024
    v_xor_b32 v87, s21, v87
    ds_read_b64_tr_b16 v[222:223], v211 offset:1536
    v_or3_b32 v5, v84, v87, v5
    v_and_b32 v5, 0x80008000, v5
    v_cmp_ne_u32 vcc, 0, v5
    s_nop 0
    s_cbranch_vccnz L_mk_rt_268
L_mk_bk_269:
    s_waitcnt lgkmcnt(4)
    v_mfma_f32_32x32x16_bf16 v[128:143], v[200:203], v[80:83], v[128:143]
    ds_read_b64_tr_b16 v[192:193], v211 offset:2048
    buffer_load_dwordx4 v[100:103], v2, s[16:19], s77 offen offset:3072 sc1
    ds_read_b64_tr_b16 v[194:195], v211 offset:2560
    v_mfma_f32_32x32x16_bf16 v[144:159], v[204:207], v[80:83], v[144:159]
    ds_read_b64_tr_b16 v[196:197], v211 offset:3072
    ds_read_b64_tr_b16 v[198:199], v211 offset:3584
    s_waitcnt lgkmcnt(4)
    s_barrier
    v_mfma_f32_32x32x16_bf16 v[128:143], v[216:219], v[84:87], v[128:143]
    ds_read_b64_tr_b16 v[200:201], v208 offset:0
    s_add_u32 s77, s71, 22528
    ds_read_b64_tr_b16 v[202:203], v208 offset:512
    buffer_load_dwordx4 v[104:107], v2, s[16:19], s77 offen offset:0 sc1
    s_waitcnt vmcnt(3)
    v_xor_b32 v88, s21, v88
    v_xor_b32 v91, s21, v91
    v_or_b32 v5, v88, v91
    v_mfma_f32_32x32x16_bf16 v[144:159], v[220:223], v[84:87], v[144:159]
    ds_read_b64_tr_b16 v[204:205], v208 offset:1024
    v_xor_b32 v92, s21, v92
    ds_read_b64_tr_b16 v[206:207], v208 offset:1536
    v_xor_b32 v95, s21, v95
    v_or3_b32 v5, v92, v95, v5
    v_and_b32 v5, 0x80008000, v5
    v_cmp_ne_u32 vcc, 0, v5
    s_nop 0
    s_cbranch_vccnz L_mk_rt_270
L_mk_bk_271:
    s_waitcnt lgkmcnt(4)
    v_mfma_f32_32x32x16_bf16 v[128:143], v[192:195], v[88:91], v[128:143]
    ds_read_b64_tr_b16 v[216:217], v208 offset:2048
    buffer_load_dwordx4 v[108:111], v2, s[16:19], s77 offen offset:1024 sc1
    ds_read_b64_tr_b16 v[218:219], v208 offset:2560
    v_mfma_f32_32x32x16_bf16 v[144:159], v[196:199], v[88:91], v[144:159]
    ds_read_b64_tr_b16 v[220:221], v208 offset:3072
    ds_read_b64_tr_b16 v[222:223], v208 offset:3584
    s_waitcnt lgkmcnt(4)
    v_mfma_f32_32x32x16_bf16 v[128:143], v[200:203], v[92:95], v[128:143]
    ds_read_b64_tr_b16 v[192:193], v208 offset:4096
    buffer_load_dwordx4 v[112:115], v2, s[16:19], s77 offen offset:2048 sc1
    ds_read_b64_tr_b16 v[194:195], v208 offset:4608
    s_waitcnt vmcnt(3)
    v_xor_b32 v96, s21, v96
    v_xor_b32 v99, s21, v99
    v_or_b32 v5, v96, v99
    v_xor_b32 v100, s21, v100
    v_mfma_f32_32x32x16_bf16 v[144:159], v[204:207], v[92:95], v[144:159]
    ds_read_b64_tr_b16 v[196:197], v208 offset:5120
    v_xor_b32 v103, s21, v103
    ds_read_b64_tr_b16 v[198:199], v208 offset:5632
    v_or3_b32 v5, v100, v103, v5
    v_and_b32 v5, 0x80008000, v5
    v_cmp_ne_u32 vcc, 0, v5
    s_nop 0
    s_cbranch_vccnz L_mk_rt_272
L_mk_bk_273:
    s_waitcnt lgkmcnt(4)
    v_mfma_f32_32x32x16_bf16 v[128:143], v[216:219], v[96:99], v[128:143]
    ds_read_b64_tr_b16 v[200:201], v208 offset:6144
    buffer_load_dwordx4 v[116:119], v2, s[16:19], s77 offen offset:3072 sc1
    ds_read_b64_tr_b16 v[202:203], v208 offset:6656
    v_mfma_f32_32x32x16_bf16 v[144:159], v[220:223], v[96:99], v[144:159]
    ds_read_b64_tr_b16 v[204:205], v208 offset:7168
    ds_read_b64_tr_b16 v[206:207], v208 offset:7680
    s_waitcnt lgkmcnt(4)
    s_barrier
    v_mfma_f32_32x32x16_bf16 v[128:143], v[192:195], v[100:103], v[128:143]
    ds_read_b64_tr_b16 v[216:217], v208 offset:8192
    s_add_u32 s77, s71, 26624
    ds_read_b64_tr_b16 v[218:219], v208 offset:8704
    buffer_load_dwordx4 v[120:123], v2, s[16:19], s77 offen offset:0 sc1
    s_waitcnt vmcnt(3)
    v_xor_b32 v104, s21, v104
    v_xor_b32 v107, s21, v107
    v_or_b32 v5, v104, v107
    v_mfma_f32_32x32x16_bf16 v[144:159], v[196:199], v[100:103], v[144:159]
    ds_read_b64_tr_b16 v[220:221], v208 offset:9216
    v_xor_b32 v108, s21, v108
    ds_read_b64_tr_b16 v[222:223], v208 offset:9728
    v_xor_b32 v111, s21, v111
    v_or3_b32 v5, v108, v111, v5
    v_and_b32 v5, 0x80008000, v5
    v_cmp_ne_u32 vcc, 0, v5
    s_nop 0
    s_cbranch_vccnz L_mk_rt_274
L_mk_bk_275:
    s_waitcnt lgkmcnt(4)
    v_mfma_f32_32x32x16_bf16 v[128:143], v[200:203], v[104:107], v[128:143]
    ds_read_b64_tr_b16 v[192:193], v209 offset:0
    buffer_load_dwordx4 v[124:127], v2, s[16:19], s77 offen offset:1024 sc1
    ds_read_b64_tr_b16 v[194:195], v209 offset:512
    s_and_b32 s70, s59, 1
    s_lshl_b32 s70, s70, 8
    s_lshl_b32 s76, s56, 7
    s_add_u32 s70, s70, s76
    s_add_u32 s70, s70, 162304
    v_mfma_f32_32x32x16_bf16 v[144:159], v[204:207], v[104:107], v[144:159]
    ds_read_b64_tr_b16 v[196:197], v209 offset:1024
    v_lshl_add_u32 v8, v4, 2, s70
    ds_read_b64_tr_b16 v[198:199], v209 offset:1536
    s_lshl_b32 s70, s59, 1
    s_add_u32 s70, s70, s56
    s_lshl_b32 s70, s70, 5
    v_add_u32 v12, s70, v4
    s_waitcnt lgkmcnt(4)
    v_mfma_f32_32x32x16_bf16 v[128:143], v[216:219], v[108:111], v[128:143]
    ds_read_b64_tr_b16 v[200:201], v209 offset:2048
    s_waitcnt vmcnt(2)
    ds_read_b64_tr_b16 v[202:203], v209 offset:2560
    v_xor_b32 v112, s21, v112
    v_xor_b32 v115, s21, v115
    v_or_b32 v5, v112, v115
    v_xor_b32 v116, s21, v116
    v_xor_b32 v119, s21, v119
    v_or3_b32 v5, v116, v119, v5
    v_and_b32 v5, 0x80008000, v5
    v_cmp_ne_u32 vcc, 0, v5
    s_nop 0
    s_cbranch_vccnz L_mk_rt_276
L_mk_bk_277:
    v_mfma_f32_32x32x16_bf16 v[144:159], v[220:223], v[108:111], v[144:159]
    ds_read_b64_tr_b16 v[204:205], v209 offset:3072
    v_mul_u32_u24 v12, 896, v12
    ds_read_b64_tr_b16 v[206:207], v209 offset:3584
    v_lshl_add_u32 v12, v3, 4, v12
    s_lshl_b32 s70, s58, 7
    s_lshl_b32 s76, s55, 5
    s_add_u32 s70, s70, s76
    v_lshlrev_b32 v10, 16, v248
    v_lshlrev_b32 v11, 16, v240
    v_add_f32 v16, v10, v11
    v_and_b32 v10, 0xffff0000, v248
    v_and_b32 v11, 0xffff0000, v240
    s_waitcnt lgkmcnt(4)
    v_mfma_f32_32x32x16_bf16 v[128:143], v[192:195], v[112:115], v[128:143]
    ds_read_b64_tr_b16 v[216:217], v209 offset:4096
    v_add_f32 v17, v10, v11
    ds_read_b64_tr_b16 v[218:219], v209 offset:4608
    v_lshlrev_b32 v10, 16, v249
    v_lshlrev_b32 v11, 16, v241
    v_add_f32 v18, v10, v11
    v_and_b32 v10, 0xffff0000, v249
    v_mfma_f32_32x32x16_bf16 v[144:159], v[196:199], v[112:115], v[144:159]
    ds_read_b64_tr_b16 v[220:221], v209 offset:5120
    v_and_b32 v11, 0xffff0000, v241
    ds_read_b64_tr_b16 v[222:223], v209 offset:5632
    v_add_f32 v19, v10, v11
    v_lshlrev_b32 v10, 16, v250
    v_lshlrev_b32 v11, 16, v242
    v_add_f32 v20, v10, v11
    s_waitcnt lgkmcnt(4)
    v_mfma_f32_32x32x16_bf16 v[128:143], v[200:203], v[116:119], v[128:143]
    ds_read_b64_tr_b16 v[192:193], v209 offset:6144
    s_waitcnt vmcnt(0)
    ds_read_b64_tr_b16 v[194:195], v209 offset:6656
    v_xor_b32 v120, s21, v120
    ds_read_b64_tr_b16 v[196:197], v209 offset:7168
    v_xor_b32 v123, s21, v123
    ds_read_b64_tr_b16 v[198:199], v209 offset:7680
    v_or_b32 v5, v120, v123
    v_xor_b32 v124, s21, v124
    v_xor_b32 v127, s21, v127
    v_or3_b32 v5, v124, v127, v5
    v_and_b32 v5, 0x80008000, v5
    v_cmp_ne_u32 vcc, 0, v5
    s_nop 0
    s_cbranch_vccnz L_mk_rt_278
L_mk_bk_279:
    v_and_b32 v10, 0xffff0000, v250
    v_and_b32 v11, 0xffff0000, v242
    v_add_f32 v21, v10, v11
    v_lshlrev_b32 v10, 16, v251
    v_lshlrev_b32 v11, 16, v243
    v_add_f32 v22, v10, v11
    v_and_b32 v10, 0xffff0000, v251
    v_and_b32 v11, 0xffff0000, v243
    v_add_f32 v23, v10, v11
    s_waitcnt lgkmcnt(4)
    v_mfma_f32_32x32x16_bf16 v[128:143], v[216:219], v[120:123], v[128:143]
    ds_read_b32 v9, v8
    s_waitcnt lgkmcnt(0)
    v_mfma_f32_32x32x16_bf16 v[128:143], v[192:195], v[124:127], v[128:143]
    s_mul_i32 s68, s56, 24576
    v_add_u32 v5, s68, v2
    s_mul_i32 s68, s56, 86016
    s_add_u32 s68, s68, 12288
    v_add_u32 v6, s68, v2
    s_branch L_mk_f2e_212
L_mk_help_211:
    s_add_u32 m0, s72, 40960
    s_mov_b32 s68, 917504
    buffer_load_dwordx4 v234, s[28:31], s68 offen lds
    s_add_u32 m0, s72, 44992
    s_nop 0
    buffer_load_dwordx4 v234, s[28:31], s68 offen offset:64 lds
    s_add_u32 m0, s72, 49152
    s_mov_b32 s68, 1146880
    buffer_load_dwordx4 v234, s[28:31], s68 offen lds
    s_add_u32 m0, s72, 53184
    s_nop 0
    buffer_load_dwordx4 v234, s[28:31], s68 offen offset:64 lds
    s_add_u32 m0, s72, 57344
    s_mov_b32 s68, 1376256
    buffer_load_dwordx4 v234, s[28:31], s68 offen lds
    s_add_u32 m0, s72, 61376
    s_nop 0
    buffer_load_dwordx4 v234, s[28:31], s68 offen offset:64 lds
    s_add_u32 m0, s72, 0
    s_mov_b32 s68, 128
    buffer_load_dwordx4 v234, s[28:31], s68 offen lds
    s_add_u32 m0, s72, 4032
    s_nop 0
    buffer_load_dwordx4 v234, s[28:31], s68 offen offset:64 lds
    s_add_u32 m0, s72, 8192
    s_mov_b32 s68, 229504
    buffer_load_dwordx4 v234, s[28:31], s68 offen lds
    s_add_u32 m0, s72, 12224
    s_nop 0
    buffer_load_dwordx4 v234, s[28:31], s68 offen offset:64 lds
    s_add_u32 m0, s72, 16384
    s_mov_b32 s68, 458880
    buffer_load_dwordx4 v234, s[28:31], s68 offen lds
    s_add_u32 m0, s72, 20416
    s_nop 0
    buffer_load_dwordx4 v234, s[28:31], s68 offen offset:64 lds
    s_add_u32 m0, s72, 24576
    s_mov_b32 s68, 688256
    buffer_load_dwordx4 v234, s[28:31], s68 offen lds
    s_add_u32 m0, s72, 28608
    s_nop 0
    buffer_load_dwordx4 v234, s[28:31], s68 offen offset:64 lds
    s_add_u32 m0, s72, 32768
    s_mov_b32 s68, 917632
    buffer_load_dwordx4 v234, s[28:31], s68 offen lds
    s_add_u32 m0, s72, 36800
    s_nop 0
    buffer_load_dwordx4 v234, s[28:31], s68 offen offset:64 lds
    s_mov_b32 s68, 1147008
    buffer_load_dwordx4 v[16:19], v234, s[28:31], s68 offen offset:0
    buffer_load_dwordx4 v[20:23], v234, s[28:31], s68 offen offset:64
    s_mov_b32 s68, 1376384
    buffer_load_dwordx4 v[24:27], v234, s[28:31], s68 offen offset:0
    buffer_load_dwordx4 v[28:31], v234, s[28:31], s68 offen offset:64
    s_add_u32 s68, s73, 0
    buffer_load_dwordx4 v[32:35], v235, s[32:35], s68 offen offset:0
    buffer_load_dwordx4 v[36:39], v235, s[32:35], s68 offen offset:64
    s_add_u32 s68, s73, 114688
    buffer_load_dwordx4 v[40:43], v235, s[32:35], s68 offen offset:0
    buffer_load_dwordx4 v[44:47], v235, s[32:35], s68 offen offset:64
    s_add_u32 s68, s73, 229376
    buffer_load_dwordx4 v[48:51], v235, s[32:35], s68 offen offset:0
    buffer_load_dwordx4 v[52:55], v235, s[32:35], s68 offen offset:64
    s_add_u32 s68, s73, 344064
    buffer_load_dwordx4 v[56:59], v235, s[32:35], s68 offen offset:0
    buffer_load_dwordx4 v[60:63], v235, s[32:35], s68 offen offset:64
    s_add_u32 s68, s73, 458752
    buffer_load_dwordx4 v[64:67], v235, s[32:35], s68 offen offset:0
    buffer_load_dwordx4 v[68:71], v235, s[32:35], s68 offen offset:64
    s_add_u32 s68, s73, 1376256
    buffer_load_dwordx4 v[72:75], v235, s[32:35], s68 offen offset:0
    buffer_load_dwordx4 v[76:79], v235, s[32:35], s68 offen offset:64
    s_add_u32 s68, s73, 1490944
    buffer_load_dwordx4 v[80:83], v235, s[32:35], s68 offen offset:0
    buffer_load_dwordx4 v[84:87], v235, s[32:35], s68 offen offset:64
    s_add_u32 s68, s73, 57344
    buffer_load_dwordx4 v[88:91], v235, s[32:35], s68 offen offset:0
    buffer_load_dwordx4 v[92:95], v235, s[32:35], s68 offen offset:64
    s_add_u32 s68, s73, 172032
    buffer_load_dwordx4 v[96:99], v235, s[32:35], s68 offen offset:0
    buffer_load_dwordx4 v[100:103], v235, s[32:35], s68 offen offset:64
    s_add_u32 s68, s73, 286720
    buffer_load_dwordx4 v[104:107], v235, s[32:35], s68 offen offset:0
    buffer_load_dwordx4 v[108:111], v235, s[32:35], s68 offen offset:64
    s_add_u32 s68, s73, 401408
    buffer_load_dwordx4 v[112:115], v235, s[32:35], s68 offen offset:0
    buffer_load_dwordx4 v[116:119], v235, s[32:35], s68 offen offset:64
    s_add_u32 s68, s73, 516096
    buffer_load_dwordx4 v[120:123], v235, s[32:35], s68 offen offset:0
    buffer_load_dwordx4 v[124:127], v235, s[32:35], s68 offen offset:64
    v_add_u32 v212, s4, v2
    v_add_u32 v213, s5, v2
    v_add_u32 v214, s6, v2
    v_add_u32 v215, s7, v2
    s_add_u32 s68, s72, 98304
    v_add_u32 v9, s68, v2
    s_and_b32 s70, s59, 1
    s_lshl_b32 s70, s70, 1
    s_add_u32 s70, s70, s56
    s_mul_i32 s70, s70, 28
    s_lshl_b32 s68, s58, 2
    s_add_u32 s70, s70, s68
    s_add_u32 s70, s70, s55
    s_lshl_b32 s70, s70, 10
    s_add_u32 s70, s70, s62
    v_lshlrev_b32 v192, 16, v244
    v_and_b32 v193, 0xffff0000, v244
    v_lshlrev_b32 v194, 16, v245
    v_and_b32 v195, 0xffff0000, v245
    v_lshlrev_b32 v196, 16, v246
    v_and_b32 v197, 0xffff0000, v246
    v_lshlrev_b32 v198, 16, v247
    v_and_b32 v199, 0xffff0000, v247
    s_lshl_b32 s68, s55, 13
    s_add_u32 s68, s68, 98304
    v_add_u32 v7, s68, v2
    s_waitcnt vmcnt(28)
    s_barrier
    ds_read_b128 v[128:131], v7 offset:0
    ds_read_b128 v[132:135], v7 offset:1024
    ds_read_b128 v[136:139], v7 offset:2048
    ds_read_b128 v[140:143], v7 offset:3072
    ds_read_b128 v[144:147], v7 offset:4096
    ds_read_b128 v[148:151], v7 offset:5120
    ds_read_b128 v[152:155], v7 offset:6144
    ds_read_b128 v[156:159], v7 offset:7168
    s_waitcnt lgkmcnt(4)
    v_add_f32 v128, v128, v136
    v_add_f32 v129, v129, v137
    v_add_f32 v130, v130, v138
    v_add_f32 v131, v131, v139
    v_add_f32 v132, v132, v140
    v_add_f32 v133, v133, v141
    v_add_f32 v134, v134, v142
    v_add_f32 v135, v135, v143
    s_waitcnt lgkmcnt(0)
    v_add_f32 v144, v144, v152
    v_add_f32 v145, v145, v153
    v_add_f32 v146, v146, v154
    v_add_f32 v147, v147, v155
    v_add_f32 v148, v148, v156
    v_add_f32 v149, v149, v157
    v_add_f32 v150, v150, v158
    v_add_f32 v151, v151, v159
    v_add_f32 v128, v128, v144
    v_add_f32 v129, v129, v145
    v_add_f32 v130, v130, v146
    v_add_f32 v131, v131, v147
    v_add_f32 v132, v132, v148
    v_add_f32 v133, v133, v149
    v_add_f32 v134, v134, v150
    v_add_f32 v135, v135, v151
    v_cvt_pk_bf16_f32 v136, v128, v129
    v_cvt_pk_bf16_f32 v137, v130, v131
    v_cvt_pk_bf16_f32 v138, v132, v133
    v_cvt_pk_bf16_f32 v139, v134, v135
    v_lshlrev_b32 v128, 16, v136
    v_and_b32 v129, 0xffff0000, v136
    v_lshlrev_b32 v130, 16, v137
    v_and_b32 v131, 0xffff0000, v137
    v_lshlrev_b32 v132, 16, v138
    v_and_b32 v133, 0xffff0000, v138
    v_lshlrev_b32 v134, 16, v139
    v_and_b32 v135, 0xffff0000, v139
    v_add_f32 v128, v128, v192
    v_add_f32 v129, v129, v193
    v_add_f32 v130, v130, v194
    v_add_f32 v131, v131, v195
    v_add_f32 v132, v132, v196
    v_add_f32 v133, v133, v197
    v_add_f32 v134, v134, v198
    v_add_f32 v135, v135, v199
    v_cvt_pk_bf16_f32 v240, v128, v129
    v_cvt_pk_bf16_f32 v241, v130, v131
    v_cvt_pk_bf16_f32 v242, v132, v133
    v_cvt_pk_bf16_f32 v243, v134, v135
    buffer_store_dwordx4 v[240:243], v2, s[16:19], s70 offen sc1
    v_lshlrev_b32 v128, 16, v240
    v_and_b32 v129, 0xffff0000, v240
    v_lshlrev_b32 v130, 16, v241
    v_and_b32 v131, 0xffff0000, v241
    v_lshlrev_b32 v132, 16, v242
    v_and_b32 v133, 0xffff0000, v242
    v_lshlrev_b32 v134, 16, v243
    v_and_b32 v135, 0xffff0000, v243
    v_add_f32 v10, v128, v129
    v_mul_f32 v11, v128, v128
    v_fma_f32 v11, v129, v129, v11
    v_add_f32 v10, v10, v130
    v_fma_f32 v11, v130, v130, v11
    v_add_f32 v10, v10, v131
    v_fma_f32 v11, v131, v131, v11
    v_add_f32 v10, v10, v132
    v_fma_f32 v11, v132, v132, v11
    v_add_f32 v10, v10, v133
    v_fma_f32 v11, v133, v133, v11
    v_add_f32 v10, v10, v134
    v_fma_f32 v11, v134, v134, v11
    v_add_f32 v10, v10, v135
    v_fma_f32 v11, v135, v135, v11
    v_mov_b32 v12, v10
    v_mov_b32 v13, v11
    s_lshl_b32 s70, s56, 10
    s_lshl_b32 s71, s55, 3
    s_add_u32 s70, s70, s71
    s_add_u32 s70, s70, 159744
    v_permlane32_swap_b32 v10, v12
    v_permlane32_swap_b32 v11, v13
    v_lshl_add_u32 v5, v4, 5, s70
    v_add_f32 v12, v10, v12
    v_add_f32 v13, v11, v13
    ds_write_b64 v5, v[12:13]
    s_waitcnt lgkmcnt(0)
    s_barrier
    s_cmp_lg_u32 s54, 4
    s_cbranch_scc1 L_mk_p4_280
    v_lshlrev_b32 v5, 3, v1
    v_lshlrev_b32 v7, 5, v1
    v_add_u32 v7, 159744, v7
    ds_read_b128 v[128:131], v7
    ds_read_b128 v[132:135], v7 offset:16
    s_and_b32 s70, s59, 1
    s_mul_i32 s70, s70, 7
    s_add_u32 s70, s70, s58
    s_lshl_b32 s70, s70, 9
    s_add_u32 s70, s70, s62
    s_add_u32 s70, s70, 114688
    s_waitcnt lgkmcnt(0)
    v_add_f32 v128, v128, v130
    v_add_f32 v129, v129, v131
    v_add_f32 v132, v132, v134
    v_add_f32 v133, v133, v135
    v_add_f32 v10, v128, v132
    v_add_f32 v11, v129, v133
    buffer_store_dwordx2 v[10:11], v5, s[16:19], s70 offen sc1
L_mk_p4_280:
    s_waitcnt vmcnt(15)
    ds_write_b128 v9, v[16:19] offset:0
    ds_write_b128 v9, v[20:23] offset:4096
    ds_write_b128 v9, v[24:27] offset:8192
    ds_write_b128 v9, v[28:31] offset:12288
    ds_write_b128 v212, v[32:35] offset:0
    ds_write_b128 v212, v[36:39] offset:1024
    ds_write_b128 v212, v[40:43] offset:2048
    ds_write_b128 v212, v[44:47] offset:3072
    ds_write_b128 v212, v[48:51] offset:4096
    ds_write_b128 v212, v[52:55] offset:5120
    s_waitcnt lgkmcnt(0)
    ds_write_b128 v212, v[56:59] offset:6144
    ds_write_b128 v212, v[60:63] offset:7168
    ds_write_b128 v212, v[64:67] offset:8192
    ds_write_b128 v212, v[68:71] offset:9216
    s_waitcnt lgkmcnt(0)
    s_barrier
    s_add_u32 m0, s5, 0
    s_add_u32 s68, s73, 573440
    buffer_load_dwordx4 v235, s[32:35], s68 offen lds
    s_add_u32 m0, s5, 960
    s_nop 0
    buffer_load_dwordx4 v235, s[32:35], s68 offen offset:64 lds
    s_add_u32 m0, s5, 2048
    s_add_u32 s68, s73, 688128
    buffer_load_dwordx4 v235, s[32:35], s68 offen lds
    s_add_u32 m0, s5, 3008
    s_nop 0
    buffer_load_dwordx4 v235, s[32:35], s68 offen offset:64 lds
    s_add_u32 m0, s5, 4096
    s_add_u32 s68, s73, 802816
    buffer_load_dwordx4 v235, s[32:35], s68 offen lds
    s_add_u32 m0, s5, 5056
    s_nop 0
    buffer_load_dwordx4 v235, s[32:35], s68 offen offset:64 lds
    s_add_u32 m0, s5, 6144
    s_add_u32 s68, s73, 917504
    buffer_load_dwordx4 v235, s[32:35], s68 offen lds
    s_add_u32 m0, s5, 7104
    s_nop 0
    buffer_load_dwordx4 v235, s[32:35], s68 offen offset:64 lds
    s_add_u32 m0, s5, 8192
    s_add_u32 s68, s73, 1032192
    buffer_load_dwordx4 v235, s[32:35], s68 offen lds
    s_add_u32 m0, s5, 9152
    s_nop 0
    buffer_load_dwordx4 v235, s[32:35], s68 offen offset:64 lds
    s_add_u32 m0, s5, 10240
    s_add_u32 s68, s73, 1146880
    buffer_load_dwordx4 v235, s[32:35], s68 offen lds
    s_add_u32 m0, s5, 11200
    s_nop 0
    buffer_load_dwordx4 v235, s[32:35], s68 offen offset:64 lds
    s_add_u32 m0, s5, 12288
    s_add_u32 s68, s73, 1261568
    buffer_load_dwordx4 v235, s[32:35], s68 offen lds
    s_add_u32 m0, s5, 13248
    s_nop 0
    buffer_load_dwordx4 v235, s[32:35], s68 offen offset:64 lds
    s_and_b32 s71, s59, 1
    s_lshl_b32 s71, s71, 1
    s_add_u32 s71, s71, s56
    s_lshl_b32 s71, s71, 2
    s_add_u32 s71, s71, s55
    s_mul_i32 s71, s71, 28672
    s_add_u32 s71, s71, s62
    s_add_u32 s71, s71, 131072
    s_waitcnt vmcnt(14)
    s_barrier
    s_add_u32 s77, s71, 0
    buffer_load_dwordx4 v[16:19], v2, s[16:19], s77 offen offset:0 sc1
    ds_write_b128 v214, v[72:75] offset:0
    ds_write_b128 v214, v[76:79] offset:1024
    buffer_load_dwordx4 v[20:23], v2, s[16:19], s77 offen offset:1024 sc1
    ds_write_b128 v214, v[80:83] offset:2048
    ds_write_b128 v214, v[84:87] offset:3072
    buffer_load_dwordx4 v[24:27], v2, s[16:19], s77 offen offset:2048 sc1
    ds_write_b128 v214, v[88:91] offset:4096
    ds_write_b128 v214, v[92:95] offset:5120
    buffer_load_dwordx4 v[28:31], v2, s[16:19], s77 offen offset:3072 sc1
    ds_write_b128 v214, v[96:99] offset:6144
    ds_write_b128 v214, v[100:103] offset:7168
    s_add_u32 s77, s71, 4096
    buffer_load_dwordx4 v[32:35], v2, s[16:19], s77 offen offset:0 sc1
    ds_write_b128 v214, v[104:107] offset:8192
    ds_write_b128 v214, v[108:111] offset:9216
    buffer_load_dwordx4 v[36:39], v2, s[16:19], s77 offen offset:1024 sc1
    buffer_load_dwordx4 v[40:43], v2, s[16:19], s77 offen offset:2048 sc1
    buffer_load_dwordx4 v[44:47], v2, s[16:19], s77 offen offset:3072 sc1
    s_waitcnt lgkmcnt(0)
    v_add_u32 v208, s4, v232
    v_add_u32 v209, s5, v232
    v_add_u32 v210, s6, v232
    v_add_u32 v211, s7, v232
    ds_read_b64_tr_b16 v[192:193], v208 offset:0
    ds_read_b64_tr_b16 v[194:195], v208 offset:512
    ds_read_b64_tr_b16 v[196:197], v208 offset:1024
    ds_read_b64_tr_b16 v[198:199], v208 offset:1536
    ds_read_b64_tr_b16 v[200:201], v208 offset:2048
    ds_read_b64_tr_b16 v[202:203], v208 offset:2560
    ds_read_b64_tr_b16 v[204:205], v208 offset:3072
    ds_read_b64_tr_b16 v[206:207], v208 offset:3584
    s_waitcnt vmcnt(6)
    v_xor_b32 v16, s21, v16
    v_xor_b32 v19, s21, v19
    v_or_b32 v5, v16, v19
    v_xor_b32 v20, s21, v20
    v_xor_b32 v23, s21, v23
    v_or3_b32 v5, v20, v23, v5
    v_and_b32 v5, 0x80008000, v5
    v_cmp_ne_u32 vcc, 0, v5
    s_nop 0
    s_cbranch_vccnz L_mk_rt_281
L_mk_bk_282:
    s_barrier
    s_waitcnt lgkmcnt(4)
    v_mfma_f32_32x32x16_bf16 v[128:143], v[192:195], v[16:19], 0
    ds_write_b128 v215, v[112:115] offset:0
    s_add_u32 s77, s71, 8192
    ds_read_b64_tr_b16 v[216:217], v208 offset:4096
    ds_read_b64_tr_b16 v[218:219], v208 offset:4608
    v_mfma_f32_32x32x16_bf16 v[144:159], v[196:199], v[16:19], 0
    ds_read_b64_tr_b16 v[220:221], v208 offset:5120
    buffer_load_dwordx4 v[48:51], v2, s[16:19], s77 offen offset:0 sc1
    ds_read_b64_tr_b16 v[222:223], v208 offset:5632
    s_waitcnt lgkmcnt(5)
    v_mfma_f32_32x32x16_bf16 v[128:143], v[200:203], v[20:23], v[128:143]
    ds_write_b128 v215, v[116:119] offset:1024
    buffer_load_dwordx4 v[52:55], v2, s[16:19], s77 offen offset:1024 sc1
    ds_read_b64_tr_b16 v[192:193], v208 offset:6144
    s_waitcnt vmcnt(6)
    ds_read_b64_tr_b16 v[194:195], v208 offset:6656
    v_xor_b32 v24, s21, v24
    v_xor_b32 v27, s21, v27
    v_or_b32 v5, v24, v27
    v_xor_b32 v28, s21, v28
    v_mfma_f32_32x32x16_bf16 v[144:159], v[204:207], v[20:23], v[144:159]
    ds_read_b64_tr_b16 v[196:197], v208 offset:7168
    v_xor_b32 v31, s21, v31
    ds_read_b64_tr_b16 v[198:199], v208 offset:7680
    v_or3_b32 v5, v28, v31, v5
    v_and_b32 v5, 0x80008000, v5
    v_cmp_ne_u32 vcc, 0, v5
    s_nop 0
    s_cbranch_vccnz L_mk_rt_283
L_mk_bk_284:
    s_waitcnt lgkmcnt(5)
    v_mfma_f32_32x32x16_bf16 v[128:143], v[216:219], v[24:27], v[128:143]
    ds_write_b128 v215, v[120:123] offset:2048
    buffer_load_dwordx4 v[56:59], v2, s[16:19], s77 offen offset:2048 sc1
    ds_read_b64_tr_b16 v[200:201], v208 offset:8192
    ds_read_b64_tr_b16 v[202:203], v208 offset:8704
    v_mfma_f32_32x32x16_bf16 v[144:159], v[220:223], v[24:27], v[144:159]
    ds_read_b64_tr_b16 v[204:205], v208 offset:9216
    ds_read_b64_tr_b16 v[206:207], v208 offset:9728
    s_waitcnt lgkmcnt(5)
    v_mfma_f32_32x32x16_bf16 v[128:143], v[192:195], v[28:31], v[128:143]
    ds_write_b128 v215, v[124:127] offset:3072
    buffer_load_dwordx4 v[60:63], v2, s[16:19], s77 offen offset:3072 sc1
    ds_read_b64_tr_b16 v[216:217], v209 offset:0
    s_waitcnt vmcnt(6)
    ds_read_b64_tr_b16 v[218:219], v209 offset:512
    v_xor_b32 v32, s21, v32
    v_xor_b32 v35, s21, v35
    v_or_b32 v5, v32, v35
    v_xor_b32 v36, s21, v36
    v_mfma_f32_32x32x16_bf16 v[144:159], v[196:199], v[28:31], v[144:159]
    ds_read_b64_tr_b16 v[220:221], v209 offset:1024
    v_xor_b32 v39, s21, v39
    ds_read_b64_tr_b16 v[222:223], v209 offset:1536
    v_or3_b32 v5, v36, v39, v5
    v_and_b32 v5, 0x80008000, v5
    v_cmp_ne_u32 vcc, 0, v5
    s_nop 0
    s_cbranch_vccnz L_mk_rt_285
L_mk_bk_286:
    s_waitcnt lgkmcnt(5)
    v_mfma_f32_32x32x16_bf16 v[128:143], v[200:203], v[32:35], v[128:143]
    ds_read_b64_tr_b16 v[192:193], v209 offset:2048
    s_add_u32 s77, s71, 12288
    ds_read_b64_tr_b16 v[194:195], v209 offset:2560
    v_mfma_f32_32x32x16_bf16 v[144:159], v[204:207], v[32:35], v[144:159]
    ds_read_b64_tr_b16 v[196:197], v209 offset:3072
    buffer_load_dwordx4 v[64:67], v2, s[16:19], s77 offen offset:0 sc1
    ds_read_b64_tr_b16 v[198:199], v209 offset:3584
    s_waitcnt lgkmcnt(4)
    v_mfma_f32_32x32x16_bf16 v[128:143], v[216:219], v[36:39], v[128:143]
    ds_read_b64_tr_b16 v[200:201], v209 offset:4096
    buffer_load_dwordx4 v[68:71], v2, s[16:19], s77 offen offset:1024 sc1
    ds_read_b64_tr_b16 v[202:203], v209 offset:4608
    s_waitcnt vmcnt(6)
    v_xor_b32 v40, s21, v40
    v_xor_b32 v43, s21, v43
    v_or_b32 v5, v40, v43
    v_xor_b32 v44, s21, v44
    v_mfma_f32_32x32x16_bf16 v[144:159], v[220:223], v[36:39], v[144:159]
    ds_read_b64_tr_b16 v[204:205], v209 offset:5120
    v_xor_b32 v47, s21, v47
    ds_read_b64_tr_b16 v[206:207], v209 offset:5632
    v_or3_b32 v5, v44, v47, v5
    v_and_b32 v5, 0x80008000, v5
    v_cmp_ne_u32 vcc, 0, v5
    s_nop 0
    s_cbranch_vccnz L_mk_rt_287
L_mk_bk_288:
    s_waitcnt lgkmcnt(4)
    v_mfma_f32_32x32x16_bf16 v[128:143], v[192:195], v[40:43], v[128:143]
    ds_read_b64_tr_b16 v[216:217], v209 offset:6144
    ds_read_b64_tr_b16 v[218:219], v209 offset:6656
    v_mfma_f32_32x32x16_bf16 v[144:159], v[196:199], v[40:43], v[144:159]
    ds_read_b64_tr_b16 v[220:221], v209 offset:7168
    ds_read_b64_tr_b16 v[222:223], v209 offset:7680
    s_waitcnt lgkmcnt(4)
    v_mfma_f32_32x32x16_bf16 v[128:143], v[200:203], v[44:47], v[128:143]
    ds_read_b64_tr_b16 v[192:193], v209 offset:8192
    s_waitcnt vmcnt(4)
    ds_read_b64_tr_b16 v[194:195], v209 offset:8704
    v_xor_b32 v48, s21, v48
    v_xor_b32 v51, s21, v51
    v_or_b32 v5, v48, v51
    v_xor_b32 v52, s21, v52
    v_mfma_f32_32x32x16_bf16 v[144:159], v[204:207], v[44:47], v[144:159]
    ds_read_b64_tr_b16 v[196:197], v209 offset:9216
    v_xor_b32 v55, s21, v55
    ds_read_b64_tr_b16 v[198:199], v209 offset:9728
    v_or3_b32 v5, v52, v55, v5
    v_and_b32 v5, 0x80008000, v5
    v_cmp_ne_u32 vcc, 0, v5
    s_nop 0
    s_cbranch_vccnz L_mk_rt_289
L_mk_bk_290:
    s_waitcnt lgkmcnt(4)
    v_mfma_f32_32x32x16_bf16 v[128:143], v[216:219], v[48:51], v[128:143]
    ds_read_b64_tr_b16 v[200:201], v209 offset:10240
    ds_read_b64_tr_b16 v[202:203], v209 offset:10752
    v_mfma_f32_32x32x16_bf16 v[144:159], v[220:223], v[48:51], v[144:159]
    ds_read_b64_tr_b16 v[204:205], v209 offset:11264
    ds_read_b64_tr_b16 v[206:207], v209 offset:11776
    s_waitcnt lgkmcnt(4)
    s_barrier
    v_mfma_f32_32x32x16_bf16 v[128:143], v[192:195], v[52:55], v[128:143]
    ds_write_b128 v212, v[160:163] offset:8192
    s_add_u32 m0, s4, 0
    ds_read_b64_tr_b16 v[216:217], v209 offset:12288
    s_add_u32 s68, s73, 630784
    ds_read_b64_tr_b16 v[218:219], v209 offset:12800
    buffer_load_dwordx4 v235, s[32:35], s68 offen lds
    s_add_u32 m0, s4, 960
    s_nop 0
    buffer_load_dwordx4 v235, s[32:35], s68 offen offset:64 lds
    s_add_u32 s77, s71, 14336
    buffer_load_dwordx4 v[72:75], v2, s[16:19], s77 offen offset:0 sc1
    s_waitcnt vmcnt(5)
    v_xor_b32 v56, s21, v56
    v_mfma_f32_32x32x16_bf16 v[144:159], v[196:199], v[52:55], v[144:159]
    ds_read_b64_tr_b16 v[220:221], v209 offset:13312
    v_xor_b32 v59, s21, v59
    ds_read_b64_tr_b16 v[222:223], v209 offset:13824
    v_or_b32 v5, v56, v59
    v_xor_b32 v60, s21, v60
    v_xor_b32 v63, s21, v63
    v_or3_b32 v5, v60, v63, v5
    v_and_b32 v5, 0x80008000, v5
    v_cmp_ne_u32 vcc, 0, v5
    s_nop 0
    s_cbranch_vccnz L_mk_rt_291
L_mk_bk_292:
    s_waitcnt lgkmcnt(5)
    v_mfma_f32_32x32x16_bf16 v[128:143], v[200:203], v[56:59], v[128:143]
    ds_write_b128 v212, v[164:167] offset:9216
    s_add_u32 m0, s4, 2048
    ds_read_b64_tr_b16 v[192:193], v210 offset:0
    s_add_u32 s68, s73, 745472
    ds_read_b64_tr_b16 v[194:195], v210 offset:512
    buffer_load_dwordx4 v235, s[32:35], s68 offen lds
    v_mfma_f32_32x32x16_bf16 v[144:159], v[204:207], v[56:59], v[144:159]
    ds_read_b64_tr_b16 v[196:197], v210 offset:1024
    s_add_u32 m0, s4, 3008
    ds_read_b64_tr_b16 v[198:199], v210 offset:1536
    buffer_load_dwordx4 v235, s[32:35], s68 offen offset:64 lds
    buffer_load_dwordx4 v[76:79], v2, s[16:19], s77 offen offset:1024 sc1
    s_waitcnt lgkmcnt(5)
    v_mfma_f32_32x32x16_bf16 v[128:143], v[216:219], v[60:63], v[128:143]
    ds_write_b128 v213, v[168:171] offset:0
    s_add_u32 m0, s4, 4096
    ds_read_b64_tr_b16 v[200:201], v210 offset:2048
    s_add_u32 s68, s73, 860160
    ds_read_b64_tr_b16 v[202:203], v210 offset:2560
    buffer_load_dwordx4 v235, s[32:35], s68 offen lds
    s_add_u32 m0, s4, 5056
    s_nop 0
    buffer_load_dwordx4 v235, s[32:35], s68 offen offset:64 lds
    buffer_load_dwordx4 v[80:83], v2, s[16:19], s77 offen offset:2048 sc1
    s_waitcnt vmcnt(9)
    v_xor_b32 v64, s21, v64
    v_mfma_f32_32x32x16_bf16 v[144:159], v[220:223], v[60:63], v[144:159]
    ds_read_b64_tr_b16 v[204:205], v210 offset:3072
    v_xor_b32 v67, s21, v67
    ds_read_b64_tr_b16 v[206:207], v210 offset:3584
    v_or_b32 v5, v64, v67
    v_xor_b32 v68, s21, v68
    v_xor_b32 v71, s21, v71
    v_or3_b32 v5, v68, v71, v5
    v_and_b32 v5, 0x80008000, v5
    v_cmp_ne_u32 vcc, 0, v5
    s_nop 0
    s_cbranch_vccnz L_mk_rt_293
L_mk_bk_294:
    s_waitcnt lgkmcnt(5)
    v_mfma_f32_32x32x16_bf16 v[128:143], v[192:195], v[64:67], v[128:143]
    ds_write_b128 v213, v[172:175] offset:1024
    s_add_u32 m0, s4, 6144
    ds_read_b64_tr_b16 v[216:217], v210 offset:4096
    s_add_u32 s68, s73, 974848
    ds_read_b64_tr_b16 v[218:219], v210 offset:4608
    buffer_load_dwordx4 v235, s[32:35], s68 offen lds
    v_mfma_f32_32x32x16_bf16 v[144:159], v[196:199], v[64:67], v[144:159]
    ds_read_b64_tr_b16 v[220:221], v210 offset:5120
    s_add_u32 m0, s4, 7104
    ds_read_b64_tr_b16 v[222:223], v210 offset:5632
    buffer_load_dwordx4 v235, s[32:35], s68 offen offset:64 lds
    buffer_load_dwordx4 v[84:87], v2, s[16:19], s77 offen offset:3072 sc1
    s_waitcnt lgkmcnt(5)
    v_mfma_f32_32x32x16_bf16 v[128:143], v[200:203], v[68:71], v[128:143]
    ds_write_b128 v213, v[176:179] offset:2048
    s_add_u32 s77, s71, 18432
    ds_read_b64_tr_b16 v[192:193], v210 offset:6144
    buffer_load_dwordx4 v[88:91], v2, s[16:19], s77 offen offset:0 sc1
    ds_read_b64_tr_b16 v[194:195], v210 offset:6656
    s_waitcnt vmcnt(7)
    v_xor_b32 v72, s21, v72
    v_xor_b32 v75, s21, v75
    v_or_b32 v5, v72, v75
    v_mfma_f32_32x32x16_bf16 v[144:159], v[204:207], v[68:71], v[144:159]
    ds_read_b64_tr_b16 v[196:197], v210 offset:7168
    v_xor_b32 v76, s21, v76
    ds_read_b64_tr_b16 v[198:199], v210 offset:7680
    v_xor_b32 v79, s21, v79
    v_or3_b32 v5, v76, v79, v5
    v_and_b32 v5, 0x80008000, v5
    v_cmp_ne_u32 vcc, 0, v5
    s_nop 0
    s_cbranch_vccnz L_mk_rt_295
L_mk_bk_296:
    s_waitcnt lgkmcnt(5)
    v_mfma_f32_32x32x16_bf16 v[128:143], v[216:219], v[72:75], v[128:143]
    ds_write_b128 v213, v[180:183] offset:3072
    buffer_load_dwordx4 v[92:95], v2, s[16:19], s77 offen offset:1024 sc1
    ds_read_b64_tr_b16 v[200:201], v210 offset:8192
    ds_read_b64_tr_b16 v[202:203], v210 offset:8704
    v_mfma_f32_32x32x16_bf16 v[144:159], v[220:223], v[72:75], v[144:159]
    ds_read_b64_tr_b16 v[204:205], v210 offset:9216
    ds_read_b64_tr_b16 v[206:207], v210 offset:9728
    s_waitcnt lgkmcnt(5)
    v_mfma_f32_32x32x16_bf16 v[128:143], v[192:195], v[76:79], v[128:143]
    ds_write_b128 v213, v[184:187] offset:4096
    buffer_load_dwordx4 v[96:99], v2, s[16:19], s77 offen offset:2048 sc1
    ds_read_b64_tr_b16 v[216:217], v211 offset:0
    s_waitcnt vmcnt(3)
    ds_read_b64_tr_b16 v[218:219], v211 offset:512
    v_xor_b32 v80, s21, v80
    v_xor_b32 v83, s21, v83
    v_or_b32 v5, v80, v83
    v_xor_b32 v84, s21, v84
    v_mfma_f32_32x32x16_bf16 v[144:159], v[196:199], v[76:79], v[144:159]
    ds_read_b64_tr_b16 v[220:221], v211 offset:1024
    v_xor_b32 v87, s21, v87
    ds_read_b64_tr_b16 v[222:223], v211 offset:1536
    v_or3_b32 v5, v84, v87, v5
    v_and_b32 v5, 0x80008000, v5
    v_cmp_ne_u32 vcc, 0, v5
    s_nop 0
    s_cbranch_vccnz L_mk_rt_297
L_mk_bk_298:
    s_waitcnt lgkmcnt(5)
    v_mfma_f32_32x32x16_bf16 v[128:143], v[200:203], v[80:83], v[128:143]
    ds_write_b128 v213, v[188:191] offset:5120
    buffer_load_dwordx4 v[100:103], v2, s[16:19], s77 offen offset:3072 sc1
    ds_read_b64_tr_b16 v[192:193], v211 offset:2048
    ds_read_b64_tr_b16 v[194:195], v211 offset:2560
    v_mfma_f32_32x32x16_bf16 v[144:159], v[204:207], v[80:83], v[144:159]
    ds_read_b64_tr_b16 v[196:197], v211 offset:3072
    ds_read_b64_tr_b16 v[198:199], v211 offset:3584
    s_waitcnt lgkmcnt(5)
    s_waitcnt vmcnt(5)
    s_barrier
    v_mfma_f32_32x32x16_bf16 v[128:143], v[216:219], v[84:87], v[128:143]
    ds_write_b128 v213, v[224:227] offset:6144
    s_add_u32 s77, s71, 22528
    ds_read_b64_tr_b16 v[200:201], v208 offset:0
    buffer_load_dwordx4 v[104:107], v2, s[16:19], s77 offen offset:0 sc1
    ds_read_b64_tr_b16 v[202:203], v208 offset:512
    s_waitcnt vmcnt(3)
    v_xor_b32 v88, s21, v88
    v_xor_b32 v91, s21, v91
    v_or_b32 v5, v88, v91
    v_mfma_f32_32x32x16_bf16 v[144:159], v[220:223], v[84:87], v[144:159]
    ds_read_b64_tr_b16 v[204:205], v208 offset:1024
    v_xor_b32 v92, s21, v92
    ds_read_b64_tr_b16 v[206:207], v208 offset:1536
    v_xor_b32 v95, s21, v95
    v_or3_b32 v5, v92, v95, v5
    v_and_b32 v5, 0x80008000, v5
    v_cmp_ne_u32 vcc, 0, v5
    s_nop 0
    s_cbranch_vccnz L_mk_rt_299
L_mk_bk_300:
    s_waitcnt lgkmcnt(5)
    v_mfma_f32_32x32x16_bf16 v[128:143], v[192:195], v[88:91], v[128:143]
    ds_write_b128 v213, v[228:231] offset:7168
    buffer_load_dwordx4 v[108:111], v2, s[16:19], s77 offen offset:1024 sc1
    ds_read_b64_tr_b16 v[216:217], v208 offset:2048
    ds_read_b64_tr_b16 v[218:219], v208 offset:2560
    v_mfma_f32_32x32x16_bf16 v[144:159], v[196:199], v[88:91], v[144:159]
    ds_read_b64_tr_b16 v[220:221], v208 offset:3072
    ds_read_b64_tr_b16 v[222:223], v208 offset:3584
    s_waitcnt lgkmcnt(5)
    v_mfma_f32_32x32x16_bf16 v[128:143], v[200:203], v[92:95], v[128:143]
    ds_read_b64_tr_b16 v[192:193], v208 offset:4096
    buffer_load_dwordx4 v[112:115], v2, s[16:19], s77 offen offset:2048 sc1
    ds_read_b64_tr_b16 v[194:195], v208 offset:4608
    s_waitcnt vmcnt(3)
    v_xor_b32 v96, s21, v96
    v_xor_b32 v99, s21, v99
    v_or_b32 v5, v96, v99
    v_xor_b32 v100, s21, v100
    v_mfma_f32_32x32x16_bf16 v[144:159], v[204:207], v[92:95], v[144:159]
    ds_read_b64_tr_b16 v[196:197], v208 offset:5120
    v_xor_b32 v103, s21, v103
    ds_read_b64_tr_b16 v[198:199], v208 offset:5632
    v_or3_b32 v5, v100, v103, v5
    v_and_b32 v5, 0x80008000, v5
    v_cmp_ne_u32 vcc, 0, v5
    s_nop 0
    s_cbranch_vccnz L_mk_rt_301
L_mk_bk_302:
    s_waitcnt lgkmcnt(4)
    v_mfma_f32_32x32x16_bf16 v[128:143], v[216:219], v[96:99], v[128:143]
    ds_read_b64_tr_b16 v[200:201], v208 offset:6144
    buffer_load_dwordx4 v[116:119], v2, s[16:19], s77 offen offset:3072 sc1
    ds_read_b64_tr_b16 v[202:203], v208 offset:6656
    v_mfma_f32_32x32x16_bf16 v[144:159], v[220:223], v[96:99], v[144:159]
    ds_read_b64_tr_b16 v[204:205], v208 offset:7168
    ds_read_b64_tr_b16 v[206:207], v208 offset:7680
    s_waitcnt lgkmcnt(4)
    s_barrier
    v_mfma_f32_32x32x16_bf16 v[128:143], v[192:195], v[100:103], v[128:143]
    ds_read_b64_tr_b16 v[216:217], v208 offset:8192
    s_add_u32 s77, s71, 26624
    ds_read_b64_tr_b16 v[218:219], v208 offset:8704
    buffer_load_dwordx4 v[120:123], v2, s[16:19], s77 offen offset:0 sc1
    s_waitcnt vmcnt(3)
    v_xor_b32 v104, s21, v104
    v_xor_b32 v107, s21, v107
    v_or_b32 v5, v104, v107
    v_mfma_f32_32x32x16_bf16 v[144:159], v[196:199], v[100:103], v[144:159]
    ds_read_b64_tr_b16 v[220:221], v208 offset:9216
    v_xor_b32 v108, s21, v108
    ds_read_b64_tr_b16 v[222:223], v208 offset:9728
    v_xor_b32 v111, s21, v111
    v_or3_b32 v5, v108, v111, v5
    v_and_b32 v5, 0x80008000, v5
    v_cmp_ne_u32 vcc, 0, v5
    s_nop 0
    s_cbranch_vccnz L_mk_rt_303
L_mk_bk_304:
    s_waitcnt lgkmcnt(4)
    v_mfma_f32_32x32x16_bf16 v[128:143], v[200:203], v[104:107], v[128:143]
    ds_read_b64_tr_b16 v[192:193], v209 offset:0
    buffer_load_dwordx4 v[124:127], v2, s[16:19], s77 offen offset:1024 sc1
    ds_read_b64_tr_b16 v[194:195], v209 offset:512
    s_and_b32 s70, s59, 1
    s_lshl_b32 s70, s70, 8
    s_lshl_b32 s76, s56, 7
    s_add_u32 s70, s70, s76
    s_add_u32 s70, s70, 162304
    v_mfma_f32_32x32x16_bf16 v[144:159], v[204:207], v[104:107], v[144:159]
    ds_read_b64_tr_b16 v[196:197], v209 offset:1024
    v_lshl_add_u32 v8, v4, 2, s70
    ds_read_b64_tr_b16 v[198:199], v209 offset:1536
    s_lshl_b32 s70, s59, 1
    s_add_u32 s70, s70, s56
    s_lshl_b32 s70, s70, 5
    v_add_u32 v12, s70, v4
    s_waitcnt lgkmcnt(4)
    v_mfma_f32_32x32x16_bf16 v[128:143], v[216:219], v[108:111], v[128:143]
    ds_read_b64_tr_b16 v[200:201], v209 offset:2048
    s_waitcnt vmcnt(2)
    ds_read_b64_tr_b16 v[202:203], v209 offset:2560
    v_xor_b32 v112, s21, v112
    v_xor_b32 v115, s21, v115
    v_or_b32 v5, v112, v115
    v_xor_b32 v116, s21, v116
    v_xor_b32 v119, s21, v119
    v_or3_b32 v5, v116, v119, v5
    v_and_b32 v5, 0x80008000, v5
    v_cmp_ne_u32 vcc, 0, v5
    s_nop 0
    s_cbranch_vccnz L_mk_rt_305
L_mk_bk_306:
    v_mfma_f32_32x32x16_bf16 v[144:159], v[220:223], v[108:111], v[144:159]
    ds_read_b64_tr_b16 v[204:205], v209 offset:3072
    v_mul_u32_u24 v12, 896, v12
    ds_read_b64_tr_b16 v[206:207], v209 offset:3584
    v_lshl_add_u32 v12, v3, 4, v12
    s_lshl_b32 s70, s58, 7
    s_lshl_b32 s76, s55, 5
    s_add_u32 s70, s70, s76
    v_lshlrev_b32 v10, 16, v248
    v_lshlrev_b32 v11, 16, v240
    v_add_f32 v16, v10, v11
    v_and_b32 v10, 0xffff0000, v248
    v_and_b32 v11, 0xffff0000, v240
    s_waitcnt lgkmcnt(4)
    v_mfma_f32_32x32x16_bf16 v[128:143], v[192:195], v[112:115], v[128:143]
    ds_read_b64_tr_b16 v[216:217], v209 offset:4096
    v_add_f32 v17, v10, v11
    ds_read_b64_tr_b16 v[218:219], v209 offset:4608
    v_lshlrev_b32 v10, 16, v249
    v_lshlrev_b32 v11, 16, v241
    v_add_f32 v18, v10, v11
    v_and_b32 v10, 0xffff0000, v249
    v_mfma_f32_32x32x16_bf16 v[144:159], v[196:199], v[112:115], v[144:159]
    ds_read_b64_tr_b16 v[220:221], v209 offset:5120
    v_and_b32 v11, 0xffff0000, v241
    ds_read_b64_tr_b16 v[222:223], v209 offset:5632
    v_add_f32 v19, v10, v11
    v_lshlrev_b32 v10, 16, v250
    v_lshlrev_b32 v11, 16, v242
    v_add_f32 v20, v10, v11
    s_waitcnt lgkmcnt(4)
    v_mfma_f32_32x32x16_bf16 v[128:143], v[200:203], v[116:119], v[128:143]
    ds_read_b64_tr_b16 v[192:193], v209 offset:6144
    s_waitcnt vmcnt(0)
    ds_read_b64_tr_b16 v[194:195], v209 offset:6656
    v_xor_b32 v120, s21, v120
    ds_read_b64_tr_b16 v[196:197], v209 offset:7168
    v_xor_b32 v123, s21, v123
    ds_read_b64_tr_b16 v[198:199], v209 offset:7680
    v_or_b32 v5, v120, v123
    v_xor_b32 v124, s21, v124
    v_xor_b32 v127, s21, v127
    v_or3_b32 v5, v124, v127, v5
    v_and_b32 v5, 0x80008000, v5
    v_cmp_ne_u32 vcc, 0, v5
    s_nop 0
    s_cbranch_vccnz L_mk_rt_307
L_mk_bk_308:
    v_and_b32 v10, 0xffff0000, v250
    v_and_b32 v11, 0xffff0000, v242
    v_add_f32 v21, v10, v11
    v_lshlrev_b32 v10, 16, v251
    v_lshlrev_b32 v11, 16, v243
    v_add_f32 v22, v10, v11
    v_and_b32 v10, 0xffff0000, v251
    v_and_b32 v11, 0xffff0000, v243
    v_add_f32 v23, v10, v11
    s_waitcnt lgkmcnt(4)
    v_mfma_f32_32x32x16_bf16 v[128:143], v[216:219], v[120:123], v[128:143]
    ds_read_b32 v9, v8
    s_waitcnt lgkmcnt(0)
    v_mfma_f32_32x32x16_bf16 v[128:143], v[192:195], v[124:127], v[128:143]
    s_mul_i32 s68, s56, 24576
    v_add_u32 v5, s68, v2
    s_mul_i32 s68, s56, 86016
    s_add_u32 s68, s68, 12288
    v_add_u32 v6, s68, v2
L_mk_f2e_212:
    s_cmp_eq_u32 s55, 1
    s_cbranch_scc1 L_mk_rk1_311
    s_cmp_eq_u32 s55, 2
    s_cbranch_scc1 L_mk_rk2_312
    s_cmp_eq_u32 s55, 3
    s_cbranch_scc1 L_mk_rk3_313
L_mk_rk0_310:
    v_mfma_f32_32x32x16_bf16 v[144:159], v[204:207], v[116:119], v[144:159]
    v_mfma_f32_32x32x16_bf16 v[144:159], v[220:223], v[120:123], v[144:159]
    ds_write_b128 v5, v[136:139] offset:10240
    ds_write_b128 v5, v[140:143] offset:11264
    v_mfma_f32_32x32x16_bf16 v[144:159], v[196:199], v[124:127], v[144:159]
    s_nop 11
    ds_write_b128 v6, v[144:147] offset:2048
    ds_write_b128 v6, v[148:151] offset:3072
    ds_write_b128 v6, v[152:155] offset:6144
    ds_write_b128 v6, v[156:159] offset:7168
    s_waitcnt lgkmcnt(0)
    s_barrier
    ds_read_b128 v[96:99], v5 offset:0
    ds_read_b128 v[100:103], v5 offset:1024
    ds_read_b128 v[104:107], v5 offset:2048
    ds_read_b128 v[108:111], v5 offset:3072
    ds_read_b128 v[112:115], v5 offset:4096
    ds_read_b128 v[116:119], v5 offset:5120
    s_waitcnt lgkmcnt(4)
    v_add_f32 v96, v96, v128
    v_add_f32 v97, v97, v129
    v_add_f32 v98, v98, v130
    v_add_f32 v99, v99, v131
    v_add_f32 v100, v100, v132
    v_add_f32 v101, v101, v133
    v_add_f32 v102, v102, v134
    v_add_f32 v103, v103, v135
    s_branch L_mk_rd_309
L_mk_rk1_311:
    v_mfma_f32_32x32x16_bf16 v[144:159], v[204:207], v[116:119], v[144:159]
    v_mfma_f32_32x32x16_bf16 v[144:159], v[220:223], v[120:123], v[144:159]
    s_nop 2
    ds_write_b128 v5, v[128:131] offset:0
    ds_write_b128 v5, v[132:135] offset:1024
    v_mfma_f32_32x32x16_bf16 v[144:159], v[196:199], v[124:127], v[144:159]
    s_nop 11
    ds_write_b128 v6, v[144:147] offset:4096
    ds_write_b128 v6, v[148:151] offset:5120
    ds_write_b128 v6, v[152:155] offset:8192
    ds_write_b128 v6, v[156:159] offset:9216
    s_waitcnt lgkmcnt(0)
    s_barrier
    ds_read_b128 v[96:99], v5 offset:6144
    ds_read_b128 v[100:103], v5 offset:7168
    ds_read_b128 v[104:107], v5 offset:8192
    ds_read_b128 v[108:111], v5 offset:9216
    ds_read_b128 v[112:115], v5 offset:10240
    ds_read_b128 v[116:119], v5 offset:11264
    s_waitcnt lgkmcnt(4)
    v_add_f32 v96, v96, v136
    v_add_f32 v97, v97, v137
    v_add_f32 v98, v98, v138
    v_add_f32 v99, v99, v139
    v_add_f32 v100, v100, v140
    v_add_f32 v101, v101, v141
    v_add_f32 v102, v102, v142
    v_add_f32 v103, v103, v143
    s_branch L_mk_rd_309
L_mk_rk2_312:
    v_mfma_f32_32x32x16_bf16 v[144:159], v[204:207], v[116:119], v[144:159]
    v_mfma_f32_32x32x16_bf16 v[144:159], v[220:223], v[120:123], v[144:159]
    s_nop 0
    ds_write_b128 v5, v[128:131] offset:2048
    ds_write_b128 v5, v[132:135] offset:3072
    v_mfma_f32_32x32x16_bf16 v[144:159], v[196:199], v[124:127], v[144:159]
    ds_write_b128 v5, v[136:139] offset:6144
    ds_write_b128 v5, v[140:143] offset:7168
    s_nop 9
    ds_write_b128 v6, v[152:155] offset:10240
    ds_write_b128 v6, v[156:159] offset:11264
    s_waitcnt lgkmcnt(0)
    s_barrier
    ds_read_b128 v[96:99], v6 offset:0
    ds_read_b128 v[100:103], v6 offset:1024
    ds_read_b128 v[104:107], v6 offset:2048
    ds_read_b128 v[108:111], v6 offset:3072
    ds_read_b128 v[112:115], v6 offset:4096
    ds_read_b128 v[116:119], v6 offset:5120
    s_waitcnt lgkmcnt(4)
    v_add_f32 v96, v96, v144
    v_add_f32 v97, v97, v145
    v_add_f32 v98, v98, v146
    v_add_f32 v99, v99, v147
    v_add_f32 v100, v100, v148
    v_add_f32 v101, v101, v149
    v_add_f32 v102, v102, v150
    v_add_f32 v103, v103, v151
    s_branch L_mk_rd_309
L_mk_rk3_313:
    v_mfma_f32_32x32x16_bf16 v[144:159], v[204:207], v[116:119], v[144:159]
    v_mfma_f32_32x32x16_bf16 v[144:159], v[220:223], v[120:123], v[144:159]
    ds_write_b128 v5, v[128:131] offset:4096
    ds_write_b128 v5, v[132:135] offset:5120
    v_mfma_f32_32x32x16_bf16 v[144:159], v[196:199], v[124:127], v[144:159]
    ds_write_b128 v5, v[136:139] offset:8192
    ds_write_b128 v5, v[140:143] offset:9216
    s_nop 9
    ds_write_b128 v6, v[144:147] offset:0
    ds_write_b128 v6, v[148:151] offset:1024
    s_waitcnt lgkmcnt(0)
    s_barrier
    ds_read_b128 v[96:99], v6 offset:6144
    ds_read_b128 v[100:103], v6 offset:7168
    ds_read_b128 v[104:107], v6 offset:8192
    ds_read_b128 v[108:111], v6 offset:9216
    ds_read_b128 v[112:115], v6 offset:10240
    ds_read_b128 v[116:119], v6 offset:11264
    s_waitcnt lgkmcnt(4)
    v_add_f32 v96, v96, v152
    v_add_f32 v97, v97, v153
    v_add_f32 v98, v98, v154
    v_add_f32 v99, v99, v155
    v_add_f32 v100, v100, v156
    v_add_f32 v101, v101, v157
    v_add_f32 v102, v102, v158
    v_add_f32 v103, v103, v159
L_mk_rd_309:
    s_waitcnt lgkmcnt(0)
    v_add_f32 v104, v104, v112
    v_add_f32 v105, v105, v113
    v_add_f32 v106, v106, v114
    v_add_f32 v107, v107, v115
    v_add_f32 v108, v108, v116
    v_add_f32 v109, v109, v117
    v_add_f32 v110, v110, v118
    v_add_f32 v111, v111, v119
    v_add_f32 v96, v96, v104
    v_add_f32 v97, v97, v105
    v_add_f32 v98, v98, v106
    v_add_f32 v99, v99, v107
    v_add_f32 v100, v100, v108
    v_add_f32 v101, v101, v109
    v_add_f32 v102, v102, v110
    v_add_f32 v103, v103, v111
    v_fma_f32 v96, v96, v9, v16
    v_fma_f32 v97, v97, v9, v17
    v_cvt_pk_bf16_f32 v104, v96, v97
    v_fma_f32 v98, v98, v9, v18
    v_fma_f32 v99, v99, v9, v19
    v_cvt_pk_bf16_f32 v105, v98, v99
    v_fma_f32 v100, v100, v9, v20
    v_fma_f32 v101, v101, v9, v21
    v_cvt_pk_bf16_f32 v106, v100, v101
    v_fma_f32 v102, v102, v9, v22
    v_fma_f32 v103, v103, v9, v23
    v_cvt_pk_bf16_f32 v107, v102, v103
    v_permlane32_swap_b32 v104, v106
    s_nop 0
    v_permlane32_swap_b32 v105, v107
    buffer_store_dwordx4 v[104:107], v12, s[36:39], s70 offen
    s_branch L_mk_fin
L_mk_rt_219:
    s_mov_b32 s78, 0
L_mk_rl_314:
    s_sleep 2
    s_add_u32 s68, s71, 32768
    buffer_load_dwordx4 v[48:51], v2, s[16:19], s68 offen offset:0 sc1
    buffer_load_dwordx4 v[52:55], v2, s[16:19], s68 offen offset:1024 sc1
    buffer_load_dwordx4 v[56:59], v2, s[16:19], s68 offen offset:2048 sc1
    buffer_load_dwordx4 v[60:63], v2, s[16:19], s68 offen offset:3072 sc1
    s_waitcnt vmcnt(0)
    s_add_u32 s78, s78, 1
    s_cmp_gt_u32 s78, 20000
    s_cbranch_scc1 L_mk_bk_220
    v_max_u32 v5, v48, v52
    v_max3_u32 v5, v56, v60, v5
    v_cmp_eq_u32 vcc, -1, v5
    s_nop 0
    s_cbranch_vccnz L_mk_rl_314
    s_branch L_mk_bk_220
L_mk_rt_221:
    s_mov_b32 s78, 0
L_mk_rl_315:
    s_sleep 2
    s_add_u32 s68, s71, 0
    buffer_load_dwordx4 v[16:19], v2, s[16:19], s68 offen offset:0 sc1
    buffer_load_dwordx4 v[20:23], v2, s[16:19], s68 offen offset:1024 sc1
    buffer_load_dwordx4 v[24:27], v2, s[16:19], s68 offen offset:2048 sc1
    buffer_load_dwordx4 v[28:31], v2, s[16:19], s68 offen offset:3072 sc1
    s_waitcnt vmcnt(0)
    s_add_u32 s78, s78, 1
    s_cmp_gt_u32 s78, 20000
    s_cbranch_scc1 L_mk_bk_222
    v_max_u32 v5, v16, v20
    v_max3_u32 v5, v24, v28, v5
    v_cmp_eq_u32 vcc, -1, v5
    s_nop 0
    s_cbranch_vccnz L_mk_rl_315
    s_branch L_mk_bk_222
L_mk_rt_223:
    s_mov_b32 s78, 0
L_mk_rl_316:
    s_sleep 2
    s_add_u32 s68, s71, 36864
    buffer_load_dwordx4 v[64:67], v2, s[16:19], s68 offen offset:0 sc1
    buffer_load_dwordx4 v[68:71], v2, s[16:19], s68 offen offset:1024 sc1
    buffer_load_dwordx4 v[72:75], v2, s[16:19], s68 offen offset:2048 sc1
    buffer_load_dwordx4 v[76:79], v2, s[16:19], s68 offen offset:3072 sc1
    s_waitcnt vmcnt(0)
    s_add_u32 s78, s78, 1
    s_cmp_gt_u32 s78, 20000
    s_cbranch_scc1 L_mk_bk_224
    v_max_u32 v5, v64, v68
    v_max3_u32 v5, v72, v76, v5
    v_cmp_eq_u32 vcc, -1, v5
    s_nop 0
    s_cbranch_vccnz L_mk_rl_316
    s_branch L_mk_bk_224
L_mk_rt_225:
    s_mov_b32 s78, 0
L_mk_rl_317:
    s_sleep 2
    s_add_u32 s68, s71, 4096
    buffer_load_dwordx4 v[32:35], v2, s[16:19], s68 offen offset:0 sc1
    buffer_load_dwordx4 v[36:39], v2, s[16:19], s68 offen offset:1024 sc1
    buffer_load_dwordx4 v[40:43], v2, s[16:19], s68 offen offset:2048 sc1
    buffer_load_dwordx4 v[44:47], v2, s[16:19], s68 offen offset:3072 sc1
    s_waitcnt vmcnt(0)
    s_add_u32 s78, s78, 1
    s_cmp_gt_u32 s78, 20000
    s_cbranch_scc1 L_mk_bk_226
    v_max_u32 v5, v32, v36
    v_max3_u32 v5, v40, v44, v5
    v_cmp_eq_u32 vcc, -1, v5
    s_nop 0
    s_cbranch_vccnz L_mk_rl_317
    s_branch L_mk_bk_226
L_mk_rt_234:
    s_mov_b32 s78, 0
L_mk_rl_318:
    s_sleep 2
    s_add_u32 s71, s70, 0
    buffer_load_dwordx4 v[16:19], v2, s[16:19], s71 offen offset:0 sc1
    buffer_load_dwordx4 v[20:23], v2, s[16:19], s71 offen offset:1024 sc1
    buffer_load_dwordx4 v[24:27], v2, s[16:19], s71 offen offset:2048 sc1
    buffer_load_dwordx4 v[28:31], v2, s[16:19], s71 offen offset:3072 sc1
    s_waitcnt vmcnt(0)
    s_add_u32 s78, s78, 1
    s_cmp_gt_u32 s78, 20000
    s_cbranch_scc1 L_mk_bk_235
    v_max_u32 v5, v16, v20
    v_max3_u32 v5, v24, v28, v5
    v_cmp_eq_u32 vcc, -1, v5
    s_nop 0
    s_cbranch_vccnz L_mk_rl_318
    s_branch L_mk_bk_235
L_mk_rt_236:
    s_mov_b32 s78, 0
L_mk_rl_319:
    s_sleep 2
    s_add_u32 s71, s70, 4096
    buffer_load_dwordx4 v[32:35], v2, s[16:19], s71 offen offset:0 sc1
    buffer_load_dwordx4 v[36:39], v2, s[16:19], s71 offen offset:1024 sc1
    buffer_load_dwordx4 v[40:43], v2, s[16:19], s71 offen offset:2048 sc1
    buffer_load_dwordx4 v[44:47], v2, s[16:19], s71 offen offset:3072 sc1
    s_waitcnt vmcnt(0)
    s_add_u32 s78, s78, 1
    s_cmp_gt_u32 s78, 20000
    s_cbranch_scc1 L_mk_bk_237
    v_max_u32 v5, v32, v36
    v_max3_u32 v5, v40, v44, v5
    v_cmp_eq_u32 vcc, -1, v5
    s_nop 0
    s_cbranch_vccnz L_mk_rl_319
    s_branch L_mk_bk_237
L_mk_rt_238:
    s_mov_b32 s78, 0
L_mk_rl_320:
    s_sleep 2
    s_add_u32 s71, s70, 8192
    buffer_load_dwordx4 v[48:51], v2, s[16:19], s71 offen offset:0 sc1
    buffer_load_dwordx4 v[52:55], v2, s[16:19], s71 offen offset:1024 sc1
    buffer_load_dwordx4 v[56:59], v2, s[16:19], s71 offen offset:2048 sc1
    buffer_load_dwordx4 v[60:63], v2, s[16:19], s71 offen offset:3072 sc1
    s_waitcnt vmcnt(0)
    s_add_u32 s78, s78, 1
    s_cmp_gt_u32 s78, 20000
    s_cbranch_scc1 L_mk_bk_239
    v_max_u32 v5, v48, v52
    v_max3_u32 v5, v56, v60, v5
    v_cmp_eq_u32 vcc, -1, v5
    s_nop 0
    s_cbranch_vccnz L_mk_rl_320
    s_branch L_mk_bk_239
L_mk_rt_240:
    s_mov_b32 s78, 0
L_mk_rl_321:
    s_sleep 2
    s_add_u32 s71, s70, 12288
    buffer_load_dwordx4 v[64:67], v2, s[16:19], s71 offen offset:0 sc1
    buffer_load_dwordx4 v[68:71], v2, s[16:19], s71 offen offset:1024 sc1
    buffer_load_dwordx4 v[72:75], v2, s[16:19], s71 offen offset:2048 sc1
    buffer_load_dwordx4 v[76:79], v2, s[16:19], s71 offen offset:3072 sc1
    s_waitcnt vmcnt(0)
    s_add_u32 s78, s78, 1
    s_cmp_gt_u32 s78, 20000
    s_cbranch_scc1 L_mk_bk_241
    v_max_u32 v5, v64, v68
    v_max3_u32 v5, v72, v76, v5
    v_cmp_eq_u32 vcc, -1, v5
    s_nop 0
    s_cbranch_vccnz L_mk_rl_321
    s_branch L_mk_bk_241
L_mk_rt_242:
    s_mov_b32 s78, 0
L_mk_rl_322:
    s_sleep 2
    s_add_u32 s71, s70, 16384
    buffer_load_dwordx4 v[80:83], v2, s[16:19], s71 offen offset:0 sc1
    buffer_load_dwordx4 v[84:87], v2, s[16:19], s71 offen offset:1024 sc1
    buffer_load_dwordx4 v[88:91], v2, s[16:19], s71 offen offset:2048 sc1
    buffer_load_dwordx4 v[92:95], v2, s[16:19], s71 offen offset:3072 sc1
    s_waitcnt vmcnt(0)
    s_add_u32 s78, s78, 1
    s_cmp_gt_u32 s78, 20000
    s_cbranch_scc1 L_mk_bk_243
    v_max_u32 v5, v80, v84
    v_max3_u32 v5, v88, v92, v5
    v_cmp_eq_u32 vcc, -1, v5
    s_nop 0
    s_cbranch_vccnz L_mk_rl_322
    s_branch L_mk_bk_243
L_mk_rt_244:
    s_mov_b32 s78, 0
L_mk_rl_323:
    s_sleep 2
    s_add_u32 s71, s70, 20480
    buffer_load_dwordx4 v[96:99], v2, s[16:19], s71 offen offset:0 sc1
    buffer_load_dwordx4 v[100:103], v2, s[16:19], s71 offen offset:1024 sc1
    buffer_load_dwordx4 v[104:107], v2, s[16:19], s71 offen offset:2048 sc1
    buffer_load_dwordx4 v[108:111], v2, s[16:19], s71 offen offset:3072 sc1
    s_waitcnt vmcnt(0)
    s_add_u32 s78, s78, 1
    s_cmp_gt_u32 s78, 20000
    s_cbranch_scc1 L_mk_bk_245
    v_max_u32 v5, v96, v100
    v_max3_u32 v5, v104, v108, v5
    v_cmp_eq_u32 vcc, -1, v5
    s_nop 0
    s_cbranch_vccnz L_mk_rl_323
    s_branch L_mk_bk_245
L_mk_xr_246:
    s_mov_b32 s78, 0
L_mk_xl_324:
    s_sleep 2
    buffer_load_dwordx4 v[216:219], v12, s[16:19], s69 offen offset:0 sc1
    buffer_load_dwordx4 v[220:223], v12, s[16:19], s69 offen offset:512 sc1
    buffer_load_dwordx4 v[224:227], v12, s[16:19], s69 offen offset:1024 sc1
    buffer_load_dwordx4 v[228:231], v12, s[16:19], s69 offen offset:1536 sc1
    s_waitcnt vmcnt(0)
    v_xor_b32 v218, s82, v218
    v_xor_b32 v219, s82, v219
    v_xor_b32 v222, s82, v222
    v_xor_b32 v223, s82, v223
    v_xor_b32 v226, s82, v226
    v_xor_b32 v227, s82, v227
    v_xor_b32 v230, s82, v230
    v_xor_b32 v231, s82, v231
    s_add_u32 s78, s78, 1
    s_cmp_gt_u32 s78, 20000
    s_cbranch_scc1 L_mk_xb_247
    v_or_b32 v7, v218, v222
    v_or3_b32 v7, v226, v230, v7
    v_cmp_ne_u32 vcc, 0, v7
    s_nop 0
    s_cbranch_vccnz L_mk_xl_324
    s_branch L_mk_xb_247
L_mk_rt_248:
    s_mov_b32 s78, 0
L_mk_rl_325:
    s_sleep 2
    buffer_load_dwordx2 v[160:161], v11, s[16:19], s76 offen offset:0 sc1
    buffer_load_dwordx2 v[162:163], v11, s[16:19], s76 offen offset:1024 sc1
    buffer_load_dwordx2 v[164:165], v11, s[16:19], s76 offen offset:2048 sc1
    buffer_load_dwordx2 v[166:167], v10, s[16:19], s76 offen offset:3072 sc1
    s_waitcnt vmcnt(0)
    s_add_u32 s78, s78, 1
    s_cmp_gt_u32 s78, 20000
    s_cbranch_scc1 L_mk_bk_249
    v_max_u32 v5, v160, v162
    v_max3_u32 v5, v164, v166, v5
    v_cmp_eq_u32 vcc, -1, v5
    s_nop 0
    s_cbranch_vccnz L_mk_rl_325
    s_branch L_mk_bk_249
L_mk_rt_250:
    s_mov_b32 s78, 0
L_mk_rl_326:
    s_sleep 2
    s_add_u32 s71, s70, 24576
    buffer_load_dwordx4 v[112:115], v2, s[16:19], s71 offen offset:0 sc1
    buffer_load_dwordx4 v[116:119], v2, s[16:19], s71 offen offset:1024 sc1
    buffer_load_dwordx4 v[120:123], v2, s[16:19], s71 offen offset:2048 sc1
    buffer_load_dwordx4 v[124:127], v2, s[16:19], s71 offen offset:3072 sc1
    s_waitcnt vmcnt(0)
    s_add_u32 s78, s78, 1
    s_cmp_gt_u32 s78, 20000
    s_cbranch_scc1 L_mk_bk_251
    v_max_u32 v5, v112, v116
    v_max3_u32 v5, v120, v124, v5
    v_cmp_eq_u32 vcc, -1, v5
    s_nop 0
    s_cbranch_vccnz L_mk_rl_326
    s_branch L_mk_bk_251
L_mk_rt_252:
    s_mov_b32 s78, 0
L_mk_rl_327:
    s_sleep 2
    s_add_u32 s68, s71, 0
    buffer_load_dwordx4 v[16:19], v2, s[16:19], s68 offen sc1
    s_add_u32 s68, s71, 1024
    buffer_load_dwordx4 v[20:23], v2, s[16:19], s68 offen sc1
    s_waitcnt vmcnt(0)
    s_add_u32 s78, s78, 1
    s_cmp_gt_u32 s78, 20000
    s_cbranch_scc1 L_mk_bk_253
    v_xor_b32 v16, s21, v16
    v_xor_b32 v19, s21, v19
    v_or_b32 v5, v16, v19
    v_xor_b32 v20, s21, v20
    v_xor_b32 v23, s21, v23
    v_or3_b32 v5, v20, v23, v5
    v_and_b32 v5, 0x80008000, v5
    v_cmp_ne_u32 vcc, 0, v5
    s_nop 0
    s_cbranch_vccnz L_mk_rl_327
    s_branch L_mk_bk_253
L_mk_rt_254:
    s_mov_b32 s78, 0
L_mk_rl_328:
    s_sleep 2
    s_add_u32 s68, s71, 2048
    buffer_load_dwordx4 v[24:27], v2, s[16:19], s68 offen sc1
    s_add_u32 s68, s71, 3072
    buffer_load_dwordx4 v[28:31], v2, s[16:19], s68 offen sc1
    s_waitcnt vmcnt(0)
    s_add_u32 s78, s78, 1
    s_cmp_gt_u32 s78, 20000
    s_cbranch_scc1 L_mk_bk_255
    v_xor_b32 v24, s21, v24
    v_xor_b32 v27, s21, v27
    v_or_b32 v5, v24, v27
    v_xor_b32 v28, s21, v28
    v_xor_b32 v31, s21, v31
    v_or3_b32 v5, v28, v31, v5
    v_and_b32 v5, 0x80008000, v5
    v_cmp_ne_u32 vcc, 0, v5
    s_nop 0
    s_cbranch_vccnz L_mk_rl_328
    s_branch L_mk_bk_255
L_mk_rt_256:
    s_mov_b32 s78, 0
L_mk_rl_329:
    s_sleep 2
    s_add_u32 s68, s71, 4096
    buffer_load_dwordx4 v[32:35], v2, s[16:19], s68 offen sc1
    s_add_u32 s68, s71, 5120
    buffer_load_dwordx4 v[36:39], v2, s[16:19], s68 offen sc1
    s_waitcnt vmcnt(0)
    s_add_u32 s78, s78, 1
    s_cmp_gt_u32 s78, 20000
    s_cbranch_scc1 L_mk_bk_257
    v_xor_b32 v32, s21, v32
    v_xor_b32 v35, s21, v35
    v_or_b32 v5, v32, v35
    v_xor_b32 v36, s21, v36
    v_xor_b32 v39, s21, v39
    v_or3_b32 v5, v36, v39, v5
    v_and_b32 v5, 0x80008000, v5
    v_cmp_ne_u32 vcc, 0, v5
    s_nop 0
    s_cbranch_vccnz L_mk_rl_329
    s_branch L_mk_bk_257
L_mk_rt_258:
    s_mov_b32 s78, 0
L_mk_rl_330:
    s_sleep 2
    s_add_u32 s68, s71, 6144
    buffer_load_dwordx4 v[40:43], v2, s[16:19], s68 offen sc1
    s_add_u32 s68, s71, 7168
    buffer_load_dwordx4 v[44:47], v2, s[16:19], s68 offen sc1
    s_waitcnt vmcnt(0)
    s_add_u32 s78, s78, 1
    s_cmp_gt_u32 s78, 20000
    s_cbranch_scc1 L_mk_bk_259
    v_xor_b32 v40, s21, v40
    v_xor_b32 v43, s21, v43
    v_or_b32 v5, v40, v43
    v_xor_b32 v44, s21, v44
    v_xor_b32 v47, s21, v47
    v_or3_b32 v5, v44, v47, v5
    v_and_b32 v5, 0x80008000, v5
    v_cmp_ne_u32 vcc, 0, v5
    s_nop 0
    s_cbranch_vccnz L_mk_rl_330
    s_branch L_mk_bk_259
L_mk_rt_260:
    s_mov_b32 s78, 0
L_mk_rl_331:
    s_sleep 2
    s_add_u32 s68, s71, 8192
    buffer_load_dwordx4 v[48:51], v2, s[16:19], s68 offen sc1
    s_add_u32 s68, s71, 9216
    buffer_load_dwordx4 v[52:55], v2, s[16:19], s68 offen sc1
    s_waitcnt vmcnt(0)
    s_add_u32 s78, s78, 1
    s_cmp_gt_u32 s78, 20000
    s_cbranch_scc1 L_mk_bk_261
    v_xor_b32 v48, s21, v48
    v_xor_b32 v51, s21, v51
    v_or_b32 v5, v48, v51
    v_xor_b32 v52, s21, v52
    v_xor_b32 v55, s21, v55
    v_or3_b32 v5, v52, v55, v5
    v_and_b32 v5, 0x80008000, v5
    v_cmp_ne_u32 vcc, 0, v5
    s_nop 0
    s_cbranch_vccnz L_mk_rl_331
    s_branch L_mk_bk_261
L_mk_rt_262:
    s_mov_b32 s78, 0
L_mk_rl_332:
    s_sleep 2
    s_add_u32 s68, s71, 10240
    buffer_load_dwordx4 v[56:59], v2, s[16:19], s68 offen sc1
    s_add_u32 s68, s71, 11264
    buffer_load_dwordx4 v[60:63], v2, s[16:19], s68 offen sc1
    s_waitcnt vmcnt(0)
    s_add_u32 s78, s78, 1
    s_cmp_gt_u32 s78, 20000
    s_cbranch_scc1 L_mk_bk_263
    v_xor_b32 v56, s21, v56
    v_xor_b32 v59, s21, v59
    v_or_b32 v5, v56, v59
    v_xor_b32 v60, s21, v60
    v_xor_b32 v63, s21, v63
    v_or3_b32 v5, v60, v63, v5
    v_and_b32 v5, 0x80008000, v5
    v_cmp_ne_u32 vcc, 0, v5
    s_nop 0
    s_cbranch_vccnz L_mk_rl_332
    s_branch L_mk_bk_263
L_mk_rt_264:
    s_mov_b32 s78, 0
L_mk_rl_333:
    s_sleep 2
    s_add_u32 s68, s71, 12288
    buffer_load_dwordx4 v[64:67], v2, s[16:19], s68 offen sc1
    s_add_u32 s68, s71, 13312
    buffer_load_dwordx4 v[68:71], v2, s[16:19], s68 offen sc1
    s_waitcnt vmcnt(0)
    s_add_u32 s78, s78, 1
    s_cmp_gt_u32 s78, 20000
    s_cbranch_scc1 L_mk_bk_265
    v_xor_b32 v64, s21, v64
    v_xor_b32 v67, s21, v67
    v_or_b32 v5, v64, v67
    v_xor_b32 v68, s21, v68
    v_xor_b32 v71, s21, v71
    v_or3_b32 v5, v68, v71, v5
    v_and_b32 v5, 0x80008000, v5
    v_cmp_ne_u32 vcc, 0, v5
    s_nop 0
    s_cbranch_vccnz L_mk_rl_333
    s_branch L_mk_bk_265
L_mk_rt_266:
    s_mov_b32 s78, 0
L_mk_rl_334:
    s_sleep 2
    s_add_u32 s68, s71, 14336
    buffer_load_dwordx4 v[72:75], v2, s[16:19], s68 offen sc1
    s_add_u32 s68, s71, 15360
    buffer_load_dwordx4 v[76:79], v2, s[16:19], s68 offen sc1
    s_waitcnt vmcnt(0)
    s_add_u32 s78, s78, 1
    s_cmp_gt_u32 s78, 20000
    s_cbranch_scc1 L_mk_bk_267
    v_xor_b32 v72, s21, v72
    v_xor_b32 v75, s21, v75
    v_or_b32 v5, v72, v75
    v_xor_b32 v76, s21, v76
    v_xor_b32 v79, s21, v79
    v_or3_b32 v5, v76, v79, v5
    v_and_b32 v5, 0x80008000, v5
    v_cmp_ne_u32 vcc, 0, v5
    s_nop 0
    s_cbranch_vccnz L_mk_rl_334
    s_branch L_mk_bk_267
L_mk_rt_268:
    s_mov_b32 s78, 0
L_mk_rl_335:
    s_sleep 2
    s_add_u32 s68, s71, 16384
    buffer_load_dwordx4 v[80:83], v2, s[16:19], s68 offen sc1
    s_add_u32 s68, s71, 17408
    buffer_load_dwordx4 v[84:87], v2, s[16:19], s68 offen sc1
    s_waitcnt vmcnt(0)
    s_add_u32 s78, s78, 1
    s_cmp_gt_u32 s78, 20000
    s_cbranch_scc1 L_mk_bk_269
    v_xor_b32 v80, s21, v80
    v_xor_b32 v83, s21, v83
    v_or_b32 v5, v80, v83
    v_xor_b32 v84, s21, v84
    v_xor_b32 v87, s21, v87
    v_or3_b32 v5, v84, v87, v5
    v_and_b32 v5, 0x80008000, v5
    v_cmp_ne_u32 vcc, 0, v5
    s_nop 0
    s_cbranch_vccnz L_mk_rl_335
    s_branch L_mk_bk_269
L_mk_rt_270:
    s_mov_b32 s78, 0
L_mk_rl_336:
    s_sleep 2
    s_add_u32 s68, s71, 18432
    buffer_load_dwordx4 v[88:91], v2, s[16:19], s68 offen sc1
    s_add_u32 s68, s71, 19456
    buffer_load_dwordx4 v[92:95], v2, s[16:19], s68 offen sc1
    s_waitcnt vmcnt(0)
    s_add_u32 s78, s78, 1
    s_cmp_gt_u32 s78, 20000
    s_cbranch_scc1 L_mk_bk_271
    v_xor_b32 v88, s21, v88
    v_xor_b32 v91, s21, v91
    v_or_b32 v5, v88, v91
    v_xor_b32 v92, s21, v92
    v_xor_b32 v95, s21, v95
    v_or3_b32 v5, v92, v95, v5
    v_and_b32 v5, 0x80008000, v5
    v_cmp_ne_u32 vcc, 0, v5
    s_nop 0
    s_cbranch_vccnz L_mk_rl_336
    s_branch L_mk_bk_271
L_mk_rt_272:
    s_mov_b32 s78, 0
L_mk_rl_337:
    s_sleep 2
    s_add_u32 s68, s71, 20480
    buffer_load_dwordx4 v[96:99], v2, s[16:19], s68 offen sc1
    s_add_u32 s68, s71, 21504
    buffer_load_dwordx4 v[100:103], v2, s[16:19], s68 offen sc1
    s_waitcnt vmcnt(0)
    s_add_u32 s78, s78, 1
    s_cmp_gt_u32 s78, 20000
    s_cbranch_scc1 L_mk_bk_273
    v_xor_b32 v96, s21, v96
    v_xor_b32 v99, s21, v99
    v_or_b32 v5, v96, v99
    v_xor_b32 v100, s21, v100
    v_xor_b32 v103, s21, v103
    v_or3_b32 v5, v100, v103, v5
    v_and_b32 v5, 0x80008000, v5
    v_cmp_ne_u32 vcc, 0, v5
    s_nop 0
    s_cbranch_vccnz L_mk_rl_337
    s_branch L_mk_bk_273
L_mk_rt_274:
    s_mov_b32 s78, 0
L_mk_rl_338:
    s_sleep 2
    s_add_u32 s68, s71, 22528
    buffer_load_dwordx4 v[104:107], v2, s[16:19], s68 offen sc1
    s_add_u32 s68, s71, 23552
    buffer_load_dwordx4 v[108:111], v2, s[16:19], s68 offen sc1
    s_waitcnt vmcnt(0)
    s_add_u32 s78, s78, 1
    s_cmp_gt_u32 s78, 20000
    s_cbranch_scc1 L_mk_bk_275
    v_xor_b32 v104, s21, v104
    v_xor_b32 v107, s21, v107
    v_or_b32 v5, v104, v107
    v_xor_b32 v108, s21, v108
    v_xor_b32 v111, s21, v111
    v_or3_b32 v5, v108, v111, v5
    v_and_b32 v5, 0x80008000, v5
    v_cmp_ne_u32 vcc, 0, v5
    s_nop 0
    s_cbranch_vccnz L_mk_rl_338
    s_branch L_mk_bk_275
L_mk_rt_276:
    s_mov_b32 s78, 0
L_mk_rl_339:
    s_sleep 2
    s_add_u32 s68, s71, 24576
    buffer_load_dwordx4 v[112:115], v2, s[16:19], s68 offen sc1
    s_add_u32 s68, s71, 25600
    buffer_load_dwordx4 v[116:119], v2, s[16:19], s68 offen sc1
    s_waitcnt vmcnt(0)
    s_add_u32 s78, s78, 1
    s_cmp_gt_u32 s78, 20000
    s_cbranch_scc1 L_mk_bk_277
    v_xor_b32 v112, s21, v112
    v_xor_b32 v115, s21, v115
    v_or_b32 v5, v112, v115
    v_xor_b32 v116, s21, v116
    v_xor_b32 v119, s21, v119
    v_or3_b32 v5, v116, v119, v5
    v_and_b32 v5, 0x80008000, v5
    v_cmp_ne_u32 vcc, 0, v5
    s_nop 0
    s_cbranch_vccnz L_mk_rl_339
    s_branch L_mk_bk_277
L_mk_rt_278:
    s_mov_b32 s78, 0
L_mk_rl_340:
    s_sleep 2
    s_add_u32 s68, s71, 26624
    buffer_load_dwordx4 v[120:123], v2, s[16:19], s68 offen sc1
    s_add_u32 s68, s71, 27648
    buffer_load_dwordx4 v[124:127], v2, s[16:19], s68 offen sc1
    s_waitcnt vmcnt(0)
    s_add_u32 s78, s78, 1
    s_cmp_gt_u32 s78, 20000
    s_cbranch_scc1 L_mk_bk_279
    v_xor_b32 v120, s21, v120
    v_xor_b32 v123, s21, v123
    v_or_b32 v5, v120, v123
    v_xor_b32 v124, s21, v124
    v_xor_b32 v127, s21, v127
    v_or3_b32 v5, v124, v127, v5
    v_and_b32 v5, 0x80008000, v5
    v_cmp_ne_u32 vcc, 0, v5
    s_nop 0
    s_cbranch_vccnz L_mk_rl_340
    s_branch L_mk_bk_279
L_mk_rt_281:
    s_mov_b32 s78, 0
L_mk_rl_341:
    s_sleep 2
    s_add_u32 s68, s71, 0
    buffer_load_dwordx4 v[16:19], v2, s[16:19], s68 offen sc1
    s_add_u32 s68, s71, 1024
    buffer_load_dwordx4 v[20:23], v2, s[16:19], s68 offen sc1
    s_waitcnt vmcnt(0)
    s_add_u32 s78, s78, 1
    s_cmp_gt_u32 s78, 20000
    s_cbranch_scc1 L_mk_bk_282
    v_xor_b32 v16, s21, v16
    v_xor_b32 v19, s21, v19
    v_or_b32 v5, v16, v19
    v_xor_b32 v20, s21, v20
    v_xor_b32 v23, s21, v23
    v_or3_b32 v5, v20, v23, v5
    v_and_b32 v5, 0x80008000, v5
    v_cmp_ne_u32 vcc, 0, v5
    s_nop 0
    s_cbranch_vccnz L_mk_rl_341
    s_branch L_mk_bk_282
L_mk_rt_283:
    s_mov_b32 s78, 0
L_mk_rl_342:
    s_sleep 2
    s_add_u32 s68, s71, 2048
    buffer_load_dwordx4 v[24:27], v2, s[16:19], s68 offen sc1
    s_add_u32 s68, s71, 3072
    buffer_load_dwordx4 v[28:31], v2, s[16:19], s68 offen sc1
    s_waitcnt vmcnt(0)
    s_add_u32 s78, s78, 1
    s_cmp_gt_u32 s78, 20000
    s_cbranch_scc1 L_mk_bk_284
    v_xor_b32 v24, s21, v24
    v_xor_b32 v27, s21, v27
    v_or_b32 v5, v24, v27
    v_xor_b32 v28, s21, v28
    v_xor_b32 v31, s21, v31
    v_or3_b32 v5, v28, v31, v5
    v_and_b32 v5, 0x80008000, v5
    v_cmp_ne_u32 vcc, 0, v5
    s_nop 0
    s_cbranch_vccnz L_mk_rl_342
    s_branch L_mk_bk_284
L_mk_rt_285:
    s_mov_b32 s78, 0
L_mk_rl_343:
    s_sleep 2
    s_add_u32 s68, s71, 4096
    buffer_load_dwordx4 v[32:35], v2, s[16:19], s68 offen sc1
    s_add_u32 s68, s71, 5120
    buffer_load_dwordx4 v[36:39], v2, s[16:19], s68 offen sc1
    s_waitcnt vmcnt(0)
    s_add_u32 s78, s78, 1
    s_cmp_gt_u32 s78, 20000
    s_cbranch_scc1 L_mk_bk_286
    v_xor_b32 v32, s21, v32
    v_xor_b32 v35, s21, v35
    v_or_b32 v5, v32, v35
    v_xor_b32 v36, s21, v36
    v_xor_b32 v39, s21, v39
    v_or3_b32 v5, v36, v39, v5
    v_and_b32 v5, 0x80008000, v5
    v_cmp_ne_u32 vcc, 0, v5
    s_nop 0
    s_cbranch_vccnz L_mk_rl_343
    s_branch L_mk_bk_286
L_mk_rt_287:
    s_mov_b32 s78, 0
L_mk_rl_344:
    s_sleep 2
    s_add_u32 s68, s71, 6144
    buffer_load_dwordx4 v[40:43], v2, s[16:19], s68 offen sc1
    s_add_u32 s68, s71, 7168
    buffer_load_dwordx4 v[44:47], v2, s[16:19], s68 offen sc1
    s_waitcnt vmcnt(0)
    s_add_u32 s78, s78, 1
    s_cmp_gt_u32 s78, 20000
    s_cbranch_scc1 L_mk_bk_288
    v_xor_b32 v40, s21, v40
    v_xor_b32 v43, s21, v43
    v_or_b32 v5, v40, v43
    v_xor_b32 v44, s21, v44
    v_xor_b32 v47, s21, v47
    v_or3_b32 v5, v44, v47, v5
    v_and_b32 v5, 0x80008000, v5
    v_cmp_ne_u32 vcc, 0, v5
    s_nop 0
    s_cbranch_vccnz L_mk_rl_344
    s_branch L_mk_bk_288
L_mk_rt_289:
    s_mov_b32 s78, 0
L_mk_rl_345:
    s_sleep 2
    s_add_u32 s68, s71, 8192
    buffer_load_dwordx4 v[48:51], v2, s[16:19], s68 offen sc1
    s_add_u32 s68, s71, 9216
    buffer_load_dwordx4 v[52:55], v2, s[16:19], s68 offen sc1
    s_waitcnt vmcnt(0)
    s_add_u32 s78, s78, 1
    s_cmp_gt_u32 s78, 20000
    s_cbranch_scc1 L_mk_bk_290
    v_xor_b32 v48, s21, v48
    v_xor_b32 v51, s21, v51
    v_or_b32 v5, v48, v51
    v_xor_b32 v52, s21, v52
    v_xor_b32 v55, s21, v55
    v_or3_b32 v5, v52, v55, v5
    v_and_b32 v5, 0x80008000, v5
    v_cmp_ne_u32 vcc, 0, v5
    s_nop 0
    s_cbranch_vccnz L_mk_rl_345
    s_branch L_mk_bk_290
L_mk_rt_291:
    s_mov_b32 s78, 0
L_mk_rl_346:
    s_sleep 2
    s_add_u32 s68, s71, 10240
    buffer_load_dwordx4 v[56:59], v2, s[16:19], s68 offen sc1
    s_add_u32 s68, s71, 11264
    buffer_load_dwordx4 v[60:63], v2, s[16:19], s68 offen sc1
    s_waitcnt vmcnt(0)
    s_add_u32 s78, s78, 1
    s_cmp_gt_u32 s78, 20000
    s_cbranch_scc1 L_mk_bk_292
    v_xor_b32 v56, s21, v56
    v_xor_b32 v59, s21, v59
    v_or_b32 v5, v56, v59
    v_xor_b32 v60, s21, v60
    v_xor_b32 v63, s21, v63
    v_or3_b32 v5, v60, v63, v5
    v_and_b32 v5, 0x80008000, v5
    v_cmp_ne_u32 vcc, 0, v5
    s_nop 0
    s_cbranch_vccnz L_mk_rl_346
    s_branch L_mk_bk_292
L_mk_rt_293:
    s_mov_b32 s78, 0
L_mk_rl_347:
    s_sleep 2
    s_add_u32 s68, s71, 12288
    buffer_load_dwordx4 v[64:67], v2, s[16:19], s68 offen sc1
    s_add_u32 s68, s71, 13312
    buffer_load_dwordx4 v[68:71], v2, s[16:19], s68 offen sc1
    s_waitcnt vmcnt(0)
    s_add_u32 s78, s78, 1
    s_cmp_gt_u32 s78, 20000
    s_cbranch_scc1 L_mk_bk_294
    v_xor_b32 v64, s21, v64
    v_xor_b32 v67, s21, v67
    v_or_b32 v5, v64, v67
    v_xor_b32 v68, s21, v68
    v_xor_b32 v71, s21, v71
    v_or3_b32 v5, v68, v71, v5
    v_and_b32 v5, 0x80008000, v5
    v_cmp_ne_u32 vcc, 0, v5
    s_nop 0
    s_cbranch_vccnz L_mk_rl_347
    s_branch L_mk_bk_294
L_mk_rt_295:
    s_mov_b32 s78, 0
L_mk_rl_348:
    s_sleep 2
    s_add_u32 s68, s71, 14336
    buffer_load_dwordx4 v[72:75], v2, s[16:19], s68 offen sc1
    s_add_u32 s68, s71, 15360
    buffer_load_dwordx4 v[76:79], v2, s[16:19], s68 offen sc1
    s_waitcnt vmcnt(0)
    s_add_u32 s78, s78, 1
    s_cmp_gt_u32 s78, 20000
    s_cbranch_scc1 L_mk_bk_296
    v_xor_b32 v72, s21, v72
    v_xor_b32 v75, s21, v75
    v_or_b32 v5, v72, v75
    v_xor_b32 v76, s21, v76
    v_xor_b32 v79, s21, v79
    v_or3_b32 v5, v76, v79, v5
    v_and_b32 v5, 0x80008000, v5
    v_cmp_ne_u32 vcc, 0, v5
    s_nop 0
    s_cbranch_vccnz L_mk_rl_348
    s_branch L_mk_bk_296
L_mk_rt_297:
    s_mov_b32 s78, 0
L_mk_rl_349:
    s_sleep 2
    s_add_u32 s68, s71, 16384
    buffer_load_dwordx4 v[80:83], v2, s[16:19], s68 offen sc1
    s_add_u32 s68, s71, 17408
    buffer_load_dwordx4 v[84:87], v2, s[16:19], s68 offen sc1
    s_waitcnt vmcnt(0)
    s_add_u32 s78, s78, 1
    s_cmp_gt_u32 s78, 20000
    s_cbranch_scc1 L_mk_bk_298
    v_xor_b32 v80, s21, v80
    v_xor_b32 v83, s21, v83
    v_or_b32 v5, v80, v83
    v_xor_b32 v84, s21, v84
    v_xor_b32 v87, s21, v87
    v_or3_b32 v5, v84, v87, v5
    v_and_b32 v5, 0x80008000, v5
    v_cmp_ne_u32 vcc, 0, v5
    s_nop 0
    s_cbranch_vccnz L_mk_rl_349
    s_branch L_mk_bk_298
L_mk_rt_299:
    s_mov_b32 s78, 0
L_mk_rl_350:
    s_sleep 2
    s_add_u32 s68, s71, 18432
    buffer_load_dwordx4 v[88:91], v2, s[16:19], s68 offen sc1
    s_add_u32 s68, s71, 19456
    buffer_load_dwordx4 v[92:95], v2, s[16:19], s68 offen sc1
    s_waitcnt vmcnt(0)
    s_add_u32 s78, s78, 1
    s_cmp_gt_u32 s78, 20000
    s_cbranch_scc1 L_mk_bk_300
    v_xor_b32 v88, s21, v88
    v_xor_b32 v91, s21, v91
    v_or_b32 v5, v88, v91
    v_xor_b32 v92, s21, v92
    v_xor_b32 v95, s21, v95
    v_or3_b32 v5, v92, v95, v5
    v_and_b32 v5, 0x80008000, v5
    v_cmp_ne_u32 vcc, 0, v5
    s_nop 0
    s_cbranch_vccnz L_mk_rl_350
    s_branch L_mk_bk_300
L_mk_rt_301:
    s_mov_b32 s78, 0
L_mk_rl_351:
    s_sleep 2
    s_add_u32 s68, s71, 20480
    buffer_load_dwordx4 v[96:99], v2, s[16:19], s68 offen sc1
    s_add_u32 s68, s71, 21504
    buffer_load_dwordx4 v[100:103], v2, s[16:19], s68 offen sc1
    s_waitcnt vmcnt(0)
    s_add_u32 s78, s78, 1
    s_cmp_gt_u32 s78, 20000
    s_cbranch_scc1 L_mk_bk_302
    v_xor_b32 v96, s21, v96
    v_xor_b32 v99, s21, v99
    v_or_b32 v5, v96, v99
    v_xor_b32 v100, s21, v100
    v_xor_b32 v103, s21, v103
    v_or3_b32 v5, v100, v103, v5
    v_and_b32 v5, 0x80008000, v5
    v_cmp_ne_u32 vcc, 0, v5
    s_nop 0
    s_cbranch_vccnz L_mk_rl_351
    s_branch L_mk_bk_302
L_mk_rt_303:
    s_mov_b32 s78, 0
L_mk_rl_352:
    s_sleep 2
    s_add_u32 s68, s71, 22528
    buffer_load_dwordx4 v[104:107], v2, s[16:19], s68 offen sc1
    s_add_u32 s68, s71, 23552
    buffer_load_dwordx4 v[108:111], v2, s[16:19], s68 offen sc1
    s_waitcnt vmcnt(0)
    s_add_u32 s78, s78, 1
    s_cmp_gt_u32 s78, 20000
    s_cbranch_scc1 L_mk_bk_304
    v_xor_b32 v104, s21, v104
    v_xor_b32 v107, s21, v107
    v_or_b32 v5, v104, v107
    v_xor_b32 v108, s21, v108
    v_xor_b32 v111, s21, v111
    v_or3_b32 v5, v108, v111, v5
    v_and_b32 v5, 0x80008000, v5
    v_cmp_ne_u32 vcc, 0, v5
    s_nop 0
    s_cbranch_vccnz L_mk_rl_352
    s_branch L_mk_bk_304
L_mk_rt_305:
    s_mov_b32 s78, 0
L_mk_rl_353:
    s_sleep 2
    s_add_u32 s68, s71, 24576
    buffer_load_dwordx4 v[112:115], v2, s[16:19], s68 offen sc1
    s_add_u32 s68, s71, 25600
    buffer_load_dwordx4 v[116:119], v2, s[16:19], s68 offen sc1
    s_waitcnt vmcnt(0)
    s_add_u32 s78, s78, 1
    s_cmp_gt_u32 s78, 20000
    s_cbranch_scc1 L_mk_bk_306
    v_xor_b32 v112, s21, v112
    v_xor_b32 v115, s21, v115
    v_or_b32 v5, v112, v115
    v_xor_b32 v116, s21, v116
    v_xor_b32 v119, s21, v119
    v_or3_b32 v5, v116, v119, v5
    v_and_b32 v5, 0x80008000, v5
    v_cmp_ne_u32 vcc, 0, v5
    s_nop 0
    s_cbranch_vccnz L_mk_rl_353
    s_branch L_mk_bk_306
L_mk_rt_307:
    s_mov_b32 s78, 0
L_mk_rl_354:
    s_sleep 2
    s_add_u32 s68, s71, 26624
    buffer_load_dwordx4 v[120:123], v2, s[16:19], s68 offen sc1
    s_add_u32 s68, s71, 27648
    buffer_load_dwordx4 v[124:127], v2, s[16:19], s68 offen sc1
    s_waitcnt vmcnt(0)
    s_add_u32 s78, s78, 1
    s_cmp_gt_u32 s78, 20000
    s_cbranch_scc1 L_mk_bk_308
    v_xor_b32 v120, s21, v120
    v_xor_b32 v123, s21, v123
    v_or_b32 v5, v120, v123
    v_xor_b32 v124, s21, v124
    v_xor_b32 v127, s21, v127
    v_or3_b32 v5, v124, v127, v5
    v_and_b32 v5, 0x80008000, v5
    v_cmp_ne_u32 vcc, 0, v5
    s_nop 0
    s_cbranch_vccnz L_mk_rl_354
    s_branch L_mk_bk_308
    s_endpgm
L_mk_codeend:
.section .rodata,"a"
.p2align 6
.amdhsa_kernel sequential_preLN__softmax_full_mha__dense_activation_squared_relu__prompt_kernel
  .amdhsa_next_free_vgpr 256
  .amdhsa_next_free_sgpr 96
  .amdhsa_accum_offset 256
  .amdhsa_group_segment_fixed_size 0
  .amdhsa_kernarg_size 88
  .amdhsa_user_sgpr_count 2
  .amdhsa_user_sgpr_kernarg_segment_ptr 1
  .amdhsa_system_sgpr_workgroup_id_x 1
.end_amdhsa_kernel
```
